```python
import torch

def _softmax(x, axis=-1):
    return torch.softmax(x, dim=axis)
def _gelu(x):
    return torch.nn.functional.gelu(x, approximate="tanh")
def _silu(x):
    return torch.nn.functional.silu(x)
def _sigmoid(x):
    return torch.sigmoid(x)
def _layernorm(x, axis=-1, eps=1e-5):
    m = x.mean(dim=axis, keepdim=True)
    v = x.var(dim=axis, keepdim=True, unbiased=False)
    return (x - m) / torch.sqrt(v + eps)
def _scatter_add(tgt, idx, src, axis=0):
    return tgt.clone().index_add_(axis, idx, src)
def _segment_sum(src, seg, n):
    out = torch.zeros((n,) + src.shape[1:], dtype=src.dtype)
    return out.index_add_(0, seg, src)
def _pad(x, pw):
    flat = tuple(v for pair in reversed(pw) for v in pair)
    return torch.nn.functional.pad(x, flat)

kernel_name = 'parallel_sum__mha_block__glu_gated_swiglu__prompt'

def setup_inputs():

    _w = (lambda a: (lambda t: t.to(torch.bfloat16) if t.is_floating_point() else t)(torch.as_tensor(a)))
    def _A_setup():
        B, S, D, H = 1, 2048, 512, 32
        return {
            "x": _w((lambda *s: torch.randn(*s, dtype=torch.bfloat16) * 0.05)(B, S, D)),
            "wqkv": _w((lambda *s: torch.randn(*s, dtype=torch.bfloat16) * 0.05)(D, 3 * D)),
            "wo": _w((lambda *s: torch.randn(*s, dtype=torch.bfloat16) * 0.05)(D, D)),
        }
    _A_in = _A_setup()

    def _B_setup():
        B, S, D, F = 1, 2048, 512, 1792
        return {
            "x": _w((lambda *s: torch.randn(*s, dtype=torch.bfloat16) * 0.05)(B, S, D)),
            "w1": _w((lambda *s: torch.randn(*s, dtype=torch.bfloat16) * 0.4)(D, F) * (2.0 / D) ** 0.5),
            "w3": _w((lambda *s: torch.randn(*s, dtype=torch.bfloat16) * 0.4)(D, F) * (2.0 / D) ** 0.5),
            "w2": _w((lambda *s: torch.randn(*s, dtype=torch.bfloat16) * 0.4)(F, D) * (2.0 / F) ** 0.5),
        }
    _B_in = _B_setup()

    return {
        "A_x": _A_in["x"],
        "A_wqkv": _A_in["wqkv"],
        "A_wo": _A_in["wo"],
        "B_x": _B_in["x"],
        "B_w1": _B_in["w1"],
        "B_w3": _B_in["w3"],
        "B_w2": _B_in["w2"],
    }

def reference(A_x, A_wqkv, A_wo, B_x, B_w1, B_w3, B_w2):
    def _A_ref(x, wqkv, wo):
        B, S, D = x.shape
        H = 32
        Dh = D // H
        qkv = (lambda x, *d: x.permute(*d))((x @ wqkv).reshape(B, S, 3, H, Dh), 2, 0, 3, 1, 4)
        q, k, v = qkv[0], qkv[1], qkv[2]
        scores = torch.einsum("bhqd,bhkd->bhqk", q, k) * (Dh ** -0.5)
        p = _softmax(scores, axis=-1)
        o = torch.einsum("bhqk,bhkd->bhqd", p, v)
        return (lambda x, *d: x.permute(*d))(o, 0, 2, 1, 3).reshape(B, S, D) @ wo

    def _B_ref(x, w1, w3, w2):
        gate = torch.einsum("bsd,df->bsf", x, w1)
        up = torch.einsum("bsd,df->bsf", x, w3)
        h = _silu(gate) * up
        out = torch.einsum("bsf,fd->bsd", h, w2)
        return out

    x = A_x
    xn = _layernorm(x, axis=-1)
    return x + _A_ref(xn, A_wqkv, A_wo) + _B_ref(xn, B_w1, B_w3, B_w2)
```

```asm
; @launch grid=(256,1,1) block=(256,1,1) lds=163840
.amdgcn_target "amdgcn-amd-amdhsa--gfx950"
.text
.globl parallel_sum__mha_block__glu_gated_swiglu__prompt_kernel
.p2align 8
.type parallel_sum__mha_block__glu_gated_swiglu__prompt_kernel,@function
parallel_sum__mha_block__glu_gated_swiglu__prompt_kernel:
  s_cmp_ge_u32 s2, 256
  s_cbranch_scc1 mk_end
  s_load_dwordx2 s[8:9], s[0:1], 0
  s_getpc_b64 s[58:59]
mk_pc:
  s_lshr_b32 s84, s2, 3
  s_lshl_b32 s84, s84, 12
  v_lshl_add_u32 v52, v0, 4, s84
  v_min_u32 v52, mk_last-mk_pc-8, v52
  global_load_dwordx2 a[250:251], v52, s[58:59]
  s_load_dwordx2 s[12:13], s[0:1], 8
  s_load_dwordx2 s[16:17], s[0:1], 32
  s_load_dwordx2 s[94:95], s[0:1], 40
  s_load_dwordx4 s[36:39], s[0:1], 64
  s_load_dwordx2 s[4:5], s[0:1], 16
  s_load_dwordx2 s[32:33], s[0:1], 48
  v_lshrrev_b32 v2, 6, v0
  v_and_b32 v1, 63, v0
  s_and_b32 s3, s2, 7
  v_readfirstlane_b32 s40, v2
  s_bfe_u32 s41, s2, 0x10002
  s_bfe_u32 s59, s2, 0x30003
  s_lshl3_add_u32 s41, s41, s59
  s_and_b32 s42, s2, 3
  s_lshr_b32 s59, s2, 6
  s_lshl2_add_u32 s42, s42, s59
  s_lshr_b32 s53, s2, 5
  s_lshl1_add_u32 s44, s42, s41
  s_and_b32 s44, s44, 7
  s_lshl_b32 s58, s44, 7
  s_movk_i32 s91, 1023
  v_lshrrev_b32 v52, 4, v1
  v_and_b32 v53, 15, v1
  v_xor_b32 v53, v53, v52
  v_lshlrev_b32 v53, 4, v53
  v_lshl_add_u32 v48, v52, 10, v53
  s_lshl_b32 s79, s40, 15
  s_lshl2_add_u32 s45, s41, s40
  s_lshl_b32 s96, s45, 15
  s_add_u32 s97, s96, 16384
  s_mov_b32 s10, 0x200000
  s_mov_b32 s11, 0x20000
  v_xor_b32 v49, 64, v48
  v_add_u32 v49, 3072, v49
  v_xor_b32 v50, 128, v48
  v_add_u32 v50, 6144, v50
  v_xor_b32 v51, 192, v48
  v_add_u32 v51, 9216, v51
  v_add_u32 v44, s58, v48
  v_add_u32 v45, s58, v49
  v_add_u32 v46, s58, v50
  v_add_u32 v47, s58, v51
  v_bfi_b32 v48, s91, v44, v48
  v_bfi_b32 v49, s91, v45, v49
  v_bfi_b32 v50, s91, v46, v50
  v_bfi_b32 v51, s91, v47, v51
  s_add_u32 m0, s79, 0
  s_nop 0
  s_waitcnt lgkmcnt(0)
  buffer_load_dwordx4 v48, s[8:11], s96 offen offset:0 lds
  buffer_load_dwordx4 v49, s[8:11], s96 offen offset:1024 lds
  buffer_load_dwordx4 v50, s[8:11], s96 offen offset:2048 lds
  buffer_load_dwordx4 v51, s[8:11], s96 offen offset:3072 lds
  s_add_u32 m0, s79, 4096
  s_nop 0
  buffer_load_dwordx4 v48, s[8:11], s97 offen offset:0 lds
  buffer_load_dwordx4 v49, s[8:11], s97 offen offset:1024 lds
  buffer_load_dwordx4 v50, s[8:11], s97 offen offset:2048 lds
  buffer_load_dwordx4 v51, s[8:11], s97 offen offset:3072 lds
  s_load_dwordx2 s[28:29], s[0:1], 56
  s_memrealtime s[86:87]
  s_sub_u32 s12, s12, 2048
  s_subb_u32 s13, s13, 0
  s_mov_b32 s14, 1574912
  s_mov_b32 s15, 0x20000
  s_mov_b32 s18, 1835008
  s_mov_b32 s19, 0x20000
  s_sub_u32 s20, s94, 2048
  s_subb_u32 s21, s95, 0
  s_mov_b32 s22, 1837056
  s_mov_b32 s23, 0x20000
  s_lshl_b32 s43, s40, 12
  s_movk_i32 s84, 3072
  s_movk_i32 s85, 3584
  v_lshrrev_b32 v52, 3, v1
  v_and_b32 v53, 7, v1
  v_lshlrev_b32 v53, 4, v53
  v_bfe_u32 v54, v1, 4, 1
  v_lshlrev_b32 v55, 6, v54
  v_xor_b32 v53, v53, v55
  v_mad_u32_u24 v11, v52, s84, v53
  v_mad_u32_u24 v13, v52, s85, v53
  v_add_u32 v12, 23552, v11
  v_add_u32 v14, 27648, v13
  v_xor_b32 v15, 32, v13
  v_xor_b32 v16, 32, v14
  v_and_b32 v52, 31, v1
  v_lshrrev_b32 v53, 5, v1
  v_and_b32 v55, 15, v1
  v_xor_b32 v55, v55, v53
  v_lshlrev_b32 v55, 4, v55
  v_lshl_add_u32 v55, v52, 8, v55
  v_add_u32 v56, s79, v55
  v_and_b32 v72, 3, v1
  v_lshlrev_b32 v72, 3, v72
  v_lshl_add_u32 v72, v54, 5, v72
  v_bfe_u32 v73, v1, 2, 2
  v_lshl_add_u32 v10, v73, 6, v72
  v_lshl_add_u32 v10, v53, 8, v10
  v_lshl_add_u32 v74, v53, 8, v10
  v_lshl_add_u32 v74, v54, 11, v74
  v_accvgpr_write_b32 a248, v74
  v_lshl_add_u32 v9, v73, 7, v72
  v_lshl_add_u32 v9, v53, 10, v9
  v_bfe_u32 v73, v1, 3, 1
  v_lshl_add_u32 v9, v73, 6, v9
  s_mul_i32 s59, s40, 57344
  s_lshl_b32 s58, s42, 6
  s_add_u32 s46, s58, 2048
  s_lshl_b32 s89, s40, 1
  s_lshl2_add_u32 s89, s44, s89
  s_lshl1_add_u32 s48, s58, s59
  s_add_u32 s85, s48, 1536
  s_mul_i32 s84, s40, 49152
  s_lshl2_add_u32 s84, s58, s84
  s_cmp_ge_u32 s42, 12
  s_cselect_b32 s47, s85, s84
  s_mov_b32 s56, 0x00003f80
  s_mov_b32 s57, 0x3f800000
  s_mov_b32 s65, 0x3f803f80
  v_xor_b32 v57, 32, v56
  v_xor_b32 v58, 64, v56
  v_xor_b32 v59, 96, v56
  v_xor_b32 v60, 128, v56
  v_xor_b32 v61, 160, v56
  v_xor_b32 v62, 192, v56
  v_xor_b32 v63, 224, v56
  v_mov_b32 v64, 0
  v_mov_b32 v65, 0
  v_mov_b32 v66, 0
  v_mov_b32 v67, 0
  v_mov_b32 v68, 0
  v_mov_b32 v69, 0
  v_mov_b32 v70, 0
  v_mov_b32 v71, 0
  s_waitcnt lgkmcnt(0)
  s_or_b32 s86, s86, 1
  v_mov_b32 v72, s86
  s_or_b32 s58, s2, s40
  s_cselect_b64 exec, 0, 1
  global_store_dword v64, v72, s[36:37] sc1
  s_mov_b64 exec, -1
  s_mov_b32 s60, 0x3eb8aa3b
  s_cmp_lt_u32 s42, 4
  s_cselect_b32 s60, s60, 1.0
  s_mov_b32 s24, s38
  s_mov_b32 s25, s39
  s_mov_b32 s26, 19922944
  s_mov_b32 s27, 0x20000
  s_bfe_u32 s84, s2, 0x20003
  s_lshl2_add_u32 s52, s3, s84
  s_mov_b32 s85, 18874368
  s_lshl_b32 s84, s42, 6
  s_add_u32 s84, s84, s45
  s_lshl_b32 s84, s84, 7
  s_add_u32 s54, s84, s85
  s_add_u32 s83, s54, 131072
  v_accvgpr_write_b32 a160, -1
  v_accvgpr_write_b32 a161, -1
  v_accvgpr_write_b32 a162, -1
  v_accvgpr_write_b32 a163, -1
  s_mov_b32 s6, 524288
  s_mov_b32 s7, 0x20000
  s_mov_b32 s34, 1835008
  s_mov_b32 s35, 0x20000
  s_mov_b32 s30, 0x200000
  s_mov_b32 s31, 0x20000
  v_lshlrev_b32 v7, 4, v1
  v_lshrrev_b32 v24, 2, v1
  v_and_b32 v25, 48, v7
  v_lshl_add_u32 v17, v24, 10, v25
  s_mul_i32 s84, s42, 7
  s_add_u32 s85, s40, 4
  s_min_u32 s85, s85, 6
  s_add_u32 s85, s85, s84
  s_add_u32 s84, s84, s40
  s_and_b32 s87, s40, 1
  s_lshl1_add_u32 s86, s42, s87
  s_lshl_b32 s87, s41, 6
  s_mul_i32 s88, s41, 147456
  s_add_u32 s88, s88, 6291456
  s_lshl_b32 s80, s84, 14
  s_add_u32 s80, s80, s87
  s_lshl_b32 s62, s84, 10
  s_add_u32 s62, s62, s88
  s_add_u32 s62, s62, 32768
  s_lshl_b32 s81, s85, 14
  s_add_u32 s81, s81, s87
  s_lshl_b32 s63, s85, 10
  s_add_u32 s63, s63, s88
  s_add_u32 s63, s63, 32768
  s_lshl_b32 s82, s86, 14
  s_add_u32 s82, s82, s87
  s_lshl_b32 s64, s86, 10
  s_add_u32 s64, s64, s88
  s_lshl_b32 s51, s42, 19
  s_lshl_b32 s84, s45, 10
  s_add_u32 s51, s51, s84
  s_mul_i32 s84, s45, 147456
  s_add_u32 s84, s84, 9469952
  s_lshl_b32 s85, s42, 11
  s_add_u32 s61, s84, s85
  s_add_u32 s67, s61, s85
  s_add_u32 s61, s61, 65536
  s_add_u32 s66, s67, 49152
  v_lshrrev_b32 v27, 5, v1
  v_and_b32 v24, 0xf0, v7
  v_lshl_add_u32 v24, v27, 8, v24
  v_bfe_u32 v25, v1, 4, 1
  v_lshl_add_u32 v8, v25, 16, v24
  v_add_u32 v26, 65536, v8
  v_accvgpr_write_b32 a244, v26
  v_xor_b32 v26, 1, v25
  v_lshlrev_b32 v26, 13, v26
  v_accvgpr_write_b32 a245, v26
  v_and_b32 v24, 31, v1
  v_lshlrev_b32 v26, 10, v24
  v_lshl_add_u32 v26, v27, 3, v26
  v_accvgpr_write_b32 a246, v26
  v_cmp_gt_u32 vcc, 32, v1
  v_and_b32 v24, 15, v1
  s_lshl_b32 s85, s52, 1
  v_add_u32 v26, s85, v25
  v_lshl_add_u32 v24, v24, 6, v26
  v_and_b32 v27, 3, v1
  v_bfe_u32 v26, v1, 2, 3
  v_lshl_add_u32 v26, v27, 6, v26
  s_lshl_b32 s84, s40, 8
  s_lshl3_add_u32 s84, s53, s84
  v_add_u32 v26, s84, v26
  v_cndmask_b32 v24, v26, v24, vcc
  s_mov_b32 s86, 18874368
  v_lshl_add_u32 v24, v24, 7, s86
  v_accvgpr_write_b32 a247, v24
  s_lshl2_add_u32 s84, s53, s40
  s_lshl_b32 s84, s84, 1
  v_and_b32 v26, 1, v1
  v_add_u32 v26, s84, v26
  v_bfe_u32 v24, v1, 2, 1
  v_lshlrev_b32 v24, 8, v24
  v_lshl_add_u32 v24, v27, 2, v24
  s_and_b32 s85, s40, 1
  s_lshl_b32 s85, s85, 9
  s_lshr_b32 s87, s52, 3
  s_lshl_b32 s87, s87, 6
  s_add_u32 s85, s85, s87
  s_lshr_b32 s87, s40, 1
  s_lshl_b32 s87, s87, 5
  s_add_u32 s85, s85, s87
  s_bfe_u32 s87, s52, 0x10002
  s_lshl4_add_u32 s85, s87, s85
  s_and_b32 s87, s52, 3
  s_add_u32 s85, s85, s87
  v_add_u32 v24, s85, v24
  v_lshl_add_u32 v24, v24, 7, s86
  v_accvgpr_write_b32 a252, v24
  v_bfe_u32 v24, v1, 2, 2
  v_lshl_add_u32 v24, v24, 4, v27
  s_lshl1_add_u32 s84, s53, s40
  s_lshl_b32 s84, s84, 2
  v_add_u32 v24, s84, v24
  v_and_b32 v24, 63, v24
  v_lshl_add_u32 v24, v25, 8, v24
  v_add_u32 v24, 256, v24
  v_cndmask_b32 v24, v26, v24, vcc
  s_lshr_b32 s85, s52, 3
  s_lshl_b32 s85, s85, 13
  s_add_u32 s85, s85, 19005440
  v_lshl_add_u32 v24, v24, 7, s85
  v_accvgpr_write_b32 a249, v24
  v_and_b32 v24, 11, v1
  v_cmp_eq_u32 vcc, 0, v24
  v_mov_b32 v26, 0x3f803f80
  s_mul_i32 s84, s40, 3072
  s_add_u32 s84, s84, 139264
  v_cndmask_b32 v26, 0, v26, vcc
  v_add_u32 v10, s84, v10
  v_accvgpr_write_b32 a240, v26
  v_accvgpr_write_b32 a241, v26
  v_accvgpr_write_b32 a242, v26
  v_accvgpr_write_b32 a243, v26
  s_lshl2_add_u32 s84, s53, s40
  s_lshl_b32 s85, s52, 16
  s_lshl_b32 s84, s84, 11
  s_add_u32 s70, s84, s85
  s_add_u32 s69, s85, 4194304
  s_add_u32 s68, s85, 2097152
  s_lshl_b32 s92, s53, 13
  s_add_u32 s92, s92, s43
  s_lshl_b32 s93, s53, 12
  s_lshr_b32 s84, s40, 1
  s_lshl1_add_u32 s85, s52, s84
  s_lshl_b32 s76, s85, 15
  s_mul_i32 s72, s85, 147456
  s_xor_b32 s85, s85, 1
  s_mul_i32 s73, s85, 147456
  s_and_b32 s84, s40, 1
  s_lshl1_add_u32 s85, s53, s84
  s_lshl_b32 s84, s85, 6
  s_add_u32 s76, s76, s84
  s_mul_i32 s74, s85, 147456
  s_xor_b32 s85, s85, 1
  s_mul_i32 s75, s85, 147456
  s_lshr_b32 s71, s76, 15
  s_lshl_b32 s71, s71, 10
  s_lshl_b32 s84, s40, 19
  s_add_u32 s71, s71, s84
  s_xor_b32 s55, s71, 1024
  s_mul_i32 s84, s40, 28672
  s_add_u32 s85, s84, 9469952
  s_add_u32 s72, s72, s85
  s_add_u32 s73, s73, s85
  s_add_u32 s85, s84, 6324224
  s_add_u32 s74, s74, s85
  s_add_u32 s75, s75, s85
  s_mov_b32 s90, 0xffff0000
  s_mov_b64 exec, 0
  s_lshr_b32 s58, s42, 2
  s_max_u32 s58, s58, 1
  s_lshl2_add_u32 s58, s58, s40
  s_cmp_eq_u32 s58, 4
  s_cbranch_scc1 mk_wA0
  s_cmp_eq_u32 s58, 5
  s_cbranch_scc1 mk_wA1
  s_cmp_eq_u32 s58, 6
  s_cbranch_scc1 mk_wA2
  s_cmp_eq_u32 s58, 7
  s_cbranch_scc1 mk_wA3
  s_cmp_eq_u32 s58, 8
  s_cbranch_scc1 mk_wB0
  s_cmp_eq_u32 s58, 9
  s_cbranch_scc1 mk_wB1
  s_cmp_eq_u32 s58, 10
  s_cbranch_scc1 mk_wB2
  s_cmp_eq_u32 s58, 11
  s_cbranch_scc1 mk_wB3
  s_cmp_eq_u32 s58, 12
  s_cbranch_scc1 mk_wC0
  s_cmp_eq_u32 s58, 13
  s_cbranch_scc1 mk_wC1
  s_cmp_eq_u32 s58, 14
  s_cbranch_scc1 mk_wC2
  s_cmp_eq_u32 s58, 15
  s_cbranch_scc1 mk_wC3
mk_wr1:
  s_mov_b64 exec, -1
  v_add_u32 v44, 256, v48
  v_add_u32 v45, 256, v49
  v_add_u32 v46, 256, v50
  v_add_u32 v47, 256, v51
  s_add_u32 m0, s79, 8192
  v_bfi_b32 v48, s91, v44, v48
  v_bfi_b32 v49, s91, v45, v49
  v_bfi_b32 v50, s91, v46, v50
  v_bfi_b32 v51, s91, v47, v51
  buffer_load_dwordx4 v48, s[8:11], s96 offen offset:0 lds
  buffer_load_dwordx4 v49, s[8:11], s96 offen offset:1024 lds
  buffer_load_dwordx4 v50, s[8:11], s96 offen offset:2048 lds
  buffer_load_dwordx4 v51, s[8:11], s96 offen offset:3072 lds
  s_add_u32 m0, s79, 12288
  s_nop 0
  buffer_load_dwordx4 v48, s[8:11], s97 offen offset:0 lds
  buffer_load_dwordx4 v49, s[8:11], s97 offen offset:1024 lds
  buffer_load_dwordx4 v50, s[8:11], s97 offen offset:2048 lds
  buffer_load_dwordx4 v51, s[8:11], s97 offen offset:3072 lds
  s_waitcnt vmcnt(9)
  ds_read_b128 v[128:131], v56 offset:0
  ds_read_b128 v[132:135], v57 offset:0
  ds_read_b128 v[136:139], v58 offset:0
  ds_read_b128 v[140:143], v59 offset:0
  ds_read_b128 v[144:147], v60 offset:0
  ds_read_b128 v[148:151], v61 offset:0
  ds_read_b128 v[152:155], v62 offset:0
  ds_read_b128 v[156:159], v63 offset:0
  v_add_u32 v44, 256, v48
  v_add_u32 v45, 256, v49
  v_add_u32 v46, 256, v50
  v_add_u32 v47, 256, v51
  s_add_u32 m0, s79, 16384
  v_bfi_b32 v48, s91, v44, v48
  v_bfi_b32 v49, s91, v45, v49
  v_bfi_b32 v50, s91, v46, v50
  v_bfi_b32 v51, s91, v47, v51
  buffer_load_dwordx4 v48, s[8:11], s96 offen offset:0 lds
  buffer_load_dwordx4 v49, s[8:11], s96 offen offset:1024 lds
  s_waitcnt lgkmcnt(0)
  v_dot2c_f32_bf16 v64, s65, v128
  v_dot2c_f32_bf16 v68, v128, v128
  v_dot2c_f32_bf16 v65, s65, v129
  v_dot2c_f32_bf16 v69, v129, v129
  v_dot2c_f32_bf16 v66, s65, v130
  v_dot2c_f32_bf16 v70, v130, v130
  v_dot2c_f32_bf16 v67, s65, v131
  v_dot2c_f32_bf16 v71, v131, v131
  v_dot2c_f32_bf16 v64, s65, v132
  v_dot2c_f32_bf16 v68, v132, v132
  v_dot2c_f32_bf16 v65, s65, v133
  v_dot2c_f32_bf16 v69, v133, v133
  v_dot2c_f32_bf16 v66, s65, v134
  v_dot2c_f32_bf16 v70, v134, v134
  v_dot2c_f32_bf16 v67, s65, v135
  v_dot2c_f32_bf16 v71, v135, v135
  buffer_load_dwordx4 v50, s[8:11], s96 offen offset:2048 lds
  buffer_load_dwordx4 v51, s[8:11], s96 offen offset:3072 lds
  v_dot2c_f32_bf16 v64, s65, v136
  v_dot2c_f32_bf16 v68, v136, v136
  v_dot2c_f32_bf16 v65, s65, v137
  v_dot2c_f32_bf16 v69, v137, v137
  v_dot2c_f32_bf16 v66, s65, v138
  v_dot2c_f32_bf16 v70, v138, v138
  v_dot2c_f32_bf16 v67, s65, v139
  v_dot2c_f32_bf16 v71, v139, v139
  v_dot2c_f32_bf16 v64, s65, v140
  v_dot2c_f32_bf16 v68, v140, v140
  v_dot2c_f32_bf16 v65, s65, v141
  v_dot2c_f32_bf16 v69, v141, v141
  v_dot2c_f32_bf16 v66, s65, v142
  v_dot2c_f32_bf16 v70, v142, v142
  v_dot2c_f32_bf16 v67, s65, v143
  v_dot2c_f32_bf16 v71, v143, v143
  s_add_u32 m0, s79, 20480
  s_nop 0
  buffer_load_dwordx4 v48, s[8:11], s97 offen offset:0 lds
  buffer_load_dwordx4 v49, s[8:11], s97 offen offset:1024 lds
  v_dot2c_f32_bf16 v64, s65, v144
  v_dot2c_f32_bf16 v68, v144, v144
  v_dot2c_f32_bf16 v65, s65, v145
  v_dot2c_f32_bf16 v69, v145, v145
  v_dot2c_f32_bf16 v66, s65, v146
  v_dot2c_f32_bf16 v70, v146, v146
  v_dot2c_f32_bf16 v67, s65, v147
  v_dot2c_f32_bf16 v71, v147, v147
  v_dot2c_f32_bf16 v64, s65, v148
  v_dot2c_f32_bf16 v68, v148, v148
  v_dot2c_f32_bf16 v65, s65, v149
  v_dot2c_f32_bf16 v69, v149, v149
  v_dot2c_f32_bf16 v66, s65, v150
  v_dot2c_f32_bf16 v70, v150, v150
  v_dot2c_f32_bf16 v67, s65, v151
  v_dot2c_f32_bf16 v71, v151, v151
  buffer_load_dwordx4 v50, s[8:11], s97 offen offset:2048 lds
  buffer_load_dwordx4 v51, s[8:11], s97 offen offset:3072 lds
  v_dot2c_f32_bf16 v64, s65, v152
  v_dot2c_f32_bf16 v68, v152, v152
  v_dot2c_f32_bf16 v65, s65, v153
  v_dot2c_f32_bf16 v69, v153, v153
  v_dot2c_f32_bf16 v66, s65, v154
  v_dot2c_f32_bf16 v70, v154, v154
  v_dot2c_f32_bf16 v67, s65, v155
  v_dot2c_f32_bf16 v71, v155, v155
  v_dot2c_f32_bf16 v64, s65, v156
  v_dot2c_f32_bf16 v68, v156, v156
  v_dot2c_f32_bf16 v65, s65, v157
  v_dot2c_f32_bf16 v69, v157, v157
  v_dot2c_f32_bf16 v66, s65, v158
  v_dot2c_f32_bf16 v70, v158, v158
  v_dot2c_f32_bf16 v67, s65, v159
  v_dot2c_f32_bf16 v71, v159, v159
  s_waitcnt vmcnt(8)
  ds_read_b128 v[160:163], v56 offset:8192
  ds_read_b128 v[164:167], v57 offset:8192
  ds_read_b128 v[168:171], v58 offset:8192
  ds_read_b128 v[172:175], v59 offset:8192
  ds_read_b128 v[176:179], v60 offset:8192
  ds_read_b128 v[180:183], v61 offset:8192
  ds_read_b128 v[184:187], v62 offset:8192
  ds_read_b128 v[188:191], v63 offset:8192
  v_add_u32 v44, 256, v48
  v_add_u32 v45, 256, v49
  v_add_u32 v46, 256, v50
  v_add_u32 v47, 256, v51
  s_add_u32 m0, s79, 24576
  v_bfi_b32 v48, s91, v44, v48
  v_bfi_b32 v49, s91, v45, v49
  v_bfi_b32 v50, s91, v46, v50
  v_bfi_b32 v51, s91, v47, v51
  buffer_load_dwordx4 v48, s[8:11], s96 offen offset:0 lds
  buffer_load_dwordx4 v49, s[8:11], s96 offen offset:1024 lds
  s_waitcnt lgkmcnt(0)
  v_dot2c_f32_bf16 v64, s65, v160
  v_dot2c_f32_bf16 v68, v160, v160
  v_dot2c_f32_bf16 v65, s65, v161
  v_dot2c_f32_bf16 v69, v161, v161
  v_dot2c_f32_bf16 v66, s65, v162
  v_dot2c_f32_bf16 v70, v162, v162
  v_dot2c_f32_bf16 v67, s65, v163
  v_dot2c_f32_bf16 v71, v163, v163
  v_dot2c_f32_bf16 v64, s65, v164
  v_dot2c_f32_bf16 v68, v164, v164
  v_dot2c_f32_bf16 v65, s65, v165
  v_dot2c_f32_bf16 v69, v165, v165
  v_dot2c_f32_bf16 v66, s65, v166
  v_dot2c_f32_bf16 v70, v166, v166
  v_dot2c_f32_bf16 v67, s65, v167
  v_dot2c_f32_bf16 v71, v167, v167
  buffer_load_dwordx4 v50, s[8:11], s96 offen offset:2048 lds
  buffer_load_dwordx4 v51, s[8:11], s96 offen offset:3072 lds
  v_dot2c_f32_bf16 v64, s65, v168
  v_dot2c_f32_bf16 v68, v168, v168
  v_dot2c_f32_bf16 v65, s65, v169
  v_dot2c_f32_bf16 v69, v169, v169
  v_dot2c_f32_bf16 v66, s65, v170
  v_dot2c_f32_bf16 v70, v170, v170
  v_dot2c_f32_bf16 v67, s65, v171
  v_dot2c_f32_bf16 v71, v171, v171
  v_dot2c_f32_bf16 v64, s65, v172
  v_dot2c_f32_bf16 v68, v172, v172
  v_dot2c_f32_bf16 v65, s65, v173
  v_dot2c_f32_bf16 v69, v173, v173
  v_dot2c_f32_bf16 v66, s65, v174
  v_dot2c_f32_bf16 v70, v174, v174
  v_dot2c_f32_bf16 v67, s65, v175
  v_dot2c_f32_bf16 v71, v175, v175
  s_add_u32 m0, s79, 28672
  s_nop 0
  buffer_load_dwordx4 v48, s[8:11], s97 offen offset:0 lds
  buffer_load_dwordx4 v49, s[8:11], s97 offen offset:1024 lds
  v_dot2c_f32_bf16 v64, s65, v176
  v_dot2c_f32_bf16 v68, v176, v176
  v_dot2c_f32_bf16 v65, s65, v177
  v_dot2c_f32_bf16 v69, v177, v177
  v_dot2c_f32_bf16 v66, s65, v178
  v_dot2c_f32_bf16 v70, v178, v178
  v_dot2c_f32_bf16 v67, s65, v179
  v_dot2c_f32_bf16 v71, v179, v179
  v_dot2c_f32_bf16 v64, s65, v180
  v_dot2c_f32_bf16 v68, v180, v180
  v_dot2c_f32_bf16 v65, s65, v181
  v_dot2c_f32_bf16 v69, v181, v181
  v_dot2c_f32_bf16 v66, s65, v182
  v_dot2c_f32_bf16 v70, v182, v182
  v_dot2c_f32_bf16 v67, s65, v183
  v_dot2c_f32_bf16 v71, v183, v183
  buffer_load_dwordx4 v50, s[8:11], s97 offen offset:2048 lds
  buffer_load_dwordx4 v51, s[8:11], s97 offen offset:3072 lds
  v_dot2c_f32_bf16 v64, s65, v184
  v_dot2c_f32_bf16 v68, v184, v184
  v_dot2c_f32_bf16 v65, s65, v185
  v_dot2c_f32_bf16 v69, v185, v185
  v_dot2c_f32_bf16 v66, s65, v186
  v_dot2c_f32_bf16 v70, v186, v186
  v_dot2c_f32_bf16 v67, s65, v187
  v_dot2c_f32_bf16 v71, v187, v187
  v_dot2c_f32_bf16 v64, s65, v188
  v_dot2c_f32_bf16 v68, v188, v188
  v_dot2c_f32_bf16 v65, s65, v189
  v_dot2c_f32_bf16 v69, v189, v189
  v_dot2c_f32_bf16 v66, s65, v190
  v_dot2c_f32_bf16 v70, v190, v190
  v_dot2c_f32_bf16 v67, s65, v191
  v_dot2c_f32_bf16 v71, v191, v191
  s_waitcnt vmcnt(8)
  ds_read_b128 v[192:195], v56 offset:16384
  ds_read_b128 v[196:199], v57 offset:16384
  ds_read_b128 v[200:203], v58 offset:16384
  ds_read_b128 v[204:207], v59 offset:16384
  ds_read_b128 v[208:211], v60 offset:16384
  ds_read_b128 v[212:215], v61 offset:16384
  ds_read_b128 v[216:219], v62 offset:16384
  ds_read_b128 v[220:223], v63 offset:16384
  s_cmp_ge_u32 s42, 12
  s_cbranch_scc1 mk_typeC
  s_cmp_ge_u32 s42, 8
  s_cbranch_scc1 mk_typeB
  s_branch mk_typeA
.p2align 12
mk_typeA:
mk_wA0:
  s_cbranch_execz mk_wJ0
  s_barrier
  s_add_u32 s49, s44, 0
  s_and_b32 s49, s49, 7
  s_mul_i32 s49, s49, 196608
  s_add_u32 s49, s49, s47
  s_add_u32 m0, s43, 131072
  s_add_u32 s50, s49, 128
  s_add_u32 s49, s49, 2048
  buffer_load_dwordx4 v11, s[12:15], s49 offen offset:0 lds
  buffer_load_dwordx4 v12, s[12:15], s49 offen offset:1024 lds
  s_waitcnt lgkmcnt(0)
  v_dot2c_f32_bf16 v64, s65, v192
  v_dot2c_f32_bf16 v68, v192, v192
  v_dot2c_f32_bf16 v65, s65, v193
  v_dot2c_f32_bf16 v69, v193, v193
  v_dot2c_f32_bf16 v66, s65, v194
  v_dot2c_f32_bf16 v70, v194, v194
  v_dot2c_f32_bf16 v67, s65, v195
  v_dot2c_f32_bf16 v71, v195, v195
  v_dot2c_f32_bf16 v64, s65, v196
  v_dot2c_f32_bf16 v68, v196, v196
  v_dot2c_f32_bf16 v65, s65, v197
  v_dot2c_f32_bf16 v69, v197, v197
  v_dot2c_f32_bf16 v66, s65, v198
  v_dot2c_f32_bf16 v70, v198, v198
  v_dot2c_f32_bf16 v67, s65, v199
  v_dot2c_f32_bf16 v71, v199, v199
  buffer_load_dwordx4 v11, s[12:15], s50 offen offset:2048 lds
  buffer_load_dwordx4 v12, s[12:15], s50 offen offset:3072 lds
  v_dot2c_f32_bf16 v64, s65, v200
  v_dot2c_f32_bf16 v68, v200, v200
  v_dot2c_f32_bf16 v65, s65, v201
  v_dot2c_f32_bf16 v69, v201, v201
  v_dot2c_f32_bf16 v66, s65, v202
  v_dot2c_f32_bf16 v70, v202, v202
  v_dot2c_f32_bf16 v67, s65, v203
  v_dot2c_f32_bf16 v71, v203, v203
  v_dot2c_f32_bf16 v64, s65, v204
  v_dot2c_f32_bf16 v68, v204, v204
  v_dot2c_f32_bf16 v65, s65, v205
  v_dot2c_f32_bf16 v69, v205, v205
  v_dot2c_f32_bf16 v66, s65, v206
  v_dot2c_f32_bf16 v70, v206, v206
  v_dot2c_f32_bf16 v67, s65, v207
  v_dot2c_f32_bf16 v71, v207, v207
  v_dot2c_f32_bf16 v64, s65, v208
  v_dot2c_f32_bf16 v68, v208, v208
  v_dot2c_f32_bf16 v65, s65, v209
  v_dot2c_f32_bf16 v69, v209, v209
  v_dot2c_f32_bf16 v66, s65, v210
  v_dot2c_f32_bf16 v70, v210, v210
  v_dot2c_f32_bf16 v67, s65, v211
  v_dot2c_f32_bf16 v71, v211, v211
  v_dot2c_f32_bf16 v64, s65, v212
  v_dot2c_f32_bf16 v68, v212, v212
  v_dot2c_f32_bf16 v65, s65, v213
  v_dot2c_f32_bf16 v69, v213, v213
  v_dot2c_f32_bf16 v66, s65, v214
  v_dot2c_f32_bf16 v70, v214, v214
  v_dot2c_f32_bf16 v67, s65, v215
  v_dot2c_f32_bf16 v71, v215, v215
  v_dot2c_f32_bf16 v64, s65, v216
  v_dot2c_f32_bf16 v68, v216, v216
  v_dot2c_f32_bf16 v65, s65, v217
  v_dot2c_f32_bf16 v69, v217, v217
  v_dot2c_f32_bf16 v66, s65, v218
  v_dot2c_f32_bf16 v70, v218, v218
  v_dot2c_f32_bf16 v67, s65, v219
  v_dot2c_f32_bf16 v71, v219, v219
  v_dot2c_f32_bf16 v64, s65, v220
  v_dot2c_f32_bf16 v68, v220, v220
  v_dot2c_f32_bf16 v65, s65, v221
  v_dot2c_f32_bf16 v69, v221, v221
  v_dot2c_f32_bf16 v66, s65, v222
  v_dot2c_f32_bf16 v70, v222, v222
  v_dot2c_f32_bf16 v67, s65, v223
  v_dot2c_f32_bf16 v71, v223, v223
  s_waitcnt vmcnt(4)
  ds_read_b128 v[224:227], v56 offset:24576
  ds_read_b128 v[228:231], v57 offset:24576
  ds_read_b128 v[232:235], v58 offset:24576
  ds_read_b128 v[236:239], v59 offset:24576
  ds_read_b128 v[240:243], v60 offset:24576
  ds_read_b128 v[244:247], v61 offset:24576
  ds_read_b128 v[248:251], v62 offset:24576
  ds_read_b128 v[252:255], v63 offset:24576
  s_waitcnt lgkmcnt(0)
  s_barrier
  v_dot2c_f32_bf16 v64, s65, v224
  v_dot2c_f32_bf16 v68, v224, v224
  v_dot2c_f32_bf16 v65, s65, v225
  v_dot2c_f32_bf16 v69, v225, v225
  v_dot2c_f32_bf16 v66, s65, v226
  v_dot2c_f32_bf16 v70, v226, v226
  v_dot2c_f32_bf16 v67, s65, v227
  v_dot2c_f32_bf16 v71, v227, v227
  v_dot2c_f32_bf16 v64, s65, v228
  v_dot2c_f32_bf16 v68, v228, v228
  v_dot2c_f32_bf16 v65, s65, v229
  v_dot2c_f32_bf16 v69, v229, v229
  v_dot2c_f32_bf16 v66, s65, v230
  v_dot2c_f32_bf16 v70, v230, v230
  v_dot2c_f32_bf16 v67, s65, v231
  v_dot2c_f32_bf16 v71, v231, v231
  v_dot2c_f32_bf16 v64, s65, v232
  v_dot2c_f32_bf16 v68, v232, v232
  v_dot2c_f32_bf16 v65, s65, v233
  v_dot2c_f32_bf16 v69, v233, v233
  v_dot2c_f32_bf16 v66, s65, v234
  v_dot2c_f32_bf16 v70, v234, v234
  v_dot2c_f32_bf16 v67, s65, v235
  v_dot2c_f32_bf16 v71, v235, v235
  v_dot2c_f32_bf16 v64, s65, v236
  v_dot2c_f32_bf16 v68, v236, v236
  v_dot2c_f32_bf16 v65, s65, v237
  v_dot2c_f32_bf16 v69, v237, v237
  v_dot2c_f32_bf16 v66, s65, v238
  v_dot2c_f32_bf16 v70, v238, v238
  v_dot2c_f32_bf16 v67, s65, v239
  v_dot2c_f32_bf16 v71, v239, v239
  v_dot2c_f32_bf16 v64, s65, v240
  v_dot2c_f32_bf16 v68, v240, v240
  v_dot2c_f32_bf16 v65, s65, v241
  v_dot2c_f32_bf16 v69, v241, v241
  v_dot2c_f32_bf16 v66, s65, v242
  v_dot2c_f32_bf16 v70, v242, v242
  v_dot2c_f32_bf16 v67, s65, v243
  v_dot2c_f32_bf16 v71, v243, v243
  v_dot2c_f32_bf16 v64, s65, v244
  v_dot2c_f32_bf16 v68, v244, v244
  v_dot2c_f32_bf16 v65, s65, v245
  v_dot2c_f32_bf16 v69, v245, v245
  v_dot2c_f32_bf16 v66, s65, v246
  v_dot2c_f32_bf16 v70, v246, v246
  v_dot2c_f32_bf16 v67, s65, v247
  v_dot2c_f32_bf16 v71, v247, v247
  v_dot2c_f32_bf16 v64, s65, v248
  v_dot2c_f32_bf16 v68, v248, v248
  v_dot2c_f32_bf16 v65, s65, v249
  v_dot2c_f32_bf16 v69, v249, v249
  v_dot2c_f32_bf16 v66, s65, v250
  v_dot2c_f32_bf16 v70, v250, v250
  v_dot2c_f32_bf16 v67, s65, v251
  v_dot2c_f32_bf16 v71, v251, v251
  v_dot2c_f32_bf16 v64, s65, v252
  v_dot2c_f32_bf16 v68, v252, v252
  v_dot2c_f32_bf16 v65, s65, v253
  v_dot2c_f32_bf16 v69, v253, v253
  v_dot2c_f32_bf16 v66, s65, v254
  v_dot2c_f32_bf16 v70, v254, v254
  v_dot2c_f32_bf16 v67, s65, v255
  v_dot2c_f32_bf16 v71, v255, v255
  s_nop 2
  v_add_f32 v64, v64, v65
  v_add_f32 v66, v66, v67
  v_add_f32 v68, v68, v69
  v_add_f32 v70, v70, v71
  v_add_f32 v64, v64, v66
  v_add_f32 v68, v68, v70
  v_mov_b32 v65, v64
  v_mov_b32 v69, v68
  s_nop 1
  v_permlane32_swap_b32 v64, v65
  v_permlane32_swap_b32 v68, v69
  v_add_f32 v64, v64, v65
  v_add_f32 v68, v68, v69
  v_mul_f32 v64, 0x3b000000, v64
  v_mul_f32 v68, 0x3b000000, v68
  v_fma_f32 v68, -v64, v64, v68
  v_max_f32 v68, 0, v68
  v_cvt_pk_bf16_f32 v22, v64, v68
  v_lshlrev_b32 v2, 16, v22
  v_xor_b32 v2, 0x80000000, v2
  v_dot2_f32_bf16 v32, v128, s56, v2
  v_dot2_f32_bf16 v33, v128, s57, v2
  v_dot2_f32_bf16 v34, v129, s56, v2
  v_dot2_f32_bf16 v35, v129, s57, v2
  v_dot2_f32_bf16 v36, v130, s56, v2
  v_dot2_f32_bf16 v37, v130, s57, v2
  v_dot2_f32_bf16 v38, v131, s56, v2
  v_dot2_f32_bf16 v39, v131, s57, v2
  v_dot2_f32_bf16 v40, v132, s56, v2
  v_dot2_f32_bf16 v41, v132, s57, v2
  v_cvt_pk_bf16_f32 v128, v32, v33
  v_dot2_f32_bf16 v42, v133, s56, v2
  v_dot2_f32_bf16 v43, v133, s57, v2
  v_cvt_pk_bf16_f32 v129, v34, v35
  v_dot2_f32_bf16 v44, v134, s56, v2
  v_dot2_f32_bf16 v45, v134, s57, v2
  v_cvt_pk_bf16_f32 v130, v36, v37
  v_dot2_f32_bf16 v46, v135, s56, v2
  v_dot2_f32_bf16 v47, v135, s57, v2
  v_cvt_pk_bf16_f32 v131, v38, v39
  v_dot2_f32_bf16 v32, v136, s56, v2
  v_dot2_f32_bf16 v33, v136, s57, v2
  v_cvt_pk_bf16_f32 v132, v40, v41
  s_add_u32 s49, s44, 1
  s_and_b32 s49, s49, 7
  s_mul_i32 s49, s49, 196608
  s_add_u32 s49, s49, s47
  s_add_u32 m0, s43, 147456
  s_add_u32 s50, s49, 128
  s_add_u32 s49, s49, 2048
  buffer_load_dwordx4 v11, s[12:15], s49 offen offset:0 lds
  buffer_load_dwordx4 v12, s[12:15], s49 offen offset:1024 lds
  buffer_load_dwordx4 v11, s[12:15], s50 offen offset:2048 lds
  buffer_load_dwordx4 v12, s[12:15], s50 offen offset:3072 lds
  v_dot2_f32_bf16 v34, v137, s56, v2
  v_dot2_f32_bf16 v35, v137, s57, v2
  v_cvt_pk_bf16_f32 v133, v42, v43
  v_dot2_f32_bf16 v36, v138, s56, v2
  v_dot2_f32_bf16 v37, v138, s57, v2
  v_cvt_pk_bf16_f32 v134, v44, v45
  v_dot2_f32_bf16 v38, v139, s56, v2
  v_dot2_f32_bf16 v39, v139, s57, v2
  v_cvt_pk_bf16_f32 v135, v46, v47
  v_dot2_f32_bf16 v40, v140, s56, v2
  v_dot2_f32_bf16 v41, v140, s57, v2
  v_cvt_pk_bf16_f32 v136, v32, v33
  v_dot2_f32_bf16 v42, v141, s56, v2
  v_dot2_f32_bf16 v43, v141, s57, v2
  v_cvt_pk_bf16_f32 v137, v34, v35
  v_dot2_f32_bf16 v44, v142, s56, v2
  v_dot2_f32_bf16 v45, v142, s57, v2
  v_cvt_pk_bf16_f32 v138, v36, v37
  v_dot2_f32_bf16 v46, v143, s56, v2
  v_dot2_f32_bf16 v47, v143, s57, v2
  v_cvt_pk_bf16_f32 v139, v38, v39
  v_dot2_f32_bf16 v32, v144, s56, v2
  v_dot2_f32_bf16 v33, v144, s57, v2
  v_cvt_pk_bf16_f32 v140, v40, v41
  v_dot2_f32_bf16 v34, v145, s56, v2
  v_dot2_f32_bf16 v35, v145, s57, v2
  v_cvt_pk_bf16_f32 v141, v42, v43
  v_dot2_f32_bf16 v36, v146, s56, v2
  v_dot2_f32_bf16 v37, v146, s57, v2
  v_cvt_pk_bf16_f32 v142, v44, v45
  v_dot2_f32_bf16 v38, v147, s56, v2
  v_dot2_f32_bf16 v39, v147, s57, v2
  v_cvt_pk_bf16_f32 v143, v46, v47
  v_dot2_f32_bf16 v40, v148, s56, v2
  v_dot2_f32_bf16 v41, v148, s57, v2
  v_cvt_pk_bf16_f32 v144, v32, v33
  v_dot2_f32_bf16 v42, v149, s56, v2
  v_dot2_f32_bf16 v43, v149, s57, v2
  v_cvt_pk_bf16_f32 v145, v34, v35
  v_dot2_f32_bf16 v44, v150, s56, v2
  v_dot2_f32_bf16 v45, v150, s57, v2
  v_cvt_pk_bf16_f32 v146, v36, v37
  v_dot2_f32_bf16 v46, v151, s56, v2
  v_dot2_f32_bf16 v47, v151, s57, v2
  v_cvt_pk_bf16_f32 v147, v38, v39
  v_dot2_f32_bf16 v32, v152, s56, v2
  v_dot2_f32_bf16 v33, v152, s57, v2
  v_cvt_pk_bf16_f32 v148, v40, v41
  v_dot2_f32_bf16 v34, v153, s56, v2
  v_dot2_f32_bf16 v35, v153, s57, v2
  v_cvt_pk_bf16_f32 v149, v42, v43
  v_dot2_f32_bf16 v36, v154, s56, v2
  v_dot2_f32_bf16 v37, v154, s57, v2
  v_cvt_pk_bf16_f32 v150, v44, v45
  v_dot2_f32_bf16 v38, v155, s56, v2
  v_dot2_f32_bf16 v39, v155, s57, v2
  v_cvt_pk_bf16_f32 v151, v46, v47
  v_dot2_f32_bf16 v40, v156, s56, v2
  v_dot2_f32_bf16 v41, v156, s57, v2
  v_cvt_pk_bf16_f32 v152, v32, v33
  v_dot2_f32_bf16 v42, v157, s56, v2
  v_dot2_f32_bf16 v43, v157, s57, v2
  v_cvt_pk_bf16_f32 v153, v34, v35
  v_dot2_f32_bf16 v44, v158, s56, v2
  v_dot2_f32_bf16 v45, v158, s57, v2
  v_cvt_pk_bf16_f32 v154, v36, v37
  v_dot2_f32_bf16 v46, v159, s56, v2
  v_dot2_f32_bf16 v47, v159, s57, v2
  v_cvt_pk_bf16_f32 v155, v38, v39
  v_dot2_f32_bf16 v32, v160, s56, v2
  v_dot2_f32_bf16 v33, v160, s57, v2
  v_cvt_pk_bf16_f32 v156, v40, v41
  s_add_u32 s49, s44, 2
  s_and_b32 s49, s49, 7
  s_mul_i32 s49, s49, 196608
  s_add_u32 s49, s49, s47
  s_add_u32 m0, s43, 0
  s_add_u32 s50, s49, 128
  s_add_u32 s49, s49, 2048
  buffer_load_dwordx4 v11, s[12:15], s49 offen offset:0 lds
  buffer_load_dwordx4 v12, s[12:15], s49 offen offset:1024 lds
  buffer_load_dwordx4 v11, s[12:15], s50 offen offset:2048 lds
  buffer_load_dwordx4 v12, s[12:15], s50 offen offset:3072 lds
  v_dot2_f32_bf16 v34, v161, s56, v2
  v_dot2_f32_bf16 v35, v161, s57, v2
  v_cvt_pk_bf16_f32 v157, v42, v43
  v_dot2_f32_bf16 v36, v162, s56, v2
  v_dot2_f32_bf16 v37, v162, s57, v2
  v_cvt_pk_bf16_f32 v158, v44, v45
  v_dot2_f32_bf16 v38, v163, s56, v2
  v_dot2_f32_bf16 v39, v163, s57, v2
  v_cvt_pk_bf16_f32 v159, v46, v47
  v_dot2_f32_bf16 v40, v164, s56, v2
  v_dot2_f32_bf16 v41, v164, s57, v2
  v_cvt_pk_bf16_f32 v160, v32, v33
  v_dot2_f32_bf16 v42, v165, s56, v2
  v_dot2_f32_bf16 v43, v165, s57, v2
  v_cvt_pk_bf16_f32 v161, v34, v35
  v_dot2_f32_bf16 v44, v166, s56, v2
  v_dot2_f32_bf16 v45, v166, s57, v2
  v_cvt_pk_bf16_f32 v162, v36, v37
  v_dot2_f32_bf16 v46, v167, s56, v2
  v_dot2_f32_bf16 v47, v167, s57, v2
  v_cvt_pk_bf16_f32 v163, v38, v39
  v_dot2_f32_bf16 v32, v168, s56, v2
  v_dot2_f32_bf16 v33, v168, s57, v2
  v_cvt_pk_bf16_f32 v164, v40, v41
  v_dot2_f32_bf16 v34, v169, s56, v2
  v_dot2_f32_bf16 v35, v169, s57, v2
  v_cvt_pk_bf16_f32 v165, v42, v43
  v_dot2_f32_bf16 v36, v170, s56, v2
  v_dot2_f32_bf16 v37, v170, s57, v2
  v_cvt_pk_bf16_f32 v166, v44, v45
  v_dot2_f32_bf16 v38, v171, s56, v2
  v_dot2_f32_bf16 v39, v171, s57, v2
  v_cvt_pk_bf16_f32 v167, v46, v47
  v_dot2_f32_bf16 v40, v172, s56, v2
  v_dot2_f32_bf16 v41, v172, s57, v2
  v_cvt_pk_bf16_f32 v168, v32, v33
  v_dot2_f32_bf16 v42, v173, s56, v2
  v_dot2_f32_bf16 v43, v173, s57, v2
  v_cvt_pk_bf16_f32 v169, v34, v35
  v_dot2_f32_bf16 v44, v174, s56, v2
  v_dot2_f32_bf16 v45, v174, s57, v2
  v_cvt_pk_bf16_f32 v170, v36, v37
  v_dot2_f32_bf16 v46, v175, s56, v2
  v_dot2_f32_bf16 v47, v175, s57, v2
  v_cvt_pk_bf16_f32 v171, v38, v39
  v_dot2_f32_bf16 v32, v176, s56, v2
  v_dot2_f32_bf16 v33, v176, s57, v2
  v_cvt_pk_bf16_f32 v172, v40, v41
  v_dot2_f32_bf16 v34, v177, s56, v2
  v_dot2_f32_bf16 v35, v177, s57, v2
  v_cvt_pk_bf16_f32 v173, v42, v43
  v_dot2_f32_bf16 v36, v178, s56, v2
  v_dot2_f32_bf16 v37, v178, s57, v2
  v_cvt_pk_bf16_f32 v174, v44, v45
  v_dot2_f32_bf16 v38, v179, s56, v2
  v_dot2_f32_bf16 v39, v179, s57, v2
  v_cvt_pk_bf16_f32 v175, v46, v47
  v_dot2_f32_bf16 v40, v180, s56, v2
  v_dot2_f32_bf16 v41, v180, s57, v2
  v_cvt_pk_bf16_f32 v176, v32, v33
  v_dot2_f32_bf16 v42, v181, s56, v2
  v_dot2_f32_bf16 v43, v181, s57, v2
  v_cvt_pk_bf16_f32 v177, v34, v35
  v_dot2_f32_bf16 v44, v182, s56, v2
  v_dot2_f32_bf16 v45, v182, s57, v2
  v_cvt_pk_bf16_f32 v178, v36, v37
  v_dot2_f32_bf16 v46, v183, s56, v2
  v_dot2_f32_bf16 v47, v183, s57, v2
  v_cvt_pk_bf16_f32 v179, v38, v39
  v_dot2_f32_bf16 v32, v184, s56, v2
  v_dot2_f32_bf16 v33, v184, s57, v2
  v_cvt_pk_bf16_f32 v180, v40, v41
  s_add_u32 s49, s44, 3
  s_and_b32 s49, s49, 7
  s_mul_i32 s49, s49, 196608
  s_add_u32 s49, s49, s47
  s_add_u32 m0, s43, 16384
  s_add_u32 s50, s49, 128
  s_add_u32 s49, s49, 2048
  buffer_load_dwordx4 v11, s[12:15], s49 offen offset:0 lds
  buffer_load_dwordx4 v12, s[12:15], s49 offen offset:1024 lds
  buffer_load_dwordx4 v11, s[12:15], s50 offen offset:2048 lds
  buffer_load_dwordx4 v12, s[12:15], s50 offen offset:3072 lds
  v_dot2_f32_bf16 v34, v185, s56, v2
  v_dot2_f32_bf16 v35, v185, s57, v2
  v_cvt_pk_bf16_f32 v181, v42, v43
  v_dot2_f32_bf16 v36, v186, s56, v2
  v_dot2_f32_bf16 v37, v186, s57, v2
  v_cvt_pk_bf16_f32 v182, v44, v45
  v_dot2_f32_bf16 v38, v187, s56, v2
  v_dot2_f32_bf16 v39, v187, s57, v2
  v_cvt_pk_bf16_f32 v183, v46, v47
  v_dot2_f32_bf16 v40, v188, s56, v2
  v_dot2_f32_bf16 v41, v188, s57, v2
  v_cvt_pk_bf16_f32 v184, v32, v33
  v_dot2_f32_bf16 v42, v189, s56, v2
  v_dot2_f32_bf16 v43, v189, s57, v2
  v_cvt_pk_bf16_f32 v185, v34, v35
  v_dot2_f32_bf16 v44, v190, s56, v2
  v_dot2_f32_bf16 v45, v190, s57, v2
  v_cvt_pk_bf16_f32 v186, v36, v37
  v_dot2_f32_bf16 v46, v191, s56, v2
  v_dot2_f32_bf16 v47, v191, s57, v2
  v_cvt_pk_bf16_f32 v187, v38, v39
  v_cvt_pk_bf16_f32 v188, v40, v41
  v_cvt_pk_bf16_f32 v189, v42, v43
  v_cvt_pk_bf16_f32 v190, v44, v45
  v_cvt_pk_bf16_f32 v191, v46, v47
  v_and_b32 v22, 0xffff0000, v22
  v_add_f32 v22, 0x3727c5ac, v22
  v_cvt_pk_bf16_f32 v22, v22, v22
  v_and_b32 v22, 0xffff0000, v22
  v_sqrt_f32 v22, v22
  s_nop 0
  v_cvt_pk_bf16_f32 v22, v22, v22
  v_and_b32 v22, 0xffff0000, v22
  v_rcp_f32 v5, v22
  v_mul_f32 v6, v22, v22
  v_mul_f32 v3, s60, v5
  v_mul_f32 v4, 0xbfb8aa3b, v5
  s_waitcnt vmcnt(12)
  s_barrier
  v_add_u32 v18, 122880, v9
  v_xor_b32 v19, 64, v18
  ds_read_b64_tr_b16 a[64:65], v18 offset:8192
  ds_read_b64_tr_b16 a[66:67], v18 offset:8704
  ds_read_b64_tr_b16 a[68:69], v19 offset:8192
  ds_read_b64_tr_b16 a[70:71], v19 offset:8704
  ds_read_b64_tr_b16 a[72:73], v18 offset:10240
  ds_read_b64_tr_b16 a[74:75], v18 offset:10752
  ds_read_b64_tr_b16 a[76:77], v19 offset:10240
  ds_read_b64_tr_b16 a[78:79], v19 offset:10752
  ds_read_b64_tr_b16 a[80:81], v18 offset:12288
  ds_read_b64_tr_b16 a[82:83], v18 offset:12800
  ds_read_b64_tr_b16 a[84:85], v19 offset:12288
  ds_read_b64_tr_b16 a[86:87], v19 offset:12800
  s_waitcnt lgkmcnt(10)
  v_mfma_f32_32x32x16_bf16 v[64:79], a[64:67], v[128:131], 0
  s_waitcnt lgkmcnt(8)
  ds_read_b64_tr_b16 a[88:89], v18 offset:14336
  ds_read_b64_tr_b16 a[90:91], v18 offset:14848
  v_lshlrev_b32 v32, 16, v192
  s_add_u32 s49, s44, 4
  s_and_b32 s49, s49, 7
  s_mul_i32 s49, s49, 196608
  v_mfma_f32_32x32x16_bf16 v[80:95], a[68:71], v[128:131], 0
  s_waitcnt lgkmcnt(8)
  ds_read_b64_tr_b16 a[92:93], v19 offset:14336
  ds_read_b64_tr_b16 a[94:95], v19 offset:14848
  s_add_u32 s49, s49, s47
  s_add_u32 m0, s43, 32768
  s_add_u32 s50, s49, 128
  s_add_u32 s49, s49, 2048
  v_mfma_f32_32x32x16_bf16 v[96:111], a[72:75], v[128:131], 0
  s_waitcnt lgkmcnt(8)
  ds_read_b64_tr_b16 a[64:65], v18 offset:16384
  ds_read_b64_tr_b16 a[66:67], v18 offset:16896
  buffer_load_dwordx4 v11, s[12:15], s49 offen offset:0 lds
  v_and_b32 v33, s90, v192
  v_lshlrev_b32 v34, 16, v193
  v_mfma_f32_32x32x16_bf16 v[112:127], a[76:79], v[128:131], 0
  s_waitcnt lgkmcnt(8)
  ds_read_b64_tr_b16 a[68:69], v19 offset:16384
  ds_read_b64_tr_b16 a[70:71], v19 offset:16896
  buffer_load_dwordx4 v12, s[12:15], s49 offen offset:1024 lds
  v_and_b32 v35, s90, v193
  v_add_f32 v32, v32, v2
  v_mfma_f32_32x32x16_bf16 v[64:79], a[80:83], v[132:135], v[64:79]
  s_waitcnt lgkmcnt(8)
  ds_read_b64_tr_b16 a[72:73], v18 offset:18432
  ds_read_b64_tr_b16 a[74:75], v18 offset:18944
  v_add_f32 v33, v33, v2
  v_add_f32 v34, v34, v2
  v_add_f32 v35, v35, v2
  v_cvt_pk_bf16_f32 v192, v32, v33
  v_mfma_f32_32x32x16_bf16 v[80:95], a[84:87], v[132:135], v[80:95]
  s_waitcnt lgkmcnt(8)
  ds_read_b64_tr_b16 a[76:77], v19 offset:18432
  ds_read_b64_tr_b16 a[78:79], v19 offset:18944
  v_cvt_pk_bf16_f32 v193, v34, v35
  v_lshlrev_b32 v36, 16, v194
  v_and_b32 v37, s90, v194
  v_lshlrev_b32 v38, 16, v195
  v_mfma_f32_32x32x16_bf16 v[96:111], a[88:91], v[132:135], v[96:111]
  s_waitcnt lgkmcnt(8)
  ds_read_b64_tr_b16 a[80:81], v18 offset:20480
  ds_read_b64_tr_b16 a[82:83], v18 offset:20992
  buffer_load_dwordx4 v11, s[12:15], s50 offen offset:2048 lds
  v_and_b32 v39, s90, v195
  v_add_f32 v36, v36, v2
  v_mfma_f32_32x32x16_bf16 v[112:127], a[92:95], v[132:135], v[112:127]
  s_waitcnt lgkmcnt(8)
  ds_read_b64_tr_b16 a[84:85], v19 offset:20480
  ds_read_b64_tr_b16 a[86:87], v19 offset:20992
  buffer_load_dwordx4 v12, s[12:15], s50 offen offset:3072 lds
  v_add_f32 v37, v37, v2
  v_add_f32 v38, v38, v2
  v_mfma_f32_32x32x16_bf16 v[64:79], a[64:67], v[136:139], v[64:79]
  s_waitcnt lgkmcnt(8)
  ds_read_b64_tr_b16 a[88:89], v18 offset:22528
  ds_read_b64_tr_b16 a[90:91], v18 offset:23040
  v_add_f32 v39, v39, v2
  s_add_u32 s49, s44, 5
  s_and_b32 s49, s49, 7
  s_mul_i32 s49, s49, 196608
  v_mfma_f32_32x32x16_bf16 v[80:95], a[68:71], v[136:139], v[80:95]
  s_waitcnt lgkmcnt(8)
  ds_read_b64_tr_b16 a[92:93], v19 offset:22528
  ds_read_b64_tr_b16 a[94:95], v19 offset:23040
  s_add_u32 s49, s49, s47
  s_add_u32 m0, s43, 49152
  s_add_u32 s50, s49, 128
  s_add_u32 s49, s49, 2048
  v_mfma_f32_32x32x16_bf16 v[96:111], a[72:75], v[136:139], v[96:111]
  s_waitcnt vmcnt(12) lgkmcnt(8)
  s_barrier
  ds_read_b64_tr_b16 a[64:65], v18 offset:24576
  ds_read_b64_tr_b16 a[66:67], v18 offset:25088
  buffer_load_dwordx4 v11, s[12:15], s49 offen offset:0 lds
  v_mfma_f32_32x32x16_bf16 v[112:127], a[76:79], v[136:139], v[112:127]
  s_waitcnt lgkmcnt(8)
  ds_read_b64_tr_b16 a[68:69], v19 offset:24576
  ds_read_b64_tr_b16 a[70:71], v19 offset:25088
  buffer_load_dwordx4 v12, s[12:15], s49 offen offset:1024 lds
  v_cvt_pk_bf16_f32 v194, v36, v37
  v_cvt_pk_bf16_f32 v195, v38, v39
  v_mfma_f32_32x32x16_bf16 v[64:79], a[80:83], v[140:143], v[64:79]
  s_waitcnt lgkmcnt(8)
  ds_read_b64_tr_b16 a[72:73], v18 offset:26624
  ds_read_b64_tr_b16 a[74:75], v18 offset:27136
  v_lshlrev_b32 v40, 16, v196
  v_and_b32 v41, s90, v196
  v_lshlrev_b32 v42, 16, v197
  v_and_b32 v43, s90, v197
  v_mfma_f32_32x32x16_bf16 v[80:95], a[84:87], v[140:143], v[80:95]
  s_waitcnt lgkmcnt(8)
  ds_read_b64_tr_b16 a[76:77], v19 offset:26624
  ds_read_b64_tr_b16 a[78:79], v19 offset:27136
  v_add_f32 v40, v40, v2
  v_add_f32 v41, v41, v2
  v_add_f32 v42, v42, v2
  v_add_f32 v43, v43, v2
  v_mfma_f32_32x32x16_bf16 v[96:111], a[88:91], v[140:143], v[96:111]
  s_waitcnt lgkmcnt(8)
  ds_read_b64_tr_b16 a[80:81], v18 offset:28672
  ds_read_b64_tr_b16 a[82:83], v18 offset:29184
  buffer_load_dwordx4 v11, s[12:15], s50 offen offset:2048 lds
  v_cvt_pk_bf16_f32 v196, v40, v41
  v_cvt_pk_bf16_f32 v197, v42, v43
  v_mfma_f32_32x32x16_bf16 v[112:127], a[92:95], v[140:143], v[112:127]
  s_waitcnt lgkmcnt(8)
  ds_read_b64_tr_b16 a[84:85], v19 offset:28672
  ds_read_b64_tr_b16 a[86:87], v19 offset:29184
  buffer_load_dwordx4 v12, s[12:15], s50 offen offset:3072 lds
  v_lshlrev_b32 v44, 16, v198
  v_and_b32 v45, s90, v198
  v_mfma_f32_32x32x16_bf16 v[64:79], a[64:67], v[144:147], v[64:79]
  s_waitcnt lgkmcnt(8)
  ds_read_b64_tr_b16 a[88:89], v18 offset:30720
  ds_read_b64_tr_b16 a[90:91], v18 offset:31232
  v_lshlrev_b32 v46, 16, v199
  s_add_u32 s49, s44, 6
  s_and_b32 s49, s49, 7
  s_mul_i32 s49, s49, 196608
  v_mfma_f32_32x32x16_bf16 v[80:95], a[68:71], v[144:147], v[80:95]
  s_waitcnt lgkmcnt(8)
  ds_read_b64_tr_b16 a[92:93], v19 offset:30720
  ds_read_b64_tr_b16 a[94:95], v19 offset:31232
  s_add_u32 s49, s49, s47
  s_add_u32 m0, s43, 65536
  s_add_u32 s50, s49, 128
  s_add_u32 s49, s49, 2048
  v_mfma_f32_32x32x16_bf16 v[96:111], a[72:75], v[144:147], v[96:111]
  s_waitcnt lgkmcnt(8)
  ds_read_b64_tr_b16 a[64:65], v18 offset:32768
  ds_read_b64_tr_b16 a[66:67], v18 offset:33280
  buffer_load_dwordx4 v11, s[12:15], s49 offen offset:0 lds
  v_and_b32 v47, s90, v199
  v_add_f32 v44, v44, v2
  v_mfma_f32_32x32x16_bf16 v[112:127], a[76:79], v[144:147], v[112:127]
  s_waitcnt lgkmcnt(8)
  ds_read_b64_tr_b16 a[68:69], v19 offset:32768
  ds_read_b64_tr_b16 a[70:71], v19 offset:33280
  buffer_load_dwordx4 v12, s[12:15], s49 offen offset:1024 lds
  v_add_f32 v45, v45, v2
  v_add_f32 v46, v46, v2
  v_mfma_f32_32x32x16_bf16 v[64:79], a[80:83], v[148:151], v[64:79]
  s_waitcnt lgkmcnt(8)
  ds_read_b64_tr_b16 a[72:73], v18 offset:34816
  ds_read_b64_tr_b16 a[74:75], v18 offset:35328
  v_add_f32 v47, v47, v2
  v_cvt_pk_bf16_f32 v198, v44, v45
  v_cvt_pk_bf16_f32 v199, v46, v47
  v_lshlrev_b32 v32, 16, v200
  v_mfma_f32_32x32x16_bf16 v[80:95], a[84:87], v[148:151], v[80:95]
  s_waitcnt lgkmcnt(8)
  ds_read_b64_tr_b16 a[76:77], v19 offset:34816
  ds_read_b64_tr_b16 a[78:79], v19 offset:35328
  v_and_b32 v33, s90, v200
  v_lshlrev_b32 v34, 16, v201
  v_and_b32 v35, s90, v201
  v_add_f32 v32, v32, v2
  v_mfma_f32_32x32x16_bf16 v[96:111], a[88:91], v[148:151], v[96:111]
  s_waitcnt lgkmcnt(8)
  ds_read_b64_tr_b16 a[80:81], v18 offset:36864
  ds_read_b64_tr_b16 a[82:83], v18 offset:37376
  buffer_load_dwordx4 v11, s[12:15], s50 offen offset:2048 lds
  v_add_f32 v33, v33, v2
  v_add_f32 v34, v34, v2
  v_mfma_f32_32x32x16_bf16 v[112:127], a[92:95], v[148:151], v[112:127]
  s_waitcnt lgkmcnt(8)
  ds_read_b64_tr_b16 a[84:85], v19 offset:36864
  ds_read_b64_tr_b16 a[86:87], v19 offset:37376
  buffer_load_dwordx4 v12, s[12:15], s50 offen offset:3072 lds
  v_add_f32 v35, v35, v2
  v_cvt_pk_bf16_f32 v200, v32, v33
  v_mfma_f32_32x32x16_bf16 v[64:79], a[64:67], v[152:155], v[64:79]
  s_waitcnt lgkmcnt(8)
  ds_read_b64_tr_b16 a[88:89], v18 offset:38912
  ds_read_b64_tr_b16 a[90:91], v18 offset:39424
  v_cvt_pk_bf16_f32 v201, v34, v35
  s_add_u32 s49, s44, 7
  s_and_b32 s49, s49, 7
  s_mul_i32 s49, s49, 196608
  v_mfma_f32_32x32x16_bf16 v[80:95], a[68:71], v[152:155], v[80:95]
  s_waitcnt lgkmcnt(8)
  ds_read_b64_tr_b16 a[92:93], v19 offset:38912
  ds_read_b64_tr_b16 a[94:95], v19 offset:39424
  s_add_u32 s49, s49, s47
  s_add_u32 m0, s43, 81920
  s_add_u32 s50, s49, 128
  s_add_u32 s49, s49, 2048
  v_subrev_u32 v18, 122880, v18
  v_subrev_u32 v19, 122880, v19
  v_mfma_f32_32x32x16_bf16 v[96:111], a[72:75], v[152:155], v[96:111]
  s_waitcnt vmcnt(16) lgkmcnt(8)
  s_barrier
  ds_read_b64_tr_b16 a[64:65], v18 offset:0
  ds_read_b64_tr_b16 a[66:67], v18 offset:512
  buffer_load_dwordx4 v11, s[12:15], s49 offen offset:0 lds
  v_mfma_f32_32x32x16_bf16 v[112:127], a[76:79], v[152:155], v[112:127]
  s_waitcnt lgkmcnt(8)
  ds_read_b64_tr_b16 a[68:69], v19 offset:0
  ds_read_b64_tr_b16 a[70:71], v19 offset:512
  buffer_load_dwordx4 v12, s[12:15], s49 offen offset:1024 lds
  v_lshlrev_b32 v36, 16, v202
  v_and_b32 v37, s90, v202
  v_mfma_f32_32x32x16_bf16 v[64:79], a[80:83], v[156:159], v[64:79]
  s_waitcnt lgkmcnt(8)
  ds_read_b64_tr_b16 a[72:73], v18 offset:2048
mk_wA1:
  s_cbranch_execz mk_wJ1
  ds_read_b64_tr_b16 a[74:75], v18 offset:2560
  v_lshlrev_b32 v38, 16, v203
  v_and_b32 v39, s90, v203
  v_add_f32 v36, v36, v2
  v_add_f32 v37, v37, v2
  v_mfma_f32_32x32x16_bf16 v[80:95], a[84:87], v[156:159], v[80:95]
  s_waitcnt lgkmcnt(8)
  ds_read_b64_tr_b16 a[76:77], v19 offset:2048
  ds_read_b64_tr_b16 a[78:79], v19 offset:2560
  v_add_f32 v38, v38, v2
  v_add_f32 v39, v39, v2
  v_cvt_pk_bf16_f32 v202, v36, v37
  v_cvt_pk_bf16_f32 v203, v38, v39
  v_mfma_f32_32x32x16_bf16 v[96:111], a[88:91], v[156:159], v[96:111]
  s_waitcnt lgkmcnt(8)
  ds_read_b64_tr_b16 a[80:81], v18 offset:4096
  ds_read_b64_tr_b16 a[82:83], v18 offset:4608
  buffer_load_dwordx4 v11, s[12:15], s50 offen offset:2048 lds
  v_lshlrev_b32 v40, 16, v204
  v_and_b32 v41, s90, v204
  v_mfma_f32_32x32x16_bf16 v[112:127], a[92:95], v[156:159], v[112:127]
  s_waitcnt lgkmcnt(8)
  ds_read_b64_tr_b16 a[84:85], v19 offset:4096
  ds_read_b64_tr_b16 a[86:87], v19 offset:4608
  buffer_load_dwordx4 v12, s[12:15], s50 offen offset:3072 lds
  v_lshrrev_b32 v11, 2, v1
  v_mul_u32_u24 v11, 3584, v11
  v_and_or_b32 v11, v7, 48, v11
  v_xor_b32 v12, 32, v11
  v_mfma_f32_32x32x16_bf16 v[64:79], a[64:67], v[160:163], v[64:79]
  s_waitcnt lgkmcnt(8)
  ds_read_b64_tr_b16 a[88:89], v18 offset:6144
  ds_read_b64_tr_b16 a[90:91], v18 offset:6656
  v_lshlrev_b32 v42, 16, v205
  s_add_u32 s49, s89, 0
  s_and_b32 s49, s49, 31
  s_mul_i32 s49, s49, 57344
  v_mfma_f32_32x32x16_bf16 v[80:95], a[68:71], v[160:163], v[80:95]
  s_waitcnt lgkmcnt(8)
  ds_read_b64_tr_b16 a[92:93], v19 offset:6144
  ds_read_b64_tr_b16 a[94:95], v19 offset:6656
  v_and_b32 v43, s90, v205
  s_add_u32 s49, s49, s46
  s_add_u32 m0, s43, 98304
  s_add_u32 s50, s49, 56320
  v_mfma_f32_32x32x16_bf16 v[96:111], a[72:75], v[160:163], v[96:111]
  s_waitcnt lgkmcnt(8)
  ds_read_b64_tr_b16 a[64:65], v18 offset:8192
  ds_read_b64_tr_b16 a[66:67], v18 offset:8704
  buffer_load_dwordx4 v11, s[16:19], s49 offen offset:0 lds
  v_add_f32 v40, v40, v2
  v_add_f32 v41, v41, v2
  v_mfma_f32_32x32x16_bf16 v[112:127], a[76:79], v[160:163], v[112:127]
  s_waitcnt lgkmcnt(8)
  ds_read_b64_tr_b16 a[68:69], v19 offset:8192
  ds_read_b64_tr_b16 a[70:71], v19 offset:8704
  buffer_load_dwordx4 v11, s[16:19], s50 offen offset:1024 lds
  v_add_f32 v42, v42, v2
  v_add_f32 v43, v43, v2
  v_mfma_f32_32x32x16_bf16 v[64:79], a[80:83], v[164:167], v[64:79]
  s_waitcnt lgkmcnt(8)
  ds_read_b64_tr_b16 a[72:73], v18 offset:10240
  ds_read_b64_tr_b16 a[74:75], v18 offset:10752
  v_cvt_pk_bf16_f32 v204, v40, v41
  v_cvt_pk_bf16_f32 v205, v42, v43
  v_lshlrev_b32 v44, 16, v206
  v_and_b32 v45, s90, v206
  v_mfma_f32_32x32x16_bf16 v[80:95], a[84:87], v[164:167], v[80:95]
  s_waitcnt lgkmcnt(8)
  ds_read_b64_tr_b16 a[76:77], v19 offset:10240
  ds_read_b64_tr_b16 a[78:79], v19 offset:10752
  v_lshlrev_b32 v46, 16, v207
  v_and_b32 v47, s90, v207
  v_add_f32 v44, v44, v2
  v_add_f32 v45, v45, v2
  v_mfma_f32_32x32x16_bf16 v[96:111], a[88:91], v[164:167], v[96:111]
  s_waitcnt lgkmcnt(8)
  ds_read_b64_tr_b16 a[80:81], v18 offset:12288
  ds_read_b64_tr_b16 a[82:83], v18 offset:12800
  buffer_load_dwordx4 v12, s[20:23], s49 offen offset:2048 lds
  v_add_f32 v46, v46, v2
  v_add_f32 v47, v47, v2
  v_mfma_f32_32x32x16_bf16 v[112:127], a[92:95], v[164:167], v[112:127]
  s_waitcnt lgkmcnt(8)
  ds_read_b64_tr_b16 a[84:85], v19 offset:12288
  ds_read_b64_tr_b16 a[86:87], v19 offset:12800
  buffer_load_dwordx4 v12, s[20:23], s50 offen offset:3072 lds
  v_cvt_pk_bf16_f32 v206, v44, v45
  v_cvt_pk_bf16_f32 v207, v46, v47
  v_mfma_f32_32x32x16_bf16 v[64:79], a[64:67], v[168:171], v[64:79]
  s_waitcnt lgkmcnt(8)
  ds_read_b64_tr_b16 a[88:89], v18 offset:14336
  ds_read_b64_tr_b16 a[90:91], v18 offset:14848
  v_lshlrev_b32 v32, 16, v208
  s_add_u32 s49, s44, 0
  s_and_b32 s49, s49, 7
  s_mul_i32 s49, s49, 229376
  v_mfma_f32_32x32x16_bf16 v[80:95], a[68:71], v[168:171], v[80:95]
  s_waitcnt lgkmcnt(8)
  ds_read_b64_tr_b16 a[92:93], v19 offset:14336
  ds_read_b64_tr_b16 a[94:95], v19 offset:14848
  v_and_b32 v33, s90, v208
  v_lshlrev_b32 v34, 16, v209
  s_add_u32 m0, s43, 131072
  s_add_u32 s49, s49, s48
  v_mfma_f32_32x32x16_bf16 v[96:111], a[72:75], v[168:171], v[96:111]
  s_waitcnt vmcnt(20) lgkmcnt(8)
  s_barrier
  ds_read_b64_tr_b16 a[64:65], v18 offset:16384
  ds_read_b64_tr_b16 a[66:67], v18 offset:16896
  buffer_load_dwordx4 v13, s[16:19], s49 offen offset:0 lds
  v_mfma_f32_32x32x16_bf16 v[112:127], a[76:79], v[168:171], v[112:127]
  s_waitcnt lgkmcnt(8)
  ds_read_b64_tr_b16 a[68:69], v19 offset:16384
  ds_read_b64_tr_b16 a[70:71], v19 offset:16896
  buffer_load_dwordx4 v14, s[16:19], s49 offen offset:1024 lds
  v_and_b32 v35, s90, v209
  v_add_f32 v32, v32, v2
  v_mfma_f32_32x32x16_bf16 v[64:79], a[80:83], v[172:175], v[64:79]
  s_waitcnt lgkmcnt(8)
  ds_read_b64_tr_b16 a[72:73], v18 offset:18432
  ds_read_b64_tr_b16 a[74:75], v18 offset:18944
  v_add_f32 v33, v33, v2
  v_add_f32 v34, v34, v2
  v_add_f32 v35, v35, v2
  v_cvt_pk_bf16_f32 v208, v32, v33
  v_mfma_f32_32x32x16_bf16 v[80:95], a[84:87], v[172:175], v[80:95]
  s_waitcnt lgkmcnt(8)
  ds_read_b64_tr_b16 a[76:77], v19 offset:18432
  ds_read_b64_tr_b16 a[78:79], v19 offset:18944
  v_cvt_pk_bf16_f32 v209, v34, v35
  v_lshlrev_b32 v36, 16, v210
  v_and_b32 v37, s90, v210
  v_lshlrev_b32 v38, 16, v211
  v_mfma_f32_32x32x16_bf16 v[96:111], a[88:91], v[172:175], v[96:111]
  s_waitcnt lgkmcnt(8)
  ds_read_b64_tr_b16 a[80:81], v18 offset:20480
  ds_read_b64_tr_b16 a[82:83], v18 offset:20992
  buffer_load_dwordx4 v15, s[20:23], s49 offen offset:2048 lds
  v_and_b32 v39, s90, v211
  v_add_f32 v36, v36, v2
  v_mfma_f32_32x32x16_bf16 v[112:127], a[92:95], v[172:175], v[112:127]
  s_waitcnt lgkmcnt(8)
  ds_read_b64_tr_b16 a[84:85], v19 offset:20480
  ds_read_b64_tr_b16 a[86:87], v19 offset:20992
  buffer_load_dwordx4 v16, s[20:23], s49 offen offset:3072 lds
  v_add_f32 v37, v37, v2
  v_add_f32 v38, v38, v2
  v_mfma_f32_32x32x16_bf16 v[64:79], a[64:67], v[176:179], v[64:79]
  s_waitcnt lgkmcnt(8)
  ds_read_b64_tr_b16 a[88:89], v18 offset:22528
  ds_read_b64_tr_b16 a[90:91], v18 offset:23040
  v_add_f32 v39, v39, v2
  v_cvt_pk_bf16_f32 v210, v36, v37
  v_cvt_pk_bf16_f32 v211, v38, v39
  v_lshlrev_b32 v40, 16, v212
  v_mfma_f32_32x32x16_bf16 v[80:95], a[68:71], v[176:179], v[80:95]
  s_waitcnt lgkmcnt(8)
  ds_read_b64_tr_b16 a[92:93], v19 offset:22528
  ds_read_b64_tr_b16 a[94:95], v19 offset:23040
  v_and_b32 v41, s90, v212
  v_lshlrev_b32 v42, 16, v213
  v_and_b32 v43, s90, v213
  v_add_f32 v40, v40, v2
  v_mfma_f32_32x32x16_bf16 v[96:111], a[72:75], v[176:179], v[96:111]
  s_waitcnt lgkmcnt(8)
  ds_read_b64_tr_b16 a[64:65], v18 offset:24576
  ds_read_b64_tr_b16 a[66:67], v18 offset:25088
  v_add_f32 v41, v41, v2
  v_add_f32 v42, v42, v2
  v_add_f32 v43, v43, v2
  v_cvt_pk_bf16_f32 v212, v40, v41
  v_mfma_f32_32x32x16_bf16 v[112:127], a[76:79], v[176:179], v[112:127]
  s_waitcnt lgkmcnt(8)
  ds_read_b64_tr_b16 a[68:69], v19 offset:24576
  ds_read_b64_tr_b16 a[70:71], v19 offset:25088
  v_cvt_pk_bf16_f32 v213, v42, v43
  v_lshlrev_b32 v44, 16, v214
  v_and_b32 v45, s90, v214
  v_lshlrev_b32 v46, 16, v215
  v_mfma_f32_32x32x16_bf16 v[64:79], a[80:83], v[180:183], v[64:79]
  s_waitcnt lgkmcnt(8)
  ds_read_b64_tr_b16 a[72:73], v18 offset:26624
  ds_read_b64_tr_b16 a[74:75], v18 offset:27136
  v_and_b32 v47, s90, v215
  v_add_f32 v44, v44, v2
  v_add_f32 v45, v45, v2
  v_add_f32 v46, v46, v2
  v_mfma_f32_32x32x16_bf16 v[80:95], a[84:87], v[180:183], v[80:95]
  s_waitcnt lgkmcnt(8)
  ds_read_b64_tr_b16 a[76:77], v19 offset:26624
  ds_read_b64_tr_b16 a[78:79], v19 offset:27136
  v_add_f32 v47, v47, v2
  v_cvt_pk_bf16_f32 v214, v44, v45
  v_cvt_pk_bf16_f32 v215, v46, v47
  v_lshlrev_b32 v32, 16, v216
  v_mfma_f32_32x32x16_bf16 v[96:111], a[88:91], v[180:183], v[96:111]
  s_waitcnt lgkmcnt(8)
  ds_read_b64_tr_b16 a[80:81], v18 offset:28672
  ds_read_b64_tr_b16 a[82:83], v18 offset:29184
  v_and_b32 v33, s90, v216
  v_lshlrev_b32 v34, 16, v217
  v_and_b32 v35, s90, v217
  v_add_f32 v32, v32, v2
  v_mfma_f32_32x32x16_bf16 v[112:127], a[92:95], v[180:183], v[112:127]
  s_waitcnt lgkmcnt(8)
  ds_read_b64_tr_b16 a[84:85], v19 offset:28672
  ds_read_b64_tr_b16 a[86:87], v19 offset:29184
  v_add_f32 v33, v33, v2
  v_add_f32 v34, v34, v2
  v_add_f32 v35, v35, v2
  v_cvt_pk_bf16_f32 v216, v32, v33
  v_mfma_f32_32x32x16_bf16 v[64:79], a[64:67], v[184:187], v[64:79]
  s_waitcnt lgkmcnt(8)
  ds_read_b64_tr_b16 a[88:89], v18 offset:30720
  ds_read_b64_tr_b16 a[90:91], v18 offset:31232
  v_cvt_pk_bf16_f32 v217, v34, v35
  v_lshlrev_b32 v36, 16, v218
  v_and_b32 v37, s90, v218
  v_lshlrev_b32 v38, 16, v219
  v_mfma_f32_32x32x16_bf16 v[80:95], a[68:71], v[184:187], v[80:95]
  s_waitcnt lgkmcnt(8)
  ds_read_b64_tr_b16 a[92:93], v19 offset:30720
  ds_read_b64_tr_b16 a[94:95], v19 offset:31232
  v_and_b32 v39, s90, v219
  v_add_f32 v36, v36, v2
  v_add_f32 v37, v37, v2
  v_add_f32 v38, v38, v2
  v_mfma_f32_32x32x16_bf16 v[96:111], a[72:75], v[184:187], v[96:111]
  s_waitcnt vmcnt(16) lgkmcnt(8)
  s_barrier
  ds_read_b64_tr_b16 a[64:65], v18 offset:32768
  ds_read_b64_tr_b16 a[66:67], v18 offset:33280
  v_add_f32 v39, v39, v2
  v_cvt_pk_bf16_f32 v218, v36, v37
  v_mfma_f32_32x32x16_bf16 v[112:127], a[76:79], v[184:187], v[112:127]
  s_waitcnt lgkmcnt(8)
  ds_read_b64_tr_b16 a[68:69], v19 offset:32768
  ds_read_b64_tr_b16 a[70:71], v19 offset:33280
  v_cvt_pk_bf16_f32 v219, v38, v39
  v_lshlrev_b32 v40, 16, v220
  v_and_b32 v41, s90, v220
  v_lshlrev_b32 v42, 16, v221
  v_mfma_f32_32x32x16_bf16 v[64:79], a[80:83], v[188:191], v[64:79]
  s_waitcnt lgkmcnt(8)
  ds_read_b64_tr_b16 a[72:73], v18 offset:34816
  ds_read_b64_tr_b16 a[74:75], v18 offset:35328
  v_and_b32 v43, s90, v221
  v_add_f32 v40, v40, v2
  v_add_f32 v41, v41, v2
  v_add_f32 v42, v42, v2
  v_mfma_f32_32x32x16_bf16 v[80:95], a[84:87], v[188:191], v[80:95]
  s_waitcnt lgkmcnt(8)
  ds_read_b64_tr_b16 a[76:77], v19 offset:34816
  ds_read_b64_tr_b16 a[78:79], v19 offset:35328
  v_add_f32 v43, v43, v2
  v_cvt_pk_bf16_f32 v220, v40, v41
  v_cvt_pk_bf16_f32 v221, v42, v43
  v_lshlrev_b32 v44, 16, v222
  v_mfma_f32_32x32x16_bf16 v[96:111], a[88:91], v[188:191], v[96:111]
  s_waitcnt lgkmcnt(8)
  ds_read_b64_tr_b16 a[80:81], v18 offset:36864
  ds_read_b64_tr_b16 a[82:83], v18 offset:37376
  v_and_b32 v45, s90, v222
  v_lshlrev_b32 v46, 16, v223
  v_and_b32 v47, s90, v223
  v_add_f32 v44, v44, v2
  v_mfma_f32_32x32x16_bf16 v[112:127], a[92:95], v[188:191], v[112:127]
  s_waitcnt lgkmcnt(8)
  ds_read_b64_tr_b16 a[84:85], v19 offset:36864
  ds_read_b64_tr_b16 a[86:87], v19 offset:37376
  v_add_f32 v45, v45, v2
  v_add_f32 v46, v46, v2
  v_add_f32 v47, v47, v2
  v_cvt_pk_bf16_f32 v222, v44, v45
  v_mfma_f32_32x32x16_bf16 v[64:79], a[64:67], v[192:195], v[64:79]
  s_waitcnt lgkmcnt(8)
  ds_read_b64_tr_b16 a[88:89], v18 offset:38912
  ds_read_b64_tr_b16 a[90:91], v18 offset:39424
  v_cvt_pk_bf16_f32 v223, v46, v47
  v_lshlrev_b32 v32, 16, v224
  v_and_b32 v33, s90, v224
  v_lshlrev_b32 v34, 16, v225
  v_mfma_f32_32x32x16_bf16 v[80:95], a[68:71], v[192:195], v[80:95]
  s_waitcnt lgkmcnt(8)
  ds_read_b64_tr_b16 a[92:93], v19 offset:38912
  ds_read_b64_tr_b16 a[94:95], v19 offset:39424
  v_and_b32 v35, s90, v225
  v_add_f32 v32, v32, v2
  v_add_f32 v33, v33, v2
  v_add_f32 v34, v34, v2
  v_mfma_f32_32x32x16_bf16 v[96:111], a[72:75], v[192:195], v[96:111]
  s_waitcnt lgkmcnt(8)
  ds_read_b64_tr_b16 a[64:65], v18 offset:40960
  ds_read_b64_tr_b16 a[66:67], v18 offset:41472
  v_add_f32 v35, v35, v2
  v_cvt_pk_bf16_f32 v224, v32, v33
  v_cvt_pk_bf16_f32 v225, v34, v35
  v_lshlrev_b32 v36, 16, v226
  v_mfma_f32_32x32x16_bf16 v[112:127], a[76:79], v[192:195], v[112:127]
  s_waitcnt lgkmcnt(8)
  ds_read_b64_tr_b16 a[68:69], v19 offset:40960
  ds_read_b64_tr_b16 a[70:71], v19 offset:41472
  v_and_b32 v37, s90, v226
  v_lshlrev_b32 v38, 16, v227
  v_and_b32 v39, s90, v227
  v_add_f32 v36, v36, v2
  v_mfma_f32_32x32x16_bf16 v[64:79], a[80:83], v[196:199], v[64:79]
  s_waitcnt lgkmcnt(8)
  ds_read_b64_tr_b16 a[72:73], v18 offset:43008
  ds_read_b64_tr_b16 a[74:75], v18 offset:43520
  v_add_f32 v37, v37, v2
  v_add_f32 v38, v38, v2
  v_add_f32 v39, v39, v2
  v_cvt_pk_bf16_f32 v226, v36, v37
  v_mfma_f32_32x32x16_bf16 v[80:95], a[84:87], v[196:199], v[80:95]
  s_waitcnt lgkmcnt(8)
  ds_read_b64_tr_b16 a[76:77], v19 offset:43008
  ds_read_b64_tr_b16 a[78:79], v19 offset:43520
  v_cvt_pk_bf16_f32 v227, v38, v39
  v_lshlrev_b32 v40, 16, v228
  v_and_b32 v41, s90, v228
  v_lshlrev_b32 v42, 16, v229
  v_mfma_f32_32x32x16_bf16 v[96:111], a[88:91], v[196:199], v[96:111]
  s_waitcnt lgkmcnt(8)
  ds_read_b64_tr_b16 a[80:81], v18 offset:45056
  ds_read_b64_tr_b16 a[82:83], v18 offset:45568
  v_and_b32 v43, s90, v229
  v_add_f32 v40, v40, v2
  v_add_f32 v41, v41, v2
  v_add_f32 v42, v42, v2
  v_mfma_f32_32x32x16_bf16 v[112:127], a[92:95], v[196:199], v[112:127]
  s_waitcnt lgkmcnt(8)
  ds_read_b64_tr_b16 a[84:85], v19 offset:45056
  ds_read_b64_tr_b16 a[86:87], v19 offset:45568
  v_add_f32 v43, v43, v2
  v_cvt_pk_bf16_f32 v228, v40, v41
  v_cvt_pk_bf16_f32 v229, v42, v43
  v_lshlrev_b32 v44, 16, v230
  v_mfma_f32_32x32x16_bf16 v[64:79], a[64:67], v[200:203], v[64:79]
  s_waitcnt lgkmcnt(8)
  ds_read_b64_tr_b16 a[88:89], v18 offset:47104
  ds_read_b64_tr_b16 a[90:91], v18 offset:47616
  v_and_b32 v45, s90, v230
  v_lshlrev_b32 v46, 16, v231
  v_and_b32 v47, s90, v231
  v_mov_b32 v30, 0
  v_mfma_f32_32x32x16_bf16 v[80:95], a[68:71], v[200:203], v[80:95]
  s_waitcnt lgkmcnt(8)
  ds_read_b64_tr_b16 a[92:93], v19 offset:47104
  ds_read_b64_tr_b16 a[94:95], v19 offset:47616
  global_load_dword v31, v30, s[36:37] sc1
  v_add_f32 v44, v44, v2
  v_add_f32 v45, v45, v2
  v_add_f32 v46, v46, v2
  v_mfma_f32_32x32x16_bf16 v[96:111], a[72:75], v[200:203], v[96:111]
  s_waitcnt lgkmcnt(8)
  ds_read_b64_tr_b16 a[64:65], v18 offset:49152
  ds_read_b64_tr_b16 a[66:67], v18 offset:49664
  v_add_f32 v47, v47, v2
  v_cvt_pk_bf16_f32 v230, v44, v45
  v_cvt_pk_bf16_f32 v231, v46, v47
  v_lshlrev_b32 v32, 16, v232
  v_mfma_f32_32x32x16_bf16 v[112:127], a[76:79], v[200:203], v[112:127]
  s_waitcnt lgkmcnt(8)
  ds_read_b64_tr_b16 a[68:69], v19 offset:49152
  ds_read_b64_tr_b16 a[70:71], v19 offset:49664
  v_and_b32 v33, s90, v232
  v_lshlrev_b32 v34, 16, v233
  v_and_b32 v35, s90, v233
  v_add_f32 v32, v32, v2
  v_mfma_f32_32x32x16_bf16 v[64:79], a[80:83], v[204:207], v[64:79]
  s_waitcnt lgkmcnt(8)
  ds_read_b64_tr_b16 a[72:73], v18 offset:51200
  ds_read_b64_tr_b16 a[74:75], v18 offset:51712
  v_add_f32 v33, v33, v2
  s_add_u32 s49, s89, 8
  s_and_b32 s49, s49, 31
  s_mul_i32 s49, s49, 57344
  v_mfma_f32_32x32x16_bf16 v[80:95], a[84:87], v[204:207], v[80:95]
  s_waitcnt lgkmcnt(8)
  ds_read_b64_tr_b16 a[76:77], v19 offset:51200
  ds_read_b64_tr_b16 a[78:79], v19 offset:51712
  v_add_f32 v34, v34, v2
  s_add_u32 s49, s49, s46
  s_add_u32 m0, s43, 114688
  s_add_u32 s50, s49, 56320
  v_mfma_f32_32x32x16_bf16 v[96:111], a[88:91], v[204:207], v[96:111]
  s_waitcnt lgkmcnt(8)
  ds_read_b64_tr_b16 a[80:81], v18 offset:53248
  ds_read_b64_tr_b16 a[82:83], v18 offset:53760
  buffer_load_dwordx4 v11, s[16:19], s49 offen offset:0 lds
  v_add_f32 v35, v35, v2
  v_cvt_pk_bf16_f32 v232, v32, v33
  v_mfma_f32_32x32x16_bf16 v[112:127], a[92:95], v[204:207], v[112:127]
  s_waitcnt lgkmcnt(8)
  ds_read_b64_tr_b16 a[84:85], v19 offset:53248
  ds_read_b64_tr_b16 a[86:87], v19 offset:53760
  v_cvt_pk_bf16_f32 v233, v34, v35
  v_lshlrev_b32 v36, 16, v234
  v_and_b32 v37, s90, v234
  v_lshlrev_b32 v38, 16, v235
  v_mfma_f32_32x32x16_bf16 v[64:79], a[64:67], v[208:211], v[64:79]
  s_waitcnt lgkmcnt(8)
  ds_read_b64_tr_b16 a[88:89], v18 offset:55296
  ds_read_b64_tr_b16 a[90:91], v18 offset:55808
  v_and_b32 v39, s90, v235
  v_add_f32 v36, v36, v2
  v_add_f32 v37, v37, v2
  v_add_f32 v38, v38, v2
  v_mfma_f32_32x32x16_bf16 v[80:95], a[68:71], v[208:211], v[80:95]
  s_waitcnt lgkmcnt(8)
  ds_read_b64_tr_b16 a[92:93], v19 offset:55296
  ds_read_b64_tr_b16 a[94:95], v19 offset:55808
  v_add_f32 v39, v39, v2
  v_cvt_pk_bf16_f32 v234, v36, v37
  v_cvt_pk_bf16_f32 v235, v38, v39
  v_lshlrev_b32 v40, 16, v236
  v_mfma_f32_32x32x16_bf16 v[96:111], a[72:75], v[208:211], v[96:111]
  s_waitcnt lgkmcnt(8)
  ds_read_b64_tr_b16 a[64:65], v18 offset:57344
  ds_read_b64_tr_b16 a[66:67], v18 offset:57856
  buffer_load_dwordx4 v11, s[16:19], s50 offen offset:1024 lds
  v_and_b32 v41, s90, v236
  v_lshlrev_b32 v42, 16, v237
  v_mfma_f32_32x32x16_bf16 v[112:127], a[76:79], v[208:211], v[112:127]
  s_waitcnt lgkmcnt(8)
  ds_read_b64_tr_b16 a[68:69], v19 offset:57344
  ds_read_b64_tr_b16 a[70:71], v19 offset:57856
  v_and_b32 v43, s90, v237
  v_add_f32 v40, v40, v2
  v_add_f32 v41, v41, v2
  v_add_f32 v42, v42, v2
  v_mfma_f32_32x32x16_bf16 v[64:79], a[80:83], v[212:215], v[64:79]
  s_waitcnt lgkmcnt(8)
  ds_read_b64_tr_b16 a[72:73], v18 offset:59392
  ds_read_b64_tr_b16 a[74:75], v18 offset:59904
  v_add_f32 v43, v43, v2
  v_cvt_pk_bf16_f32 v236, v40, v41
  v_cvt_pk_bf16_f32 v237, v42, v43
  v_lshlrev_b32 v44, 16, v238
  v_mfma_f32_32x32x16_bf16 v[80:95], a[84:87], v[212:215], v[80:95]
  s_waitcnt lgkmcnt(8)
  ds_read_b64_tr_b16 a[76:77], v19 offset:59392
  ds_read_b64_tr_b16 a[78:79], v19 offset:59904
  v_and_b32 v45, s90, v238
  v_lshlrev_b32 v46, 16, v239
  v_add_u32 v18, 61440, v18
  v_add_u32 v19, 61440, v19
  v_mfma_f32_32x32x16_bf16 v[96:111], a[88:91], v[212:215], v[96:111]
  s_waitcnt lgkmcnt(8)
  ds_read_b64_tr_b16 a[80:81], v18 offset:0
  ds_read_b64_tr_b16 a[82:83], v18 offset:512
  buffer_load_dwordx4 v12, s[20:23], s49 offen offset:2048 lds
  v_and_b32 v47, s90, v239
  v_add_f32 v44, v44, v2
  v_mfma_f32_32x32x16_bf16 v[112:127], a[92:95], v[212:215], v[112:127]
  s_waitcnt lgkmcnt(8)
  ds_read_b64_tr_b16 a[84:85], v19 offset:0
  ds_read_b64_tr_b16 a[86:87], v19 offset:512
  v_add_f32 v45, v45, v2
  v_add_f32 v46, v46, v2
  v_add_f32 v47, v47, v2
  v_cvt_pk_bf16_f32 v238, v44, v45
  v_mfma_f32_32x32x16_bf16 v[64:79], a[64:67], v[216:219], v[64:79]
  s_waitcnt lgkmcnt(8)
  ds_read_b64_tr_b16 a[88:89], v18 offset:2048
  ds_read_b64_tr_b16 a[90:91], v18 offset:2560
  v_cvt_pk_bf16_f32 v239, v46, v47
  v_lshlrev_b32 v32, 16, v240
  v_and_b32 v33, s90, v240
  v_lshlrev_b32 v34, 16, v241
  v_mfma_f32_32x32x16_bf16 v[80:95], a[68:71], v[216:219], v[80:95]
  s_waitcnt lgkmcnt(8)
  ds_read_b64_tr_b16 a[92:93], v19 offset:2048
  ds_read_b64_tr_b16 a[94:95], v19 offset:2560
  v_and_b32 v35, s90, v241
  v_add_f32 v32, v32, v2
  v_add_f32 v33, v33, v2
  v_add_f32 v34, v34, v2
  v_mfma_f32_32x32x16_bf16 v[96:111], a[72:75], v[216:219], v[96:111]
  s_waitcnt vmcnt(12) lgkmcnt(8)
  s_barrier
  ds_read_b64_tr_b16 a[64:65], v18 offset:4096
  ds_read_b64_tr_b16 a[66:67], v18 offset:4608
  buffer_load_dwordx4 v12, s[20:23], s50 offen offset:3072 lds
  v_mfma_f32_32x32x16_bf16 v[112:127], a[76:79], v[216:219], v[112:127]
  s_waitcnt lgkmcnt(8)
  ds_read_b64_tr_b16 a[68:69], v19 offset:4096
  ds_read_b64_tr_b16 a[70:71], v19 offset:4608
  v_add_f32 v35, v35, v2
  v_cvt_pk_bf16_f32 v240, v32, v33
  v_cvt_pk_bf16_f32 v241, v34, v35
  v_lshlrev_b32 v36, 16, v242
  v_mfma_f32_32x32x16_bf16 v[64:79], a[80:83], v[220:223], v[64:79]
  s_waitcnt lgkmcnt(8)
  ds_read_b64_tr_b16 a[72:73], v18 offset:6144
  ds_read_b64_tr_b16 a[74:75], v18 offset:6656
  v_and_b32 v37, s90, v242
  s_add_u32 s49, s89, 16
  s_and_b32 s49, s49, 31
  s_mul_i32 s49, s49, 57344
  v_mfma_f32_32x32x16_bf16 v[80:95], a[84:87], v[220:223], v[80:95]
  s_waitcnt lgkmcnt(8)
  ds_read_b64_tr_b16 a[76:77], v19 offset:6144
  ds_read_b64_tr_b16 a[78:79], v19 offset:6656
  v_lshlrev_b32 v38, 16, v243
  s_add_u32 s49, s49, s46
  s_add_u32 m0, s43, 0
  s_add_u32 s50, s49, 56320
  v_mfma_f32_32x32x16_bf16 v[96:111], a[88:91], v[220:223], v[96:111]
  s_waitcnt lgkmcnt(8)
  ds_read_b64_tr_b16 a[80:81], v18 offset:8192
  ds_read_b64_tr_b16 a[82:83], v18 offset:8704
  buffer_load_dwordx4 v11, s[16:19], s49 offen offset:0 lds
  v_and_b32 v39, s90, v243
  v_add_f32 v36, v36, v2
  v_mfma_f32_32x32x16_bf16 v[112:127], a[92:95], v[220:223], v[112:127]
  s_waitcnt lgkmcnt(8)
  ds_read_b64_tr_b16 a[84:85], v19 offset:8192
  ds_read_b64_tr_b16 a[86:87], v19 offset:8704
  v_add_f32 v37, v37, v2
  v_add_f32 v38, v38, v2
  v_add_f32 v39, v39, v2
  v_cvt_pk_bf16_f32 v242, v36, v37
  v_mfma_f32_32x32x16_bf16 v[64:79], a[64:67], v[224:227], v[64:79]
  s_waitcnt lgkmcnt(8)
  ds_read_b64_tr_b16 a[88:89], v18 offset:10240
  ds_read_b64_tr_b16 a[90:91], v18 offset:10752
  v_cvt_pk_bf16_f32 v243, v38, v39
  v_lshlrev_b32 v40, 16, v244
  v_and_b32 v41, s90, v244
  v_lshlrev_b32 v42, 16, v245
  v_mfma_f32_32x32x16_bf16 v[80:95], a[68:71], v[224:227], v[80:95]
  s_waitcnt lgkmcnt(8)
  ds_read_b64_tr_b16 a[92:93], v19 offset:10240
  ds_read_b64_tr_b16 a[94:95], v19 offset:10752
  v_and_b32 v43, s90, v245
  v_add_f32 v40, v40, v2
  v_add_f32 v41, v41, v2
  v_add_f32 v42, v42, v2
  v_mfma_f32_32x32x16_bf16 v[96:111], a[72:75], v[224:227], v[96:111]
  s_waitcnt lgkmcnt(8)
  ds_read_b64_tr_b16 a[64:65], v18 offset:12288
  ds_read_b64_tr_b16 a[66:67], v18 offset:12800
  buffer_load_dwordx4 v11, s[16:19], s50 offen offset:1024 lds
  v_add_f32 v43, v43, v2
  v_cvt_pk_bf16_f32 v244, v40, v41
  v_mfma_f32_32x32x16_bf16 v[112:127], a[76:79], v[224:227], v[112:127]
  s_waitcnt lgkmcnt(8)
  ds_read_b64_tr_b16 a[68:69], v19 offset:12288
  ds_read_b64_tr_b16 a[70:71], v19 offset:12800
  v_cvt_pk_bf16_f32 v245, v42, v43
  v_lshlrev_b32 v44, 16, v246
  v_and_b32 v45, s90, v246
  v_lshlrev_b32 v46, 16, v247
  v_mfma_f32_32x32x16_bf16 v[64:79], a[80:83], v[228:231], v[64:79]
  s_waitcnt lgkmcnt(8)
  ds_read_b64_tr_b16 a[72:73], v18 offset:14336
  ds_read_b64_tr_b16 a[74:75], v18 offset:14848
  v_and_b32 v47, s90, v247
  v_add_f32 v44, v44, v2
  v_add_f32 v45, v45, v2
  v_add_f32 v46, v46, v2
  v_mfma_f32_32x32x16_bf16 v[80:95], a[84:87], v[228:231], v[80:95]
  s_waitcnt lgkmcnt(8)
  ds_read_b64_tr_b16 a[76:77], v19 offset:14336
  ds_read_b64_tr_b16 a[78:79], v19 offset:14848
  v_add_f32 v47, v47, v2
  v_cvt_pk_bf16_f32 v246, v44, v45
  v_cvt_pk_bf16_f32 v247, v46, v47
  v_lshlrev_b32 v32, 16, v248
  v_mfma_f32_32x32x16_bf16 v[96:111], a[88:91], v[228:231], v[96:111]
  s_waitcnt lgkmcnt(8)
  ds_read_b64_tr_b16 a[80:81], v18 offset:16384
  ds_read_b64_tr_b16 a[82:83], v18 offset:16896
  buffer_load_dwordx4 v12, s[20:23], s49 offen offset:2048 lds
  v_and_b32 v33, s90, v248
  v_lshlrev_b32 v34, 16, v249
  v_mfma_f32_32x32x16_bf16 v[112:127], a[92:95], v[228:231], v[112:127]
  s_waitcnt lgkmcnt(8)
  ds_read_b64_tr_b16 a[84:85], v19 offset:16384
  ds_read_b64_tr_b16 a[86:87], v19 offset:16896
  v_and_b32 v35, s90, v249
  v_add_f32 v32, v32, v2
  v_add_f32 v33, v33, v2
  v_add_f32 v34, v34, v2
  v_mfma_f32_32x32x16_bf16 v[64:79], a[64:67], v[232:235], v[64:79]
  s_waitcnt lgkmcnt(8)
  ds_read_b64_tr_b16 a[88:89], v18 offset:18432
  ds_read_b64_tr_b16 a[90:91], v18 offset:18944
  v_add_f32 v35, v35, v2
  v_cvt_pk_bf16_f32 v248, v32, v33
  v_cvt_pk_bf16_f32 v249, v34, v35
  v_lshlrev_b32 v36, 16, v250
  v_mfma_f32_32x32x16_bf16 v[80:95], a[68:71], v[232:235], v[80:95]
  s_waitcnt lgkmcnt(8)
  ds_read_b64_tr_b16 a[92:93], v19 offset:18432
  ds_read_b64_tr_b16 a[94:95], v19 offset:18944
  v_and_b32 v37, s90, v250
  v_lshlrev_b32 v38, 16, v251
  v_and_b32 v39, s90, v251
  v_add_f32 v36, v36, v2
  v_mfma_f32_32x32x16_bf16 v[96:111], a[72:75], v[232:235], v[96:111]
  s_waitcnt lgkmcnt(8)
  ds_read_b64_tr_b16 a[64:65], v18 offset:20480
  ds_read_b64_tr_b16 a[66:67], v18 offset:20992
  buffer_load_dwordx4 v12, s[20:23], s50 offen offset:3072 lds
  v_add_f32 v37, v37, v2
  v_add_f32 v38, v38, v2
  v_mfma_f32_32x32x16_bf16 v[112:127], a[76:79], v[232:235], v[112:127]
  s_waitcnt lgkmcnt(8)
  ds_read_b64_tr_b16 a[68:69], v19 offset:20480
  ds_read_b64_tr_b16 a[70:71], v19 offset:20992
  v_add_f32 v39, v39, v2
  v_cvt_pk_bf16_f32 v250, v36, v37
  v_cvt_pk_bf16_f32 v251, v38, v39
  v_lshlrev_b32 v40, 16, v252
  v_mfma_f32_32x32x16_bf16 v[64:79], a[80:83], v[236:239], v[64:79]
  s_waitcnt lgkmcnt(8)
  ds_read_b64_tr_b16 a[72:73], v18 offset:22528
  ds_read_b64_tr_b16 a[74:75], v18 offset:23040
  v_and_b32 v41, s90, v252
  s_add_u32 s49, s89, 24
  s_and_b32 s49, s49, 31
  s_mul_i32 s49, s49, 57344
  v_mfma_f32_32x32x16_bf16 v[80:95], a[84:87], v[236:239], v[80:95]
  s_waitcnt lgkmcnt(8)
  ds_read_b64_tr_b16 a[76:77], v19 offset:22528
  ds_read_b64_tr_b16 a[78:79], v19 offset:23040
  v_lshlrev_b32 v42, 16, v253
  s_add_u32 s49, s49, s46
  s_add_u32 m0, s43, 16384
  s_add_u32 s50, s49, 56320
  v_mfma_f32_32x32x16_bf16 v[96:111], a[88:91], v[236:239], v[96:111]
  s_waitcnt lgkmcnt(8)
  ds_read_b64_tr_b16 a[80:81], v18 offset:24576
  ds_read_b64_tr_b16 a[82:83], v18 offset:25088
  buffer_load_dwordx4 v11, s[16:19], s49 offen offset:0 lds
  v_and_b32 v43, s90, v253
  v_add_f32 v40, v40, v2
  v_mfma_f32_32x32x16_bf16 v[112:127], a[92:95], v[236:239], v[112:127]
  s_waitcnt lgkmcnt(8)
  ds_read_b64_tr_b16 a[84:85], v19 offset:24576
  ds_read_b64_tr_b16 a[86:87], v19 offset:25088
  v_add_f32 v41, v41, v2
  v_add_f32 v42, v42, v2
  v_add_f32 v43, v43, v2
  v_cvt_pk_bf16_f32 v252, v40, v41
  v_mfma_f32_32x32x16_bf16 v[64:79], a[64:67], v[240:243], v[64:79]
  s_waitcnt lgkmcnt(8)
  ds_read_b64_tr_b16 a[88:89], v18 offset:26624
  ds_read_b64_tr_b16 a[90:91], v18 offset:27136
  v_cvt_pk_bf16_f32 v253, v42, v43
  v_lshlrev_b32 v44, 16, v254
  v_and_b32 v45, s90, v254
  v_lshlrev_b32 v46, 16, v255
  v_mfma_f32_32x32x16_bf16 v[80:95], a[68:71], v[240:243], v[80:95]
  s_waitcnt lgkmcnt(8)
  ds_read_b64_tr_b16 a[92:93], v19 offset:26624
  ds_read_b64_tr_b16 a[94:95], v19 offset:27136
  v_and_b32 v47, s90, v255
  v_add_f32 v44, v44, v2
  v_add_f32 v45, v45, v2
  v_add_f32 v46, v46, v2
  v_mfma_f32_32x32x16_bf16 v[96:111], a[72:75], v[240:243], v[96:111]
  s_waitcnt lgkmcnt(8)
  ds_read_b64_tr_b16 a[64:65], v18 offset:28672
  ds_read_b64_tr_b16 a[66:67], v18 offset:29184
  buffer_load_dwordx4 v11, s[16:19], s50 offen offset:1024 lds
  v_add_f32 v47, v47, v2
  v_cvt_pk_bf16_f32 v254, v44, v45
mk_wA2:
  s_cbranch_execz mk_wJ2
  v_mfma_f32_32x32x16_bf16 v[112:127], a[76:79], v[240:243], v[112:127]
  s_waitcnt lgkmcnt(8)
  ds_read_b64_tr_b16 a[68:69], v19 offset:28672
  ds_read_b64_tr_b16 a[70:71], v19 offset:29184
  v_cvt_pk_bf16_f32 v255, v46, v47
  v_mfma_f32_32x32x16_bf16 v[64:79], a[80:83], v[244:247], v[64:79]
  s_waitcnt lgkmcnt(8)
  ds_read_b64_tr_b16 a[72:73], v18 offset:30720
  ds_read_b64_tr_b16 a[74:75], v18 offset:31232
  v_mfma_f32_32x32x16_bf16 v[80:95], a[84:87], v[244:247], v[80:95]
  s_waitcnt lgkmcnt(8)
  ds_read_b64_tr_b16 a[76:77], v19 offset:30720
  ds_read_b64_tr_b16 a[78:79], v19 offset:31232
  v_mfma_f32_32x32x16_bf16 v[96:111], a[88:91], v[244:247], v[96:111]
  s_waitcnt lgkmcnt(8)
  ds_read_b64_tr_b16 a[80:81], v18 offset:32768
  ds_read_b64_tr_b16 a[82:83], v18 offset:33280
  buffer_load_dwordx4 v12, s[20:23], s49 offen offset:2048 lds
  v_mfma_f32_32x32x16_bf16 v[112:127], a[92:95], v[244:247], v[112:127]
  s_waitcnt lgkmcnt(8)
  ds_read_b64_tr_b16 a[84:85], v19 offset:32768
  ds_read_b64_tr_b16 a[86:87], v19 offset:33280
  v_mfma_f32_32x32x16_bf16 v[64:79], a[64:67], v[248:251], v[64:79]
  s_waitcnt lgkmcnt(8)
  ds_read_b64_tr_b16 a[88:89], v18 offset:34816
  ds_read_b64_tr_b16 a[90:91], v18 offset:35328
  v_mfma_f32_32x32x16_bf16 v[80:95], a[68:71], v[248:251], v[80:95]
  s_waitcnt lgkmcnt(8)
  ds_read_b64_tr_b16 a[92:93], v19 offset:34816
  ds_read_b64_tr_b16 a[94:95], v19 offset:35328
  v_accvgpr_read_b32 v18, a248
  v_add_u32 v18, 61440, v18
  v_xor_b32 v19, 32, v18
  v_mfma_f32_32x32x16_bf16 v[96:111], a[72:75], v[248:251], v[96:111]
  s_waitcnt vmcnt(7) lgkmcnt(8)
  s_barrier
  ds_read_b64_tr_b16 a[64:65], v18 offset:36864
  ds_read_b64_tr_b16 a[66:67], v18 offset:37120
  buffer_load_dwordx4 v12, s[20:23], s50 offen offset:3072 lds
  v_mfma_f32_32x32x16_bf16 v[112:127], a[76:79], v[248:251], v[112:127]
  s_waitcnt lgkmcnt(8)
  ds_read_b64_tr_b16 a[68:69], v19 offset:36864
  ds_read_b64_tr_b16 a[70:71], v19 offset:37120
  v_mfma_f32_32x32x16_bf16 v[64:79], a[80:83], v[252:255], v[64:79]
  s_waitcnt lgkmcnt(8)
  ds_read_b64_tr_b16 a[72:73], v18 offset:37888
  ds_read_b64_tr_b16 a[74:75], v18 offset:38144
  s_add_u32 s49, s44, 1
  s_and_b32 s49, s49, 7
  s_mul_i32 s49, s49, 229376
  v_mfma_f32_32x32x16_bf16 v[80:95], a[84:87], v[252:255], v[80:95]
  s_waitcnt lgkmcnt(8)
  ds_read_b64_tr_b16 a[76:77], v19 offset:37888
  ds_read_b64_tr_b16 a[78:79], v19 offset:38144
  s_add_u32 m0, s43, 147456
  s_add_u32 s49, s49, s48
  v_cmp_eq_u32 vcc, 0, v31
  s_cbranch_vccnz mk_pdA_spin
mk_pdA_ok:
  v_readfirstlane_b32 s94, v31
  v_readfirstlane_b32 s95, v31
  v_mfma_f32_32x32x16_bf16 v[96:111], a[88:91], v[252:255], v[96:111]
  s_waitcnt lgkmcnt(8)
  ds_read_b64_tr_b16 a[80:81], v18 offset:40960
  ds_read_b64_tr_b16 a[82:83], v18 offset:41216
  buffer_load_dwordx4 v13, s[16:19], s49 offen offset:0 lds
  v_mfma_f32_32x32x16_bf16 v[112:127], a[92:95], v[252:255], v[112:127]
  s_waitcnt lgkmcnt(8)
  ds_read_b64_tr_b16 a[84:85], v19 offset:40960
  ds_read_b64_tr_b16 a[86:87], v19 offset:41216
  buffer_load_dwordx4 v14, s[16:19], s49 offen offset:1024 lds
  v_mfma_f32_32x32x16_bf16 a[128:143], a[64:67], v[128:131], 0
  s_waitcnt lgkmcnt(8)
  ds_read_b64_tr_b16 a[88:89], v18 offset:41984
  ds_read_b64_tr_b16 a[90:91], v18 offset:42240
  v_mfma_f32_32x32x16_bf16 a[144:159], a[68:71], v[128:131], 0
  s_waitcnt lgkmcnt(8)
  ds_read_b64_tr_b16 a[92:93], v19 offset:41984
  ds_read_b64_tr_b16 a[94:95], v19 offset:42240
  v_mfma_f32_32x32x16_bf16 a[128:143], a[72:75], v[132:135], a[128:143]
  s_waitcnt lgkmcnt(8)
  ds_read_b64_tr_b16 a[64:65], v18 offset:45056
  ds_read_b64_tr_b16 a[66:67], v18 offset:45312
  buffer_load_dwordx4 v15, s[20:23], s49 offen offset:2048 lds
  v_mfma_f32_32x32x16_bf16 a[144:159], a[76:79], v[132:135], a[144:159]
  s_waitcnt lgkmcnt(8)
  ds_read_b64_tr_b16 a[68:69], v19 offset:45056
  ds_read_b64_tr_b16 a[70:71], v19 offset:45312
  buffer_load_dwordx4 v16, s[20:23], s49 offen offset:3072 lds
  v_mfma_f32_32x32x16_bf16 a[128:143], a[80:83], v[136:139], a[128:143]
  s_waitcnt lgkmcnt(8)
  ds_read_b64_tr_b16 a[72:73], v18 offset:46080
  ds_read_b64_tr_b16 a[74:75], v18 offset:46336
  s_add_u32 s58, s51, 0
  v_mul_f32 v64, v64, v3
  v_mul_f32 v65, v65, v3
  v_mul_f32 v66, v66, v3
  v_mfma_f32_32x32x16_bf16 a[144:159], a[84:87], v[136:139], a[144:159]
  s_waitcnt lgkmcnt(8)
  ds_read_b64_tr_b16 a[76:77], v19 offset:46080
  ds_read_b64_tr_b16 a[78:79], v19 offset:46336
  v_mul_f32 v67, v67, v3
  v_mul_f32 v68, v68, v3
  v_mul_f32 v69, v69, v3
  v_mul_f32 v70, v70, v3
  v_mfma_f32_32x32x16_bf16 a[128:143], a[88:91], v[140:143], a[128:143]
  s_waitcnt lgkmcnt(8)
  ds_read_b64_tr_b16 a[80:81], v18 offset:49152
  ds_read_b64_tr_b16 a[82:83], v18 offset:49408
  v_mul_f32 v71, v71, v3
  v_mul_f32 v72, v72, v3
  v_mul_f32 v73, v73, v3
  v_mul_f32 v74, v74, v3
  v_mfma_f32_32x32x16_bf16 a[144:159], a[92:95], v[140:143], a[144:159]
  s_waitcnt lgkmcnt(8)
  ds_read_b64_tr_b16 a[84:85], v19 offset:49152
  ds_read_b64_tr_b16 a[86:87], v19 offset:49408
  v_mul_f32 v75, v75, v3
  v_mul_f32 v76, v76, v3
  v_mul_f32 v77, v77, v3
  v_mul_f32 v78, v78, v3
  v_mfma_f32_32x32x16_bf16 a[128:143], a[64:67], v[144:147], a[128:143]
  s_waitcnt lgkmcnt(8)
  ds_read_b64_tr_b16 a[88:89], v18 offset:50176
  ds_read_b64_tr_b16 a[90:91], v18 offset:50432
  v_mul_f32 v79, v79, v3
  v_cvt_pk_bf16_f32 v64, v64, v65
  v_cvt_pk_bf16_f32 v65, v66, v67
  v_cvt_pk_bf16_f32 v66, v68, v69
  v_mfma_f32_32x32x16_bf16 a[144:159], a[68:71], v[144:147], a[144:159]
  s_waitcnt lgkmcnt(8)
  ds_read_b64_tr_b16 a[92:93], v19 offset:50176
  ds_read_b64_tr_b16 a[94:95], v19 offset:50432
  v_cvt_pk_bf16_f32 v67, v70, v71
  v_cvt_pk_bf16_f32 v68, v72, v73
  v_cvt_pk_bf16_f32 v69, v74, v75
  v_cvt_pk_bf16_f32 v70, v76, v77
  v_mfma_f32_32x32x16_bf16 a[128:143], a[72:75], v[148:151], a[128:143]
  s_waitcnt lgkmcnt(8)
  ds_read_b64_tr_b16 a[64:65], v18 offset:53248
  ds_read_b64_tr_b16 a[66:67], v18 offset:53504
  v_cvt_pk_bf16_f32 v71, v78, v79
  v_add_u32 v72, s58, v7
  v_add_u32 v73, 65536, v72
  v_mfma_f32_32x32x16_bf16 a[144:159], a[76:79], v[148:151], a[144:159]
  s_waitcnt lgkmcnt(8)
  ds_read_b64_tr_b16 a[68:69], v19 offset:53248
  ds_read_b64_tr_b16 a[70:71], v19 offset:53504
  global_store_dwordx4 v72, v[64:67], s[38:39] offset:0 sc1
  global_store_dwordx4 v73, v[68:71], s[38:39] offset:0 sc1
  v_mfma_f32_32x32x16_bf16 a[128:143], a[80:83], v[152:155], a[128:143]
  s_waitcnt lgkmcnt(8)
  ds_read_b64_tr_b16 a[72:73], v18 offset:54272
  ds_read_b64_tr_b16 a[74:75], v18 offset:54528
  s_add_u32 s58, s51, 131072
  v_mul_f32 v80, v80, v3
  v_mul_f32 v81, v81, v3
  v_mul_f32 v82, v82, v3
  v_mfma_f32_32x32x16_bf16 a[144:159], a[84:87], v[152:155], a[144:159]
  s_waitcnt lgkmcnt(8)
  ds_read_b64_tr_b16 a[76:77], v19 offset:54272
  ds_read_b64_tr_b16 a[78:79], v19 offset:54528
  v_mul_f32 v83, v83, v3
  v_mul_f32 v84, v84, v3
  v_mul_f32 v85, v85, v3
  v_mul_f32 v86, v86, v3
  v_mfma_f32_32x32x16_bf16 a[128:143], a[88:91], v[156:159], a[128:143]
  s_waitcnt lgkmcnt(8)
  ds_read_b64_tr_b16 a[80:81], v18 offset:57344
  ds_read_b64_tr_b16 a[82:83], v18 offset:57600
  v_mul_f32 v87, v87, v3
  v_mul_f32 v88, v88, v3
  v_mul_f32 v89, v89, v3
  v_mul_f32 v90, v90, v3
  v_mfma_f32_32x32x16_bf16 a[144:159], a[92:95], v[156:159], a[144:159]
  s_waitcnt lgkmcnt(8)
  ds_read_b64_tr_b16 a[84:85], v19 offset:57344
  ds_read_b64_tr_b16 a[86:87], v19 offset:57600
  v_mul_f32 v91, v91, v3
  v_mul_f32 v92, v92, v3
  v_mul_f32 v93, v93, v3
  v_mul_f32 v94, v94, v3
  v_mfma_f32_32x32x16_bf16 a[128:143], a[64:67], v[160:163], a[128:143]
  s_waitcnt lgkmcnt(8)
  ds_read_b64_tr_b16 a[88:89], v18 offset:58368
  ds_read_b64_tr_b16 a[90:91], v18 offset:58624
  v_mul_f32 v95, v95, v3
  v_cvt_pk_bf16_f32 v80, v80, v81
  v_cvt_pk_bf16_f32 v81, v82, v83
  v_cvt_pk_bf16_f32 v82, v84, v85
  v_mfma_f32_32x32x16_bf16 a[144:159], a[68:71], v[160:163], a[144:159]
  s_waitcnt lgkmcnt(8)
  ds_read_b64_tr_b16 a[92:93], v19 offset:58368
  ds_read_b64_tr_b16 a[94:95], v19 offset:58624
  v_cvt_pk_bf16_f32 v83, v86, v87
  v_cvt_pk_bf16_f32 v84, v88, v89
  v_add_u32 v18, 61440, v18
  v_add_u32 v19, 61440, v19
  v_mfma_f32_32x32x16_bf16 a[128:143], a[72:75], v[164:167], a[128:143]
  s_waitcnt lgkmcnt(8)
  ds_read_b64_tr_b16 a[64:65], v18 offset:0
  ds_read_b64_tr_b16 a[66:67], v18 offset:256
  v_cvt_pk_bf16_f32 v85, v90, v91
  v_cvt_pk_bf16_f32 v86, v92, v93
  v_cvt_pk_bf16_f32 v87, v94, v95
  v_add_u32 v88, s58, v7
  v_mfma_f32_32x32x16_bf16 a[144:159], a[76:79], v[164:167], a[144:159]
  s_waitcnt lgkmcnt(8)
  ds_read_b64_tr_b16 a[68:69], v19 offset:0
  ds_read_b64_tr_b16 a[70:71], v19 offset:256
  v_add_u32 v89, 65536, v88
  v_mfma_f32_32x32x16_bf16 a[128:143], a[80:83], v[168:171], a[128:143]
  s_waitcnt lgkmcnt(8)
  ds_read_b64_tr_b16 a[72:73], v18 offset:1024
  ds_read_b64_tr_b16 a[74:75], v18 offset:1280
  global_store_dwordx4 v88, v[80:83], s[38:39] offset:0 sc1
  global_store_dwordx4 v89, v[84:87], s[38:39] offset:0 sc1
  v_mfma_f32_32x32x16_bf16 a[144:159], a[84:87], v[168:171], a[144:159]
  s_waitcnt lgkmcnt(8)
  ds_read_b64_tr_b16 a[76:77], v19 offset:1024
  ds_read_b64_tr_b16 a[78:79], v19 offset:1280
  v_mfma_f32_32x32x16_bf16 a[128:143], a[88:91], v[172:175], a[128:143]
  s_waitcnt lgkmcnt(8)
  ds_read_b64_tr_b16 a[80:81], v18 offset:4096
  ds_read_b64_tr_b16 a[82:83], v18 offset:4352
  v_mfma_f32_32x32x16_bf16 a[144:159], a[92:95], v[172:175], a[144:159]
  s_waitcnt lgkmcnt(8)
  ds_read_b64_tr_b16 a[84:85], v19 offset:4096
  ds_read_b64_tr_b16 a[86:87], v19 offset:4352
  v_mfma_f32_32x32x16_bf16 a[128:143], a[64:67], v[176:179], a[128:143]
  s_waitcnt lgkmcnt(8)
  ds_read_b64_tr_b16 a[88:89], v18 offset:5120
  ds_read_b64_tr_b16 a[90:91], v18 offset:5376
  s_add_u32 s58, s51, 262144
  v_mul_f32 v96, v96, v3
  v_mul_f32 v97, v97, v3
  v_mul_f32 v98, v98, v3
  v_mfma_f32_32x32x16_bf16 a[144:159], a[68:71], v[176:179], a[144:159]
  s_waitcnt lgkmcnt(8)
  ds_read_b64_tr_b16 a[92:93], v19 offset:5120
  ds_read_b64_tr_b16 a[94:95], v19 offset:5376
  v_mul_f32 v99, v99, v3
  v_mul_f32 v100, v100, v3
  v_subrev_u32 v18, 122880, v18
  v_subrev_u32 v19, 122880, v19
  v_mfma_f32_32x32x16_bf16 a[128:143], a[72:75], v[180:183], a[128:143]
  s_waitcnt vmcnt(8) lgkmcnt(8)
  s_barrier
  ds_read_b64_tr_b16 a[64:65], v18 offset:0
  ds_read_b64_tr_b16 a[66:67], v18 offset:256
  v_mul_f32 v101, v101, v3
  v_mul_f32 v102, v102, v3
  v_mfma_f32_32x32x16_bf16 a[144:159], a[76:79], v[180:183], a[144:159]
  s_waitcnt lgkmcnt(8)
  ds_read_b64_tr_b16 a[68:69], v19 offset:0
  ds_read_b64_tr_b16 a[70:71], v19 offset:256
  v_mul_f32 v103, v103, v3
  v_mul_f32 v104, v104, v3
  v_mul_f32 v105, v105, v3
  v_mul_f32 v106, v106, v3
  v_mfma_f32_32x32x16_bf16 a[128:143], a[80:83], v[184:187], a[128:143]
  s_waitcnt lgkmcnt(8)
  ds_read_b64_tr_b16 a[72:73], v18 offset:1024
  ds_read_b64_tr_b16 a[74:75], v18 offset:1280
  v_mul_f32 v107, v107, v3
  v_mul_f32 v108, v108, v3
  v_mul_f32 v109, v109, v3
  v_mul_f32 v110, v110, v3
  v_mfma_f32_32x32x16_bf16 a[144:159], a[84:87], v[184:187], a[144:159]
  s_waitcnt lgkmcnt(8)
  ds_read_b64_tr_b16 a[76:77], v19 offset:1024
  ds_read_b64_tr_b16 a[78:79], v19 offset:1280
  v_mul_f32 v111, v111, v3
  v_cvt_pk_bf16_f32 v96, v96, v97
  v_cvt_pk_bf16_f32 v97, v98, v99
  v_cvt_pk_bf16_f32 v98, v100, v101
  v_mfma_f32_32x32x16_bf16 a[128:143], a[88:91], v[188:191], a[128:143]
  s_waitcnt lgkmcnt(8)
  ds_read_b64_tr_b16 a[80:81], v18 offset:4096
  ds_read_b64_tr_b16 a[82:83], v18 offset:4352
  v_cvt_pk_bf16_f32 v99, v102, v103
  v_cvt_pk_bf16_f32 v100, v104, v105
  v_cvt_pk_bf16_f32 v101, v106, v107
  v_cvt_pk_bf16_f32 v102, v108, v109
  v_mfma_f32_32x32x16_bf16 a[144:159], a[92:95], v[188:191], a[144:159]
  s_waitcnt lgkmcnt(8)
  ds_read_b64_tr_b16 a[84:85], v19 offset:4096
  ds_read_b64_tr_b16 a[86:87], v19 offset:4352
  v_cvt_pk_bf16_f32 v103, v110, v111
  v_add_u32 v104, s58, v7
  v_add_u32 v105, 65536, v104
  v_mfma_f32_32x32x16_bf16 a[128:143], a[64:67], v[192:195], a[128:143]
  s_waitcnt lgkmcnt(8)
  ds_read_b64_tr_b16 a[88:89], v18 offset:5120
  ds_read_b64_tr_b16 a[90:91], v18 offset:5376
  global_store_dwordx4 v104, v[96:99], s[38:39] offset:0 sc1
  global_store_dwordx4 v105, v[100:103], s[38:39] offset:0 sc1
  s_add_u32 s58, s51, 393216
  v_mul_f32 v112, v112, v3
  v_mfma_f32_32x32x16_bf16 a[144:159], a[68:71], v[192:195], a[144:159]
  s_waitcnt lgkmcnt(8)
  ds_read_b64_tr_b16 a[92:93], v19 offset:5120
  ds_read_b64_tr_b16 a[94:95], v19 offset:5376
  v_mul_f32 v113, v113, v3
  v_mul_f32 v114, v114, v3
  v_mul_f32 v115, v115, v3
  v_mul_f32 v116, v116, v3
  v_mfma_f32_32x32x16_bf16 a[128:143], a[72:75], v[196:199], a[128:143]
  s_waitcnt lgkmcnt(8)
  ds_read_b64_tr_b16 a[64:65], v18 offset:8192
  ds_read_b64_tr_b16 a[66:67], v18 offset:8448
  v_mul_f32 v117, v117, v3
  v_mul_f32 v118, v118, v3
  v_mul_f32 v119, v119, v3
  v_mul_f32 v120, v120, v3
  v_mfma_f32_32x32x16_bf16 a[144:159], a[76:79], v[196:199], a[144:159]
  s_waitcnt lgkmcnt(8)
  ds_read_b64_tr_b16 a[68:69], v19 offset:8192
  ds_read_b64_tr_b16 a[70:71], v19 offset:8448
  v_mul_f32 v121, v121, v3
  v_mul_f32 v122, v122, v3
  v_mul_f32 v123, v123, v3
  v_mul_f32 v124, v124, v3
  v_mfma_f32_32x32x16_bf16 a[128:143], a[80:83], v[200:203], a[128:143]
  s_waitcnt lgkmcnt(8)
  ds_read_b64_tr_b16 a[72:73], v18 offset:9216
  ds_read_b64_tr_b16 a[74:75], v18 offset:9472
  v_mul_f32 v125, v125, v3
  v_mul_f32 v126, v126, v3
  v_mul_f32 v127, v127, v3
  v_cvt_pk_bf16_f32 v112, v112, v113
  v_mfma_f32_32x32x16_bf16 a[144:159], a[84:87], v[200:203], a[144:159]
  s_waitcnt lgkmcnt(8)
  ds_read_b64_tr_b16 a[76:77], v19 offset:9216
  ds_read_b64_tr_b16 a[78:79], v19 offset:9472
  v_cvt_pk_bf16_f32 v113, v114, v115
  v_cvt_pk_bf16_f32 v114, v116, v117
  v_cvt_pk_bf16_f32 v115, v118, v119
  v_cvt_pk_bf16_f32 v116, v120, v121
  v_mfma_f32_32x32x16_bf16 a[128:143], a[88:91], v[204:207], a[128:143]
  s_waitcnt lgkmcnt(8)
  ds_read_b64_tr_b16 a[80:81], v18 offset:12288
  ds_read_b64_tr_b16 a[82:83], v18 offset:12544
  v_cvt_pk_bf16_f32 v117, v122, v123
  v_cvt_pk_bf16_f32 v118, v124, v125
  v_cvt_pk_bf16_f32 v119, v126, v127
  v_add_u32 v120, s58, v7
  v_mfma_f32_32x32x16_bf16 a[144:159], a[92:95], v[204:207], a[144:159]
  s_waitcnt lgkmcnt(8)
  ds_read_b64_tr_b16 a[84:85], v19 offset:12288
  ds_read_b64_tr_b16 a[86:87], v19 offset:12544
  v_add_u32 v121, 65536, v120
  v_mfma_f32_32x32x16_bf16 a[128:143], a[64:67], v[208:211], a[128:143]
  s_waitcnt lgkmcnt(8)
  ds_read_b64_tr_b16 a[88:89], v18 offset:13312
  ds_read_b64_tr_b16 a[90:91], v18 offset:13568
  global_store_dwordx4 v120, v[112:115], s[38:39] offset:0 sc1
  s_add_u32 s49, s44, 2
  s_and_b32 s49, s49, 7
  s_mul_i32 s49, s49, 229376
  v_mfma_f32_32x32x16_bf16 a[144:159], a[68:71], v[208:211], a[144:159]
  s_waitcnt lgkmcnt(8)
  ds_read_b64_tr_b16 a[92:93], v19 offset:13312
  ds_read_b64_tr_b16 a[94:95], v19 offset:13568
  global_store_dwordx4 v121, v[116:119], s[38:39] offset:0 sc1
  s_add_u32 m0, s43, 65536
  s_add_u32 s49, s49, s48
  v_mfma_f32_32x32x16_bf16 a[128:143], a[72:75], v[212:215], a[128:143]
  s_waitcnt lgkmcnt(8)
  ds_read_b64_tr_b16 a[64:65], v18 offset:16384
  ds_read_b64_tr_b16 a[66:67], v18 offset:16640
  buffer_load_dwordx4 v13, s[16:19], s49 offen offset:0 lds
  v_mfma_f32_32x32x16_bf16 a[144:159], a[76:79], v[212:215], a[144:159]
  s_waitcnt lgkmcnt(8)
  ds_read_b64_tr_b16 a[68:69], v19 offset:16384
  ds_read_b64_tr_b16 a[70:71], v19 offset:16640
  buffer_load_dwordx4 v14, s[16:19], s49 offen offset:1024 lds
  v_mfma_f32_32x32x16_bf16 a[128:143], a[80:83], v[216:219], a[128:143]
  s_waitcnt lgkmcnt(8)
  ds_read_b64_tr_b16 a[72:73], v18 offset:17408
  ds_read_b64_tr_b16 a[74:75], v18 offset:17664
  v_mfma_f32_32x32x16_bf16 a[144:159], a[84:87], v[216:219], a[144:159]
  s_waitcnt lgkmcnt(8)
  ds_read_b64_tr_b16 a[76:77], v19 offset:17408
  ds_read_b64_tr_b16 a[78:79], v19 offset:17664
  v_mfma_f32_32x32x16_bf16 a[128:143], a[88:91], v[220:223], a[128:143]
  s_waitcnt lgkmcnt(8)
  ds_read_b64_tr_b16 a[80:81], v18 offset:20480
  ds_read_b64_tr_b16 a[82:83], v18 offset:20736
  buffer_load_dwordx4 v15, s[20:23], s49 offen offset:2048 lds
  v_mfma_f32_32x32x16_bf16 a[144:159], a[92:95], v[220:223], a[144:159]
  s_waitcnt lgkmcnt(8)
  ds_read_b64_tr_b16 a[84:85], v19 offset:20480
  ds_read_b64_tr_b16 a[86:87], v19 offset:20736
  buffer_load_dwordx4 v16, s[20:23], s49 offen offset:3072 lds
  v_mfma_f32_32x32x16_bf16 a[128:143], a[64:67], v[224:227], a[128:143]
  s_waitcnt lgkmcnt(8)
  ds_read_b64_tr_b16 a[88:89], v18 offset:21504
  ds_read_b64_tr_b16 a[90:91], v18 offset:21760
  s_add_u32 s49, s44, 3
  s_and_b32 s49, s49, 7
  s_mul_i32 s49, s49, 229376
  v_mfma_f32_32x32x16_bf16 a[144:159], a[68:71], v[224:227], a[144:159]
  s_waitcnt lgkmcnt(8)
  ds_read_b64_tr_b16 a[92:93], v19 offset:21504
  ds_read_b64_tr_b16 a[94:95], v19 offset:21760
  s_add_u32 m0, s43, 32768
  s_add_u32 s49, s49, s48
  v_mfma_f32_32x32x16_bf16 a[128:143], a[72:75], v[228:231], a[128:143]
  s_waitcnt lgkmcnt(8)
  ds_read_b64_tr_b16 a[64:65], v18 offset:24576
  ds_read_b64_tr_b16 a[66:67], v18 offset:24832
  buffer_load_dwordx4 v13, s[16:19], s49 offen offset:0 lds
  v_mfma_f32_32x32x16_bf16 a[144:159], a[76:79], v[228:231], a[144:159]
  s_waitcnt lgkmcnt(8)
  ds_read_b64_tr_b16 a[68:69], v19 offset:24576
  ds_read_b64_tr_b16 a[70:71], v19 offset:24832
  buffer_load_dwordx4 v14, s[16:19], s49 offen offset:1024 lds
  v_mfma_f32_32x32x16_bf16 a[128:143], a[80:83], v[232:235], a[128:143]
  s_waitcnt lgkmcnt(8)
  ds_read_b64_tr_b16 a[72:73], v18 offset:25600
  ds_read_b64_tr_b16 a[74:75], v18 offset:25856
  v_mfma_f32_32x32x16_bf16 a[144:159], a[84:87], v[232:235], a[144:159]
  s_waitcnt lgkmcnt(8)
  ds_read_b64_tr_b16 a[76:77], v19 offset:25600
  ds_read_b64_tr_b16 a[78:79], v19 offset:25856
  v_mfma_f32_32x32x16_bf16 a[128:143], a[88:91], v[236:239], a[128:143]
  s_waitcnt lgkmcnt(8)
  ds_read_b64_tr_b16 a[80:81], v18 offset:28672
  ds_read_b64_tr_b16 a[82:83], v18 offset:28928
  buffer_load_dwordx4 v15, s[20:23], s49 offen offset:2048 lds
  v_mfma_f32_32x32x16_bf16 a[144:159], a[92:95], v[236:239], a[144:159]
  s_waitcnt lgkmcnt(8)
  ds_read_b64_tr_b16 a[84:85], v19 offset:28672
  ds_read_b64_tr_b16 a[86:87], v19 offset:28928
  buffer_load_dwordx4 v16, s[20:23], s49 offen offset:3072 lds
  v_mfma_f32_32x32x16_bf16 a[128:143], a[64:67], v[240:243], a[128:143]
  s_waitcnt lgkmcnt(8)
  ds_read_b64_tr_b16 a[88:89], v18 offset:29696
  ds_read_b64_tr_b16 a[90:91], v18 offset:29952
  v_mfma_f32_32x32x16_bf16 a[144:159], a[68:71], v[240:243], a[144:159]
  s_waitcnt lgkmcnt(8)
  ds_read_b64_tr_b16 a[92:93], v19 offset:29696
  ds_read_b64_tr_b16 a[94:95], v19 offset:29952
  v_bfe_u32 v18, v1, 4, 1
  v_lshl_add_u32 v18, v18, 11, v9
  v_add_u32 v18, 122880, v18
  v_xor_b32 v19, 32, v18
  v_xor_b32 v20, 64, v18
  v_xor_b32 v21, 96, v18
  v_mfma_f32_32x32x16_bf16 a[128:143], a[72:75], v[244:247], a[128:143]
  s_waitcnt vmcnt(16) lgkmcnt(8)
  s_barrier
  ds_read_b64_tr_b16 a[64:65], v18 offset:8192
  ds_read_b64_tr_b16 a[66:67], v18 offset:8704
  v_mfma_f32_32x32x16_bf16 a[144:159], a[76:79], v[244:247], a[144:159]
  s_waitcnt lgkmcnt(8)
  ds_read_b64_tr_b16 a[68:69], v19 offset:8192
  ds_read_b64_tr_b16 a[70:71], v19 offset:8704
  v_mfma_f32_32x32x16_bf16 a[128:143], a[80:83], v[248:251], a[128:143]
  s_waitcnt lgkmcnt(8)
  ds_read_b64_tr_b16 a[72:73], v20 offset:8192
  ds_read_b64_tr_b16 a[74:75], v20 offset:8704
  s_add_u32 s49, s44, 4
  s_and_b32 s49, s49, 7
  s_mul_i32 s49, s49, 229376
  v_mfma_f32_32x32x16_bf16 a[144:159], a[84:87], v[248:251], a[144:159]
  s_waitcnt lgkmcnt(8)
  ds_read_b64_tr_b16 a[76:77], v21 offset:8192
  ds_read_b64_tr_b16 a[78:79], v21 offset:8704
  s_add_u32 m0, s43, 49152
  s_add_u32 s49, s49, s48
  v_mfma_f32_32x32x16_bf16 a[128:143], a[88:91], v[252:255], a[128:143]
  s_waitcnt lgkmcnt(8)
  ds_read_b64_tr_b16 a[80:81], v18 offset:12288
  ds_read_b64_tr_b16 a[82:83], v18 offset:12800
  buffer_load_dwordx4 v13, s[16:19], s49 offen offset:0 lds
  v_mfma_f32_32x32x16_bf16 a[144:159], a[92:95], v[252:255], a[144:159]
  s_waitcnt lgkmcnt(8)
  ds_read_b64_tr_b16 a[84:85], v19 offset:12288
  ds_read_b64_tr_b16 a[86:87], v19 offset:12800
  buffer_load_dwordx4 v14, s[16:19], s49 offen offset:1024 lds
  v_mfma_f32_32x32x16_bf16 v[64:79], a[64:67], v[128:131], 0
  s_waitcnt lgkmcnt(8)
  ds_read_b64_tr_b16 a[88:89], v20 offset:12288
  ds_read_b64_tr_b16 a[90:91], v20 offset:12800
  v_mfma_f32_32x32x16_bf16 v[80:95], a[68:71], v[128:131], 0
  s_waitcnt lgkmcnt(8)
  ds_read_b64_tr_b16 a[92:93], v21 offset:12288
  ds_read_b64_tr_b16 a[94:95], v21 offset:12800
  v_mfma_f32_32x32x16_bf16 v[96:111], a[72:75], v[128:131], 0
  s_waitcnt lgkmcnt(8)
  ds_read_b64_tr_b16 a[64:65], v18 offset:16384
  ds_read_b64_tr_b16 a[66:67], v18 offset:16896
  buffer_load_dwordx4 v15, s[20:23], s49 offen offset:2048 lds
  v_mfma_f32_32x32x16_bf16 v[112:127], a[76:79], v[128:131], 0
  s_waitcnt lgkmcnt(8)
  ds_read_b64_tr_b16 a[68:69], v19 offset:16384
  ds_read_b64_tr_b16 a[70:71], v19 offset:16896
  buffer_load_dwordx4 v16, s[20:23], s49 offen offset:3072 lds
  v_mov_b32 v46, s83
  v_mov_b32 v47, s94
  v_mfma_f32_32x32x16_bf16 v[64:79], a[80:83], v[132:135], v[64:79]
  s_waitcnt lgkmcnt(8)
  ds_read_b64_tr_b16 a[72:73], v20 offset:16384
  ds_read_b64_tr_b16 a[74:75], v20 offset:16896
  s_waitcnt vmcnt(12)
  s_mov_b64 exec, 1
  global_store_dword v46, v47, s[38:39] sc1
  s_mov_b64 exec, -1
  v_mfma_f32_32x32x16_bf16 v[80:95], a[84:87], v[132:135], v[80:95]
  s_waitcnt lgkmcnt(8)
  ds_read_b64_tr_b16 a[76:77], v21 offset:16384
  ds_read_b64_tr_b16 a[78:79], v21 offset:16896
  v_accvgpr_read_b32 v22, a128
  v_accvgpr_read_b32 v23, a129
  v_accvgpr_read_b32 v26, a130
  v_accvgpr_read_b32 v27, a131
  v_mfma_f32_32x32x16_bf16 v[96:111], a[88:91], v[132:135], v[96:111]
  s_waitcnt lgkmcnt(8)
  ds_read_b64_tr_b16 a[80:81], v18 offset:20480
  ds_read_b64_tr_b16 a[82:83], v18 offset:20992
  v_mul_f32 v24, v22, v4
  v_mul_f32 v25, v23, v4
  v_mul_f32 v2, v26, v4
  v_mul_f32 v5, v27, v4
  v_mfma_f32_32x32x16_bf16 v[112:127], a[92:95], v[132:135], v[112:127]
  s_waitcnt lgkmcnt(8)
  ds_read_b64_tr_b16 a[84:85], v19 offset:20480
  ds_read_b64_tr_b16 a[86:87], v19 offset:20992
  v_exp_f32 v24, v24
  v_exp_f32 v25, v25
  v_mfma_f32_32x32x16_bf16 v[64:79], a[64:67], v[136:139], v[64:79]
  s_waitcnt lgkmcnt(8)
  ds_read_b64_tr_b16 a[88:89], v20 offset:20480
  ds_read_b64_tr_b16 a[90:91], v20 offset:20992
  s_add_u32 s49, s44, 5
  s_and_b32 s49, s49, 7
  s_mul_i32 s49, s49, 229376
  v_mfma_f32_32x32x16_bf16 v[80:95], a[68:71], v[136:139], v[80:95]
  s_waitcnt lgkmcnt(8)
  ds_read_b64_tr_b16 a[92:93], v21 offset:20480
  ds_read_b64_tr_b16 a[94:95], v21 offset:20992
  v_exp_f32 v2, v2
  s_add_u32 m0, s43, 81920
  s_add_u32 s49, s49, s48
  v_mfma_f32_32x32x16_bf16 v[96:111], a[72:75], v[136:139], v[96:111]
  s_waitcnt lgkmcnt(8)
  ds_read_b64_tr_b16 a[64:65], v18 offset:24576
  ds_read_b64_tr_b16 a[66:67], v18 offset:25088
  buffer_load_dwordx4 v13, s[16:19], s49 offen offset:0 lds
  v_exp_f32 v5, v5
  v_mfma_f32_32x32x16_bf16 v[112:127], a[76:79], v[136:139], v[112:127]
  s_waitcnt lgkmcnt(8)
  ds_read_b64_tr_b16 a[68:69], v19 offset:24576
  ds_read_b64_tr_b16 a[70:71], v19 offset:25088
  buffer_load_dwordx4 v14, s[16:19], s49 offen offset:1024 lds
  v_fma_f32 v24, v24, v6, v6
  v_fma_f32 v25, v25, v6, v6
  v_mfma_f32_32x32x16_bf16 v[64:79], a[80:83], v[140:143], v[64:79]
  s_waitcnt lgkmcnt(8)
  ds_read_b64_tr_b16 a[72:73], v20 offset:24576
  ds_read_b64_tr_b16 a[74:75], v20 offset:25088
  v_fma_f32 v2, v2, v6, v6
  v_fma_f32 v5, v5, v6, v6
  v_rcp_f32 v24, v24
  v_mfma_f32_32x32x16_bf16 v[80:95], a[84:87], v[140:143], v[80:95]
  s_waitcnt lgkmcnt(8)
  ds_read_b64_tr_b16 a[76:77], v21 offset:24576
  ds_read_b64_tr_b16 a[78:79], v21 offset:25088
  v_rcp_f32 v25, v25
  v_rcp_f32 v2, v2
  v_mfma_f32_32x32x16_bf16 v[96:111], a[88:91], v[140:143], v[96:111]
  s_waitcnt lgkmcnt(8)
  ds_read_b64_tr_b16 a[80:81], v18 offset:28672
  ds_read_b64_tr_b16 a[82:83], v18 offset:29184
  buffer_load_dwordx4 v15, s[20:23], s49 offen offset:2048 lds
  v_rcp_f32 v5, v5
  v_mfma_f32_32x32x16_bf16 v[112:127], a[92:95], v[140:143], v[112:127]
  s_waitcnt lgkmcnt(8)
  ds_read_b64_tr_b16 a[84:85], v19 offset:28672
  ds_read_b64_tr_b16 a[86:87], v19 offset:29184
  buffer_load_dwordx4 v16, s[20:23], s49 offen offset:3072 lds
  v_mul_f32 v22, v22, v24
  v_mul_f32 v23, v23, v25
  v_mfma_f32_32x32x16_bf16 v[64:79], a[64:67], v[144:147], v[64:79]
  s_waitcnt lgkmcnt(8)
  ds_read_b64_tr_b16 a[88:89], v20 offset:28672
  ds_read_b64_tr_b16 a[90:91], v20 offset:29184
  v_mul_f32 v26, v26, v2
  s_add_u32 s49, s44, 6
  s_and_b32 s49, s49, 7
  s_mul_i32 s49, s49, 229376
  v_mfma_f32_32x32x16_bf16 v[80:95], a[68:71], v[144:147], v[80:95]
  s_waitcnt lgkmcnt(8)
  ds_read_b64_tr_b16 a[92:93], v21 offset:28672
  ds_read_b64_tr_b16 a[94:95], v21 offset:29184
  v_mul_f32 v27, v27, v5
  v_accvgpr_read_b32 v24, a136
  s_add_u32 m0, s43, 98304
  s_add_u32 s49, s49, s48
  v_mfma_f32_32x32x16_bf16 v[96:111], a[72:75], v[144:147], v[96:111]
  s_waitcnt lgkmcnt(8)
  ds_read_b64_tr_b16 a[64:65], v18 offset:32768
  ds_read_b64_tr_b16 a[66:67], v18 offset:33280
  buffer_load_dwordx4 v13, s[16:19], s49 offen offset:0 lds
  v_accvgpr_read_b32 v25, a137
  v_accvgpr_read_b32 v2, a138
  v_mfma_f32_32x32x16_bf16 v[112:127], a[76:79], v[144:147], v[112:127]
  s_waitcnt lgkmcnt(8)
  ds_read_b64_tr_b16 a[68:69], v19 offset:32768
  ds_read_b64_tr_b16 a[70:71], v19 offset:33280
  buffer_load_dwordx4 v14, s[16:19], s49 offen offset:1024 lds
  v_accvgpr_read_b32 v5, a139
  v_mul_f32 v22, v22, v24
  v_mfma_f32_32x32x16_bf16 v[64:79], a[80:83], v[148:151], v[64:79]
  s_waitcnt lgkmcnt(8)
  ds_read_b64_tr_b16 a[72:73], v20 offset:32768
  ds_read_b64_tr_b16 a[74:75], v20 offset:33280
  v_mul_f32 v23, v23, v25
  v_mul_f32 v26, v26, v2
  v_mul_f32 v27, v27, v5
  v_cvt_pk_bf16_f32 v48, v22, v23
mk_wA3:
  s_cbranch_execz mk_wJ3
  v_mfma_f32_32x32x16_bf16 v[80:95], a[84:87], v[148:151], v[80:95]
  s_waitcnt lgkmcnt(8)
  ds_read_b64_tr_b16 a[76:77], v21 offset:32768
  ds_read_b64_tr_b16 a[78:79], v21 offset:33280
  v_cvt_pk_bf16_f32 v49, v26, v27
  v_accvgpr_read_b32 v22, a132
  v_accvgpr_read_b32 v23, a133
  v_accvgpr_read_b32 v26, a134
  v_mfma_f32_32x32x16_bf16 v[96:111], a[88:91], v[148:151], v[96:111]
  s_waitcnt lgkmcnt(8)
  ds_read_b64_tr_b16 a[80:81], v18 offset:36864
  ds_read_b64_tr_b16 a[82:83], v18 offset:37376
  buffer_load_dwordx4 v15, s[20:23], s49 offen offset:2048 lds
  v_accvgpr_read_b32 v27, a135
  v_mul_f32 v24, v22, v4
  v_mfma_f32_32x32x16_bf16 v[112:127], a[92:95], v[148:151], v[112:127]
  s_waitcnt lgkmcnt(8)
  ds_read_b64_tr_b16 a[84:85], v19 offset:36864
  ds_read_b64_tr_b16 a[86:87], v19 offset:37376
  buffer_load_dwordx4 v16, s[20:23], s49 offen offset:3072 lds
  v_mul_f32 v25, v23, v4
  v_mul_f32 v2, v26, v4
  v_mfma_f32_32x32x16_bf16 v[64:79], a[64:67], v[152:155], v[64:79]
  s_waitcnt lgkmcnt(8)
  ds_read_b64_tr_b16 a[88:89], v20 offset:36864
  ds_read_b64_tr_b16 a[90:91], v20 offset:37376
  v_mul_f32 v5, v27, v4
  s_add_u32 s49, s44, 7
  s_and_b32 s49, s49, 7
  s_mul_i32 s49, s49, 229376
  v_mfma_f32_32x32x16_bf16 v[80:95], a[68:71], v[152:155], v[80:95]
  s_waitcnt lgkmcnt(8)
  ds_read_b64_tr_b16 a[92:93], v21 offset:36864
  ds_read_b64_tr_b16 a[94:95], v21 offset:37376
  s_add_u32 m0, s43, 114688
  s_add_u32 s49, s49, s48
  v_subrev_u32 v18, 61440, v18
  v_subrev_u32 v19, 61440, v19
  v_subrev_u32 v20, 61440, v20
  v_subrev_u32 v21, 61440, v21
  v_mfma_f32_32x32x16_bf16 v[96:111], a[72:75], v[152:155], v[96:111]
  s_waitcnt vmcnt(13) lgkmcnt(8)
  s_barrier
  ds_read_b64_tr_b16 a[64:65], v18 offset:4096
  ds_read_b64_tr_b16 a[66:67], v18 offset:4608
  buffer_load_dwordx4 v13, s[16:19], s49 offen offset:0 lds
  v_mfma_f32_32x32x16_bf16 v[112:127], a[76:79], v[152:155], v[112:127]
  s_waitcnt lgkmcnt(8)
  ds_read_b64_tr_b16 a[68:69], v19 offset:4096
  ds_read_b64_tr_b16 a[70:71], v19 offset:4608
  buffer_load_dwordx4 v14, s[16:19], s49 offen offset:1024 lds
  v_exp_f32 v24, v24
  v_mfma_f32_32x32x16_bf16 v[64:79], a[80:83], v[156:159], v[64:79]
  s_waitcnt lgkmcnt(8)
  ds_read_b64_tr_b16 a[72:73], v20 offset:4096
  ds_read_b64_tr_b16 a[74:75], v20 offset:4608
  v_exp_f32 v25, v25
  v_exp_f32 v2, v2
  v_mfma_f32_32x32x16_bf16 v[80:95], a[84:87], v[156:159], v[80:95]
  s_waitcnt lgkmcnt(8)
  ds_read_b64_tr_b16 a[76:77], v21 offset:4096
  ds_read_b64_tr_b16 a[78:79], v21 offset:4608
  v_exp_f32 v5, v5
  v_fma_f32 v24, v24, v6, v6
  v_fma_f32 v25, v25, v6, v6
  v_mfma_f32_32x32x16_bf16 v[96:111], a[88:91], v[156:159], v[96:111]
  s_waitcnt lgkmcnt(8)
  ds_read_b64_tr_b16 a[80:81], v18 offset:8192
  ds_read_b64_tr_b16 a[82:83], v18 offset:8704
  buffer_load_dwordx4 v15, s[20:23], s49 offen offset:2048 lds
  v_fma_f32 v2, v2, v6, v6
  v_fma_f32 v5, v5, v6, v6
  v_mfma_f32_32x32x16_bf16 v[112:127], a[92:95], v[156:159], v[112:127]
  s_waitcnt lgkmcnt(8)
  ds_read_b64_tr_b16 a[84:85], v19 offset:8192
  ds_read_b64_tr_b16 a[86:87], v19 offset:8704
  buffer_load_dwordx4 v16, s[20:23], s49 offen offset:3072 lds
  v_rcp_f32 v24, v24
  v_mfma_f32_32x32x16_bf16 v[64:79], a[64:67], v[160:163], v[64:79]
  s_waitcnt lgkmcnt(8)
  ds_read_b64_tr_b16 a[88:89], v20 offset:8192
  ds_read_b64_tr_b16 a[90:91], v20 offset:8704
  v_rcp_f32 v25, v25
  v_rcp_f32 v2, v2
  v_mfma_f32_32x32x16_bf16 v[80:95], a[68:71], v[160:163], v[80:95]
  s_waitcnt lgkmcnt(8)
  ds_read_b64_tr_b16 a[92:93], v21 offset:8192
  ds_read_b64_tr_b16 a[94:95], v21 offset:8704
  v_rcp_f32 v5, v5
  v_mul_f32 v22, v22, v24
  v_mul_f32 v23, v23, v25
  v_mfma_f32_32x32x16_bf16 v[96:111], a[72:75], v[160:163], v[96:111]
  s_waitcnt lgkmcnt(8)
  ds_read_b64_tr_b16 a[64:65], v18 offset:12288
  ds_read_b64_tr_b16 a[66:67], v18 offset:12800
  v_mul_f32 v26, v26, v2
  v_mul_f32 v27, v27, v5
  v_accvgpr_read_b32 v24, a140
  v_accvgpr_read_b32 v25, a141
  v_mfma_f32_32x32x16_bf16 v[112:127], a[76:79], v[160:163], v[112:127]
  s_waitcnt lgkmcnt(8)
  ds_read_b64_tr_b16 a[68:69], v19 offset:12288
  ds_read_b64_tr_b16 a[70:71], v19 offset:12800
  v_accvgpr_read_b32 v2, a142
  v_accvgpr_read_b32 v5, a143
  v_mul_f32 v22, v22, v24
  v_mul_f32 v23, v23, v25
  v_mfma_f32_32x32x16_bf16 v[64:79], a[80:83], v[164:167], v[64:79]
  s_waitcnt lgkmcnt(8)
  ds_read_b64_tr_b16 a[72:73], v20 offset:12288
  ds_read_b64_tr_b16 a[74:75], v20 offset:12800
  v_mul_f32 v26, v26, v2
  v_mul_f32 v27, v27, v5
  v_cvt_pk_bf16_f32 v50, v22, v23
  v_cvt_pk_bf16_f32 v51, v26, v27
  v_mfma_f32_32x32x16_bf16 v[80:95], a[84:87], v[164:167], v[80:95]
  s_waitcnt lgkmcnt(8)
  ds_read_b64_tr_b16 a[76:77], v21 offset:12288
  ds_read_b64_tr_b16 a[78:79], v21 offset:12800
  v_accvgpr_read_b32 v22, a144
  v_accvgpr_read_b32 v23, a145
  v_accvgpr_read_b32 v26, a146
  v_accvgpr_read_b32 v27, a147
  v_mfma_f32_32x32x16_bf16 v[96:111], a[88:91], v[164:167], v[96:111]
  s_waitcnt lgkmcnt(8)
  ds_read_b64_tr_b16 a[80:81], v18 offset:16384
  ds_read_b64_tr_b16 a[82:83], v18 offset:16896
  v_mul_f32 v24, v22, v4
  v_mul_f32 v25, v23, v4
  v_mul_f32 v2, v26, v4
  v_mul_f32 v5, v27, v4
  v_mfma_f32_32x32x16_bf16 v[112:127], a[92:95], v[164:167], v[112:127]
  s_waitcnt lgkmcnt(8)
  ds_read_b64_tr_b16 a[84:85], v19 offset:16384
  ds_read_b64_tr_b16 a[86:87], v19 offset:16896
  v_exp_f32 v24, v24
  v_add_u32 v32, s67, v7
  v_add_u32 v33, s70, v7
  v_mfma_f32_32x32x16_bf16 v[64:79], a[64:67], v[168:171], v[64:79]
  s_waitcnt lgkmcnt(8)
  ds_read_b64_tr_b16 a[88:89], v20 offset:16384
  ds_read_b64_tr_b16 a[90:91], v20 offset:16896
  v_exp_f32 v25, v25
  v_exp_f32 v2, v2
  v_mfma_f32_32x32x16_bf16 v[80:95], a[68:71], v[168:171], v[80:95]
  s_waitcnt lgkmcnt(8)
  ds_read_b64_tr_b16 a[92:93], v21 offset:16384
  ds_read_b64_tr_b16 a[94:95], v21 offset:16896
  s_lshr_b32 s57, s2, 3
  s_lshl2_add_u32 s57, s57, s40
  s_lshl_b32 s57, s57, 8
  v_lshl_add_u32 v57, v1, 2, s57
  v_subrev_u32 v18, 61440, v18
  v_subrev_u32 v19, 61440, v19
  v_subrev_u32 v20, 61440, v20
  v_subrev_u32 v21, 61440, v21
  v_mfma_f32_32x32x16_bf16 v[96:111], a[72:75], v[168:171], v[96:111]
  s_waitcnt lgkmcnt(8)
  ds_read_b64_tr_b16 a[64:65], v18 offset:32768
  ds_read_b64_tr_b16 a[66:67], v18 offset:33280
  s_getpc_b64 s[22:23]
mk_pcA:
  s_add_u32 s22, s22, mk_join-mk_pcA
  s_addc_u32 s23, s23, 0
  v_mfma_f32_32x32x16_bf16 v[112:127], a[76:79], v[168:171], v[112:127]
  s_waitcnt lgkmcnt(8)
  ds_read_b64_tr_b16 a[68:69], v19 offset:32768
  ds_read_b64_tr_b16 a[70:71], v19 offset:33280
  global_load_dword v45, v57, s[22:23]
  v_mov_b32 v44, s54
  v_add_u32 v37, s92, v7
  v_mfma_f32_32x32x16_bf16 v[64:79], a[80:83], v[172:175], v[64:79]
  s_waitcnt lgkmcnt(8)
  ds_read_b64_tr_b16 a[72:73], v20 offset:32768
  ds_read_b64_tr_b16 a[74:75], v20 offset:33280
  v_exp_f32 v5, v5
  v_fma_f32 v24, v24, v6, v6
  v_fma_f32 v25, v25, v6, v6
  v_mfma_f32_32x32x16_bf16 v[80:95], a[84:87], v[172:175], v[80:95]
  s_waitcnt lgkmcnt(8)
  ds_read_b64_tr_b16 a[76:77], v21 offset:32768
  ds_read_b64_tr_b16 a[78:79], v21 offset:33280
  v_fma_f32 v2, v2, v6, v6
  v_fma_f32 v5, v5, v6, v6
  v_rcp_f32 v24, v24
  v_mfma_f32_32x32x16_bf16 v[96:111], a[88:91], v[172:175], v[96:111]
  s_waitcnt lgkmcnt(8)
  ds_read_b64_tr_b16 a[80:81], v18 offset:36864
  ds_read_b64_tr_b16 a[82:83], v18 offset:37376
  v_rcp_f32 v25, v25
  v_rcp_f32 v2, v2
  v_mfma_f32_32x32x16_bf16 v[112:127], a[92:95], v[172:175], v[112:127]
  s_waitcnt lgkmcnt(8)
  ds_read_b64_tr_b16 a[84:85], v19 offset:36864
  ds_read_b64_tr_b16 a[86:87], v19 offset:37376
  v_rcp_f32 v5, v5
  v_and_b32 v37, 0xffff, v37
  v_add_u32 v34, s62, v7
  v_mfma_f32_32x32x16_bf16 v[64:79], a[64:67], v[176:179], v[64:79]
  s_waitcnt lgkmcnt(8)
  ds_read_b64_tr_b16 a[88:89], v20 offset:36864
  ds_read_b64_tr_b16 a[90:91], v20 offset:37376
  v_mul_f32 v22, v22, v24
  v_mul_f32 v23, v23, v25
  v_mul_f32 v26, v26, v2
  v_mul_f32 v27, v27, v5
  v_mfma_f32_32x32x16_bf16 v[80:95], a[68:71], v[176:179], v[80:95]
  s_waitcnt lgkmcnt(8)
  ds_read_b64_tr_b16 a[92:93], v21 offset:36864
  ds_read_b64_tr_b16 a[94:95], v21 offset:37376
  v_accvgpr_read_b32 v24, a152
  v_accvgpr_read_b32 v25, a153
  v_accvgpr_read_b32 v2, a154
  v_accvgpr_read_b32 v5, a155
  v_mfma_f32_32x32x16_bf16 v[96:111], a[72:75], v[176:179], v[96:111]
  s_waitcnt lgkmcnt(8)
  ds_read_b64_tr_b16 a[64:65], v18 offset:40960
  ds_read_b64_tr_b16 a[66:67], v18 offset:41472
  v_mul_f32 v22, v22, v24
  v_mul_f32 v23, v23, v25
  v_mul_f32 v26, v26, v2
  v_mul_f32 v27, v27, v5
  v_mfma_f32_32x32x16_bf16 v[112:127], a[76:79], v[176:179], v[112:127]
  s_waitcnt lgkmcnt(8)
  ds_read_b64_tr_b16 a[68:69], v19 offset:40960
  ds_read_b64_tr_b16 a[70:71], v19 offset:41472
  v_cvt_pk_bf16_f32 v52, v22, v23
  v_cvt_pk_bf16_f32 v53, v26, v27
  v_add_u32 v41, s80, v17
  v_add_u32 v38, 16384, v37
  v_mfma_f32_32x32x16_bf16 v[64:79], a[80:83], v[180:183], v[64:79]
  s_waitcnt lgkmcnt(8)
  ds_read_b64_tr_b16 a[72:73], v20 offset:40960
  ds_read_b64_tr_b16 a[74:75], v20 offset:41472
  v_accvgpr_read_b32 v22, a148
  v_accvgpr_read_b32 v23, a149
  v_accvgpr_read_b32 v26, a150
  v_accvgpr_read_b32 v11, a249
  v_mfma_f32_32x32x16_bf16 v[80:95], a[84:87], v[180:183], v[80:95]
  s_waitcnt lgkmcnt(8)
  ds_read_b64_tr_b16 a[76:77], v21 offset:40960
  ds_read_b64_tr_b16 a[78:79], v21 offset:41472
  v_accvgpr_read_b32 v27, a151
  v_mul_f32 v24, v22, v4
  v_mul_f32 v25, v23, v4
  v_mul_f32 v2, v26, v4
  v_mfma_f32_32x32x16_bf16 v[96:111], a[88:91], v[180:183], v[96:111]
  s_waitcnt lgkmcnt(8)
  ds_read_b64_tr_b16 a[80:81], v18 offset:45056
  ds_read_b64_tr_b16 a[82:83], v18 offset:45568
  v_mul_f32 v5, v27, v4
  v_exp_f32 v24, v24
  v_mfma_f32_32x32x16_bf16 v[112:127], a[92:95], v[180:183], v[112:127]
  s_waitcnt lgkmcnt(8)
  ds_read_b64_tr_b16 a[84:85], v19 offset:45056
  ds_read_b64_tr_b16 a[86:87], v19 offset:45568
  v_exp_f32 v25, v25
  v_and_b32 v38, 0xffff, v38
  v_add_u32 v35, s63, v7
  v_mfma_f32_32x32x16_bf16 v[64:79], a[64:67], v[184:187], v[64:79]
  s_waitcnt lgkmcnt(8)
  ds_read_b64_tr_b16 a[88:89], v20 offset:45056
  ds_read_b64_tr_b16 a[90:91], v20 offset:45568
  v_exp_f32 v2, v2
  v_exp_f32 v5, v5
  v_mfma_f32_32x32x16_bf16 v[80:95], a[68:71], v[184:187], v[80:95]
  s_waitcnt lgkmcnt(8)
  ds_read_b64_tr_b16 a[92:93], v21 offset:45056
  ds_read_b64_tr_b16 a[94:95], v21 offset:45568
  global_load_dword v12, v11, s[38:39] sc1
  v_fma_f32 v24, v24, v6, v6
  v_fma_f32 v25, v25, v6, v6
  v_fma_f32 v2, v2, v6, v6
  v_mfma_f32_32x32x16_bf16 v[96:111], a[72:75], v[184:187], v[96:111]
  s_waitcnt vmcnt(2) lgkmcnt(8)
  s_barrier
  ds_read_b64_tr_b16 a[64:65], v18 offset:49152
  ds_read_b64_tr_b16 a[66:67], v18 offset:49664
  v_fma_f32 v5, v5, v6, v6
  v_mfma_f32_32x32x16_bf16 v[112:127], a[76:79], v[184:187], v[112:127]
  s_waitcnt lgkmcnt(8)
  ds_read_b64_tr_b16 a[68:69], v19 offset:49152
  ds_read_b64_tr_b16 a[70:71], v19 offset:49664
  v_rcp_f32 v24, v24
  v_add_u32 v42, s81, v17
  v_add_u32 v39, 32768, v37
  v_mfma_f32_32x32x16_bf16 v[64:79], a[80:83], v[188:191], v[64:79]
  s_waitcnt lgkmcnt(8)
  ds_read_b64_tr_b16 a[72:73], v20 offset:49152
  ds_read_b64_tr_b16 a[74:75], v20 offset:49664
  v_rcp_f32 v25, v25
  v_rcp_f32 v2, v2
  v_mfma_f32_32x32x16_bf16 v[80:95], a[84:87], v[188:191], v[80:95]
  s_waitcnt lgkmcnt(8)
  ds_read_b64_tr_b16 a[76:77], v21 offset:49152
  ds_read_b64_tr_b16 a[78:79], v21 offset:49664
  v_rcp_f32 v5, v5
  v_mul_f32 v22, v22, v24
  v_mul_f32 v23, v23, v25
  v_mfma_f32_32x32x16_bf16 v[96:111], a[88:91], v[188:191], v[96:111]
  s_waitcnt lgkmcnt(8)
  ds_read_b64_tr_b16 a[80:81], v18 offset:53248
  ds_read_b64_tr_b16 a[82:83], v18 offset:53760
  v_mul_f32 v26, v26, v2
  s_lshr_b32 s59, s43, 2
  s_add_u32 s59, s59, 131072
  v_add_u32 v13, s59, v7
  v_mfma_f32_32x32x16_bf16 v[112:127], a[92:95], v[188:191], v[112:127]
  s_waitcnt lgkmcnt(8)
  ds_read_b64_tr_b16 a[84:85], v19 offset:53248
  ds_read_b64_tr_b16 a[86:87], v19 offset:53760
  v_mul_f32 v27, v27, v5
  v_accvgpr_read_b32 v24, a156
  v_and_b32 v39, 0xffff, v39
  v_add_u32 v36, s64, v7
  v_mfma_f32_32x32x16_bf16 v[64:79], a[64:67], v[192:195], v[64:79]
  s_waitcnt lgkmcnt(8)
  ds_read_b64_tr_b16 a[88:89], v20 offset:53248
  ds_read_b64_tr_b16 a[90:91], v20 offset:53760
  ds_write_b128 v13, a[240:243] offset:0
  v_accvgpr_read_b32 v25, a157
  v_mfma_f32_32x32x16_bf16 v[80:95], a[68:71], v[192:195], v[80:95]
  s_waitcnt lgkmcnt(9)
  ds_read_b64_tr_b16 a[92:93], v21 offset:53248
  ds_read_b64_tr_b16 a[94:95], v21 offset:53760
  v_accvgpr_read_b32 v2, a158
  v_accvgpr_read_b32 v5, a159
  v_mul_f32 v22, v22, v24
  v_mul_f32 v23, v23, v25
  v_mfma_f32_32x32x16_bf16 v[96:111], a[72:75], v[192:195], v[96:111]
  s_waitcnt lgkmcnt(9)
  ds_read_b64_tr_b16 a[64:65], v18 offset:57344
  ds_read_b64_tr_b16 a[66:67], v18 offset:57856
  v_mul_f32 v26, v26, v2
  v_mul_f32 v27, v27, v5
  v_cvt_pk_bf16_f32 v54, v22, v23
  v_cvt_pk_bf16_f32 v55, v26, v27
  v_mfma_f32_32x32x16_bf16 v[112:127], a[76:79], v[192:195], v[112:127]
  s_waitcnt lgkmcnt(9)
  ds_read_b64_tr_b16 a[68:69], v19 offset:57344
  ds_read_b64_tr_b16 a[70:71], v19 offset:57856
  v_add_u32 v3, s61, v7
  v_add_u32 v43, s82, v17
  v_add_u32 v40, 49152, v37
  v_mfma_f32_32x32x16_bf16 v[64:79], a[80:83], v[196:199], v[64:79]
  s_waitcnt lgkmcnt(9)
  ds_read_b64_tr_b16 a[72:73], v20 offset:57344
  ds_read_b64_tr_b16 a[74:75], v20 offset:57856
  ds_write_b128 v13, a[240:243] offset:4096
  v_mfma_f32_32x32x16_bf16 v[80:95], a[84:87], v[196:199], v[80:95]
  s_waitcnt lgkmcnt(10)
  ds_read_b64_tr_b16 a[76:77], v21 offset:57344
  ds_read_b64_tr_b16 a[78:79], v21 offset:57856
  v_add_u32 v18, 61440, v18
  v_add_u32 v19, 61440, v19
  v_add_u32 v20, 61440, v20
  v_add_u32 v21, 61440, v21
  v_mfma_f32_32x32x16_bf16 v[96:111], a[88:91], v[196:199], v[96:111]
  s_waitcnt lgkmcnt(9)
  ds_read_b64_tr_b16 a[80:81], v18 offset:0
  ds_read_b64_tr_b16 a[82:83], v18 offset:512
  v_mfma_f32_32x32x16_bf16 v[112:127], a[92:95], v[196:199], v[112:127]
  s_waitcnt lgkmcnt(9)
  ds_read_b64_tr_b16 a[84:85], v19 offset:0
  ds_read_b64_tr_b16 a[86:87], v19 offset:512
  v_and_b32 v40, 0xffff, v40
  v_mfma_f32_32x32x16_bf16 v[64:79], a[64:67], v[200:203], v[64:79]
  s_waitcnt lgkmcnt(9)
  ds_read_b64_tr_b16 a[88:89], v20 offset:0
  ds_read_b64_tr_b16 a[90:91], v20 offset:512
  v_mfma_f32_32x32x16_bf16 v[80:95], a[68:71], v[200:203], v[80:95]
  s_waitcnt lgkmcnt(9)
  ds_read_b64_tr_b16 a[92:93], v21 offset:0
  ds_read_b64_tr_b16 a[94:95], v21 offset:512
  s_add_u32 s80, s38, s68
  s_addc_u32 s81, s39, 0
  v_mfma_f32_32x32x16_bf16 v[96:111], a[72:75], v[200:203], v[96:111]
  s_waitcnt lgkmcnt(8)
  ds_read_b64_tr_b16 a[64:65], v18 offset:20480
  ds_read_b64_tr_b16 a[66:67], v18 offset:20992
  s_add_u32 s82, s38, s69
  s_addc_u32 s83, s39, 0
  v_mfma_f32_32x32x16_bf16 v[112:127], a[76:79], v[200:203], v[112:127]
  s_waitcnt lgkmcnt(8)
  ds_read_b64_tr_b16 a[68:69], v19 offset:20480
  ds_read_b64_tr_b16 a[70:71], v19 offset:20992
  v_mfma_f32_32x32x16_bf16 v[64:79], a[80:83], v[204:207], v[64:79]
  s_waitcnt lgkmcnt(8)
  ds_read_b64_tr_b16 a[72:73], v20 offset:20480
  ds_read_b64_tr_b16 a[74:75], v20 offset:20992
  v_mfma_f32_32x32x16_bf16 v[80:95], a[84:87], v[204:207], v[80:95]
  s_waitcnt lgkmcnt(8)
  ds_read_b64_tr_b16 a[76:77], v21 offset:20480
  ds_read_b64_tr_b16 a[78:79], v21 offset:20992
  v_mfma_f32_32x32x16_bf16 v[96:111], a[88:91], v[204:207], v[96:111]
  s_waitcnt lgkmcnt(8)
  ds_read_b64_tr_b16 a[80:81], v18 offset:24576
  ds_read_b64_tr_b16 a[82:83], v18 offset:25088
  s_add_u32 s12, s38, s72
  s_addc_u32 s13, s39, 0
  v_mfma_f32_32x32x16_bf16 v[112:127], a[92:95], v[204:207], v[112:127]
  s_waitcnt lgkmcnt(8)
  ds_read_b64_tr_b16 a[84:85], v19 offset:24576
  ds_read_b64_tr_b16 a[86:87], v19 offset:25088
  s_add_u32 m0, s43, 0
  v_mfma_f32_32x32x16_bf16 v[64:79], a[64:67], v[208:211], v[64:79]
  s_waitcnt lgkmcnt(8)
  ds_read_b64_tr_b16 a[88:89], v20 offset:24576
  ds_read_b64_tr_b16 a[90:91], v20 offset:25088
  s_waitcnt vmcnt(0)
  v_cmp_ne_u32 vcc, s94, v12
  s_cbranch_vccnz mk_pqA_spin
mk_pqA_ok:
  v_mfma_f32_32x32x16_bf16 v[80:95], a[68:71], v[208:211], v[80:95]
  s_waitcnt lgkmcnt(8)
  ds_read_b64_tr_b16 a[92:93], v21 offset:24576
  ds_read_b64_tr_b16 a[94:95], v21 offset:25088
  global_load_lds_dwordx4 v37, s[80:81] offset:0 sc1
  v_mfma_f32_32x32x16_bf16 v[96:111], a[72:75], v[208:211], v[96:111]
  s_waitcnt lgkmcnt(8)
  ds_read_b64_tr_b16 a[64:65], v18 offset:28672
  ds_read_b64_tr_b16 a[66:67], v18 offset:29184
  s_add_u32 s14, s38, s74
  s_addc_u32 s15, s39, 0
  v_mfma_f32_32x32x16_bf16 v[112:127], a[76:79], v[208:211], v[112:127]
  s_waitcnt lgkmcnt(8)
  ds_read_b64_tr_b16 a[68:69], v19 offset:28672
  ds_read_b64_tr_b16 a[70:71], v19 offset:29184
  v_mfma_f32_32x32x16_bf16 v[64:79], a[80:83], v[212:215], v[64:79]
  s_waitcnt lgkmcnt(8)
  ds_read_b64_tr_b16 a[72:73], v20 offset:28672
  ds_read_b64_tr_b16 a[74:75], v20 offset:29184
  global_load_lds_dwordx4 v37, s[80:81] offset:1024 sc1
  v_mfma_f32_32x32x16_bf16 v[80:95], a[84:87], v[212:215], v[80:95]
  s_waitcnt lgkmcnt(8)
  ds_read_b64_tr_b16 a[76:77], v21 offset:28672
  ds_read_b64_tr_b16 a[78:79], v21 offset:29184
  v_mfma_f32_32x32x16_bf16 v[96:111], a[88:91], v[212:215], v[96:111]
  s_waitcnt lgkmcnt(8)
  ds_read_b64_tr_b16 a[80:81], v18 offset:32768
  ds_read_b64_tr_b16 a[82:83], v18 offset:33280
  s_add_u32 s16, s38, s73
  s_addc_u32 s17, s39, 0
  v_mfma_f32_32x32x16_bf16 v[112:127], a[92:95], v[212:215], v[112:127]
  s_waitcnt lgkmcnt(8)
  ds_read_b64_tr_b16 a[84:85], v19 offset:32768
  ds_read_b64_tr_b16 a[86:87], v19 offset:33280
  global_load_lds_dwordx4 v37, s[80:81] offset:2048 sc1
  v_mfma_f32_32x32x16_bf16 v[64:79], a[64:67], v[216:219], v[64:79]
  s_waitcnt lgkmcnt(8)
  ds_read_b64_tr_b16 a[88:89], v20 offset:32768
  ds_read_b64_tr_b16 a[90:91], v20 offset:33280
  v_mfma_f32_32x32x16_bf16 v[80:95], a[68:71], v[216:219], v[80:95]
  s_waitcnt lgkmcnt(8)
  ds_read_b64_tr_b16 a[92:93], v21 offset:32768
  ds_read_b64_tr_b16 a[94:95], v21 offset:33280
  v_mfma_f32_32x32x16_bf16 v[96:111], a[72:75], v[216:219], v[96:111]
  s_waitcnt lgkmcnt(8)
  ds_read_b64_tr_b16 a[64:65], v18 offset:36864
  ds_read_b64_tr_b16 a[66:67], v18 offset:37376
  global_load_lds_dwordx4 v37, s[80:81] offset:3072 sc1
  s_add_u32 s18, s38, s75
  s_addc_u32 s19, s39, 0
  v_mfma_f32_32x32x16_bf16 v[112:127], a[76:79], v[216:219], v[112:127]
  s_waitcnt lgkmcnt(8)
  ds_read_b64_tr_b16 a[68:69], v19 offset:36864
  ds_read_b64_tr_b16 a[70:71], v19 offset:37376
  v_mfma_f32_32x32x16_bf16 v[64:79], a[80:83], v[220:223], v[64:79]
  s_waitcnt lgkmcnt(8)
  ds_read_b64_tr_b16 a[72:73], v20 offset:36864
  ds_read_b64_tr_b16 a[74:75], v20 offset:37376
  v_mfma_f32_32x32x16_bf16 v[80:95], a[84:87], v[220:223], v[80:95]
  s_waitcnt lgkmcnt(8)
  ds_read_b64_tr_b16 a[76:77], v21 offset:36864
  ds_read_b64_tr_b16 a[78:79], v21 offset:37376
  buffer_load_dwordx4 v[128:131], v7, s[24:27], s70 offen offset:0 sc1
  s_add_u32 m0, s43, 65536
  v_mfma_f32_32x32x16_bf16 v[96:111], a[88:91], v[220:223], v[96:111]
  s_waitcnt lgkmcnt(8)
  ds_read_b64_tr_b16 a[80:81], v18 offset:40960
  ds_read_b64_tr_b16 a[82:83], v18 offset:41472
  s_mul_i32 s56, s40, 20480
  s_add_u32 s56, s56, 32768
  v_mfma_f32_32x32x16_bf16 v[112:127], a[92:95], v[220:223], v[112:127]
  s_waitcnt lgkmcnt(8)
  ds_read_b64_tr_b16 a[84:85], v19 offset:40960
  ds_read_b64_tr_b16 a[86:87], v19 offset:41472
  v_mfma_f32_32x32x16_bf16 v[64:79], a[64:67], v[224:227], v[64:79]
  s_waitcnt lgkmcnt(8)
  ds_read_b64_tr_b16 a[88:89], v20 offset:40960
  ds_read_b64_tr_b16 a[90:91], v20 offset:41472
  v_mfma_f32_32x32x16_bf16 v[80:95], a[68:71], v[224:227], v[80:95]
  s_waitcnt lgkmcnt(8)
  ds_read_b64_tr_b16 a[92:93], v21 offset:40960
  ds_read_b64_tr_b16 a[94:95], v21 offset:41472
  buffer_load_dwordx4 v[132:135], v7, s[24:27], s70 offen offset:1024 sc1
  v_mfma_f32_32x32x16_bf16 v[96:111], a[72:75], v[224:227], v[96:111]
  s_waitcnt lgkmcnt(8)
  ds_read_b64_tr_b16 a[64:65], v18 offset:45056
  ds_read_b64_tr_b16 a[66:67], v18 offset:45568
  v_mfma_f32_32x32x16_bf16 v[112:127], a[76:79], v[224:227], v[112:127]
  s_waitcnt lgkmcnt(8)
  ds_read_b64_tr_b16 a[68:69], v19 offset:45056
  ds_read_b64_tr_b16 a[70:71], v19 offset:45568
  v_mfma_f32_32x32x16_bf16 v[64:79], a[80:83], v[228:231], v[64:79]
  s_waitcnt lgkmcnt(8)
  ds_read_b64_tr_b16 a[72:73], v20 offset:45056
  ds_read_b64_tr_b16 a[74:75], v20 offset:45568
  global_load_lds_dwordx4 v37, s[82:83] offset:0 sc1
  v_mfma_f32_32x32x16_bf16 v[80:95], a[84:87], v[228:231], v[80:95]
  s_waitcnt lgkmcnt(8)
  ds_read_b64_tr_b16 a[76:77], v21 offset:45056
  ds_read_b64_tr_b16 a[78:79], v21 offset:45568
  v_mfma_f32_32x32x16_bf16 v[96:111], a[88:91], v[228:231], v[96:111]
  s_waitcnt lgkmcnt(8)
  ds_read_b64_tr_b16 a[80:81], v18 offset:49152
  ds_read_b64_tr_b16 a[82:83], v18 offset:49664
  v_mfma_f32_32x32x16_bf16 v[112:127], a[92:95], v[228:231], v[112:127]
  s_waitcnt lgkmcnt(8)
  ds_read_b64_tr_b16 a[84:85], v19 offset:49152
  ds_read_b64_tr_b16 a[86:87], v19 offset:49664
  global_load_lds_dwordx4 v37, s[82:83] offset:1024 sc1
  v_mfma_f32_32x32x16_bf16 v[64:79], a[64:67], v[232:235], v[64:79]
  s_waitcnt lgkmcnt(8)
  ds_read_b64_tr_b16 a[88:89], v20 offset:49152
  ds_read_b64_tr_b16 a[90:91], v20 offset:49664
  v_mfma_f32_32x32x16_bf16 v[80:95], a[68:71], v[232:235], v[80:95]
  s_waitcnt lgkmcnt(8)
  ds_read_b64_tr_b16 a[92:93], v21 offset:49152
  ds_read_b64_tr_b16 a[94:95], v21 offset:49664
  v_mfma_f32_32x32x16_bf16 v[96:111], a[72:75], v[232:235], v[96:111]
  s_waitcnt lgkmcnt(8)
  ds_read_b64_tr_b16 a[64:65], v18 offset:53248
  ds_read_b64_tr_b16 a[66:67], v18 offset:53760
  global_load_lds_dwordx4 v37, s[82:83] offset:2048 sc1
  v_mfma_f32_32x32x16_bf16 v[112:127], a[76:79], v[232:235], v[112:127]
  s_waitcnt lgkmcnt(8)
  ds_read_b64_tr_b16 a[68:69], v19 offset:53248
  ds_read_b64_tr_b16 a[70:71], v19 offset:53760
  v_mfma_f32_32x32x16_bf16 v[64:79], a[80:83], v[236:239], v[64:79]
  s_waitcnt lgkmcnt(8)
  ds_read_b64_tr_b16 a[72:73], v20 offset:53248
  ds_read_b64_tr_b16 a[74:75], v20 offset:53760
  v_mfma_f32_32x32x16_bf16 v[80:95], a[84:87], v[236:239], v[80:95]
  s_waitcnt lgkmcnt(8)
  ds_read_b64_tr_b16 a[76:77], v21 offset:53248
  ds_read_b64_tr_b16 a[78:79], v21 offset:53760
  global_load_lds_dwordx4 v37, s[82:83] offset:3072 sc1
  v_mfma_f32_32x32x16_bf16 v[96:111], a[88:91], v[236:239], v[96:111]
  s_waitcnt lgkmcnt(8)
  ds_read_b64_tr_b16 a[80:81], v18 offset:57344
  ds_read_b64_tr_b16 a[82:83], v18 offset:57856
  v_mfma_f32_32x32x16_bf16 v[112:127], a[92:95], v[236:239], v[112:127]
  s_waitcnt lgkmcnt(8)
  ds_read_b64_tr_b16 a[84:85], v19 offset:57344
  ds_read_b64_tr_b16 a[86:87], v19 offset:57856
  v_mfma_f32_32x32x16_bf16 v[64:79], a[64:67], v[240:243], v[64:79]
  s_waitcnt lgkmcnt(8)
  ds_read_b64_tr_b16 a[88:89], v20 offset:57344
  ds_read_b64_tr_b16 a[90:91], v20 offset:57856
  v_mfma_f32_32x32x16_bf16 v[80:95], a[68:71], v[240:243], v[80:95]
  s_waitcnt lgkmcnt(8)
  ds_read_b64_tr_b16 a[92:93], v21 offset:57344
  ds_read_b64_tr_b16 a[94:95], v21 offset:57856
  v_add_u32 v18, 61440, v18
  v_add_u32 v19, 61440, v19
  v_add_u32 v20, 61440, v20
  v_add_u32 v21, 61440, v21
  v_mfma_f32_32x32x16_bf16 v[96:111], a[72:75], v[240:243], v[96:111]
  s_waitcnt lgkmcnt(8)
  ds_read_b64_tr_b16 a[64:65], v18 offset:0
  ds_read_b64_tr_b16 a[66:67], v18 offset:512
  v_mfma_f32_32x32x16_bf16 v[112:127], a[76:79], v[240:243], v[112:127]
  s_waitcnt lgkmcnt(8)
  ds_read_b64_tr_b16 a[68:69], v19 offset:0
  ds_read_b64_tr_b16 a[70:71], v19 offset:512
  v_mfma_f32_32x32x16_bf16 v[64:79], a[80:83], v[244:247], v[64:79]
  s_waitcnt lgkmcnt(8)
  ds_read_b64_tr_b16 a[72:73], v20 offset:0
  ds_read_b64_tr_b16 a[74:75], v20 offset:512
  v_mfma_f32_32x32x16_bf16 v[80:95], a[84:87], v[244:247], v[80:95]
  s_waitcnt lgkmcnt(8)
  ds_read_b64_tr_b16 a[76:77], v21 offset:0
  ds_read_b64_tr_b16 a[78:79], v21 offset:512
  v_mfma_f32_32x32x16_bf16 v[96:111], a[88:91], v[244:247], v[96:111]
  s_waitcnt lgkmcnt(8)
  ds_read_b64_tr_b16 a[80:81], v18 offset:4096
  ds_read_b64_tr_b16 a[82:83], v18 offset:4608
  v_mfma_f32_32x32x16_bf16 v[112:127], a[92:95], v[244:247], v[112:127]
  s_waitcnt lgkmcnt(8)
  ds_read_b64_tr_b16 a[84:85], v19 offset:4096
  ds_read_b64_tr_b16 a[86:87], v19 offset:4608
  v_mfma_f32_32x32x16_bf16 v[64:79], a[64:67], v[248:251], v[64:79]
  s_waitcnt lgkmcnt(8)
  ds_read_b64_tr_b16 a[88:89], v20 offset:4096
  ds_read_b64_tr_b16 a[90:91], v20 offset:4608
  v_mfma_f32_32x32x16_bf16 v[80:95], a[68:71], v[248:251], v[80:95]
  s_waitcnt lgkmcnt(8)
  ds_read_b64_tr_b16 a[92:93], v21 offset:4096
  ds_read_b64_tr_b16 a[94:95], v21 offset:4608
  v_mfma_f32_32x32x16_bf16 v[96:111], a[72:75], v[248:251], v[96:111]
  s_waitcnt lgkmcnt(8)
  v_mfma_f32_32x32x16_bf16 v[112:127], a[76:79], v[248:251], v[112:127]
  s_waitcnt lgkmcnt(6)
  v_mfma_f32_32x32x16_bf16 v[64:79], a[80:83], v[252:255], v[64:79]
  s_waitcnt lgkmcnt(4)
  v_mfma_f32_32x32x16_bf16 v[80:95], a[84:87], v[252:255], v[80:95]
  s_waitcnt lgkmcnt(2)
  v_mfma_f32_32x32x16_bf16 v[96:111], a[88:91], v[252:255], v[96:111]
  s_waitcnt lgkmcnt(0)
  v_mfma_f32_32x32x16_bf16 v[112:127], a[92:95], v[252:255], v[112:127]
  s_waitcnt lgkmcnt(0)
  s_branch mk_join
.p2align 12
mk_join:
mk_wJ0:
  s_cbranch_execz mk_wJ4
  v_accvgpr_read_b32 v241, a244
  v_accvgpr_read_b32 v242, a245
  v_accvgpr_read_b32 v56, a246
  v_accvgpr_read_b32 v58, a247
  v_accvgpr_read_b32 v59, a252
  v_add_u32 v61, 4096, v7
  v_add_u32 v248, 12288, v7
  v_add_u32 v249, 20480, v7
  v_add_u32 v250, 28672, v7
  s_and_b32 s58, s2, 1
  s_lshl_b32 s58, s58, 12
  v_add_u32 v62, s58, v7
  s_lshr_b32 s58, s93, 2
  v_add_u32 v63, s58, v7
  s_nop 3
  v_pk_mul_f32 v[24:25], v[64:65], v[4:5] op_sel_hi:[1,0]
  v_pk_mul_f32 v[26:27], v[66:67], v[4:5] op_sel_hi:[1,0]
  v_pk_mul_f32 v[28:29], v[68:69], v[4:5] op_sel_hi:[1,0]
  v_pk_mul_f32 v[30:31], v[70:71], v[4:5] op_sel_hi:[1,0]
  v_exp_f32 v24, v24
  v_exp_f32 v25, v25
  v_exp_f32 v26, v26
  v_exp_f32 v27, v27
  v_exp_f32 v28, v28
  v_exp_f32 v29, v29
  v_exp_f32 v30, v30
  v_exp_f32 v31, v31
  v_pk_mul_f32 v[72:73], v[64:65], v[72:73]
  v_pk_fma_f32 v[24:25], v[24:25], v[6:7], v[6:7] op_sel_hi:[1,0,0]
  v_pk_fma_f32 v[26:27], v[26:27], v[6:7], v[6:7] op_sel_hi:[1,0,0]
  v_pk_fma_f32 v[28:29], v[28:29], v[6:7], v[6:7] op_sel_hi:[1,0,0]
  v_pk_fma_f32 v[30:31], v[30:31], v[6:7], v[6:7] op_sel_hi:[1,0,0]
  v_rcp_f32 v24, v24
  v_rcp_f32 v25, v25
  v_rcp_f32 v26, v26
  v_rcp_f32 v27, v27
  v_rcp_f32 v28, v28
  v_rcp_f32 v29, v29
  v_rcp_f32 v30, v30
  v_rcp_f32 v31, v31
  v_pk_mul_f32 v[74:75], v[66:67], v[74:75]
  v_pk_mul_f32 v[76:77], v[68:69], v[76:77]
  v_pk_mul_f32 v[78:79], v[70:71], v[78:79]
  v_pk_mul_f32 v[72:73], v[72:73], v[24:25]
  v_pk_mul_f32 v[74:75], v[74:75], v[26:27]
  v_pk_mul_f32 v[76:77], v[76:77], v[28:29]
  v_pk_mul_f32 v[78:79], v[78:79], v[30:31]
  v_cvt_pk_bf16_f32 v64, v72, v73
  v_cvt_pk_bf16_f32 v65, v74, v75
  v_cvt_pk_bf16_f32 v66, v76, v77
  v_cvt_pk_bf16_f32 v67, v78, v79
  v_pk_mul_f32 v[24:25], v[80:81], v[4:5] op_sel_hi:[1,0]
  v_pk_mul_f32 v[26:27], v[82:83], v[4:5] op_sel_hi:[1,0]
  v_pk_mul_f32 v[28:29], v[84:85], v[4:5] op_sel_hi:[1,0]
  v_pk_mul_f32 v[30:31], v[86:87], v[4:5] op_sel_hi:[1,0]
  v_exp_f32 v24, v24
  v_exp_f32 v25, v25
  v_exp_f32 v26, v26
  v_exp_f32 v27, v27
  v_exp_f32 v28, v28
  v_exp_f32 v29, v29
  v_exp_f32 v30, v30
  v_exp_f32 v31, v31
  v_pk_mul_f32 v[88:89], v[80:81], v[88:89]
  v_pk_fma_f32 v[24:25], v[24:25], v[6:7], v[6:7] op_sel_hi:[1,0,0]
  v_pk_fma_f32 v[26:27], v[26:27], v[6:7], v[6:7] op_sel_hi:[1,0,0]
  v_pk_fma_f32 v[28:29], v[28:29], v[6:7], v[6:7] op_sel_hi:[1,0,0]
  v_pk_fma_f32 v[30:31], v[30:31], v[6:7], v[6:7] op_sel_hi:[1,0,0]
  v_rcp_f32 v24, v24
  v_rcp_f32 v25, v25
  v_rcp_f32 v26, v26
  v_rcp_f32 v27, v27
  v_rcp_f32 v28, v28
  v_rcp_f32 v29, v29
  v_rcp_f32 v30, v30
  v_rcp_f32 v31, v31
  v_pk_mul_f32 v[90:91], v[82:83], v[90:91]
  v_pk_mul_f32 v[92:93], v[84:85], v[92:93]
  v_pk_mul_f32 v[94:95], v[86:87], v[94:95]
  v_pk_mul_f32 v[88:89], v[88:89], v[24:25]
  v_pk_mul_f32 v[90:91], v[90:91], v[26:27]
  v_pk_mul_f32 v[92:93], v[92:93], v[28:29]
  v_pk_mul_f32 v[94:95], v[94:95], v[30:31]
  v_cvt_pk_bf16_f32 v80, v88, v89
  v_cvt_pk_bf16_f32 v81, v90, v91
  v_cvt_pk_bf16_f32 v82, v92, v93
  v_cvt_pk_bf16_f32 v83, v94, v95
  v_pk_mul_f32 v[24:25], v[96:97], v[4:5] op_sel_hi:[1,0]
  v_pk_mul_f32 v[26:27], v[98:99], v[4:5] op_sel_hi:[1,0]
  v_pk_mul_f32 v[28:29], v[100:101], v[4:5] op_sel_hi:[1,0]
  v_pk_mul_f32 v[30:31], v[102:103], v[4:5] op_sel_hi:[1,0]
  v_exp_f32 v24, v24
  v_exp_f32 v25, v25
  v_exp_f32 v26, v26
  v_exp_f32 v27, v27
  v_exp_f32 v28, v28
  v_exp_f32 v29, v29
  v_exp_f32 v30, v30
  v_exp_f32 v31, v31
  v_pk_mul_f32 v[104:105], v[96:97], v[104:105]
  v_pk_fma_f32 v[24:25], v[24:25], v[6:7], v[6:7] op_sel_hi:[1,0,0]
  v_pk_fma_f32 v[26:27], v[26:27], v[6:7], v[6:7] op_sel_hi:[1,0,0]
  v_pk_fma_f32 v[28:29], v[28:29], v[6:7], v[6:7] op_sel_hi:[1,0,0]
  v_pk_fma_f32 v[30:31], v[30:31], v[6:7], v[6:7] op_sel_hi:[1,0,0]
  v_rcp_f32 v24, v24
  v_rcp_f32 v25, v25
  v_rcp_f32 v26, v26
  v_rcp_f32 v27, v27
  v_rcp_f32 v28, v28
  v_rcp_f32 v29, v29
  v_rcp_f32 v30, v30
  v_rcp_f32 v31, v31
  v_pk_mul_f32 v[106:107], v[98:99], v[106:107]
  v_pk_mul_f32 v[108:109], v[100:101], v[108:109]
  v_pk_mul_f32 v[110:111], v[102:103], v[110:111]
  v_pk_mul_f32 v[104:105], v[104:105], v[24:25]
  v_pk_mul_f32 v[106:107], v[106:107], v[26:27]
  v_pk_mul_f32 v[108:109], v[108:109], v[28:29]
  v_pk_mul_f32 v[110:111], v[110:111], v[30:31]
  v_cvt_pk_bf16_f32 v96, v104, v105
  v_cvt_pk_bf16_f32 v97, v106, v107
  v_cvt_pk_bf16_f32 v98, v108, v109
  v_cvt_pk_bf16_f32 v99, v110, v111
  v_pk_mul_f32 v[24:25], v[112:113], v[4:5] op_sel_hi:[1,0]
  v_pk_mul_f32 v[26:27], v[114:115], v[4:5] op_sel_hi:[1,0]
  v_pk_mul_f32 v[28:29], v[116:117], v[4:5] op_sel_hi:[1,0]
  v_pk_mul_f32 v[30:31], v[118:119], v[4:5] op_sel_hi:[1,0]
  v_exp_f32 v24, v24
  v_exp_f32 v25, v25
  v_exp_f32 v26, v26
  v_exp_f32 v27, v27
  v_exp_f32 v28, v28
  v_exp_f32 v29, v29
  v_exp_f32 v30, v30
  v_exp_f32 v31, v31
  v_pk_mul_f32 v[120:121], v[112:113], v[120:121]
  v_pk_fma_f32 v[24:25], v[24:25], v[6:7], v[6:7] op_sel_hi:[1,0,0]
  v_pk_fma_f32 v[26:27], v[26:27], v[6:7], v[6:7] op_sel_hi:[1,0,0]
  v_pk_fma_f32 v[28:29], v[28:29], v[6:7], v[6:7] op_sel_hi:[1,0,0]
  v_pk_fma_f32 v[30:31], v[30:31], v[6:7], v[6:7] op_sel_hi:[1,0,0]
  v_rcp_f32 v24, v24
  v_rcp_f32 v25, v25
  v_rcp_f32 v26, v26
  v_rcp_f32 v27, v27
  v_rcp_f32 v28, v28
  v_rcp_f32 v29, v29
  v_rcp_f32 v30, v30
  v_rcp_f32 v31, v31
  v_pk_mul_f32 v[122:123], v[114:115], v[122:123]
  v_pk_mul_f32 v[124:125], v[116:117], v[124:125]
  v_pk_mul_f32 v[126:127], v[118:119], v[126:127]
  v_pk_mul_f32 v[120:121], v[120:121], v[24:25]
  v_pk_mul_f32 v[122:123], v[122:123], v[26:27]
  v_pk_mul_f32 v[124:125], v[124:125], v[28:29]
  v_pk_mul_f32 v[126:127], v[126:127], v[30:31]
  v_cvt_pk_bf16_f32 v112, v120, v121
  v_cvt_pk_bf16_f32 v113, v122, v123
  v_cvt_pk_bf16_f32 v114, v124, v125
  v_cvt_pk_bf16_f32 v115, v126, v127
  v_xor_b32 v57, 4096, v62
  v_add_u32 v56, s76, v56
  s_waitcnt vmcnt(0)
  s_barrier
  ds_read_b128 v[136:139], v7 offset:0
  ds_read_b128 v[140:143], v7 offset:1024
  ds_read_b128 v[144:147], v241 offset:0
  ds_read_b128 v[148:151], v241 offset:512
  s_waitcnt lgkmcnt(3)
  v_mfma_f32_32x32x16_bf16 v[160:175], v[136:139], v[128:131], 0
  s_nop 6
  v_mfma_f32_32x32x16_bf16 v[176:191], v[136:139], v[132:135], 0
  s_waitcnt lgkmcnt(0)
  s_nop 3
  global_store_dwordx4 v33, a[160:163], s[38:39] offset:0 sc1
  v_exp_f32 v160, v160
  v_exp_f32 v161, v161
  v_exp_f32 v162, v162
  v_cvt_pk_bf16_f32 v192, v160, v161
  v_exp_f32 v163, v163
  v_exp_f32 v164, v164
  v_cvt_pk_bf16_f32 v193, v162, v163
  v_exp_f32 v165, v165
  v_exp_f32 v166, v166
  v_cvt_pk_bf16_f32 v194, v164, v165
  v_exp_f32 v167, v167
  v_exp_f32 v168, v168
  v_cvt_pk_bf16_f32 v195, v166, v167
  v_exp_f32 v169, v169
  v_exp_f32 v170, v170
  v_cvt_pk_bf16_f32 v196, v168, v169
  v_exp_f32 v171, v171
  v_exp_f32 v172, v172
  v_cvt_pk_bf16_f32 v197, v170, v171
  v_exp_f32 v173, v173
  v_exp_f32 v174, v174
  v_exp_f32 v175, v175
  v_cvt_pk_bf16_f32 v198, v172, v173
  v_cvt_pk_bf16_f32 v199, v174, v175
  v_mfma_f32_32x32x16_bf16 v[160:175], v[140:143], v[128:131], 0
  ds_read_b128 v[136:139], v7 offset:2048
  global_store_dwordx4 v33, a[160:163], s[38:39] offset:1024 sc1
  v_exp_f32 v176, v176
  v_exp_f32 v177, v177
  v_exp_f32 v178, v178
  v_cvt_pk_bf16_f32 v200, v176, v177
  v_exp_f32 v179, v179
  v_exp_f32 v180, v180
  v_cvt_pk_bf16_f32 v201, v178, v179
  v_exp_f32 v181, v181
  v_mfma_f32_32x32x16_bf16 v[208:223], v[144:147], v[192:195], 0
  ds_read_b128 v[152:155], v241 offset:1024
  v_exp_f32 v182, v182
  v_cvt_pk_bf16_f32 v202, v180, v181
  v_exp_f32 v183, v183
  v_exp_f32 v184, v184
  v_cvt_pk_bf16_f32 v203, v182, v183
  v_exp_f32 v185, v185
  v_exp_f32 v186, v186
  v_cvt_pk_bf16_f32 v204, v184, v185
  v_mfma_f32_32x32x16_bf16 v[208:223], v[148:151], v[196:199], v[208:223]
  ds_read_b128 v[156:159], v241 offset:1536
  v_exp_f32 v187, v187
  v_exp_f32 v188, v188
  v_cvt_pk_bf16_f32 v205, v186, v187
  v_exp_f32 v189, v189
  v_exp_f32 v190, v190
  v_exp_f32 v191, v191
  v_cvt_pk_bf16_f32 v206, v188, v189
  v_cvt_pk_bf16_f32 v207, v190, v191
  v_mfma_f32_32x32x16_bf16 v[176:191], v[140:143], v[132:135], 0
  global_store_dwordx4 v3, v[48:51], s[38:39] offset:0 sc1
  v_exp_f32 v160, v160
  v_exp_f32 v161, v161
  v_exp_f32 v162, v162
  v_cvt_pk_bf16_f32 v192, v160, v161
  v_exp_f32 v163, v163
  v_exp_f32 v164, v164
  v_cvt_pk_bf16_f32 v193, v162, v163
  v_exp_f32 v165, v165
  v_mfma_f32_32x32x16_bf16 v[224:239], v[144:147], v[200:203], 0
  v_exp_f32 v166, v166
  v_cvt_pk_bf16_f32 v194, v164, v165
  v_exp_f32 v167, v167
  v_exp_f32 v168, v168
  v_cvt_pk_bf16_f32 v195, v166, v167
  v_exp_f32 v169, v169
  v_exp_f32 v170, v170
  v_cvt_pk_bf16_f32 v196, v168, v169
  v_mfma_f32_32x32x16_bf16 v[224:239], v[148:151], v[204:207], v[224:239]
  s_waitcnt lgkmcnt(0)
  v_exp_f32 v171, v171
  v_exp_f32 v172, v172
  v_cvt_pk_bf16_f32 v197, v170, v171
  v_exp_f32 v173, v173
  v_exp_f32 v174, v174
  v_exp_f32 v175, v175
  v_cvt_pk_bf16_f32 v198, v172, v173
  v_cvt_pk_bf16_f32 v199, v174, v175
  v_mfma_f32_32x32x16_bf16 v[160:175], v[136:139], v[128:131], 0
  ds_read_b128 v[140:143], v7 offset:3072
  v_exp_f32 v176, v176
  v_exp_f32 v177, v177
  v_exp_f32 v178, v178
  v_cvt_pk_bf16_f32 v200, v176, v177
  v_exp_f32 v179, v179
  v_exp_f32 v180, v180
  v_cvt_pk_bf16_f32 v201, v178, v179
  v_exp_f32 v181, v181
  v_mfma_f32_32x32x16_bf16 v[208:223], v[152:155], v[192:195], v[208:223]
  ds_read_b128 v[144:147], v241 offset:2048
  v_exp_f32 v182, v182
  v_cvt_pk_bf16_f32 v202, v180, v181
  v_exp_f32 v183, v183
  v_exp_f32 v184, v184
  v_cvt_pk_bf16_f32 v203, v182, v183
  v_exp_f32 v185, v185
  v_exp_f32 v186, v186
  v_cvt_pk_bf16_f32 v204, v184, v185
  v_mfma_f32_32x32x16_bf16 v[208:223], v[156:159], v[196:199], v[208:223]
  ds_read_b128 v[148:151], v241 offset:2560
  v_exp_f32 v187, v187
  v_exp_f32 v188, v188
  v_cvt_pk_bf16_f32 v205, v186, v187
  v_exp_f32 v189, v189
  v_exp_f32 v190, v190
  v_exp_f32 v191, v191
  v_cvt_pk_bf16_f32 v206, v188, v189
  v_cvt_pk_bf16_f32 v207, v190, v191
  v_mfma_f32_32x32x16_bf16 v[176:191], v[136:139], v[132:135], 0
  s_add_u32 m0, s43, 16384
  v_exp_f32 v160, v160
  v_exp_f32 v161, v161
  v_exp_f32 v162, v162
  v_cvt_pk_bf16_f32 v192, v160, v161
  v_exp_f32 v163, v163
  v_exp_f32 v164, v164
  v_cvt_pk_bf16_f32 v193, v162, v163
  v_exp_f32 v165, v165
  v_mfma_f32_32x32x16_bf16 v[224:239], v[152:155], v[200:203], v[224:239]
  global_load_lds_dwordx4 v38, s[80:81] offset:0 sc1
  v_exp_f32 v166, v166
  v_cvt_pk_bf16_f32 v194, v164, v165
  v_exp_f32 v167, v167
  v_exp_f32 v168, v168
  v_cvt_pk_bf16_f32 v195, v166, v167
  v_exp_f32 v169, v169
  v_exp_f32 v170, v170
  v_cvt_pk_bf16_f32 v196, v168, v169
  v_mfma_f32_32x32x16_bf16 v[224:239], v[156:159], v[204:207], v[224:239]
  s_waitcnt lgkmcnt(0)
  v_exp_f32 v171, v171
  v_exp_f32 v172, v172
  v_cvt_pk_bf16_f32 v197, v170, v171
  v_exp_f32 v173, v173
  v_exp_f32 v174, v174
  v_exp_f32 v175, v175
  v_cvt_pk_bf16_f32 v198, v172, v173
  v_cvt_pk_bf16_f32 v199, v174, v175
  v_mfma_f32_32x32x16_bf16 v[160:175], v[140:143], v[128:131], 0
  ds_read_b128 v[136:139], v7 offset:4096
  global_load_lds_dwordx4 v38, s[80:81] offset:1024 sc1
  v_exp_f32 v176, v176
  v_exp_f32 v177, v177
  v_exp_f32 v178, v178
  v_cvt_pk_bf16_f32 v200, v176, v177
  v_exp_f32 v179, v179
  v_exp_f32 v180, v180
  v_cvt_pk_bf16_f32 v201, v178, v179
  v_exp_f32 v181, v181
  v_mfma_f32_32x32x16_bf16 v[208:223], v[144:147], v[192:195], v[208:223]
  ds_read_b128 v[152:155], v241 offset:3072
  global_store_dwordx4 v3, v[52:55], s[38:39] offset:1024 sc1
  v_exp_f32 v182, v182
  v_cvt_pk_bf16_f32 v202, v180, v181
  v_exp_f32 v183, v183
  v_exp_f32 v184, v184
  v_cvt_pk_bf16_f32 v203, v182, v183
  v_exp_f32 v185, v185
  v_exp_f32 v186, v186
  v_cvt_pk_bf16_f32 v204, v184, v185
  v_mfma_f32_32x32x16_bf16 v[208:223], v[148:151], v[196:199], v[208:223]
  ds_read_b128 v[156:159], v241 offset:3584
  v_exp_f32 v187, v187
  v_exp_f32 v188, v188
  v_cvt_pk_bf16_f32 v205, v186, v187
  v_exp_f32 v189, v189
  v_exp_f32 v190, v190
  v_exp_f32 v191, v191
  v_cvt_pk_bf16_f32 v206, v188, v189
  v_cvt_pk_bf16_f32 v207, v190, v191
  v_mfma_f32_32x32x16_bf16 v[176:191], v[140:143], v[132:135], 0
  global_load_lds_dwordx4 v38, s[80:81] offset:2048 sc1
  v_exp_f32 v160, v160
  v_exp_f32 v161, v161
  v_exp_f32 v162, v162
  v_cvt_pk_bf16_f32 v192, v160, v161
  v_exp_f32 v163, v163
  v_exp_f32 v164, v164
  v_cvt_pk_bf16_f32 v193, v162, v163
  v_exp_f32 v165, v165
  v_mfma_f32_32x32x16_bf16 v[224:239], v[144:147], v[200:203], v[224:239]
  global_load_lds_dwordx4 v38, s[80:81] offset:3072 sc1
  v_exp_f32 v166, v166
  v_cvt_pk_bf16_f32 v194, v164, v165
  v_exp_f32 v167, v167
  v_exp_f32 v168, v168
  v_cvt_pk_bf16_f32 v195, v166, v167
  v_exp_f32 v169, v169
  v_exp_f32 v170, v170
  v_cvt_pk_bf16_f32 v196, v168, v169
  v_mfma_f32_32x32x16_bf16 v[224:239], v[148:151], v[204:207], v[224:239]
  s_waitcnt lgkmcnt(0)
  v_exp_f32 v171, v171
  v_exp_f32 v172, v172
  v_cvt_pk_bf16_f32 v197, v170, v171
  v_exp_f32 v173, v173
  v_exp_f32 v174, v174
  v_exp_f32 v175, v175
  v_cvt_pk_bf16_f32 v198, v172, v173
  v_cvt_pk_bf16_f32 v199, v174, v175
  v_mfma_f32_32x32x16_bf16 v[160:175], v[136:139], v[128:131], 0
  ds_read_b128 v[140:143], v7 offset:5120
  global_store_dwordx4 v32, v[64:67], s[38:39] offset:0 sc1
  v_exp_f32 v176, v176
  v_exp_f32 v177, v177
  v_exp_f32 v178, v178
  v_cvt_pk_bf16_f32 v200, v176, v177
  v_exp_f32 v179, v179
  v_exp_f32 v180, v180
  v_cvt_pk_bf16_f32 v201, v178, v179
  v_exp_f32 v181, v181
  v_mfma_f32_32x32x16_bf16 v[208:223], v[152:155], v[192:195], v[208:223]
  ds_read_b128 v[144:147], v241 offset:4096
  v_exp_f32 v182, v182
  v_cvt_pk_bf16_f32 v202, v180, v181
  v_exp_f32 v183, v183
  v_exp_f32 v184, v184
  v_cvt_pk_bf16_f32 v203, v182, v183
  v_exp_f32 v185, v185
  v_exp_f32 v186, v186
  v_cvt_pk_bf16_f32 v204, v184, v185
  v_mfma_f32_32x32x16_bf16 v[208:223], v[156:159], v[196:199], v[208:223]
  ds_read_b128 v[148:151], v241 offset:4608
  v_exp_f32 v187, v187
  v_exp_f32 v188, v188
  v_cvt_pk_bf16_f32 v205, v186, v187
  v_exp_f32 v189, v189
  v_exp_f32 v190, v190
  v_exp_f32 v191, v191
  v_cvt_pk_bf16_f32 v206, v188, v189
  v_cvt_pk_bf16_f32 v207, v190, v191
  v_mfma_f32_32x32x16_bf16 v[176:191], v[136:139], v[132:135], 0
  s_add_u32 m0, s43, 81920
  v_exp_f32 v160, v160
  v_exp_f32 v161, v161
  v_exp_f32 v162, v162
  v_cvt_pk_bf16_f32 v192, v160, v161
  v_exp_f32 v163, v163
  v_exp_f32 v164, v164
  v_cvt_pk_bf16_f32 v193, v162, v163
  v_exp_f32 v165, v165
  v_mfma_f32_32x32x16_bf16 v[224:239], v[152:155], v[200:203], v[224:239]
  global_load_lds_dwordx4 v38, s[82:83] offset:0 sc1
  v_exp_f32 v166, v166
  v_cvt_pk_bf16_f32 v194, v164, v165
  v_exp_f32 v167, v167
  v_exp_f32 v168, v168
  v_cvt_pk_bf16_f32 v195, v166, v167
  v_exp_f32 v169, v169
  v_exp_f32 v170, v170
  v_cvt_pk_bf16_f32 v196, v168, v169
  v_mfma_f32_32x32x16_bf16 v[224:239], v[156:159], v[204:207], v[224:239]
  s_waitcnt lgkmcnt(0)
  v_exp_f32 v171, v171
  v_exp_f32 v172, v172
  v_cvt_pk_bf16_f32 v197, v170, v171
  v_exp_f32 v173, v173
  v_exp_f32 v174, v174
  v_exp_f32 v175, v175
  v_cvt_pk_bf16_f32 v198, v172, v173
  v_cvt_pk_bf16_f32 v199, v174, v175
  v_mfma_f32_32x32x16_bf16 v[160:175], v[140:143], v[128:131], 0
  ds_read_b128 v[136:139], v7 offset:6144
  global_load_lds_dwordx4 v38, s[82:83] offset:1024 sc1
  v_exp_f32 v176, v176
  v_exp_f32 v177, v177
  v_exp_f32 v178, v178
  v_cvt_pk_bf16_f32 v200, v176, v177
  v_exp_f32 v179, v179
  v_exp_f32 v180, v180
  v_cvt_pk_bf16_f32 v201, v178, v179
  v_exp_f32 v181, v181
  v_mfma_f32_32x32x16_bf16 v[208:223], v[144:147], v[192:195], v[208:223]
  ds_read_b128 v[152:155], v241 offset:5120
  global_store_dwordx4 v32, v[80:83], s[38:39] offset:1024 sc1
  v_exp_f32 v182, v182
  v_cvt_pk_bf16_f32 v202, v180, v181
  v_exp_f32 v183, v183
  v_exp_f32 v184, v184
  v_cvt_pk_bf16_f32 v203, v182, v183
  v_exp_f32 v185, v185
  v_exp_f32 v186, v186
  v_cvt_pk_bf16_f32 v204, v184, v185
  v_mfma_f32_32x32x16_bf16 v[208:223], v[148:151], v[196:199], v[208:223]
  ds_read_b128 v[156:159], v241 offset:5632
  v_exp_f32 v187, v187
  v_exp_f32 v188, v188
  v_cvt_pk_bf16_f32 v205, v186, v187
  v_exp_f32 v189, v189
  v_exp_f32 v190, v190
  v_exp_f32 v191, v191
  v_cvt_pk_bf16_f32 v206, v188, v189
  v_cvt_pk_bf16_f32 v207, v190, v191
  v_mfma_f32_32x32x16_bf16 v[176:191], v[140:143], v[132:135], 0
  global_load_lds_dwordx4 v38, s[82:83] offset:2048 sc1
  v_exp_f32 v160, v160
  v_exp_f32 v161, v161
  v_exp_f32 v162, v162
  v_cvt_pk_bf16_f32 v192, v160, v161
  v_exp_f32 v163, v163
  v_exp_f32 v164, v164
  v_cvt_pk_bf16_f32 v193, v162, v163
  v_exp_f32 v165, v165
  v_mfma_f32_32x32x16_bf16 v[224:239], v[144:147], v[200:203], v[224:239]
  global_load_lds_dwordx4 v38, s[82:83] offset:3072 sc1
  v_exp_f32 v166, v166
  v_cvt_pk_bf16_f32 v194, v164, v165
  v_exp_f32 v167, v167
  v_exp_f32 v168, v168
  v_cvt_pk_bf16_f32 v195, v166, v167
  v_exp_f32 v169, v169
  v_exp_f32 v170, v170
  v_cvt_pk_bf16_f32 v196, v168, v169
  v_mfma_f32_32x32x16_bf16 v[224:239], v[148:151], v[204:207], v[224:239]
  s_waitcnt lgkmcnt(0)
  v_exp_f32 v171, v171
  v_exp_f32 v172, v172
  v_cvt_pk_bf16_f32 v197, v170, v171
  v_exp_f32 v173, v173
  v_exp_f32 v174, v174
  v_exp_f32 v175, v175
  v_cvt_pk_bf16_f32 v198, v172, v173
  v_cvt_pk_bf16_f32 v199, v174, v175
  v_mfma_f32_32x32x16_bf16 v[160:175], v[136:139], v[128:131], 0
  ds_read_b128 v[140:143], v7 offset:7168
  global_store_dwordx4 v32, v[96:99], s[38:39] offset:2048 sc1
  v_exp_f32 v176, v176
  v_exp_f32 v177, v177
  v_exp_f32 v178, v178
  v_cvt_pk_bf16_f32 v200, v176, v177
  v_exp_f32 v179, v179
  v_exp_f32 v180, v180
  v_cvt_pk_bf16_f32 v201, v178, v179
  v_exp_f32 v181, v181
  v_mfma_f32_32x32x16_bf16 v[208:223], v[152:155], v[192:195], v[208:223]
  ds_read_b128 v[144:147], v241 offset:6144
  v_exp_f32 v182, v182
  v_cvt_pk_bf16_f32 v202, v180, v181
  v_exp_f32 v183, v183
  v_exp_f32 v184, v184
  v_cvt_pk_bf16_f32 v203, v182, v183
  v_exp_f32 v185, v185
  v_exp_f32 v186, v186
  v_cvt_pk_bf16_f32 v204, v184, v185
  v_mfma_f32_32x32x16_bf16 v[208:223], v[156:159], v[196:199], v[208:223]
  ds_read_b128 v[148:151], v241 offset:6656
  v_exp_f32 v187, v187
  v_exp_f32 v188, v188
  v_cvt_pk_bf16_f32 v205, v186, v187
  v_exp_f32 v189, v189
  v_exp_f32 v190, v190
  v_exp_f32 v191, v191
  v_cvt_pk_bf16_f32 v206, v188, v189
  v_cvt_pk_bf16_f32 v207, v190, v191
  v_mfma_f32_32x32x16_bf16 v[176:191], v[136:139], v[132:135], 0
  s_mul_i32 s59, s40, 3072
  v_exp_f32 v160, v160
  v_exp_f32 v161, v161
  v_exp_f32 v162, v162
  v_cvt_pk_bf16_f32 v192, v160, v161
  v_exp_f32 v163, v163
  v_exp_f32 v164, v164
  v_cvt_pk_bf16_f32 v193, v162, v163
  v_exp_f32 v165, v165
  v_mfma_f32_32x32x16_bf16 v[224:239], v[152:155], v[200:203], v[224:239]
  v_exp_f32 v166, v166
  v_cvt_pk_bf16_f32 v194, v164, v165
  v_exp_f32 v167, v167
  v_exp_f32 v168, v168
  v_cvt_pk_bf16_f32 v195, v166, v167
  v_exp_f32 v169, v169
  v_exp_f32 v170, v170
  v_cvt_pk_bf16_f32 v196, v168, v169
  v_mfma_f32_32x32x16_bf16 v[224:239], v[156:159], v[204:207], v[224:239]
  s_waitcnt lgkmcnt(0)
  v_exp_f32 v171, v171
  v_exp_f32 v172, v172
  v_cvt_pk_bf16_f32 v197, v170, v171
  v_exp_f32 v173, v173
  v_exp_f32 v174, v174
  v_exp_f32 v175, v175
  v_cvt_pk_bf16_f32 v198, v172, v173
  v_cvt_pk_bf16_f32 v199, v174, v175
  v_mfma_f32_32x32x16_bf16 v[160:175], v[140:143], v[128:131], 0
  ds_read_b128 v[136:139], v7 offset:8192
  global_store_dwordx4 v32, v[112:115], s[38:39] offset:3072 sc1
  v_exp_f32 v176, v176
  v_exp_f32 v177, v177
  v_exp_f32 v178, v178
  v_cvt_pk_bf16_f32 v200, v176, v177
  v_exp_f32 v179, v179
  v_exp_f32 v180, v180
  v_cvt_pk_bf16_f32 v201, v178, v179
  v_exp_f32 v181, v181
  v_mfma_f32_32x32x16_bf16 v[208:223], v[144:147], v[192:195], v[208:223]
  ds_read_b128 v[152:155], v241 offset:7168
  v_exp_f32 v182, v182
  v_cvt_pk_bf16_f32 v202, v180, v181
  v_exp_f32 v183, v183
  v_exp_f32 v184, v184
  v_cvt_pk_bf16_f32 v203, v182, v183
  v_exp_f32 v185, v185
  v_exp_f32 v186, v186
  v_cvt_pk_bf16_f32 v204, v184, v185
  v_mfma_f32_32x32x16_bf16 v[208:223], v[148:151], v[196:199], v[208:223]
  ds_read_b128 v[156:159], v241 offset:7680
  v_exp_f32 v187, v187
  v_exp_f32 v188, v188
  v_cvt_pk_bf16_f32 v205, v186, v187
  v_exp_f32 v189, v189
  v_exp_f32 v190, v190
  v_exp_f32 v191, v191
  v_cvt_pk_bf16_f32 v206, v188, v189
  v_cvt_pk_bf16_f32 v207, v190, v191
  v_mfma_f32_32x32x16_bf16 v[176:191], v[140:143], v[132:135], 0
  s_add_u32 m0, s59, 139264
  v_exp_f32 v160, v160
  v_exp_f32 v161, v161
  v_exp_f32 v162, v162
  v_cvt_pk_bf16_f32 v192, v160, v161
  v_exp_f32 v163, v163
  v_exp_f32 v164, v164
  v_cvt_pk_bf16_f32 v193, v162, v163
  v_exp_f32 v165, v165
  v_mfma_f32_32x32x16_bf16 v[224:239], v[144:147], v[200:203], v[224:239]
  buffer_load_dwordx4 v41, s[32:35], 0 offen lds
  v_exp_f32 v166, v166
  v_cvt_pk_bf16_f32 v194, v164, v165
  v_exp_f32 v167, v167
  v_exp_f32 v168, v168
  v_cvt_pk_bf16_f32 v195, v166, v167
  v_exp_f32 v169, v169
  v_exp_f32 v170, v170
  v_cvt_pk_bf16_f32 v196, v168, v169
  v_mfma_f32_32x32x16_bf16 v[224:239], v[148:151], v[204:207], v[224:239]
  s_waitcnt lgkmcnt(0)
  s_add_u32 m0, s59, 140288
  v_exp_f32 v171, v171
  v_exp_f32 v172, v172
  v_cvt_pk_bf16_f32 v197, v170, v171
  v_exp_f32 v173, v173
  v_exp_f32 v174, v174
  v_exp_f32 v175, v175
  v_cvt_pk_bf16_f32 v198, v172, v173
  v_cvt_pk_bf16_f32 v199, v174, v175
  v_mfma_f32_32x32x16_bf16 v[160:175], v[136:139], v[128:131], 0
  ds_read_b128 v[140:143], v7 offset:9216
  buffer_load_dwordx4 v42, s[32:35], 0 offen lds
  v_add_u32 v241, v242, v241
  v_exp_f32 v176, v176
  v_exp_f32 v177, v177
  v_exp_f32 v178, v178
  v_cvt_pk_bf16_f32 v200, v176, v177
  v_exp_f32 v179, v179
  v_exp_f32 v180, v180
  v_cvt_pk_bf16_f32 v201, v178, v179
  v_exp_f32 v181, v181
  v_mfma_f32_32x32x16_bf16 v[208:223], v[152:155], v[192:195], v[208:223]
  ds_read_b128 v[144:147], v241 offset:0
  s_add_u32 m0, s59, 141312
  v_exp_f32 v182, v182
  v_cvt_pk_bf16_f32 v202, v180, v181
  v_exp_f32 v183, v183
  v_exp_f32 v184, v184
  v_cvt_pk_bf16_f32 v203, v182, v183
  v_exp_f32 v185, v185
  v_exp_f32 v186, v186
  v_mfma_f32_32x32x16_bf16 v[208:223], v[156:159], v[196:199], v[208:223]
  ds_read_b128 v[148:151], v241 offset:512
  buffer_load_dwordx4 v43, s[4:7], 0 offen lds
  v_cvt_pk_bf16_f32 v204, v184, v185
  v_exp_f32 v187, v187
  v_exp_f32 v188, v188
  v_cvt_pk_bf16_f32 v205, v186, v187
  v_exp_f32 v189, v189
  v_exp_f32 v190, v190
  v_exp_f32 v191, v191
  v_cvt_pk_bf16_f32 v206, v188, v189
  v_cvt_pk_bf16_f32 v207, v190, v191
  v_mfma_f32_32x32x16_bf16 v[176:191], v[136:139], v[132:135], 0
  s_sub_u32 s32, s14, s56
  s_subb_u32 s33, s15, 0
  v_exp_f32 v160, v160
  v_exp_f32 v161, v161
  v_exp_f32 v162, v162
  v_cvt_pk_bf16_f32 v192, v160, v161
  v_exp_f32 v163, v163
  v_exp_f32 v164, v164
  v_cvt_pk_bf16_f32 v193, v162, v163
  v_exp_f32 v165, v165
  v_mfma_f32_32x32x16_bf16 v[224:239], v[152:155], v[200:203], v[224:239]
  v_exp_f32 v166, v166
  v_cvt_pk_bf16_f32 v194, v164, v165
  v_exp_f32 v167, v167
  v_exp_f32 v168, v168
  v_cvt_pk_bf16_f32 v195, v166, v167
  v_exp_f32 v169, v169
  v_exp_f32 v170, v170
  v_cvt_pk_bf16_f32 v196, v168, v169
  v_mfma_f32_32x32x16_bf16 v[224:239], v[156:159], v[204:207], v[224:239]
  s_waitcnt lgkmcnt(0)
  v_exp_f32 v171, v171
  v_exp_f32 v172, v172
  v_cvt_pk_bf16_f32 v197, v170, v171
  v_exp_f32 v173, v173
  v_exp_f32 v174, v174
  v_exp_f32 v175, v175
  v_cvt_pk_bf16_f32 v198, v172, v173
  v_cvt_pk_bf16_f32 v199, v174, v175
  v_mfma_f32_32x32x16_bf16 v[160:175], v[140:143], v[128:131], 0
  ds_read_b128 v[136:139], v7 offset:10240
  v_exp_f32 v176, v176
mk_wJ1:
  s_cbranch_execz mk_wJ5
  v_exp_f32 v177, v177
  v_exp_f32 v178, v178
  v_cvt_pk_bf16_f32 v200, v176, v177
  v_exp_f32 v179, v179
  v_exp_f32 v180, v180
  v_cvt_pk_bf16_f32 v201, v178, v179
  v_exp_f32 v181, v181
  v_mfma_f32_32x32x16_bf16 v[208:223], v[144:147], v[192:195], v[208:223]
  ds_read_b128 v[152:155], v241 offset:1024
  v_exp_f32 v182, v182
  v_cvt_pk_bf16_f32 v202, v180, v181
  v_exp_f32 v183, v183
  v_exp_f32 v184, v184
  v_cvt_pk_bf16_f32 v203, v182, v183
  v_exp_f32 v185, v185
  v_exp_f32 v186, v186
  v_cvt_pk_bf16_f32 v204, v184, v185
  v_mfma_f32_32x32x16_bf16 v[208:223], v[148:151], v[196:199], v[208:223]
  ds_read_b128 v[156:159], v241 offset:1536
  v_exp_f32 v187, v187
  v_exp_f32 v188, v188
  v_cvt_pk_bf16_f32 v205, v186, v187
  v_exp_f32 v189, v189
  v_exp_f32 v190, v190
  v_exp_f32 v191, v191
  v_cvt_pk_bf16_f32 v206, v188, v189
  v_cvt_pk_bf16_f32 v207, v190, v191
  v_mfma_f32_32x32x16_bf16 v[176:191], v[140:143], v[132:135], 0
  s_sub_u32 s34, s18, s56
  s_subb_u32 s35, s19, 0
  v_exp_f32 v160, v160
  v_exp_f32 v161, v161
  v_exp_f32 v162, v162
  v_cvt_pk_bf16_f32 v192, v160, v161
  v_exp_f32 v163, v163
  v_exp_f32 v164, v164
  v_cvt_pk_bf16_f32 v193, v162, v163
  v_exp_f32 v165, v165
  v_mfma_f32_32x32x16_bf16 v[224:239], v[144:147], v[200:203], v[224:239]
  v_exp_f32 v166, v166
  v_cvt_pk_bf16_f32 v194, v164, v165
  v_exp_f32 v167, v167
  v_exp_f32 v168, v168
  v_cvt_pk_bf16_f32 v195, v166, v167
  v_exp_f32 v169, v169
  v_exp_f32 v170, v170
  v_cvt_pk_bf16_f32 v196, v168, v169
  v_mfma_f32_32x32x16_bf16 v[224:239], v[148:151], v[204:207], v[224:239]
  s_waitcnt lgkmcnt(0)
  v_exp_f32 v171, v171
  v_exp_f32 v172, v172
  v_cvt_pk_bf16_f32 v197, v170, v171
  v_exp_f32 v173, v173
  v_exp_f32 v174, v174
  v_exp_f32 v175, v175
  v_cvt_pk_bf16_f32 v198, v172, v173
  v_cvt_pk_bf16_f32 v199, v174, v175
  v_mfma_f32_32x32x16_bf16 v[160:175], v[136:139], v[128:131], 0
  ds_read_b128 v[140:143], v7 offset:11264
  v_exp_f32 v176, v176
  v_exp_f32 v177, v177
  v_exp_f32 v178, v178
  v_cvt_pk_bf16_f32 v200, v176, v177
  v_exp_f32 v179, v179
  v_exp_f32 v180, v180
  v_cvt_pk_bf16_f32 v201, v178, v179
  v_exp_f32 v181, v181
  v_mfma_f32_32x32x16_bf16 v[208:223], v[152:155], v[192:195], v[208:223]
  ds_read_b128 v[144:147], v241 offset:2048
  v_exp_f32 v182, v182
  v_cvt_pk_bf16_f32 v202, v180, v181
  v_exp_f32 v183, v183
  v_exp_f32 v184, v184
  v_cvt_pk_bf16_f32 v203, v182, v183
  v_exp_f32 v185, v185
  v_exp_f32 v186, v186
  v_cvt_pk_bf16_f32 v204, v184, v185
  v_mfma_f32_32x32x16_bf16 v[208:223], v[156:159], v[196:199], v[208:223]
  ds_read_b128 v[148:151], v241 offset:2560
  v_exp_f32 v187, v187
  v_exp_f32 v188, v188
  v_cvt_pk_bf16_f32 v205, v186, v187
  v_exp_f32 v189, v189
  v_exp_f32 v190, v190
  v_exp_f32 v191, v191
  v_cvt_pk_bf16_f32 v206, v188, v189
  v_cvt_pk_bf16_f32 v207, v190, v191
  v_mfma_f32_32x32x16_bf16 v[176:191], v[136:139], v[132:135], 0
  s_add_u32 s4, s38, s71
  s_addc_u32 s5, s39, 0
  v_exp_f32 v160, v160
  v_exp_f32 v161, v161
  v_exp_f32 v162, v162
  v_cvt_pk_bf16_f32 v192, v160, v161
  v_exp_f32 v163, v163
  v_exp_f32 v164, v164
  v_cvt_pk_bf16_f32 v193, v162, v163
  v_exp_f32 v165, v165
  v_mfma_f32_32x32x16_bf16 v[224:239], v[152:155], v[200:203], v[224:239]
  v_exp_f32 v166, v166
  v_cvt_pk_bf16_f32 v194, v164, v165
  v_exp_f32 v167, v167
  v_exp_f32 v168, v168
  v_cvt_pk_bf16_f32 v195, v166, v167
  v_exp_f32 v169, v169
  v_exp_f32 v170, v170
  v_cvt_pk_bf16_f32 v196, v168, v169
  v_mfma_f32_32x32x16_bf16 v[224:239], v[156:159], v[204:207], v[224:239]
  s_waitcnt lgkmcnt(0)
  v_exp_f32 v171, v171
  v_exp_f32 v172, v172
  v_cvt_pk_bf16_f32 v197, v170, v171
  v_exp_f32 v173, v173
  v_exp_f32 v174, v174
  v_exp_f32 v175, v175
  v_cvt_pk_bf16_f32 v198, v172, v173
  v_cvt_pk_bf16_f32 v199, v174, v175
  v_mfma_f32_32x32x16_bf16 v[160:175], v[140:143], v[128:131], 0
  ds_read_b128 v[136:139], v7 offset:12288
  v_exp_f32 v176, v176
  v_exp_f32 v177, v177
  v_exp_f32 v178, v178
  v_cvt_pk_bf16_f32 v200, v176, v177
  v_exp_f32 v179, v179
  v_exp_f32 v180, v180
  v_cvt_pk_bf16_f32 v201, v178, v179
  v_exp_f32 v181, v181
  v_mfma_f32_32x32x16_bf16 v[208:223], v[144:147], v[192:195], v[208:223]
  ds_read_b128 v[152:155], v241 offset:3072
  v_exp_f32 v182, v182
  v_cvt_pk_bf16_f32 v202, v180, v181
  v_exp_f32 v183, v183
  v_exp_f32 v184, v184
  v_cvt_pk_bf16_f32 v203, v182, v183
  v_exp_f32 v185, v185
  v_exp_f32 v186, v186
  v_cvt_pk_bf16_f32 v204, v184, v185
  v_mfma_f32_32x32x16_bf16 v[208:223], v[148:151], v[196:199], v[208:223]
  ds_read_b128 v[156:159], v241 offset:3584
  v_exp_f32 v187, v187
  v_exp_f32 v188, v188
  v_cvt_pk_bf16_f32 v205, v186, v187
  v_exp_f32 v189, v189
  v_exp_f32 v190, v190
  v_exp_f32 v191, v191
  v_cvt_pk_bf16_f32 v206, v188, v189
  v_cvt_pk_bf16_f32 v207, v190, v191
  v_mfma_f32_32x32x16_bf16 v[176:191], v[140:143], v[132:135], 0
  s_add_u32 s6, s38, s55
  s_addc_u32 s7, s39, 0
  v_exp_f32 v160, v160
  v_exp_f32 v161, v161
  v_exp_f32 v162, v162
  v_cvt_pk_bf16_f32 v192, v160, v161
  v_exp_f32 v163, v163
  v_exp_f32 v164, v164
  v_cvt_pk_bf16_f32 v193, v162, v163
  v_exp_f32 v165, v165
  v_mfma_f32_32x32x16_bf16 v[224:239], v[144:147], v[200:203], v[224:239]
  v_exp_f32 v166, v166
  v_cvt_pk_bf16_f32 v194, v164, v165
  v_exp_f32 v167, v167
  v_exp_f32 v168, v168
  v_cvt_pk_bf16_f32 v195, v166, v167
  v_exp_f32 v169, v169
  v_exp_f32 v170, v170
  v_cvt_pk_bf16_f32 v196, v168, v169
  v_mfma_f32_32x32x16_bf16 v[224:239], v[148:151], v[204:207], v[224:239]
  s_waitcnt lgkmcnt(0)
  v_exp_f32 v171, v171
  v_exp_f32 v172, v172
  v_cvt_pk_bf16_f32 v197, v170, v171
  v_exp_f32 v173, v173
  v_exp_f32 v174, v174
  v_exp_f32 v175, v175
  v_cvt_pk_bf16_f32 v198, v172, v173
  v_cvt_pk_bf16_f32 v199, v174, v175
  v_mfma_f32_32x32x16_bf16 v[160:175], v[136:139], v[128:131], 0
  ds_read_b128 v[140:143], v7 offset:13312
  v_exp_f32 v176, v176
  v_exp_f32 v177, v177
  v_exp_f32 v178, v178
  v_cvt_pk_bf16_f32 v200, v176, v177
  v_exp_f32 v179, v179
  v_exp_f32 v180, v180
  v_cvt_pk_bf16_f32 v201, v178, v179
  v_exp_f32 v181, v181
  v_mfma_f32_32x32x16_bf16 v[208:223], v[152:155], v[192:195], v[208:223]
  ds_read_b128 v[144:147], v241 offset:4096
  v_exp_f32 v182, v182
  v_cvt_pk_bf16_f32 v202, v180, v181
  v_exp_f32 v183, v183
  v_exp_f32 v184, v184
  v_cvt_pk_bf16_f32 v203, v182, v183
  v_exp_f32 v185, v185
  v_exp_f32 v186, v186
  v_cvt_pk_bf16_f32 v204, v184, v185
  v_mfma_f32_32x32x16_bf16 v[208:223], v[156:159], v[196:199], v[208:223]
  ds_read_b128 v[148:151], v241 offset:4608
  v_exp_f32 v187, v187
  v_exp_f32 v188, v188
  v_cvt_pk_bf16_f32 v205, v186, v187
  v_exp_f32 v189, v189
  v_exp_f32 v190, v190
  v_exp_f32 v191, v191
  v_cvt_pk_bf16_f32 v206, v188, v189
  v_cvt_pk_bf16_f32 v207, v190, v191
  v_mfma_f32_32x32x16_bf16 v[176:191], v[136:139], v[132:135], 0
  v_exp_f32 v160, v160
  v_exp_f32 v161, v161
  v_exp_f32 v162, v162
  v_cvt_pk_bf16_f32 v192, v160, v161
  v_exp_f32 v163, v163
  v_exp_f32 v164, v164
  v_cvt_pk_bf16_f32 v193, v162, v163
  v_exp_f32 v165, v165
  v_mfma_f32_32x32x16_bf16 v[224:239], v[152:155], v[200:203], v[224:239]
  v_exp_f32 v166, v166
  v_cvt_pk_bf16_f32 v194, v164, v165
  v_exp_f32 v167, v167
  v_exp_f32 v168, v168
  v_cvt_pk_bf16_f32 v195, v166, v167
  v_exp_f32 v169, v169
  v_exp_f32 v170, v170
  v_cvt_pk_bf16_f32 v196, v168, v169
  v_mfma_f32_32x32x16_bf16 v[224:239], v[156:159], v[204:207], v[224:239]
  s_waitcnt lgkmcnt(0)
  v_exp_f32 v171, v171
  v_exp_f32 v172, v172
  v_cvt_pk_bf16_f32 v197, v170, v171
  v_exp_f32 v173, v173
  v_exp_f32 v174, v174
  v_exp_f32 v175, v175
  v_cvt_pk_bf16_f32 v198, v172, v173
  v_cvt_pk_bf16_f32 v199, v174, v175
  v_mfma_f32_32x32x16_bf16 v[160:175], v[140:143], v[128:131], 0
  ds_read_b128 v[136:139], v7 offset:14336
  v_exp_f32 v176, v176
  v_exp_f32 v177, v177
  v_exp_f32 v178, v178
  v_cvt_pk_bf16_f32 v200, v176, v177
  v_exp_f32 v179, v179
  v_exp_f32 v180, v180
  v_cvt_pk_bf16_f32 v201, v178, v179
  v_exp_f32 v181, v181
  v_mfma_f32_32x32x16_bf16 v[208:223], v[144:147], v[192:195], v[208:223]
  ds_read_b128 v[152:155], v241 offset:5120
  v_exp_f32 v182, v182
  v_cvt_pk_bf16_f32 v202, v180, v181
  v_exp_f32 v183, v183
  v_exp_f32 v184, v184
  v_cvt_pk_bf16_f32 v203, v182, v183
  v_exp_f32 v185, v185
  v_exp_f32 v186, v186
  v_cvt_pk_bf16_f32 v204, v184, v185
  v_mfma_f32_32x32x16_bf16 v[208:223], v[148:151], v[196:199], v[208:223]
  ds_read_b128 v[156:159], v241 offset:5632
  v_exp_f32 v187, v187
  v_exp_f32 v188, v188
  v_cvt_pk_bf16_f32 v205, v186, v187
  v_exp_f32 v189, v189
  v_exp_f32 v190, v190
  v_exp_f32 v191, v191
  v_cvt_pk_bf16_f32 v206, v188, v189
  v_cvt_pk_bf16_f32 v207, v190, v191
  v_mfma_f32_32x32x16_bf16 v[176:191], v[140:143], v[132:135], 0
  v_exp_f32 v160, v160
  v_exp_f32 v161, v161
  v_exp_f32 v162, v162
  v_cvt_pk_bf16_f32 v192, v160, v161
  v_exp_f32 v163, v163
  v_exp_f32 v164, v164
  v_cvt_pk_bf16_f32 v193, v162, v163
  v_exp_f32 v165, v165
  v_mfma_f32_32x32x16_bf16 v[224:239], v[144:147], v[200:203], v[224:239]
  v_exp_f32 v166, v166
  v_cvt_pk_bf16_f32 v194, v164, v165
  v_exp_f32 v167, v167
  v_exp_f32 v168, v168
  v_cvt_pk_bf16_f32 v195, v166, v167
  v_exp_f32 v169, v169
  v_exp_f32 v170, v170
  v_cvt_pk_bf16_f32 v196, v168, v169
  v_mfma_f32_32x32x16_bf16 v[224:239], v[148:151], v[204:207], v[224:239]
  s_waitcnt lgkmcnt(0)
  v_exp_f32 v171, v171
  v_exp_f32 v172, v172
  v_cvt_pk_bf16_f32 v197, v170, v171
  v_exp_f32 v173, v173
  v_exp_f32 v174, v174
  v_exp_f32 v175, v175
  v_cvt_pk_bf16_f32 v198, v172, v173
  v_cvt_pk_bf16_f32 v199, v174, v175
  v_mfma_f32_32x32x16_bf16 v[160:175], v[136:139], v[128:131], 0
  ds_read_b128 v[140:143], v7 offset:15360
  v_exp_f32 v176, v176
  v_exp_f32 v177, v177
  v_exp_f32 v178, v178
  v_cvt_pk_bf16_f32 v200, v176, v177
  v_exp_f32 v179, v179
  v_exp_f32 v180, v180
  v_cvt_pk_bf16_f32 v201, v178, v179
  v_exp_f32 v181, v181
  v_mfma_f32_32x32x16_bf16 v[208:223], v[152:155], v[192:195], v[208:223]
  ds_read_b128 v[144:147], v241 offset:6144
  v_exp_f32 v182, v182
  v_cvt_pk_bf16_f32 v202, v180, v181
  v_exp_f32 v183, v183
  v_exp_f32 v184, v184
  v_cvt_pk_bf16_f32 v203, v182, v183
  v_exp_f32 v185, v185
  v_exp_f32 v186, v186
  v_cvt_pk_bf16_f32 v204, v184, v185
  v_mfma_f32_32x32x16_bf16 v[208:223], v[156:159], v[196:199], v[208:223]
  ds_read_b128 v[148:151], v241 offset:6656
  v_exp_f32 v187, v187
  v_exp_f32 v188, v188
  v_cvt_pk_bf16_f32 v205, v186, v187
  v_exp_f32 v189, v189
  v_exp_f32 v190, v190
  v_exp_f32 v191, v191
  v_cvt_pk_bf16_f32 v206, v188, v189
  v_cvt_pk_bf16_f32 v207, v190, v191
  v_mfma_f32_32x32x16_bf16 v[176:191], v[136:139], v[132:135], 0
  s_waitcnt vmcnt(5)
  s_barrier
  v_exp_f32 v160, v160
  v_exp_f32 v161, v161
  v_exp_f32 v162, v162
  v_cvt_pk_bf16_f32 v192, v160, v161
  v_exp_f32 v163, v163
  v_exp_f32 v164, v164
  v_cvt_pk_bf16_f32 v193, v162, v163
  v_exp_f32 v165, v165
  v_mfma_f32_32x32x16_bf16 v[224:239], v[152:155], v[200:203], v[224:239]
  v_exp_f32 v166, v166
  v_cvt_pk_bf16_f32 v194, v164, v165
  v_exp_f32 v167, v167
  v_exp_f32 v168, v168
  v_cvt_pk_bf16_f32 v195, v166, v167
  v_exp_f32 v169, v169
  v_exp_f32 v170, v170
  v_cvt_pk_bf16_f32 v196, v168, v169
  v_mfma_f32_32x32x16_bf16 v[224:239], v[156:159], v[204:207], v[224:239]
  s_waitcnt lgkmcnt(0)
  v_exp_f32 v171, v171
  v_exp_f32 v172, v172
  v_cvt_pk_bf16_f32 v197, v170, v171
  v_exp_f32 v173, v173
  v_exp_f32 v174, v174
  v_exp_f32 v175, v175
  v_cvt_pk_bf16_f32 v198, v172, v173
  v_cvt_pk_bf16_f32 v199, v174, v175
  v_mfma_f32_32x32x16_bf16 v[160:175], v[140:143], v[128:131], 0
  ds_read_b128 v[136:139], v7 offset:16384
  v_exp_f32 v176, v176
  v_exp_f32 v177, v177
  v_exp_f32 v178, v178
  v_cvt_pk_bf16_f32 v200, v176, v177
  v_exp_f32 v179, v179
  v_exp_f32 v180, v180
  v_cvt_pk_bf16_f32 v201, v178, v179
  v_exp_f32 v181, v181
  v_mfma_f32_32x32x16_bf16 v[208:223], v[144:147], v[192:195], v[208:223]
  ds_read_b128 v[152:155], v241 offset:7168
  v_exp_f32 v182, v182
  v_cvt_pk_bf16_f32 v202, v180, v181
  v_exp_f32 v183, v183
  v_exp_f32 v184, v184
  v_cvt_pk_bf16_f32 v203, v182, v183
  v_exp_f32 v185, v185
  v_exp_f32 v186, v186
  v_cvt_pk_bf16_f32 v204, v184, v185
  v_mfma_f32_32x32x16_bf16 v[208:223], v[148:151], v[196:199], v[208:223]
  ds_read_b128 v[156:159], v241 offset:7680
  v_exp_f32 v187, v187
  v_exp_f32 v188, v188
  v_cvt_pk_bf16_f32 v205, v186, v187
  v_exp_f32 v189, v189
  v_exp_f32 v190, v190
  v_exp_f32 v191, v191
  v_cvt_pk_bf16_f32 v206, v188, v189
  v_cvt_pk_bf16_f32 v207, v190, v191
  v_mfma_f32_32x32x16_bf16 v[176:191], v[140:143], v[132:135], 0
  v_exp_f32 v160, v160
  v_exp_f32 v161, v161
  v_exp_f32 v162, v162
  v_cvt_pk_bf16_f32 v192, v160, v161
  v_exp_f32 v163, v163
  v_exp_f32 v164, v164
  v_cvt_pk_bf16_f32 v193, v162, v163
  v_exp_f32 v165, v165
  v_mfma_f32_32x32x16_bf16 v[224:239], v[144:147], v[200:203], v[224:239]
  v_exp_f32 v166, v166
  v_cvt_pk_bf16_f32 v194, v164, v165
  v_exp_f32 v167, v167
  v_exp_f32 v168, v168
  v_cvt_pk_bf16_f32 v195, v166, v167
  v_exp_f32 v169, v169
  v_exp_f32 v170, v170
  v_cvt_pk_bf16_f32 v196, v168, v169
  v_mfma_f32_32x32x16_bf16 v[224:239], v[148:151], v[204:207], v[224:239]
  s_waitcnt lgkmcnt(0)
  v_exp_f32 v171, v171
  v_exp_f32 v172, v172
  v_cvt_pk_bf16_f32 v197, v170, v171
  v_exp_f32 v173, v173
  v_exp_f32 v174, v174
  v_exp_f32 v175, v175
  v_cvt_pk_bf16_f32 v198, v172, v173
  v_cvt_pk_bf16_f32 v199, v174, v175
  v_mfma_f32_32x32x16_bf16 v[160:175], v[136:139], v[128:131], 0
  ds_read_b128 v[140:143], v7 offset:17408
  v_add_u32 v241, v242, v241
  v_exp_f32 v176, v176
  v_exp_f32 v177, v177
  v_exp_f32 v178, v178
  v_cvt_pk_bf16_f32 v200, v176, v177
  v_exp_f32 v179, v179
  v_exp_f32 v180, v180
  v_cvt_pk_bf16_f32 v201, v178, v179
  v_exp_f32 v181, v181
  v_mfma_f32_32x32x16_bf16 v[208:223], v[152:155], v[192:195], v[208:223]
  ds_read_b128 v[144:147], v241 offset:0
  v_exp_f32 v182, v182
  v_cvt_pk_bf16_f32 v202, v180, v181
  v_exp_f32 v183, v183
  v_exp_f32 v184, v184
  v_cvt_pk_bf16_f32 v203, v182, v183
  v_exp_f32 v185, v185
  v_exp_f32 v186, v186
  v_mfma_f32_32x32x16_bf16 v[208:223], v[156:159], v[196:199], v[208:223]
  ds_read_b128 v[148:151], v241 offset:512
  v_cvt_pk_bf16_f32 v204, v184, v185
  v_exp_f32 v187, v187
  v_exp_f32 v188, v188
  v_cvt_pk_bf16_f32 v205, v186, v187
  v_exp_f32 v189, v189
  v_exp_f32 v190, v190
  v_exp_f32 v191, v191
  v_cvt_pk_bf16_f32 v206, v188, v189
  v_cvt_pk_bf16_f32 v207, v190, v191
  v_mfma_f32_32x32x16_bf16 v[176:191], v[136:139], v[132:135], 0
  s_waitcnt vmcnt(0)
  ds_read_b64_tr_b16 a[96:97], v10 offset:0
  ds_read_b64_tr_b16 a[98:99], v10 offset:512
  v_exp_f32 v160, v160
  v_exp_f32 v161, v161
  v_exp_f32 v162, v162
  v_cvt_pk_bf16_f32 v192, v160, v161
  v_exp_f32 v163, v163
  v_exp_f32 v164, v164
  v_cvt_pk_bf16_f32 v193, v162, v163
  v_exp_f32 v165, v165
  v_mfma_f32_32x32x16_bf16 v[224:239], v[152:155], v[200:203], v[224:239]
  ds_read_b64_tr_b16 a[100:101], v10 offset:1024
  ds_read_b64_tr_b16 a[102:103], v10 offset:1536
  v_exp_f32 v166, v166
  v_cvt_pk_bf16_f32 v194, v164, v165
  v_exp_f32 v167, v167
  v_exp_f32 v168, v168
  v_cvt_pk_bf16_f32 v195, v166, v167
  v_exp_f32 v169, v169
  v_exp_f32 v170, v170
  v_cvt_pk_bf16_f32 v196, v168, v169
  v_mfma_f32_32x32x16_bf16 v[224:239], v[156:159], v[204:207], v[224:239]
  s_waitcnt lgkmcnt(4)
  v_exp_f32 v171, v171
  v_exp_f32 v172, v172
  v_cvt_pk_bf16_f32 v197, v170, v171
  v_exp_f32 v173, v173
  v_exp_f32 v174, v174
  v_exp_f32 v175, v175
  v_cvt_pk_bf16_f32 v198, v172, v173
  v_cvt_pk_bf16_f32 v199, v174, v175
  v_mfma_f32_32x32x16_bf16 v[160:175], v[140:143], v[128:131], 0
  ds_read_b128 v[136:139], v7 offset:18432
  ds_read_b64_tr_b16 a[104:105], v10 offset:2048
  ds_read_b64_tr_b16 a[106:107], v10 offset:2560
  v_exp_f32 v176, v176
  v_exp_f32 v177, v177
  v_exp_f32 v178, v178
  v_cvt_pk_bf16_f32 v200, v176, v177
  v_exp_f32 v179, v179
  v_exp_f32 v180, v180
  v_cvt_pk_bf16_f32 v201, v178, v179
  v_exp_f32 v181, v181
  v_mfma_f32_32x32x16_bf16 v[208:223], v[144:147], v[192:195], v[208:223]
  ds_read_b128 v[152:155], v241 offset:1024
  v_exp_f32 v182, v182
  v_cvt_pk_bf16_f32 v202, v180, v181
  v_exp_f32 v183, v183
  v_exp_f32 v184, v184
  v_cvt_pk_bf16_f32 v203, v182, v183
  v_exp_f32 v185, v185
  v_exp_f32 v186, v186
  v_cvt_pk_bf16_f32 v204, v184, v185
  v_mfma_f32_32x32x16_bf16 v[208:223], v[148:151], v[196:199], v[208:223]
  ds_read_b128 v[156:159], v241 offset:1536
  v_exp_f32 v187, v187
  v_exp_f32 v188, v188
  v_cvt_pk_bf16_f32 v205, v186, v187
  v_exp_f32 v189, v189
  v_exp_f32 v190, v190
  v_exp_f32 v191, v191
  v_cvt_pk_bf16_f32 v206, v188, v189
  v_cvt_pk_bf16_f32 v207, v190, v191
  v_mfma_f32_32x32x16_bf16 v[176:191], v[140:143], v[132:135], 0
  s_add_u32 m0, s43, 32768
  v_exp_f32 v160, v160
  v_exp_f32 v161, v161
  v_exp_f32 v162, v162
  v_cvt_pk_bf16_f32 v192, v160, v161
  v_exp_f32 v163, v163
  v_exp_f32 v164, v164
  v_cvt_pk_bf16_f32 v193, v162, v163
  v_exp_f32 v165, v165
  v_mfma_f32_32x32x16_bf16 v[224:239], v[144:147], v[200:203], v[224:239]
  global_load_lds_dwordx4 v39, s[80:81] offset:0 sc1
  v_exp_f32 v166, v166
  v_cvt_pk_bf16_f32 v194, v164, v165
  v_exp_f32 v167, v167
  v_exp_f32 v168, v168
  v_cvt_pk_bf16_f32 v195, v166, v167
  v_exp_f32 v169, v169
  v_exp_f32 v170, v170
  v_cvt_pk_bf16_f32 v196, v168, v169
  v_mfma_f32_32x32x16_bf16 v[224:239], v[148:151], v[204:207], v[224:239]
  s_waitcnt lgkmcnt(0)
  global_load_lds_dwordx4 v39, s[80:81] offset:1024 sc1
  v_exp_f32 v171, v171
  v_exp_f32 v172, v172
  v_cvt_pk_bf16_f32 v197, v170, v171
  v_exp_f32 v173, v173
  v_exp_f32 v174, v174
  v_exp_f32 v175, v175
  v_cvt_pk_bf16_f32 v198, v172, v173
  v_cvt_pk_bf16_f32 v199, v174, v175
  v_mfma_f32_32x32x16_bf16 v[160:175], v[136:139], v[128:131], 0
  ds_read_b128 v[140:143], v7 offset:19456
  global_store_dwordx4 v34, a[96:99], s[38:39] sc1
  v_exp_f32 v176, v176
  v_exp_f32 v177, v177
  v_exp_f32 v178, v178
  v_cvt_pk_bf16_f32 v200, v176, v177
  v_exp_f32 v179, v179
  v_exp_f32 v180, v180
  v_cvt_pk_bf16_f32 v201, v178, v179
  v_exp_f32 v181, v181
  v_mfma_f32_32x32x16_bf16 v[208:223], v[152:155], v[192:195], v[208:223]
  ds_read_b128 v[144:147], v241 offset:2048
  global_store_dwordx4 v35, a[100:103], s[38:39] sc1
  v_exp_f32 v182, v182
  v_cvt_pk_bf16_f32 v202, v180, v181
  v_exp_f32 v183, v183
  v_exp_f32 v184, v184
  v_cvt_pk_bf16_f32 v203, v182, v183
  v_exp_f32 v185, v185
  v_exp_f32 v186, v186
  v_cvt_pk_bf16_f32 v204, v184, v185
  v_mfma_f32_32x32x16_bf16 v[208:223], v[156:159], v[196:199], v[208:223]
  ds_read_b128 v[148:151], v241 offset:2560
  global_store_dwordx4 v36, a[104:107], s[38:39] sc1
  v_exp_f32 v187, v187
  v_exp_f32 v188, v188
  v_cvt_pk_bf16_f32 v205, v186, v187
  v_exp_f32 v189, v189
  v_exp_f32 v190, v190
  v_exp_f32 v191, v191
  v_cvt_pk_bf16_f32 v206, v188, v189
  v_cvt_pk_bf16_f32 v207, v190, v191
  v_mfma_f32_32x32x16_bf16 v[176:191], v[136:139], v[132:135], 0
  global_load_lds_dwordx4 v39, s[80:81] offset:2048 sc1
  v_exp_f32 v160, v160
  v_exp_f32 v161, v161
  v_exp_f32 v162, v162
  v_cvt_pk_bf16_f32 v192, v160, v161
  v_exp_f32 v163, v163
  v_exp_f32 v164, v164
  v_cvt_pk_bf16_f32 v193, v162, v163
  v_exp_f32 v165, v165
  v_mfma_f32_32x32x16_bf16 v[224:239], v[152:155], v[200:203], v[224:239]
  v_exp_f32 v166, v166
  v_cvt_pk_bf16_f32 v194, v164, v165
  v_exp_f32 v167, v167
  v_exp_f32 v168, v168
  v_cvt_pk_bf16_f32 v195, v166, v167
  v_exp_f32 v169, v169
  v_exp_f32 v170, v170
  v_cvt_pk_bf16_f32 v196, v168, v169
  v_mfma_f32_32x32x16_bf16 v[224:239], v[156:159], v[204:207], v[224:239]
  s_waitcnt lgkmcnt(0)
  v_exp_f32 v171, v171
  v_exp_f32 v172, v172
  v_cvt_pk_bf16_f32 v197, v170, v171
  v_exp_f32 v173, v173
  v_exp_f32 v174, v174
  v_exp_f32 v175, v175
  v_cvt_pk_bf16_f32 v198, v172, v173
  v_cvt_pk_bf16_f32 v199, v174, v175
  v_mfma_f32_32x32x16_bf16 v[160:175], v[140:143], v[128:131], 0
  ds_read_b128 v[136:139], v7 offset:20480
  global_load_lds_dwordx4 v39, s[80:81] offset:3072 sc1
  v_exp_f32 v176, v176
  v_exp_f32 v177, v177
  v_exp_f32 v178, v178
  v_cvt_pk_bf16_f32 v200, v176, v177
  v_exp_f32 v179, v179
  v_exp_f32 v180, v180
  v_cvt_pk_bf16_f32 v201, v178, v179
  v_exp_f32 v181, v181
  v_mfma_f32_32x32x16_bf16 v[208:223], v[144:147], v[192:195], v[208:223]
  ds_read_b128 v[152:155], v241 offset:3072
  v_exp_f32 v182, v182
  v_cvt_pk_bf16_f32 v202, v180, v181
  v_exp_f32 v183, v183
  v_exp_f32 v184, v184
  v_cvt_pk_bf16_f32 v203, v182, v183
  v_exp_f32 v185, v185
  v_exp_f32 v186, v186
  v_cvt_pk_bf16_f32 v204, v184, v185
  v_mfma_f32_32x32x16_bf16 v[208:223], v[148:151], v[196:199], v[208:223]
  ds_read_b128 v[156:159], v241 offset:3584
  v_exp_f32 v187, v187
  v_exp_f32 v188, v188
  v_cvt_pk_bf16_f32 v205, v186, v187
  v_exp_f32 v189, v189
  v_exp_f32 v190, v190
  v_exp_f32 v191, v191
  v_cvt_pk_bf16_f32 v206, v188, v189
  v_cvt_pk_bf16_f32 v207, v190, v191
  v_mfma_f32_32x32x16_bf16 v[176:191], v[140:143], v[132:135], 0
  s_add_u32 m0, s43, 98304
  v_exp_f32 v160, v160
  v_exp_f32 v161, v161
  v_exp_f32 v162, v162
  v_cvt_pk_bf16_f32 v192, v160, v161
  v_exp_f32 v163, v163
  v_exp_f32 v164, v164
  v_cvt_pk_bf16_f32 v193, v162, v163
  v_exp_f32 v165, v165
  v_mfma_f32_32x32x16_bf16 v[224:239], v[144:147], v[200:203], v[224:239]
  global_load_lds_dwordx4 v39, s[82:83] offset:0 sc1
  v_exp_f32 v166, v166
  v_cvt_pk_bf16_f32 v194, v164, v165
  v_exp_f32 v167, v167
  v_exp_f32 v168, v168
  v_cvt_pk_bf16_f32 v195, v166, v167
  v_exp_f32 v169, v169
  v_exp_f32 v170, v170
  v_cvt_pk_bf16_f32 v196, v168, v169
  v_mfma_f32_32x32x16_bf16 v[224:239], v[148:151], v[204:207], v[224:239]
  s_waitcnt lgkmcnt(0)
  v_exp_f32 v171, v171
  v_exp_f32 v172, v172
  v_cvt_pk_bf16_f32 v197, v170, v171
  v_exp_f32 v173, v173
  v_exp_f32 v174, v174
  v_exp_f32 v175, v175
  v_cvt_pk_bf16_f32 v198, v172, v173
  v_cvt_pk_bf16_f32 v199, v174, v175
  v_mfma_f32_32x32x16_bf16 v[160:175], v[136:139], v[128:131], 0
  ds_read_b128 v[140:143], v7 offset:21504
  global_load_lds_dwordx4 v39, s[82:83] offset:1024 sc1
  v_exp_f32 v176, v176
  v_exp_f32 v177, v177
  v_exp_f32 v178, v178
  v_cvt_pk_bf16_f32 v200, v176, v177
  v_exp_f32 v179, v179
  v_exp_f32 v180, v180
  v_cvt_pk_bf16_f32 v201, v178, v179
  v_exp_f32 v181, v181
  v_mfma_f32_32x32x16_bf16 v[208:223], v[152:155], v[192:195], v[208:223]
  ds_read_b128 v[144:147], v241 offset:4096
  v_exp_f32 v182, v182
  v_cvt_pk_bf16_f32 v202, v180, v181
  v_exp_f32 v183, v183
  v_exp_f32 v184, v184
  v_cvt_pk_bf16_f32 v203, v182, v183
  v_exp_f32 v185, v185
  v_exp_f32 v186, v186
  v_cvt_pk_bf16_f32 v204, v184, v185
  v_mfma_f32_32x32x16_bf16 v[208:223], v[156:159], v[196:199], v[208:223]
  ds_read_b128 v[148:151], v241 offset:4608
  v_exp_f32 v187, v187
  v_exp_f32 v188, v188
  v_cvt_pk_bf16_f32 v205, v186, v187
  v_exp_f32 v189, v189
  v_exp_f32 v190, v190
  v_exp_f32 v191, v191
  v_cvt_pk_bf16_f32 v206, v188, v189
  v_cvt_pk_bf16_f32 v207, v190, v191
  v_mfma_f32_32x32x16_bf16 v[176:191], v[136:139], v[132:135], 0
  global_load_lds_dwordx4 v39, s[82:83] offset:2048 sc1
  v_exp_f32 v160, v160
  v_exp_f32 v161, v161
  v_exp_f32 v162, v162
  v_cvt_pk_bf16_f32 v192, v160, v161
  v_exp_f32 v163, v163
  v_exp_f32 v164, v164
  v_cvt_pk_bf16_f32 v193, v162, v163
  v_exp_f32 v165, v165
  v_mfma_f32_32x32x16_bf16 v[224:239], v[152:155], v[200:203], v[224:239]
  v_exp_f32 v166, v166
  v_cvt_pk_bf16_f32 v194, v164, v165
  v_exp_f32 v167, v167
  v_exp_f32 v168, v168
  v_cvt_pk_bf16_f32 v195, v166, v167
  v_exp_f32 v169, v169
  v_exp_f32 v170, v170
  v_cvt_pk_bf16_f32 v196, v168, v169
mk_wJ2:
  s_cbranch_execz mk_wJ6
  v_mfma_f32_32x32x16_bf16 v[224:239], v[156:159], v[204:207], v[224:239]
  s_waitcnt lgkmcnt(0)
  v_exp_f32 v171, v171
  v_exp_f32 v172, v172
  v_cvt_pk_bf16_f32 v197, v170, v171
  v_exp_f32 v173, v173
  v_exp_f32 v174, v174
  v_exp_f32 v175, v175
  v_cvt_pk_bf16_f32 v198, v172, v173
  v_cvt_pk_bf16_f32 v199, v174, v175
  v_mfma_f32_32x32x16_bf16 v[160:175], v[140:143], v[128:131], 0
  ds_read_b128 v[136:139], v7 offset:22528
  global_load_lds_dwordx4 v39, s[82:83] offset:3072 sc1
  v_exp_f32 v176, v176
  v_exp_f32 v177, v177
  v_exp_f32 v178, v178
  v_cvt_pk_bf16_f32 v200, v176, v177
  v_exp_f32 v179, v179
  v_exp_f32 v180, v180
  v_cvt_pk_bf16_f32 v201, v178, v179
  v_exp_f32 v181, v181
  v_mfma_f32_32x32x16_bf16 v[208:223], v[144:147], v[192:195], v[208:223]
  ds_read_b128 v[152:155], v241 offset:5120
  v_exp_f32 v182, v182
  v_cvt_pk_bf16_f32 v202, v180, v181
  v_exp_f32 v183, v183
  v_exp_f32 v184, v184
  v_cvt_pk_bf16_f32 v203, v182, v183
  v_exp_f32 v185, v185
  v_exp_f32 v186, v186
  v_cvt_pk_bf16_f32 v204, v184, v185
  v_mfma_f32_32x32x16_bf16 v[208:223], v[148:151], v[196:199], v[208:223]
  ds_read_b128 v[156:159], v241 offset:5632
  v_exp_f32 v187, v187
  v_exp_f32 v188, v188
  v_cvt_pk_bf16_f32 v205, v186, v187
  v_exp_f32 v189, v189
  v_exp_f32 v190, v190
  v_exp_f32 v191, v191
  v_cvt_pk_bf16_f32 v206, v188, v189
  v_cvt_pk_bf16_f32 v207, v190, v191
  v_mfma_f32_32x32x16_bf16 v[176:191], v[140:143], v[132:135], 0
  s_add_u32 m0, s43, 49152
  v_exp_f32 v160, v160
  v_exp_f32 v161, v161
  v_exp_f32 v162, v162
  v_cvt_pk_bf16_f32 v192, v160, v161
  v_exp_f32 v163, v163
  v_exp_f32 v164, v164
  v_cvt_pk_bf16_f32 v193, v162, v163
  v_exp_f32 v165, v165
  v_mfma_f32_32x32x16_bf16 v[224:239], v[144:147], v[200:203], v[224:239]
  global_load_lds_dwordx4 v40, s[80:81] offset:0 sc1
  v_exp_f32 v166, v166
  v_cvt_pk_bf16_f32 v194, v164, v165
  v_exp_f32 v167, v167
  v_exp_f32 v168, v168
  v_cvt_pk_bf16_f32 v195, v166, v167
  v_exp_f32 v169, v169
  v_exp_f32 v170, v170
  v_cvt_pk_bf16_f32 v196, v168, v169
  v_mfma_f32_32x32x16_bf16 v[224:239], v[148:151], v[204:207], v[224:239]
  s_waitcnt lgkmcnt(0)
  v_exp_f32 v171, v171
  v_exp_f32 v172, v172
  v_cvt_pk_bf16_f32 v197, v170, v171
  v_exp_f32 v173, v173
  v_exp_f32 v174, v174
  v_exp_f32 v175, v175
  v_cvt_pk_bf16_f32 v198, v172, v173
  v_cvt_pk_bf16_f32 v199, v174, v175
  v_mfma_f32_32x32x16_bf16 v[160:175], v[136:139], v[128:131], 0
  ds_read_b128 v[140:143], v7 offset:23552
  global_load_lds_dwordx4 v40, s[80:81] offset:1024 sc1
  v_exp_f32 v176, v176
  v_exp_f32 v177, v177
  v_exp_f32 v178, v178
  v_cvt_pk_bf16_f32 v200, v176, v177
  v_exp_f32 v179, v179
  v_exp_f32 v180, v180
  v_cvt_pk_bf16_f32 v201, v178, v179
  v_exp_f32 v181, v181
  v_mfma_f32_32x32x16_bf16 v[208:223], v[152:155], v[192:195], v[208:223]
  ds_read_b128 v[144:147], v241 offset:6144
  v_exp_f32 v182, v182
  v_cvt_pk_bf16_f32 v202, v180, v181
  v_exp_f32 v183, v183
  v_exp_f32 v184, v184
  v_cvt_pk_bf16_f32 v203, v182, v183
  v_exp_f32 v185, v185
  v_exp_f32 v186, v186
  v_cvt_pk_bf16_f32 v204, v184, v185
  v_mfma_f32_32x32x16_bf16 v[208:223], v[156:159], v[196:199], v[208:223]
  ds_read_b128 v[148:151], v241 offset:6656
  v_exp_f32 v187, v187
  v_exp_f32 v188, v188
  v_cvt_pk_bf16_f32 v205, v186, v187
  v_exp_f32 v189, v189
  v_exp_f32 v190, v190
  v_exp_f32 v191, v191
  v_cvt_pk_bf16_f32 v206, v188, v189
  v_cvt_pk_bf16_f32 v207, v190, v191
  v_mfma_f32_32x32x16_bf16 v[176:191], v[136:139], v[132:135], 0
  global_load_lds_dwordx4 v40, s[80:81] offset:2048 sc1
  v_exp_f32 v160, v160
  v_exp_f32 v161, v161
  v_exp_f32 v162, v162
  v_cvt_pk_bf16_f32 v192, v160, v161
  v_exp_f32 v163, v163
  v_exp_f32 v164, v164
  v_cvt_pk_bf16_f32 v193, v162, v163
  v_exp_f32 v165, v165
  v_mfma_f32_32x32x16_bf16 v[224:239], v[152:155], v[200:203], v[224:239]
  v_exp_f32 v166, v166
  v_cvt_pk_bf16_f32 v194, v164, v165
  v_exp_f32 v167, v167
  v_exp_f32 v168, v168
  v_cvt_pk_bf16_f32 v195, v166, v167
  v_exp_f32 v169, v169
  v_exp_f32 v170, v170
  v_cvt_pk_bf16_f32 v196, v168, v169
  v_mfma_f32_32x32x16_bf16 v[224:239], v[156:159], v[204:207], v[224:239]
  s_waitcnt lgkmcnt(0)
  v_exp_f32 v171, v171
  v_exp_f32 v172, v172
  v_cvt_pk_bf16_f32 v197, v170, v171
  v_exp_f32 v173, v173
  v_exp_f32 v174, v174
  v_exp_f32 v175, v175
  v_cvt_pk_bf16_f32 v198, v172, v173
  v_cvt_pk_bf16_f32 v199, v174, v175
  v_mfma_f32_32x32x16_bf16 v[160:175], v[140:143], v[128:131], 0
  ds_read_b128 v[136:139], v7 offset:24576
  global_load_lds_dwordx4 v40, s[80:81] offset:3072 sc1
  v_exp_f32 v176, v176
  v_exp_f32 v177, v177
  v_exp_f32 v178, v178
  v_cvt_pk_bf16_f32 v200, v176, v177
  v_exp_f32 v179, v179
  v_exp_f32 v180, v180
  v_cvt_pk_bf16_f32 v201, v178, v179
  v_exp_f32 v181, v181
  v_mfma_f32_32x32x16_bf16 v[208:223], v[144:147], v[192:195], v[208:223]
  ds_read_b128 v[152:155], v241 offset:7168
  v_exp_f32 v182, v182
  v_cvt_pk_bf16_f32 v202, v180, v181
  v_exp_f32 v183, v183
  v_exp_f32 v184, v184
  v_cvt_pk_bf16_f32 v203, v182, v183
  v_exp_f32 v185, v185
  v_exp_f32 v186, v186
  v_cvt_pk_bf16_f32 v204, v184, v185
  v_mfma_f32_32x32x16_bf16 v[208:223], v[148:151], v[196:199], v[208:223]
  ds_read_b128 v[156:159], v241 offset:7680
  v_exp_f32 v187, v187
  v_exp_f32 v188, v188
  v_cvt_pk_bf16_f32 v205, v186, v187
  v_exp_f32 v189, v189
  v_exp_f32 v190, v190
  v_exp_f32 v191, v191
  v_cvt_pk_bf16_f32 v206, v188, v189
  v_cvt_pk_bf16_f32 v207, v190, v191
  v_mfma_f32_32x32x16_bf16 v[176:191], v[140:143], v[132:135], 0
  s_add_u32 m0, s43, 114688
  v_exp_f32 v160, v160
  v_exp_f32 v161, v161
  v_exp_f32 v162, v162
  v_cvt_pk_bf16_f32 v192, v160, v161
  v_exp_f32 v163, v163
  v_exp_f32 v164, v164
  v_cvt_pk_bf16_f32 v193, v162, v163
  v_exp_f32 v165, v165
  v_mfma_f32_32x32x16_bf16 v[224:239], v[144:147], v[200:203], v[224:239]
  global_load_lds_dwordx4 v40, s[82:83] offset:0 sc1
  v_exp_f32 v166, v166
  v_cvt_pk_bf16_f32 v194, v164, v165
  v_exp_f32 v167, v167
  v_exp_f32 v168, v168
  v_cvt_pk_bf16_f32 v195, v166, v167
  v_exp_f32 v169, v169
  v_exp_f32 v170, v170
  v_cvt_pk_bf16_f32 v196, v168, v169
  v_mfma_f32_32x32x16_bf16 v[224:239], v[148:151], v[204:207], v[224:239]
  s_waitcnt lgkmcnt(0)
  v_exp_f32 v171, v171
  v_exp_f32 v172, v172
  v_cvt_pk_bf16_f32 v197, v170, v171
  v_exp_f32 v173, v173
  v_exp_f32 v174, v174
  v_exp_f32 v175, v175
  v_cvt_pk_bf16_f32 v198, v172, v173
  v_cvt_pk_bf16_f32 v199, v174, v175
  v_mfma_f32_32x32x16_bf16 v[160:175], v[136:139], v[128:131], 0
  ds_read_b128 v[140:143], v7 offset:25600
  global_load_lds_dwordx4 v40, s[82:83] offset:1024 sc1
  v_add_u32 v241, v242, v241
  v_exp_f32 v176, v176
  v_exp_f32 v177, v177
  v_exp_f32 v178, v178
  v_cvt_pk_bf16_f32 v200, v176, v177
  v_exp_f32 v179, v179
  v_exp_f32 v180, v180
  v_cvt_pk_bf16_f32 v201, v178, v179
  v_exp_f32 v181, v181
  v_mfma_f32_32x32x16_bf16 v[208:223], v[152:155], v[192:195], v[208:223]
  ds_read_b128 v[144:147], v241 offset:0
  v_exp_f32 v182, v182
  v_cvt_pk_bf16_f32 v202, v180, v181
  v_exp_f32 v183, v183
  v_exp_f32 v184, v184
  v_cvt_pk_bf16_f32 v203, v182, v183
  v_exp_f32 v185, v185
  v_exp_f32 v186, v186
  v_mfma_f32_32x32x16_bf16 v[208:223], v[156:159], v[196:199], v[208:223]
  ds_read_b128 v[148:151], v241 offset:512
  v_cvt_pk_bf16_f32 v204, v184, v185
  v_exp_f32 v187, v187
  v_exp_f32 v188, v188
  v_cvt_pk_bf16_f32 v205, v186, v187
  v_exp_f32 v189, v189
  v_exp_f32 v190, v190
  v_exp_f32 v191, v191
  v_cvt_pk_bf16_f32 v206, v188, v189
  v_cvt_pk_bf16_f32 v207, v190, v191
  v_mfma_f32_32x32x16_bf16 v[176:191], v[136:139], v[132:135], 0
  global_load_lds_dwordx4 v40, s[82:83] offset:2048 sc1
  v_exp_f32 v160, v160
  v_exp_f32 v161, v161
  v_exp_f32 v162, v162
  v_cvt_pk_bf16_f32 v192, v160, v161
  v_exp_f32 v163, v163
  v_exp_f32 v164, v164
  v_cvt_pk_bf16_f32 v193, v162, v163
  v_exp_f32 v165, v165
  v_mfma_f32_32x32x16_bf16 v[224:239], v[152:155], v[200:203], v[224:239]
  v_exp_f32 v166, v166
  v_cvt_pk_bf16_f32 v194, v164, v165
  v_exp_f32 v167, v167
  v_exp_f32 v168, v168
  v_cvt_pk_bf16_f32 v195, v166, v167
  v_exp_f32 v169, v169
  v_exp_f32 v170, v170
  v_cvt_pk_bf16_f32 v196, v168, v169
  v_mfma_f32_32x32x16_bf16 v[224:239], v[156:159], v[204:207], v[224:239]
  s_waitcnt lgkmcnt(0)
  v_exp_f32 v171, v171
  v_exp_f32 v172, v172
  v_cvt_pk_bf16_f32 v197, v170, v171
  v_exp_f32 v173, v173
  v_exp_f32 v174, v174
  v_exp_f32 v175, v175
  v_cvt_pk_bf16_f32 v198, v172, v173
  v_cvt_pk_bf16_f32 v199, v174, v175
  v_mfma_f32_32x32x16_bf16 v[160:175], v[140:143], v[128:131], 0
  ds_read_b128 v[136:139], v7 offset:26624
  global_load_lds_dwordx4 v40, s[82:83] offset:3072 sc1
  v_exp_f32 v176, v176
  v_exp_f32 v177, v177
  v_exp_f32 v178, v178
  v_cvt_pk_bf16_f32 v200, v176, v177
  v_exp_f32 v179, v179
  v_exp_f32 v180, v180
  v_cvt_pk_bf16_f32 v201, v178, v179
  v_exp_f32 v181, v181
  v_mfma_f32_32x32x16_bf16 v[208:223], v[144:147], v[192:195], v[208:223]
  ds_read_b128 v[152:155], v241 offset:1024
  v_exp_f32 v182, v182
  v_cvt_pk_bf16_f32 v202, v180, v181
  v_exp_f32 v183, v183
  v_exp_f32 v184, v184
  v_cvt_pk_bf16_f32 v203, v182, v183
  v_exp_f32 v185, v185
  v_exp_f32 v186, v186
  v_cvt_pk_bf16_f32 v204, v184, v185
  v_mfma_f32_32x32x16_bf16 v[208:223], v[148:151], v[196:199], v[208:223]
  ds_read_b128 v[156:159], v241 offset:1536
  v_exp_f32 v187, v187
  v_exp_f32 v188, v188
  v_cvt_pk_bf16_f32 v205, v186, v187
  v_exp_f32 v189, v189
  v_exp_f32 v190, v190
  v_exp_f32 v191, v191
  v_cvt_pk_bf16_f32 v206, v188, v189
  v_cvt_pk_bf16_f32 v207, v190, v191
  v_mfma_f32_32x32x16_bf16 v[176:191], v[140:143], v[132:135], 0
  s_waitcnt vmcnt(14)
  s_mov_b64 exec, 1
  global_store_dword v44, v47, s[38:39] sc1
  s_mov_b64 exec, -1
  v_exp_f32 v160, v160
  v_exp_f32 v161, v161
  v_exp_f32 v162, v162
  v_cvt_pk_bf16_f32 v192, v160, v161
  v_exp_f32 v163, v163
  v_exp_f32 v164, v164
  v_cvt_pk_bf16_f32 v193, v162, v163
  v_exp_f32 v165, v165
  v_mfma_f32_32x32x16_bf16 v[224:239], v[144:147], v[200:203], v[224:239]
  v_exp_f32 v166, v166
  v_cvt_pk_bf16_f32 v194, v164, v165
  v_exp_f32 v167, v167
  v_exp_f32 v168, v168
  v_cvt_pk_bf16_f32 v195, v166, v167
  v_exp_f32 v169, v169
  v_exp_f32 v170, v170
  v_cvt_pk_bf16_f32 v196, v168, v169
  v_mfma_f32_32x32x16_bf16 v[224:239], v[148:151], v[204:207], v[224:239]
  s_waitcnt lgkmcnt(0)
  v_exp_f32 v171, v171
  v_exp_f32 v172, v172
  v_cvt_pk_bf16_f32 v197, v170, v171
  v_exp_f32 v173, v173
  v_exp_f32 v174, v174
  v_exp_f32 v175, v175
  v_cvt_pk_bf16_f32 v198, v172, v173
  v_cvt_pk_bf16_f32 v199, v174, v175
  v_mfma_f32_32x32x16_bf16 v[160:175], v[136:139], v[128:131], 0
  ds_read_b128 v[140:143], v7 offset:27648
  v_exp_f32 v176, v176
  v_exp_f32 v177, v177
  v_exp_f32 v178, v178
  v_cvt_pk_bf16_f32 v200, v176, v177
  v_exp_f32 v179, v179
  v_exp_f32 v180, v180
  v_cvt_pk_bf16_f32 v201, v178, v179
  v_exp_f32 v181, v181
  v_mfma_f32_32x32x16_bf16 v[208:223], v[152:155], v[192:195], v[208:223]
  ds_read_b128 v[144:147], v241 offset:2048
  v_exp_f32 v182, v182
  v_cvt_pk_bf16_f32 v202, v180, v181
  v_exp_f32 v183, v183
  v_exp_f32 v184, v184
  v_cvt_pk_bf16_f32 v203, v182, v183
  v_exp_f32 v185, v185
  v_exp_f32 v186, v186
  v_cvt_pk_bf16_f32 v204, v184, v185
  v_mfma_f32_32x32x16_bf16 v[208:223], v[156:159], v[196:199], v[208:223]
  ds_read_b128 v[148:151], v241 offset:2560
  v_exp_f32 v187, v187
  v_exp_f32 v188, v188
  v_cvt_pk_bf16_f32 v205, v186, v187
  v_exp_f32 v189, v189
  v_exp_f32 v190, v190
  v_exp_f32 v191, v191
  v_cvt_pk_bf16_f32 v206, v188, v189
  v_cvt_pk_bf16_f32 v207, v190, v191
  v_mfma_f32_32x32x16_bf16 v[176:191], v[136:139], v[132:135], 0
  v_exp_f32 v160, v160
  v_exp_f32 v161, v161
  v_exp_f32 v162, v162
  v_cvt_pk_bf16_f32 v192, v160, v161
  v_exp_f32 v163, v163
  v_exp_f32 v164, v164
  v_cvt_pk_bf16_f32 v193, v162, v163
  v_exp_f32 v165, v165
  v_mfma_f32_32x32x16_bf16 v[224:239], v[152:155], v[200:203], v[224:239]
  v_exp_f32 v166, v166
  v_cvt_pk_bf16_f32 v194, v164, v165
  v_exp_f32 v167, v167
  v_exp_f32 v168, v168
  v_cvt_pk_bf16_f32 v195, v166, v167
  v_exp_f32 v169, v169
  v_exp_f32 v170, v170
  v_cvt_pk_bf16_f32 v196, v168, v169
  v_mfma_f32_32x32x16_bf16 v[224:239], v[156:159], v[204:207], v[224:239]
  s_waitcnt lgkmcnt(0)
  v_exp_f32 v171, v171
  v_exp_f32 v172, v172
  v_cvt_pk_bf16_f32 v197, v170, v171
  v_exp_f32 v173, v173
  v_exp_f32 v174, v174
  v_exp_f32 v175, v175
  v_cvt_pk_bf16_f32 v198, v172, v173
  v_cvt_pk_bf16_f32 v199, v174, v175
  v_mfma_f32_32x32x16_bf16 v[160:175], v[140:143], v[128:131], 0
  ds_read_b128 v[136:139], v7 offset:28672
  v_exp_f32 v176, v176
  v_exp_f32 v177, v177
  v_exp_f32 v178, v178
  v_cvt_pk_bf16_f32 v200, v176, v177
  v_exp_f32 v179, v179
  v_exp_f32 v180, v180
  v_cvt_pk_bf16_f32 v201, v178, v179
  v_exp_f32 v181, v181
  v_mfma_f32_32x32x16_bf16 v[208:223], v[144:147], v[192:195], v[208:223]
  ds_read_b128 v[152:155], v241 offset:3072
  v_exp_f32 v182, v182
  v_cvt_pk_bf16_f32 v202, v180, v181
  v_exp_f32 v183, v183
  v_exp_f32 v184, v184
  v_cvt_pk_bf16_f32 v203, v182, v183
  v_exp_f32 v185, v185
  v_exp_f32 v186, v186
  v_cvt_pk_bf16_f32 v204, v184, v185
  v_mfma_f32_32x32x16_bf16 v[208:223], v[148:151], v[196:199], v[208:223]
  ds_read_b128 v[156:159], v241 offset:3584
  v_exp_f32 v187, v187
  v_exp_f32 v188, v188
  v_cvt_pk_bf16_f32 v205, v186, v187
  v_exp_f32 v189, v189
  v_exp_f32 v190, v190
  v_exp_f32 v191, v191
  v_cvt_pk_bf16_f32 v206, v188, v189
  v_cvt_pk_bf16_f32 v207, v190, v191
  v_mfma_f32_32x32x16_bf16 v[176:191], v[140:143], v[132:135], 0
  v_exp_f32 v160, v160
  v_exp_f32 v161, v161
  v_exp_f32 v162, v162
  v_cvt_pk_bf16_f32 v192, v160, v161
  v_exp_f32 v163, v163
  v_exp_f32 v164, v164
  v_cvt_pk_bf16_f32 v193, v162, v163
  v_exp_f32 v165, v165
  v_mfma_f32_32x32x16_bf16 v[224:239], v[144:147], v[200:203], v[224:239]
  v_exp_f32 v166, v166
  v_cvt_pk_bf16_f32 v194, v164, v165
  v_exp_f32 v167, v167
  v_exp_f32 v168, v168
  v_cvt_pk_bf16_f32 v195, v166, v167
  v_exp_f32 v169, v169
  v_exp_f32 v170, v170
  v_cvt_pk_bf16_f32 v196, v168, v169
  v_mfma_f32_32x32x16_bf16 v[224:239], v[148:151], v[204:207], v[224:239]
  s_waitcnt lgkmcnt(0)
  v_exp_f32 v171, v171
  v_exp_f32 v172, v172
  v_cvt_pk_bf16_f32 v197, v170, v171
  v_exp_f32 v173, v173
  v_exp_f32 v174, v174
  v_exp_f32 v175, v175
  v_cvt_pk_bf16_f32 v198, v172, v173
  v_cvt_pk_bf16_f32 v199, v174, v175
  v_mfma_f32_32x32x16_bf16 v[160:175], v[136:139], v[128:131], 0
  ds_read_b128 v[140:143], v7 offset:29696
  v_exp_f32 v176, v176
  v_exp_f32 v177, v177
  v_exp_f32 v178, v178
  v_cvt_pk_bf16_f32 v200, v176, v177
  v_exp_f32 v179, v179
  v_exp_f32 v180, v180
  v_cvt_pk_bf16_f32 v201, v178, v179
  v_exp_f32 v181, v181
  v_mfma_f32_32x32x16_bf16 v[208:223], v[152:155], v[192:195], v[208:223]
  ds_read_b128 v[144:147], v241 offset:4096
  v_exp_f32 v182, v182
  v_cvt_pk_bf16_f32 v202, v180, v181
  v_exp_f32 v183, v183
  v_exp_f32 v184, v184
  v_cvt_pk_bf16_f32 v203, v182, v183
  v_exp_f32 v185, v185
  v_exp_f32 v186, v186
  v_cvt_pk_bf16_f32 v204, v184, v185
  v_mfma_f32_32x32x16_bf16 v[208:223], v[156:159], v[196:199], v[208:223]
  ds_read_b128 v[148:151], v241 offset:4608
  v_exp_f32 v187, v187
  v_exp_f32 v188, v188
  v_cvt_pk_bf16_f32 v205, v186, v187
  v_exp_f32 v189, v189
  v_exp_f32 v190, v190
  v_exp_f32 v191, v191
  v_cvt_pk_bf16_f32 v206, v188, v189
  v_cvt_pk_bf16_f32 v207, v190, v191
  v_mfma_f32_32x32x16_bf16 v[176:191], v[136:139], v[132:135], 0
  v_exp_f32 v160, v160
  v_exp_f32 v161, v161
  v_exp_f32 v162, v162
  v_cvt_pk_bf16_f32 v192, v160, v161
  v_exp_f32 v163, v163
  v_exp_f32 v164, v164
  v_cvt_pk_bf16_f32 v193, v162, v163
  v_exp_f32 v165, v165
  v_mfma_f32_32x32x16_bf16 v[224:239], v[152:155], v[200:203], v[224:239]
  v_exp_f32 v166, v166
  v_cvt_pk_bf16_f32 v194, v164, v165
  v_exp_f32 v167, v167
  v_exp_f32 v168, v168
  v_cvt_pk_bf16_f32 v195, v166, v167
  v_exp_f32 v169, v169
  v_exp_f32 v170, v170
  v_cvt_pk_bf16_f32 v196, v168, v169
  v_mfma_f32_32x32x16_bf16 v[224:239], v[156:159], v[204:207], v[224:239]
  s_waitcnt lgkmcnt(0)
  v_exp_f32 v171, v171
  v_exp_f32 v172, v172
  v_cvt_pk_bf16_f32 v197, v170, v171
  v_exp_f32 v173, v173
  v_exp_f32 v174, v174
  v_exp_f32 v175, v175
  v_cvt_pk_bf16_f32 v198, v172, v173
  v_cvt_pk_bf16_f32 v199, v174, v175
  v_mfma_f32_32x32x16_bf16 v[160:175], v[140:143], v[128:131], 0
  ds_read_b128 v[136:139], v7 offset:30720
  v_exp_f32 v176, v176
  v_exp_f32 v177, v177
  v_exp_f32 v178, v178
  v_cvt_pk_bf16_f32 v200, v176, v177
  v_exp_f32 v179, v179
  v_exp_f32 v180, v180
  v_cvt_pk_bf16_f32 v201, v178, v179
  v_exp_f32 v181, v181
  v_mfma_f32_32x32x16_bf16 v[208:223], v[144:147], v[192:195], v[208:223]
  ds_read_b128 v[152:155], v241 offset:5120
  v_exp_f32 v182, v182
  v_cvt_pk_bf16_f32 v202, v180, v181
  v_exp_f32 v183, v183
  v_exp_f32 v184, v184
  v_cvt_pk_bf16_f32 v203, v182, v183
  v_exp_f32 v185, v185
  v_exp_f32 v186, v186
  v_cvt_pk_bf16_f32 v204, v184, v185
  v_mfma_f32_32x32x16_bf16 v[208:223], v[148:151], v[196:199], v[208:223]
  ds_read_b128 v[156:159], v241 offset:5632
  v_exp_f32 v187, v187
  v_exp_f32 v188, v188
  v_cvt_pk_bf16_f32 v205, v186, v187
  v_exp_f32 v189, v189
  v_exp_f32 v190, v190
  v_exp_f32 v191, v191
  v_cvt_pk_bf16_f32 v206, v188, v189
  v_cvt_pk_bf16_f32 v207, v190, v191
  v_mfma_f32_32x32x16_bf16 v[176:191], v[140:143], v[132:135], 0
  v_exp_f32 v160, v160
  v_exp_f32 v161, v161
  v_exp_f32 v162, v162
  v_cvt_pk_bf16_f32 v192, v160, v161
  v_exp_f32 v163, v163
  v_exp_f32 v164, v164
  v_cvt_pk_bf16_f32 v193, v162, v163
  v_exp_f32 v165, v165
  v_mfma_f32_32x32x16_bf16 v[224:239], v[144:147], v[200:203], v[224:239]
  v_exp_f32 v166, v166
  v_cvt_pk_bf16_f32 v194, v164, v165
  v_exp_f32 v167, v167
  v_exp_f32 v168, v168
  v_cvt_pk_bf16_f32 v195, v166, v167
  v_exp_f32 v169, v169
  v_exp_f32 v170, v170
  v_cvt_pk_bf16_f32 v196, v168, v169
  v_mfma_f32_32x32x16_bf16 v[224:239], v[148:151], v[204:207], v[224:239]
  s_waitcnt lgkmcnt(0)
  v_exp_f32 v171, v171
  v_exp_f32 v172, v172
  v_cvt_pk_bf16_f32 v197, v170, v171
  v_exp_f32 v173, v173
  v_exp_f32 v174, v174
  v_exp_f32 v175, v175
  v_cvt_pk_bf16_f32 v198, v172, v173
  v_cvt_pk_bf16_f32 v199, v174, v175
  v_mfma_f32_32x32x16_bf16 v[160:175], v[136:139], v[128:131], 0
  ds_read_b128 v[140:143], v7 offset:31744
  v_exp_f32 v176, v176
  v_exp_f32 v177, v177
  v_exp_f32 v178, v178
  v_cvt_pk_bf16_f32 v200, v176, v177
  v_exp_f32 v179, v179
  v_exp_f32 v180, v180
  v_cvt_pk_bf16_f32 v201, v178, v179
  v_exp_f32 v181, v181
  v_mfma_f32_32x32x16_bf16 v[208:223], v[152:155], v[192:195], v[208:223]
  ds_read_b128 v[144:147], v241 offset:6144
  v_exp_f32 v182, v182
  v_cvt_pk_bf16_f32 v202, v180, v181
  v_exp_f32 v183, v183
  v_exp_f32 v184, v184
  v_cvt_pk_bf16_f32 v203, v182, v183
  v_exp_f32 v185, v185
  v_exp_f32 v186, v186
  v_cvt_pk_bf16_f32 v204, v184, v185
  v_mfma_f32_32x32x16_bf16 v[208:223], v[156:159], v[196:199], v[208:223]
  ds_read_b128 v[148:151], v241 offset:6656
  v_exp_f32 v187, v187
  v_exp_f32 v188, v188
  v_cvt_pk_bf16_f32 v205, v186, v187
  v_exp_f32 v189, v189
  v_exp_f32 v190, v190
  v_exp_f32 v191, v191
  v_cvt_pk_bf16_f32 v206, v188, v189
  v_cvt_pk_bf16_f32 v207, v190, v191
  v_mfma_f32_32x32x16_bf16 v[176:191], v[136:139], v[132:135], 0
  s_waitcnt vmcnt(1)
  s_barrier
  v_exp_f32 v160, v160
  v_exp_f32 v161, v161
  v_exp_f32 v162, v162
  v_cvt_pk_bf16_f32 v192, v160, v161
  v_exp_f32 v163, v163
  v_exp_f32 v164, v164
  v_cvt_pk_bf16_f32 v193, v162, v163
  v_exp_f32 v165, v165
  v_mfma_f32_32x32x16_bf16 v[224:239], v[152:155], v[200:203], v[224:239]
  v_exp_f32 v166, v166
  v_cvt_pk_bf16_f32 v194, v164, v165
  v_exp_f32 v167, v167
  v_exp_f32 v168, v168
  v_cvt_pk_bf16_f32 v195, v166, v167
  v_exp_f32 v169, v169
  v_exp_f32 v170, v170
  v_cvt_pk_bf16_f32 v196, v168, v169
  v_mfma_f32_32x32x16_bf16 v[224:239], v[156:159], v[204:207], v[224:239]
  s_waitcnt lgkmcnt(0)
  v_exp_f32 v171, v171
  v_exp_f32 v172, v172
  v_cvt_pk_bf16_f32 v197, v170, v171
  v_exp_f32 v173, v173
  v_exp_f32 v174, v174
  v_exp_f32 v175, v175
  v_cvt_pk_bf16_f32 v198, v172, v173
  v_cvt_pk_bf16_f32 v199, v174, v175
  v_mfma_f32_32x32x16_bf16 v[160:175], v[140:143], v[128:131], 0
  ds_read_b128 v[136:139], v7 offset:32768
  global_load_dword v60, v58, s[38:39] sc1
  v_exp_f32 v176, v176
  v_exp_f32 v177, v177
  v_exp_f32 v178, v178
  v_cvt_pk_bf16_f32 v200, v176, v177
  v_exp_f32 v179, v179
  v_exp_f32 v180, v180
  v_cvt_pk_bf16_f32 v201, v178, v179
  v_exp_f32 v181, v181
  v_mfma_f32_32x32x16_bf16 v[208:223], v[144:147], v[192:195], v[208:223]
  ds_read_b128 v[152:155], v241 offset:7168
  v_exp_f32 v182, v182
  v_cvt_pk_bf16_f32 v202, v180, v181
  v_exp_f32 v183, v183
  v_exp_f32 v184, v184
  v_cvt_pk_bf16_f32 v203, v182, v183
  v_exp_f32 v185, v185
  v_exp_f32 v186, v186
  v_cvt_pk_bf16_f32 v204, v184, v185
  v_mfma_f32_32x32x16_bf16 v[208:223], v[148:151], v[196:199], v[208:223]
  ds_read_b128 v[156:159], v241 offset:7680
  v_exp_f32 v187, v187
  v_exp_f32 v188, v188
  v_cvt_pk_bf16_f32 v205, v186, v187
  v_exp_f32 v189, v189
  v_exp_f32 v190, v190
  v_exp_f32 v191, v191
  v_cvt_pk_bf16_f32 v206, v188, v189
  v_cvt_pk_bf16_f32 v207, v190, v191
  v_mfma_f32_32x32x16_bf16 v[176:191], v[140:143], v[132:135], 0
  v_exp_f32 v160, v160
  v_exp_f32 v161, v161
  v_exp_f32 v162, v162
  v_cvt_pk_bf16_f32 v192, v160, v161
  v_exp_f32 v163, v163
  v_exp_f32 v164, v164
  v_cvt_pk_bf16_f32 v193, v162, v163
  v_exp_f32 v165, v165
  v_mfma_f32_32x32x16_bf16 v[224:239], v[144:147], v[200:203], v[224:239]
  v_exp_f32 v166, v166
  v_cvt_pk_bf16_f32 v194, v164, v165
  v_exp_f32 v167, v167
  v_exp_f32 v168, v168
  v_cvt_pk_bf16_f32 v195, v166, v167
  v_exp_f32 v169, v169
  v_exp_f32 v170, v170
  v_cvt_pk_bf16_f32 v196, v168, v169
  v_mfma_f32_32x32x16_bf16 v[224:239], v[148:151], v[204:207], v[224:239]
  s_waitcnt lgkmcnt(0)
  v_exp_f32 v171, v171
  v_exp_f32 v172, v172
  v_cvt_pk_bf16_f32 v197, v170, v171
  v_exp_f32 v173, v173
  v_exp_f32 v174, v174
  v_exp_f32 v175, v175
  v_cvt_pk_bf16_f32 v198, v172, v173
  v_cvt_pk_bf16_f32 v199, v174, v175
  v_mfma_f32_32x32x16_bf16 v[160:175], v[136:139], v[128:131], 0
  ds_read_b128 v[140:143], v7 offset:33792
  v_add_u32 v241, v242, v241
  v_exp_f32 v176, v176
  v_exp_f32 v177, v177
  v_exp_f32 v178, v178
  v_cvt_pk_bf16_f32 v200, v176, v177
  v_exp_f32 v179, v179
  v_exp_f32 v180, v180
  v_cvt_pk_bf16_f32 v201, v178, v179
  v_exp_f32 v181, v181
  v_mfma_f32_32x32x16_bf16 v[208:223], v[152:155], v[192:195], v[208:223]
  ds_read_b128 v[144:147], v241 offset:0
  v_exp_f32 v182, v182
  v_cvt_pk_bf16_f32 v202, v180, v181
  v_exp_f32 v183, v183
  v_exp_f32 v184, v184
  v_cvt_pk_bf16_f32 v203, v182, v183
  v_exp_f32 v185, v185
  v_exp_f32 v186, v186
  v_mfma_f32_32x32x16_bf16 v[208:223], v[156:159], v[196:199], v[208:223]
  ds_read_b128 v[148:151], v241 offset:512
  v_cvt_pk_bf16_f32 v204, v184, v185
  v_exp_f32 v187, v187
  v_exp_f32 v188, v188
  v_cvt_pk_bf16_f32 v205, v186, v187
  v_exp_f32 v189, v189
  v_exp_f32 v190, v190
  v_exp_f32 v191, v191
  v_cvt_pk_bf16_f32 v206, v188, v189
  v_cvt_pk_bf16_f32 v207, v190, v191
  v_mfma_f32_32x32x16_bf16 v[176:191], v[136:139], v[132:135], 0
  v_exp_f32 v160, v160
  v_exp_f32 v161, v161
  v_exp_f32 v162, v162
  v_cvt_pk_bf16_f32 v192, v160, v161
  v_exp_f32 v163, v163
  v_exp_f32 v164, v164
  v_cvt_pk_bf16_f32 v193, v162, v163
  v_exp_f32 v165, v165
  v_mfma_f32_32x32x16_bf16 v[224:239], v[152:155], v[200:203], v[224:239]
  v_exp_f32 v166, v166
  v_cvt_pk_bf16_f32 v194, v164, v165
  v_exp_f32 v167, v167
  v_exp_f32 v168, v168
mk_wJ3:
  s_cbranch_execz mk_wr1
  v_cvt_pk_bf16_f32 v195, v166, v167
  v_exp_f32 v169, v169
  v_exp_f32 v170, v170
  v_cvt_pk_bf16_f32 v196, v168, v169
  v_mfma_f32_32x32x16_bf16 v[224:239], v[156:159], v[204:207], v[224:239]
  s_waitcnt lgkmcnt(0)
  v_exp_f32 v171, v171
  v_exp_f32 v172, v172
  v_cvt_pk_bf16_f32 v197, v170, v171
  v_exp_f32 v173, v173
  v_exp_f32 v174, v174
  v_exp_f32 v175, v175
  v_cvt_pk_bf16_f32 v198, v172, v173
  v_cvt_pk_bf16_f32 v199, v174, v175
  v_mfma_f32_32x32x16_bf16 v[160:175], v[140:143], v[128:131], 0
  ds_read_b128 v[136:139], v7 offset:34816
  v_exp_f32 v176, v176
  v_exp_f32 v177, v177
  v_exp_f32 v178, v178
  v_cvt_pk_bf16_f32 v200, v176, v177
  v_exp_f32 v179, v179
  v_exp_f32 v180, v180
  v_cvt_pk_bf16_f32 v201, v178, v179
  v_exp_f32 v181, v181
  v_mfma_f32_32x32x16_bf16 v[208:223], v[144:147], v[192:195], v[208:223]
  ds_read_b128 v[152:155], v241 offset:1024
  v_exp_f32 v182, v182
  v_cvt_pk_bf16_f32 v202, v180, v181
  v_exp_f32 v183, v183
  v_exp_f32 v184, v184
  v_cvt_pk_bf16_f32 v203, v182, v183
  v_exp_f32 v185, v185
  v_exp_f32 v186, v186
  v_cvt_pk_bf16_f32 v204, v184, v185
  v_mfma_f32_32x32x16_bf16 v[208:223], v[148:151], v[196:199], v[208:223]
  ds_read_b128 v[156:159], v241 offset:1536
  v_exp_f32 v187, v187
  v_exp_f32 v188, v188
  v_cvt_pk_bf16_f32 v205, v186, v187
  v_exp_f32 v189, v189
  v_exp_f32 v190, v190
  v_exp_f32 v191, v191
  v_cvt_pk_bf16_f32 v206, v188, v189
  v_cvt_pk_bf16_f32 v207, v190, v191
  s_waitcnt vmcnt(0)
  v_cmp_ne_u32 vcc, s94, v60
  s_cbranch_vccnz mk_ph_spin
mk_ph_ok:
  v_mfma_f32_32x32x16_bf16 v[176:191], v[140:143], v[132:135], 0
  global_load_dwordx4 a[64:67], v61, s[12:13] offset:-4096 sc1
  global_load_dwordx4 a[68:71], v61, s[14:15] offset:-4096 sc1
  v_exp_f32 v160, v160
  v_exp_f32 v161, v161
  v_exp_f32 v162, v162
  v_cvt_pk_bf16_f32 v192, v160, v161
  v_exp_f32 v163, v163
  v_exp_f32 v164, v164
  v_cvt_pk_bf16_f32 v193, v162, v163
  v_exp_f32 v165, v165
  v_mfma_f32_32x32x16_bf16 v[224:239], v[144:147], v[200:203], v[224:239]
  global_load_dwordx4 a[72:75], v61, s[16:17] offset:-4096 sc1
  v_exp_f32 v166, v166
  v_cvt_pk_bf16_f32 v194, v164, v165
  v_exp_f32 v167, v167
  v_exp_f32 v168, v168
  v_cvt_pk_bf16_f32 v195, v166, v167
  v_exp_f32 v169, v169
  v_exp_f32 v170, v170
  v_cvt_pk_bf16_f32 v196, v168, v169
  v_mfma_f32_32x32x16_bf16 v[224:239], v[148:151], v[204:207], v[224:239]
  s_waitcnt lgkmcnt(0)
  global_load_dwordx4 a[76:79], v61, s[18:19] offset:-4096 sc1
  v_exp_f32 v171, v171
  v_exp_f32 v172, v172
  v_cvt_pk_bf16_f32 v197, v170, v171
  v_exp_f32 v173, v173
  v_exp_f32 v174, v174
  v_exp_f32 v175, v175
  v_cvt_pk_bf16_f32 v198, v172, v173
  v_cvt_pk_bf16_f32 v199, v174, v175
  v_mfma_f32_32x32x16_bf16 v[160:175], v[136:139], v[128:131], 0
  ds_read_b128 v[140:143], v7 offset:35840
  global_load_dwordx4 a[80:83], v61, s[12:13] offset:-3072 sc1
  global_load_dwordx4 a[84:87], v61, s[14:15] offset:-3072 sc1
  v_exp_f32 v176, v176
  v_exp_f32 v177, v177
  v_exp_f32 v178, v178
  v_cvt_pk_bf16_f32 v200, v176, v177
  v_exp_f32 v179, v179
  v_exp_f32 v180, v180
  v_cvt_pk_bf16_f32 v201, v178, v179
  v_exp_f32 v181, v181
  v_mfma_f32_32x32x16_bf16 v[208:223], v[152:155], v[192:195], v[208:223]
  ds_read_b128 v[144:147], v241 offset:2048
  global_load_dwordx4 a[88:91], v61, s[16:17] offset:-3072 sc1
  v_exp_f32 v182, v182
  v_cvt_pk_bf16_f32 v202, v180, v181
  v_exp_f32 v183, v183
  v_exp_f32 v184, v184
  v_cvt_pk_bf16_f32 v203, v182, v183
  v_exp_f32 v185, v185
  v_exp_f32 v186, v186
  v_cvt_pk_bf16_f32 v204, v184, v185
  v_mfma_f32_32x32x16_bf16 v[208:223], v[156:159], v[196:199], v[208:223]
  ds_read_b128 v[148:151], v241 offset:2560
  global_load_dwordx4 a[92:95], v61, s[18:19] offset:-3072 sc1
  v_exp_f32 v187, v187
  v_exp_f32 v188, v188
  v_cvt_pk_bf16_f32 v205, v186, v187
  v_exp_f32 v189, v189
  v_exp_f32 v190, v190
  v_exp_f32 v191, v191
  v_cvt_pk_bf16_f32 v206, v188, v189
  v_cvt_pk_bf16_f32 v207, v190, v191
  v_mfma_f32_32x32x16_bf16 v[176:191], v[136:139], v[132:135], 0
  global_load_dwordx4 a[96:99], v61, s[12:13] offset:-2048 sc1
  v_exp_f32 v160, v160
  v_exp_f32 v161, v161
  v_exp_f32 v162, v162
  v_cvt_pk_bf16_f32 v192, v160, v161
  v_exp_f32 v163, v163
  v_exp_f32 v164, v164
  v_cvt_pk_bf16_f32 v193, v162, v163
  v_exp_f32 v165, v165
  v_mfma_f32_32x32x16_bf16 v[224:239], v[152:155], v[200:203], v[224:239]
  global_load_dwordx4 a[100:103], v61, s[14:15] offset:-2048 sc1
  v_exp_f32 v166, v166
  v_cvt_pk_bf16_f32 v194, v164, v165
  v_exp_f32 v167, v167
  v_exp_f32 v168, v168
  v_cvt_pk_bf16_f32 v195, v166, v167
  v_exp_f32 v169, v169
  v_exp_f32 v170, v170
  v_cvt_pk_bf16_f32 v196, v168, v169
  v_mfma_f32_32x32x16_bf16 v[224:239], v[156:159], v[204:207], v[224:239]
  s_waitcnt lgkmcnt(0)
  v_exp_f32 v171, v171
  v_exp_f32 v172, v172
  v_cvt_pk_bf16_f32 v197, v170, v171
  v_exp_f32 v173, v173
  v_exp_f32 v174, v174
  v_exp_f32 v175, v175
  v_cvt_pk_bf16_f32 v198, v172, v173
  v_cvt_pk_bf16_f32 v199, v174, v175
  v_mfma_f32_32x32x16_bf16 v[160:175], v[140:143], v[128:131], 0
  ds_read_b128 v[136:139], v7 offset:36864
  global_load_dwordx4 a[104:107], v61, s[16:17] offset:-2048 sc1
  v_exp_f32 v176, v176
  v_exp_f32 v177, v177
  v_exp_f32 v178, v178
  v_cvt_pk_bf16_f32 v200, v176, v177
  v_exp_f32 v179, v179
  v_exp_f32 v180, v180
  v_cvt_pk_bf16_f32 v201, v178, v179
  v_exp_f32 v181, v181
  v_mfma_f32_32x32x16_bf16 v[208:223], v[144:147], v[192:195], v[208:223]
  ds_read_b128 v[152:155], v241 offset:3072
  global_load_dwordx4 a[108:111], v61, s[18:19] offset:-2048 sc1
  v_exp_f32 v182, v182
  v_cvt_pk_bf16_f32 v202, v180, v181
  v_exp_f32 v183, v183
  v_exp_f32 v184, v184
  v_cvt_pk_bf16_f32 v203, v182, v183
  v_exp_f32 v185, v185
  v_exp_f32 v186, v186
  v_cvt_pk_bf16_f32 v204, v184, v185
  v_mfma_f32_32x32x16_bf16 v[208:223], v[148:151], v[196:199], v[208:223]
  ds_read_b128 v[156:159], v241 offset:3584
  v_exp_f32 v187, v187
  v_exp_f32 v188, v188
  v_cvt_pk_bf16_f32 v205, v186, v187
  v_exp_f32 v189, v189
  v_exp_f32 v190, v190
  v_exp_f32 v191, v191
  v_cvt_pk_bf16_f32 v206, v188, v189
  v_cvt_pk_bf16_f32 v207, v190, v191
  v_mfma_f32_32x32x16_bf16 v[176:191], v[140:143], v[132:135], 0
  buffer_load_dwordx2 v[48:49], v56, s[8:11], 0 offen offset:0
  v_exp_f32 v160, v160
  v_exp_f32 v161, v161
  v_exp_f32 v162, v162
  v_cvt_pk_bf16_f32 v192, v160, v161
  v_exp_f32 v163, v163
  v_exp_f32 v164, v164
  v_cvt_pk_bf16_f32 v193, v162, v163
  v_exp_f32 v165, v165
  v_mfma_f32_32x32x16_bf16 v[224:239], v[144:147], v[200:203], v[224:239]
  v_exp_f32 v166, v166
  v_cvt_pk_bf16_f32 v194, v164, v165
  v_exp_f32 v167, v167
  v_exp_f32 v168, v168
  v_cvt_pk_bf16_f32 v195, v166, v167
  v_exp_f32 v169, v169
  v_exp_f32 v170, v170
  v_cvt_pk_bf16_f32 v196, v168, v169
  v_mfma_f32_32x32x16_bf16 v[224:239], v[148:151], v[204:207], v[224:239]
  s_waitcnt lgkmcnt(0)
  v_exp_f32 v171, v171
  v_exp_f32 v172, v172
  v_cvt_pk_bf16_f32 v197, v170, v171
  v_exp_f32 v173, v173
  v_exp_f32 v174, v174
  v_exp_f32 v175, v175
  v_cvt_pk_bf16_f32 v198, v172, v173
  v_cvt_pk_bf16_f32 v199, v174, v175
  v_mfma_f32_32x32x16_bf16 v[160:175], v[136:139], v[128:131], 0
  ds_read_b128 v[140:143], v7 offset:37888
  v_exp_f32 v176, v176
  v_exp_f32 v177, v177
  v_exp_f32 v178, v178
  v_cvt_pk_bf16_f32 v200, v176, v177
  v_exp_f32 v179, v179
  v_exp_f32 v180, v180
  v_cvt_pk_bf16_f32 v201, v178, v179
  v_exp_f32 v181, v181
  v_mfma_f32_32x32x16_bf16 v[208:223], v[152:155], v[192:195], v[208:223]
  ds_read_b128 v[144:147], v241 offset:4096
  v_exp_f32 v182, v182
  v_cvt_pk_bf16_f32 v202, v180, v181
  v_exp_f32 v183, v183
  v_exp_f32 v184, v184
  v_cvt_pk_bf16_f32 v203, v182, v183
  v_exp_f32 v185, v185
  v_exp_f32 v186, v186
  v_cvt_pk_bf16_f32 v204, v184, v185
  v_mfma_f32_32x32x16_bf16 v[208:223], v[156:159], v[196:199], v[208:223]
  ds_read_b128 v[148:151], v241 offset:4608
  v_exp_f32 v187, v187
  v_exp_f32 v188, v188
  v_cvt_pk_bf16_f32 v205, v186, v187
  v_exp_f32 v189, v189
  v_exp_f32 v190, v190
  v_exp_f32 v191, v191
  v_cvt_pk_bf16_f32 v206, v188, v189
  v_cvt_pk_bf16_f32 v207, v190, v191
  v_mfma_f32_32x32x16_bf16 v[176:191], v[136:139], v[132:135], 0
  global_load_dwordx4 a[176:179], v57, s[32:33] offset:0 sc1
  v_exp_f32 v160, v160
  v_exp_f32 v161, v161
  v_exp_f32 v162, v162
  v_cvt_pk_bf16_f32 v192, v160, v161
  v_exp_f32 v163, v163
  v_mfma_f32_32x32x16_bf16 v[224:239], v[152:155], v[200:203], v[224:239]
  v_exp_f32 v164, v164
  v_cvt_pk_bf16_f32 v193, v162, v163
  v_exp_f32 v165, v165
  v_exp_f32 v166, v166
  v_mfma_f32_32x32x16_bf16 v[224:239], v[156:159], v[204:207], v[224:239]
  s_waitcnt vmcnt(10) lgkmcnt(0)
  v_cvt_pk_bf16_f32 v194, v164, v165
  v_exp_f32 v167, v167
  v_exp_f32 v168, v168
  v_cvt_pk_bf16_f32 v195, v166, v167
  v_exp_f32 v169, v169
  v_mfma_f32_32x32x16_bf16 v[32:47], a[68:71], a[64:67], 0
  v_exp_f32 v170, v170
  v_cvt_pk_bf16_f32 v196, v168, v169
  v_exp_f32 v171, v171
  v_exp_f32 v172, v172
  v_cvt_pk_bf16_f32 v197, v170, v171
  v_mfma_f32_32x32x16_bf16 a[16:31], a[76:79], a[64:67], 0
  v_exp_f32 v173, v173
  v_exp_f32 v174, v174
  v_exp_f32 v175, v175
  v_cvt_pk_bf16_f32 v198, v172, v173
  v_cvt_pk_bf16_f32 v199, v174, v175
  v_mfma_f32_32x32x16_bf16 v[160:175], v[140:143], v[128:131], 0
  ds_read_b128 v[136:139], v7 offset:38912
  v_exp_f32 v176, v176
  v_exp_f32 v177, v177
  v_exp_f32 v178, v178
  v_cvt_pk_bf16_f32 v200, v176, v177
  v_exp_f32 v179, v179
  v_exp_f32 v180, v180
  v_mfma_f32_32x32x16_bf16 v[208:223], v[144:147], v[192:195], v[208:223]
  ds_read_b128 v[152:155], v241 offset:5120
  v_cvt_pk_bf16_f32 v201, v178, v179
  v_exp_f32 v181, v181
  v_exp_f32 v182, v182
  v_cvt_pk_bf16_f32 v202, v180, v181
  v_exp_f32 v183, v183
  v_exp_f32 v184, v184
  v_mfma_f32_32x32x16_bf16 v[208:223], v[148:151], v[196:199], v[208:223]
  ds_read_b128 v[156:159], v241 offset:5632
  v_cvt_pk_bf16_f32 v203, v182, v183
  v_exp_f32 v185, v185
  v_exp_f32 v186, v186
  v_cvt_pk_bf16_f32 v204, v184, v185
  v_exp_f32 v187, v187
  v_exp_f32 v188, v188
  v_mfma_f32_32x32x16_bf16 a[32:47], a[68:71], a[72:75], 0
  v_cvt_pk_bf16_f32 v205, v186, v187
  v_exp_f32 v189, v189
  v_exp_f32 v190, v190
  v_exp_f32 v191, v191
  v_cvt_pk_bf16_f32 v206, v188, v189
  v_cvt_pk_bf16_f32 v207, v190, v191
  v_mfma_f32_32x32x16_bf16 v[176:191], v[140:143], v[132:135], 0
  buffer_load_dwordx2 v[50:51], v56, s[8:11], 0 offen offset:16
  v_exp_f32 v160, v160
  v_exp_f32 v161, v161
  v_exp_f32 v162, v162
  v_cvt_pk_bf16_f32 v192, v160, v161
  v_exp_f32 v163, v163
  v_exp_f32 v164, v164
  v_mfma_f32_32x32x16_bf16 v[224:239], v[144:147], v[200:203], v[224:239]
  v_cvt_pk_bf16_f32 v193, v162, v163
  v_exp_f32 v165, v165
  v_exp_f32 v166, v166
  v_cvt_pk_bf16_f32 v194, v164, v165
  v_exp_f32 v167, v167
  v_exp_f32 v168, v168
  v_mfma_f32_32x32x16_bf16 v[224:239], v[148:151], v[204:207], v[224:239]
  s_waitcnt lgkmcnt(0)
  global_load_dwordx4 a[180:183], v57, s[34:35] offset:0 sc1
  v_cvt_pk_bf16_f32 v195, v166, v167
  v_exp_f32 v169, v169
  v_exp_f32 v170, v170
  v_cvt_pk_bf16_f32 v196, v168, v169
  v_exp_f32 v171, v171
  v_exp_f32 v172, v172
  v_mfma_f32_32x32x16_bf16 a[48:63], a[76:79], a[72:75], 0
  s_waitcnt vmcnt(8)
  v_cvt_pk_bf16_f32 v197, v170, v171
  v_exp_f32 v173, v173
  v_exp_f32 v174, v174
  v_exp_f32 v175, v175
  v_cvt_pk_bf16_f32 v198, v172, v173
  v_cvt_pk_bf16_f32 v199, v174, v175
  v_mfma_f32_32x32x16_bf16 v[160:175], v[136:139], v[128:131], 0
  ds_read_b128 v[140:143], v7 offset:39936
  global_load_dwordx4 v[64:67], v249, s[12:13] offset:-1024 sc1
  v_exp_f32 v176, v176
  v_exp_f32 v177, v177
  v_exp_f32 v178, v178
  v_cvt_pk_bf16_f32 v200, v176, v177
  v_exp_f32 v179, v179
  v_mfma_f32_32x32x16_bf16 v[208:223], v[152:155], v[192:195], v[208:223]
  ds_read_b128 v[144:147], v241 offset:6144
  v_exp_f32 v180, v180
  v_cvt_pk_bf16_f32 v201, v178, v179
  v_exp_f32 v181, v181
  v_exp_f32 v182, v182
  v_mfma_f32_32x32x16_bf16 v[208:223], v[156:159], v[196:199], v[208:223]
  ds_read_b128 v[148:151], v241 offset:6656
  global_load_dwordx4 v[68:71], v249, s[14:15] offset:-1024 sc1
  v_cvt_pk_bf16_f32 v202, v180, v181
  v_exp_f32 v183, v183
  v_exp_f32 v184, v184
  v_cvt_pk_bf16_f32 v203, v182, v183
  v_exp_f32 v185, v185
  v_mfma_f32_32x32x16_bf16 v[32:47], a[84:87], a[80:83], v[32:47]
  global_load_dwordx4 a[64:67], v61, s[12:13] offset:-1024 sc1
  v_exp_f32 v186, v186
  v_cvt_pk_bf16_f32 v204, v184, v185
  v_exp_f32 v187, v187
  v_exp_f32 v188, v188
  v_cvt_pk_bf16_f32 v205, v186, v187
  v_mfma_f32_32x32x16_bf16 a[16:31], a[92:95], a[80:83], a[16:31]
  global_load_dwordx4 a[68:71], v61, s[14:15] offset:-1024 sc1
  v_exp_f32 v189, v189
  v_exp_f32 v190, v190
  v_exp_f32 v191, v191
  v_cvt_pk_bf16_f32 v206, v188, v189
  v_cvt_pk_bf16_f32 v207, v190, v191
  v_mfma_f32_32x32x16_bf16 v[176:191], v[136:139], v[132:135], 0
  global_load_dwordx4 v[72:75], v249, s[16:17] offset:-1024 sc1
  v_exp_f32 v160, v160
  v_exp_f32 v161, v161
  v_exp_f32 v162, v162
  v_cvt_pk_bf16_f32 v192, v160, v161
  v_exp_f32 v163, v163
  v_exp_f32 v164, v164
  v_mfma_f32_32x32x16_bf16 v[224:239], v[152:155], v[200:203], v[224:239]
  v_cvt_pk_bf16_f32 v193, v162, v163
  v_exp_f32 v165, v165
  v_exp_f32 v166, v166
  v_cvt_pk_bf16_f32 v194, v164, v165
  v_exp_f32 v167, v167
  v_exp_f32 v168, v168
  v_mfma_f32_32x32x16_bf16 v[224:239], v[156:159], v[204:207], v[224:239]
  s_waitcnt lgkmcnt(0)
  v_cvt_pk_bf16_f32 v195, v166, v167
  v_exp_f32 v169, v169
  v_exp_f32 v170, v170
  v_cvt_pk_bf16_f32 v196, v168, v169
  v_exp_f32 v171, v171
  v_exp_f32 v172, v172
  v_mfma_f32_32x32x16_bf16 a[32:47], a[84:87], a[88:91], a[32:47]
  global_load_dwordx4 a[72:75], v61, s[16:17] offset:-1024 sc1
  v_cvt_pk_bf16_f32 v197, v170, v171
  v_exp_f32 v173, v173
  v_exp_f32 v174, v174
  v_exp_f32 v175, v175
  v_cvt_pk_bf16_f32 v198, v172, v173
  v_cvt_pk_bf16_f32 v199, v174, v175
  v_mfma_f32_32x32x16_bf16 v[160:175], v[140:143], v[128:131], 0
  ds_read_b128 v[136:139], v7 offset:40960
  global_load_dwordx4 v[76:79], v249, s[18:19] offset:-1024 sc1
  v_exp_f32 v176, v176
  v_exp_f32 v177, v177
  v_exp_f32 v178, v178
  v_cvt_pk_bf16_f32 v200, v176, v177
  v_exp_f32 v179, v179
  v_exp_f32 v180, v180
  v_mfma_f32_32x32x16_bf16 v[208:223], v[144:147], v[192:195], v[208:223]
  ds_read_b128 v[152:155], v241 offset:7168
  v_cvt_pk_bf16_f32 v201, v178, v179
  v_exp_f32 v181, v181
  v_exp_f32 v182, v182
  v_cvt_pk_bf16_f32 v202, v180, v181
  v_exp_f32 v183, v183
  v_exp_f32 v184, v184
  v_mfma_f32_32x32x16_bf16 v[208:223], v[148:151], v[196:199], v[208:223]
  ds_read_b128 v[156:159], v241 offset:7680
  v_cvt_pk_bf16_f32 v203, v182, v183
  v_exp_f32 v185, v185
  v_exp_f32 v186, v186
  v_cvt_pk_bf16_f32 v204, v184, v185
  v_exp_f32 v187, v187
  v_exp_f32 v188, v188
  v_mfma_f32_32x32x16_bf16 a[48:63], a[92:95], a[88:91], a[48:63]
  s_waitcnt vmcnt(11)
  global_load_dwordx4 a[76:79], v61, s[18:19] offset:-1024 sc1
  v_cvt_pk_bf16_f32 v205, v186, v187
  v_exp_f32 v189, v189
  v_exp_f32 v190, v190
  v_exp_f32 v191, v191
  v_cvt_pk_bf16_f32 v206, v188, v189
  v_cvt_pk_bf16_f32 v207, v190, v191
  v_mfma_f32_32x32x16_bf16 v[176:191], v[140:143], v[132:135], 0
  buffer_load_dwordx2 v[52:53], v56, s[8:11], 0 offen offset:32
  v_exp_f32 v160, v160
  v_exp_f32 v161, v161
  v_exp_f32 v162, v162
  v_cvt_pk_bf16_f32 v192, v160, v161
  v_exp_f32 v163, v163
  v_exp_f32 v164, v164
  v_mfma_f32_32x32x16_bf16 v[224:239], v[144:147], v[200:203], v[224:239]
  v_cvt_pk_bf16_f32 v193, v162, v163
  v_exp_f32 v165, v165
  v_exp_f32 v166, v166
  v_cvt_pk_bf16_f32 v194, v164, v165
  v_exp_f32 v167, v167
  v_exp_f32 v168, v168
  v_mfma_f32_32x32x16_bf16 v[224:239], v[148:151], v[204:207], v[224:239]
  s_waitcnt lgkmcnt(0)
  global_load_dwordx4 a[184:187], v57, s[32:33] offset:1024 sc1
  v_cvt_pk_bf16_f32 v195, v166, v167
  v_exp_f32 v169, v169
  v_exp_f32 v170, v170
  v_cvt_pk_bf16_f32 v196, v168, v169
  v_exp_f32 v171, v171
  v_exp_f32 v172, v172
  v_mfma_f32_32x32x16_bf16 v[32:47], a[100:103], a[96:99], v[32:47]
  global_load_dwordx4 a[80:83], v61, s[12:13] offset:0 sc1
  v_cvt_pk_bf16_f32 v197, v170, v171
  v_exp_f32 v173, v173
  v_exp_f32 v174, v174
  v_exp_f32 v175, v175
  v_cvt_pk_bf16_f32 v198, v172, v173
  v_cvt_pk_bf16_f32 v199, v174, v175
  v_mfma_f32_32x32x16_bf16 v[160:175], v[136:139], v[128:131], 0
  ds_read_b128 v[140:143], v7 offset:41984
  global_load_dwordx4 v[80:83], v249, s[12:13] offset:0 sc1
  v_add_u32 v241, v242, v241
  v_exp_f32 v176, v176
  v_exp_f32 v177, v177
  v_exp_f32 v178, v178
  v_cvt_pk_bf16_f32 v200, v176, v177
  v_mfma_f32_32x32x16_bf16 v[208:223], v[152:155], v[192:195], v[208:223]
  ds_read_b128 v[144:147], v241 offset:0
  v_exp_f32 v179, v179
  v_exp_f32 v180, v180
  v_cvt_pk_bf16_f32 v201, v178, v179
  v_exp_f32 v181, v181
  v_exp_f32 v182, v182
  v_mfma_f32_32x32x16_bf16 v[208:223], v[156:159], v[196:199], v[208:223]
  ds_read_b128 v[148:151], v241 offset:512
  v_cvt_pk_bf16_f32 v202, v180, v181
  v_exp_f32 v183, v183
  v_exp_f32 v184, v184
  v_cvt_pk_bf16_f32 v203, v182, v183
  v_exp_f32 v185, v185
  v_mfma_f32_32x32x16_bf16 a[16:31], a[108:111], a[96:99], a[16:31]
  global_load_dwordx4 a[84:87], v61, s[14:15] offset:0 sc1
  v_exp_f32 v186, v186
  v_cvt_pk_bf16_f32 v204, v184, v185
  v_exp_f32 v187, v187
  v_exp_f32 v188, v188
  v_cvt_pk_bf16_f32 v205, v186, v187
  v_mfma_f32_32x32x16_bf16 a[32:47], a[100:103], a[104:107], a[32:47]
  global_load_dwordx4 a[88:91], v61, s[16:17] offset:0 sc1
  v_exp_f32 v189, v189
  v_exp_f32 v190, v190
  v_exp_f32 v191, v191
  v_cvt_pk_bf16_f32 v206, v188, v189
  v_cvt_pk_bf16_f32 v207, v190, v191
  v_mfma_f32_32x32x16_bf16 v[176:191], v[136:139], v[132:135], 0
  global_load_dwordx4 a[188:191], v57, s[34:35] offset:1024 sc1
  v_exp_f32 v160, v160
  v_exp_f32 v161, v161
  v_exp_f32 v162, v162
  v_cvt_pk_bf16_f32 v192, v160, v161
  v_exp_f32 v163, v163
  v_exp_f32 v164, v164
  v_mfma_f32_32x32x16_bf16 v[224:239], v[152:155], v[200:203], v[224:239]
  v_cvt_pk_bf16_f32 v193, v162, v163
  v_exp_f32 v165, v165
  v_exp_f32 v166, v166
  v_cvt_pk_bf16_f32 v194, v164, v165
  v_exp_f32 v167, v167
  v_exp_f32 v168, v168
  v_mfma_f32_32x32x16_bf16 v[224:239], v[156:159], v[204:207], v[224:239]
  s_waitcnt lgkmcnt(0)
  global_load_dwordx4 v[84:87], v249, s[14:15] offset:0 sc1
  v_cvt_pk_bf16_f32 v195, v166, v167
  v_exp_f32 v169, v169
  v_exp_f32 v170, v170
  v_cvt_pk_bf16_f32 v196, v168, v169
  v_exp_f32 v171, v171
  v_exp_f32 v172, v172
  v_mfma_f32_32x32x16_bf16 a[48:63], a[108:111], a[104:107], a[48:63]
  s_waitcnt vmcnt(8)
  global_load_dwordx4 a[92:95], v61, s[18:19] offset:0 sc1
  v_cvt_pk_bf16_f32 v197, v170, v171
  v_exp_f32 v173, v173
  v_exp_f32 v174, v174
  v_exp_f32 v175, v175
  v_cvt_pk_bf16_f32 v198, v172, v173
  v_cvt_pk_bf16_f32 v199, v174, v175
  v_mfma_f32_32x32x16_bf16 v[160:175], v[140:143], v[128:131], 0
  ds_read_b128 v[136:139], v7 offset:43008
  global_load_dwordx4 v[88:91], v249, s[16:17] offset:0 sc1
  v_exp_f32 v176, v176
  v_exp_f32 v177, v177
  v_exp_f32 v178, v178
  v_cvt_pk_bf16_f32 v200, v176, v177
  v_exp_f32 v179, v179
  v_exp_f32 v180, v180
  v_mfma_f32_32x32x16_bf16 v[208:223], v[144:147], v[192:195], v[208:223]
  ds_read_b128 v[152:155], v241 offset:1024
  v_cvt_pk_bf16_f32 v201, v178, v179
  v_exp_f32 v181, v181
  v_exp_f32 v182, v182
  v_cvt_pk_bf16_f32 v202, v180, v181
  v_exp_f32 v183, v183
  v_exp_f32 v184, v184
  v_mfma_f32_32x32x16_bf16 v[208:223], v[148:151], v[196:199], v[208:223]
  ds_read_b128 v[156:159], v241 offset:1536
  v_cvt_pk_bf16_f32 v203, v182, v183
  v_exp_f32 v185, v185
  v_exp_f32 v186, v186
  v_cvt_pk_bf16_f32 v204, v184, v185
  v_exp_f32 v187, v187
  v_exp_f32 v188, v188
  v_mfma_f32_32x32x16_bf16 v[32:47], a[68:71], a[64:67], v[32:47]
  global_load_dwordx4 a[96:99], v61, s[12:13] offset:1024 sc1
  v_cvt_pk_bf16_f32 v205, v186, v187
  v_exp_f32 v189, v189
  v_exp_f32 v190, v190
  v_exp_f32 v191, v191
  v_cvt_pk_bf16_f32 v206, v188, v189
  v_cvt_pk_bf16_f32 v207, v190, v191
  v_mfma_f32_32x32x16_bf16 v[176:191], v[140:143], v[132:135], 0
  buffer_load_dwordx2 v[54:55], v56, s[8:11], 0 offen offset:48
  v_exp_f32 v160, v160
  v_exp_f32 v161, v161
  v_exp_f32 v162, v162
  v_cvt_pk_bf16_f32 v192, v160, v161
  v_exp_f32 v163, v163
  v_mfma_f32_32x32x16_bf16 v[224:239], v[144:147], v[200:203], v[224:239]
  v_exp_f32 v164, v164
  v_cvt_pk_bf16_f32 v193, v162, v163
  v_exp_f32 v165, v165
  v_exp_f32 v166, v166
  v_mfma_f32_32x32x16_bf16 v[224:239], v[148:151], v[204:207], v[224:239]
  s_waitcnt lgkmcnt(0)
  global_load_dwordx4 v[92:95], v249, s[18:19] offset:0 sc1
  v_cvt_pk_bf16_f32 v194, v164, v165
  v_exp_f32 v167, v167
  v_exp_f32 v168, v168
  v_cvt_pk_bf16_f32 v195, v166, v167
  v_exp_f32 v169, v169
  v_mfma_f32_32x32x16_bf16 a[16:31], a[76:79], a[64:67], a[16:31]
  global_load_dwordx4 a[100:103], v61, s[14:15] offset:1024 sc1
  v_exp_f32 v170, v170
  v_cvt_pk_bf16_f32 v196, v168, v169
  v_exp_f32 v171, v171
  v_exp_f32 v172, v172
  v_cvt_pk_bf16_f32 v197, v170, v171
  v_mfma_f32_32x32x16_bf16 a[32:47], a[68:71], a[72:75], a[32:47]
  global_load_dwordx4 a[104:107], v61, s[16:17] offset:1024 sc1
  v_exp_f32 v173, v173
  v_exp_f32 v174, v174
  v_exp_f32 v175, v175
  v_cvt_pk_bf16_f32 v198, v172, v173
  v_cvt_pk_bf16_f32 v199, v174, v175
  v_mfma_f32_32x32x16_bf16 v[160:175], v[136:139], v[128:131], 0
  ds_read_b128 v[140:143], v7 offset:44032
  global_load_dwordx4 v[96:99], v249, s[12:13] offset:1024 sc1
  v_exp_f32 v176, v176
  v_exp_f32 v177, v177
  v_exp_f32 v178, v178
  v_cvt_pk_bf16_f32 v200, v176, v177
  v_exp_f32 v179, v179
  v_exp_f32 v180, v180
  v_mfma_f32_32x32x16_bf16 v[208:223], v[152:155], v[192:195], v[208:223]
  ds_read_b128 v[144:147], v241 offset:2048
  v_cvt_pk_bf16_f32 v201, v178, v179
  v_exp_f32 v181, v181
  v_exp_f32 v182, v182
  v_cvt_pk_bf16_f32 v202, v180, v181
  v_exp_f32 v183, v183
  v_exp_f32 v184, v184
  v_mfma_f32_32x32x16_bf16 v[208:223], v[156:159], v[196:199], v[208:223]
  ds_read_b128 v[148:151], v241 offset:2560
  v_cvt_pk_bf16_f32 v203, v182, v183
  v_exp_f32 v185, v185
  v_exp_f32 v186, v186
  v_cvt_pk_bf16_f32 v204, v184, v185
  v_exp_f32 v187, v187
  v_exp_f32 v188, v188
  v_mfma_f32_32x32x16_bf16 a[48:63], a[76:79], a[72:75], a[48:63]
  s_waitcnt vmcnt(7)
  global_load_dwordx4 a[108:111], v61, s[18:19] offset:1024 sc1
  v_cvt_pk_bf16_f32 v205, v186, v187
  v_exp_f32 v189, v189
  v_exp_f32 v190, v190
  v_exp_f32 v191, v191
  v_cvt_pk_bf16_f32 v206, v188, v189
  v_cvt_pk_bf16_f32 v207, v190, v191
  v_mfma_f32_32x32x16_bf16 v[176:191], v[136:139], v[132:135], 0
  global_load_dwordx4 a[192:195], v57, s[32:33] offset:2048 sc1
  v_exp_f32 v160, v160
  v_exp_f32 v161, v161
  v_exp_f32 v162, v162
  v_cvt_pk_bf16_f32 v192, v160, v161
  v_exp_f32 v163, v163
  v_exp_f32 v164, v164
  v_mfma_f32_32x32x16_bf16 v[224:239], v[152:155], v[200:203], v[224:239]
  v_cvt_pk_bf16_f32 v193, v162, v163
  v_exp_f32 v165, v165
  v_exp_f32 v166, v166
  v_cvt_pk_bf16_f32 v194, v164, v165
  v_exp_f32 v167, v167
  v_exp_f32 v168, v168
  v_mfma_f32_32x32x16_bf16 v[224:239], v[156:159], v[204:207], v[224:239]
  s_waitcnt lgkmcnt(0)
  v_cvt_pk_bf16_f32 v195, v166, v167
  v_exp_f32 v169, v169
  v_exp_f32 v170, v170
  v_cvt_pk_bf16_f32 v196, v168, v169
  v_exp_f32 v171, v171
  v_exp_f32 v172, v172
  v_mfma_f32_32x32x16_bf16 v[32:47], a[84:87], a[80:83], v[32:47]
  global_load_dwordx4 a[64:67], v61, s[12:13] offset:2048 sc1
  v_cvt_pk_bf16_f32 v197, v170, v171
  v_exp_f32 v173, v173
  v_exp_f32 v174, v174
  v_exp_f32 v175, v175
  v_cvt_pk_bf16_f32 v198, v172, v173
  v_cvt_pk_bf16_f32 v199, v174, v175
  v_mfma_f32_32x32x16_bf16 v[160:175], v[140:143], v[128:131], 0
  ds_read_b128 v[136:139], v7 offset:45056
  global_load_dwordx4 v[100:103], v249, s[14:15] offset:1024 sc1
  v_exp_f32 v176, v176
  v_exp_f32 v177, v177
  v_exp_f32 v178, v178
  v_cvt_pk_bf16_f32 v200, v176, v177
  v_exp_f32 v179, v179
  v_exp_f32 v180, v180
  v_mfma_f32_32x32x16_bf16 v[208:223], v[144:147], v[192:195], v[208:223]
  ds_read_b128 v[152:155], v241 offset:3072
  v_cvt_pk_bf16_f32 v201, v178, v179
  v_exp_f32 v181, v181
  v_exp_f32 v182, v182
  v_cvt_pk_bf16_f32 v202, v180, v181
  v_exp_f32 v183, v183
  v_exp_f32 v184, v184
  v_mfma_f32_32x32x16_bf16 v[208:223], v[148:151], v[196:199], v[208:223]
  ds_read_b128 v[156:159], v241 offset:3584
  v_cvt_pk_bf16_f32 v203, v182, v183
  v_exp_f32 v185, v185
  v_exp_f32 v186, v186
  v_cvt_pk_bf16_f32 v204, v184, v185
  v_exp_f32 v187, v187
  v_exp_f32 v188, v188
  v_mfma_f32_32x32x16_bf16 a[16:31], a[92:95], a[80:83], a[16:31]
  global_load_dwordx4 a[68:71], v61, s[14:15] offset:2048 sc1
  v_cvt_pk_bf16_f32 v205, v186, v187
  v_exp_f32 v189, v189
  v_exp_f32 v190, v190
mk_wJ4:
  s_cbranch_execz mk_wr1
  v_exp_f32 v191, v191
  v_cvt_pk_bf16_f32 v206, v188, v189
  v_cvt_pk_bf16_f32 v207, v190, v191
  v_mfma_f32_32x32x16_bf16 v[176:191], v[140:143], v[132:135], 0
  global_load_dwordx4 a[196:199], v57, s[34:35] offset:2048 sc1
  v_exp_f32 v160, v160
  v_exp_f32 v161, v161
  v_exp_f32 v162, v162
  v_cvt_pk_bf16_f32 v192, v160, v161
  v_exp_f32 v163, v163
  v_mfma_f32_32x32x16_bf16 v[224:239], v[144:147], v[200:203], v[224:239]
  v_exp_f32 v164, v164
  v_cvt_pk_bf16_f32 v193, v162, v163
  v_exp_f32 v165, v165
  v_exp_f32 v166, v166
  v_mfma_f32_32x32x16_bf16 v[224:239], v[148:151], v[204:207], v[224:239]
  s_waitcnt lgkmcnt(0)
  global_load_dwordx4 v[104:107], v249, s[16:17] offset:1024 sc1
  v_cvt_pk_bf16_f32 v194, v164, v165
  v_exp_f32 v167, v167
  v_exp_f32 v168, v168
  v_cvt_pk_bf16_f32 v195, v166, v167
  v_exp_f32 v169, v169
  v_mfma_f32_32x32x16_bf16 a[32:47], a[84:87], a[88:91], a[32:47]
  global_load_dwordx4 a[72:75], v61, s[16:17] offset:2048 sc1
  v_exp_f32 v170, v170
  v_cvt_pk_bf16_f32 v196, v168, v169
  v_exp_f32 v171, v171
  v_exp_f32 v172, v172
  v_cvt_pk_bf16_f32 v197, v170, v171
  v_mfma_f32_32x32x16_bf16 a[48:63], a[92:95], a[88:91], a[48:63]
  s_waitcnt vmcnt(7)
  global_load_dwordx4 a[76:79], v61, s[18:19] offset:2048 sc1
  v_exp_f32 v173, v173
  v_exp_f32 v174, v174
  v_exp_f32 v175, v175
  v_cvt_pk_bf16_f32 v198, v172, v173
  v_cvt_pk_bf16_f32 v199, v174, v175
  v_mfma_f32_32x32x16_bf16 v[160:175], v[136:139], v[128:131], 0
  ds_read_b128 v[140:143], v7 offset:46080
  global_load_dwordx4 v[108:111], v249, s[18:19] offset:1024 sc1
  v_exp_f32 v176, v176
  v_exp_f32 v177, v177
  v_exp_f32 v178, v178
  v_cvt_pk_bf16_f32 v200, v176, v177
  v_exp_f32 v179, v179
  v_exp_f32 v180, v180
  v_mfma_f32_32x32x16_bf16 v[208:223], v[152:155], v[192:195], v[208:223]
  ds_read_b128 v[144:147], v241 offset:4096
  v_cvt_pk_bf16_f32 v201, v178, v179
  v_exp_f32 v181, v181
  v_exp_f32 v182, v182
  v_cvt_pk_bf16_f32 v202, v180, v181
  v_exp_f32 v183, v183
  v_exp_f32 v184, v184
  v_mfma_f32_32x32x16_bf16 v[208:223], v[156:159], v[196:199], v[208:223]
  ds_read_b128 v[148:151], v241 offset:4608
  v_cvt_pk_bf16_f32 v203, v182, v183
  v_exp_f32 v185, v185
  v_exp_f32 v186, v186
  v_cvt_pk_bf16_f32 v204, v184, v185
  v_exp_f32 v187, v187
  v_exp_f32 v188, v188
  v_mfma_f32_32x32x16_bf16 v[32:47], a[100:103], a[96:99], v[32:47]
  global_load_dwordx4 a[80:83], v61, s[12:13] offset:3072 sc1
  v_cvt_pk_bf16_f32 v205, v186, v187
  v_exp_f32 v189, v189
  v_exp_f32 v190, v190
  v_exp_f32 v191, v191
  v_cvt_pk_bf16_f32 v206, v188, v189
  v_cvt_pk_bf16_f32 v207, v190, v191
  v_mfma_f32_32x32x16_bf16 v[176:191], v[136:139], v[132:135], 0
  global_load_dword v60, v59, s[38:39] sc1
  v_exp_f32 v160, v160
  v_exp_f32 v161, v161
  v_exp_f32 v162, v162
  v_cvt_pk_bf16_f32 v192, v160, v161
  v_exp_f32 v163, v163
  v_exp_f32 v164, v164
  v_mfma_f32_32x32x16_bf16 v[224:239], v[152:155], v[200:203], v[224:239]
  v_cvt_pk_bf16_f32 v193, v162, v163
  v_exp_f32 v165, v165
  v_exp_f32 v166, v166
  v_cvt_pk_bf16_f32 v194, v164, v165
  v_exp_f32 v167, v167
  v_exp_f32 v168, v168
  v_mfma_f32_32x32x16_bf16 v[224:239], v[156:159], v[204:207], v[224:239]
  s_waitcnt lgkmcnt(0)
  global_load_dwordx4 v[112:115], v249, s[12:13] offset:2048 sc1
  v_cvt_pk_bf16_f32 v195, v166, v167
  v_exp_f32 v169, v169
  v_exp_f32 v170, v170
  v_cvt_pk_bf16_f32 v196, v168, v169
  v_exp_f32 v171, v171
  v_exp_f32 v172, v172
  v_mfma_f32_32x32x16_bf16 a[16:31], a[108:111], a[96:99], a[16:31]
  global_load_dwordx4 a[84:87], v61, s[14:15] offset:3072 sc1
  v_cvt_pk_bf16_f32 v197, v170, v171
  v_exp_f32 v173, v173
  v_exp_f32 v174, v174
  v_exp_f32 v175, v175
  v_cvt_pk_bf16_f32 v198, v172, v173
  v_cvt_pk_bf16_f32 v199, v174, v175
  v_mfma_f32_32x32x16_bf16 v[160:175], v[140:143], v[128:131], 0
  ds_read_b128 v[136:139], v7 offset:47104
  global_load_dwordx4 v[116:119], v249, s[14:15] offset:2048 sc1
  v_exp_f32 v176, v176
  v_exp_f32 v177, v177
  v_exp_f32 v178, v178
  v_cvt_pk_bf16_f32 v200, v176, v177
  v_exp_f32 v179, v179
  v_mfma_f32_32x32x16_bf16 v[208:223], v[144:147], v[192:195], v[208:223]
  ds_read_b128 v[152:155], v241 offset:5120
  v_exp_f32 v180, v180
  v_cvt_pk_bf16_f32 v201, v178, v179
  v_exp_f32 v181, v181
  v_exp_f32 v182, v182
  v_mfma_f32_32x32x16_bf16 v[208:223], v[148:151], v[196:199], v[208:223]
  ds_read_b128 v[156:159], v241 offset:5632
  v_cvt_pk_bf16_f32 v202, v180, v181
  v_exp_f32 v183, v183
  v_exp_f32 v184, v184
  v_cvt_pk_bf16_f32 v203, v182, v183
  v_exp_f32 v185, v185
  v_mfma_f32_32x32x16_bf16 a[32:47], a[100:103], a[104:107], a[32:47]
  global_load_dwordx4 a[88:91], v61, s[16:17] offset:3072 sc1
  v_exp_f32 v186, v186
  v_cvt_pk_bf16_f32 v204, v184, v185
  v_exp_f32 v187, v187
  v_exp_f32 v188, v188
  v_cvt_pk_bf16_f32 v205, v186, v187
  v_mfma_f32_32x32x16_bf16 a[48:63], a[108:111], a[104:107], a[48:63]
  s_waitcnt vmcnt(7)
  global_load_dwordx4 a[92:95], v61, s[18:19] offset:3072 sc1
  v_exp_f32 v189, v189
  v_exp_f32 v190, v190
  v_exp_f32 v191, v191
  v_cvt_pk_bf16_f32 v206, v188, v189
  v_cvt_pk_bf16_f32 v207, v190, v191
  v_mfma_f32_32x32x16_bf16 v[176:191], v[140:143], v[132:135], 0
  global_load_dwordx4 a[200:203], v57, s[32:33] offset:3072 sc1
  v_exp_f32 v160, v160
  v_exp_f32 v161, v161
  v_exp_f32 v162, v162
  v_cvt_pk_bf16_f32 v192, v160, v161
  v_exp_f32 v163, v163
  v_exp_f32 v164, v164
  v_mfma_f32_32x32x16_bf16 v[224:239], v[144:147], v[200:203], v[224:239]
  v_cvt_pk_bf16_f32 v193, v162, v163
  v_exp_f32 v165, v165
  v_exp_f32 v166, v166
  v_cvt_pk_bf16_f32 v194, v164, v165
  v_exp_f32 v167, v167
  v_exp_f32 v168, v168
  v_mfma_f32_32x32x16_bf16 v[224:239], v[148:151], v[204:207], v[224:239]
  s_waitcnt lgkmcnt(0)
  v_cvt_pk_bf16_f32 v195, v166, v167
  v_exp_f32 v169, v169
  v_exp_f32 v170, v170
  v_cvt_pk_bf16_f32 v196, v168, v169
  v_exp_f32 v171, v171
  v_exp_f32 v172, v172
  v_mfma_f32_32x32x16_bf16 v[32:47], a[68:71], a[64:67], v[32:47]
  global_load_dwordx4 a[96:99], v248, s[12:13] offset:-4096 sc1
  v_cvt_pk_bf16_f32 v197, v170, v171
  v_exp_f32 v173, v173
  v_exp_f32 v174, v174
  v_exp_f32 v175, v175
  v_cvt_pk_bf16_f32 v198, v172, v173
  v_cvt_pk_bf16_f32 v199, v174, v175
  v_mfma_f32_32x32x16_bf16 v[160:175], v[136:139], v[128:131], 0
  ds_read_b128 v[140:143], v7 offset:48128
  global_load_dwordx4 v[120:123], v249, s[16:17] offset:2048 sc1
  v_exp_f32 v176, v176
  v_exp_f32 v177, v177
  v_exp_f32 v178, v178
  v_cvt_pk_bf16_f32 v200, v176, v177
  v_exp_f32 v179, v179
  v_exp_f32 v180, v180
  v_mfma_f32_32x32x16_bf16 v[208:223], v[152:155], v[192:195], v[208:223]
  ds_read_b128 v[144:147], v241 offset:6144
  v_cvt_pk_bf16_f32 v201, v178, v179
  v_exp_f32 v181, v181
  v_exp_f32 v182, v182
  v_cvt_pk_bf16_f32 v202, v180, v181
  v_exp_f32 v183, v183
  v_exp_f32 v184, v184
  v_mfma_f32_32x32x16_bf16 v[208:223], v[156:159], v[196:199], v[208:223]
  ds_read_b128 v[148:151], v241 offset:6656
  v_cvt_pk_bf16_f32 v203, v182, v183
  v_exp_f32 v185, v185
  v_exp_f32 v186, v186
  v_cvt_pk_bf16_f32 v204, v184, v185
  v_exp_f32 v187, v187
  v_exp_f32 v188, v188
  v_mfma_f32_32x32x16_bf16 a[16:31], a[76:79], a[64:67], a[16:31]
  global_load_dwordx4 a[100:103], v248, s[14:15] offset:-4096 sc1
  v_cvt_pk_bf16_f32 v205, v186, v187
  v_exp_f32 v189, v189
  v_exp_f32 v190, v190
  v_exp_f32 v191, v191
  v_cvt_pk_bf16_f32 v206, v188, v189
  v_cvt_pk_bf16_f32 v207, v190, v191
  v_mfma_f32_32x32x16_bf16 v[176:191], v[136:139], v[132:135], 0
  global_load_dwordx4 a[204:207], v57, s[34:35] offset:3072 sc1
  v_exp_f32 v160, v160
  v_exp_f32 v161, v161
  v_exp_f32 v162, v162
  v_cvt_pk_bf16_f32 v192, v160, v161
  v_exp_f32 v163, v163
  v_exp_f32 v164, v164
  v_mfma_f32_32x32x16_bf16 v[224:239], v[152:155], v[200:203], v[224:239]
  v_cvt_pk_bf16_f32 v193, v162, v163
  v_exp_f32 v165, v165
  v_exp_f32 v166, v166
  v_cvt_pk_bf16_f32 v194, v164, v165
  v_exp_f32 v167, v167
  v_exp_f32 v168, v168
  v_mfma_f32_32x32x16_bf16 v[224:239], v[156:159], v[204:207], v[224:239]
  s_waitcnt lgkmcnt(0)
  global_load_dwordx4 v[124:127], v249, s[18:19] offset:2048 sc1
  v_cvt_pk_bf16_f32 v195, v166, v167
  v_exp_f32 v169, v169
  v_exp_f32 v170, v170
  v_cvt_pk_bf16_f32 v196, v168, v169
  v_exp_f32 v171, v171
  v_exp_f32 v172, v172
  v_mfma_f32_32x32x16_bf16 a[32:47], a[68:71], a[72:75], a[32:47]
  global_load_dwordx4 a[104:107], v248, s[16:17] offset:-4096 sc1
  v_cvt_pk_bf16_f32 v197, v170, v171
  v_exp_f32 v173, v173
  v_exp_f32 v174, v174
  v_exp_f32 v175, v175
  v_cvt_pk_bf16_f32 v198, v172, v173
  v_cvt_pk_bf16_f32 v199, v174, v175
  v_mfma_f32_32x32x16_bf16 v[160:175], v[140:143], v[128:131], 0
  ds_read_b128 v[136:139], v7 offset:49152
  global_load_dwordx4 a[0:3], v249, s[12:13] offset:3072 sc1
  v_exp_f32 v176, v176
  v_exp_f32 v177, v177
  v_exp_f32 v178, v178
  v_cvt_pk_bf16_f32 v200, v176, v177
  v_exp_f32 v179, v179
  v_mfma_f32_32x32x16_bf16 v[208:223], v[144:147], v[192:195], v[208:223]
  ds_read_b128 v[152:155], v241 offset:7168
  v_exp_f32 v180, v180
  v_cvt_pk_bf16_f32 v201, v178, v179
  v_exp_f32 v181, v181
  v_exp_f32 v182, v182
  v_mfma_f32_32x32x16_bf16 v[208:223], v[148:151], v[196:199], v[208:223]
  ds_read_b128 v[156:159], v241 offset:7680
  v_cvt_pk_bf16_f32 v202, v180, v181
  v_exp_f32 v183, v183
  v_exp_f32 v184, v184
  v_cvt_pk_bf16_f32 v203, v182, v183
  v_exp_f32 v185, v185
  v_mfma_f32_32x32x16_bf16 a[48:63], a[76:79], a[72:75], a[48:63]
  s_waitcnt vmcnt(8)
  global_load_dwordx4 a[108:111], v248, s[18:19] offset:-4096 sc1
  v_exp_f32 v186, v186
  v_cvt_pk_bf16_f32 v204, v184, v185
  v_exp_f32 v187, v187
  v_exp_f32 v188, v188
  v_cvt_pk_bf16_f32 v205, v186, v187
  v_mfma_f32_32x32x16_bf16 v[32:47], a[84:87], a[80:83], v[32:47]
  global_load_dwordx4 a[64:67], v248, s[12:13] offset:-3072 sc1
  v_exp_f32 v189, v189
  v_exp_f32 v190, v190
  v_exp_f32 v191, v191
  v_cvt_pk_bf16_f32 v206, v188, v189
  v_cvt_pk_bf16_f32 v207, v190, v191
  v_mfma_f32_32x32x16_bf16 v[176:191], v[140:143], v[132:135], 0
  global_load_dwordx4 a[4:7], v249, s[14:15] offset:3072 sc1
  v_exp_f32 v160, v160
  v_exp_f32 v161, v161
  v_exp_f32 v162, v162
  v_cvt_pk_bf16_f32 v192, v160, v161
  v_exp_f32 v163, v163
  v_exp_f32 v164, v164
  v_mfma_f32_32x32x16_bf16 v[224:239], v[144:147], v[200:203], v[224:239]
  v_cvt_pk_bf16_f32 v193, v162, v163
  v_exp_f32 v165, v165
  v_exp_f32 v166, v166
  v_cvt_pk_bf16_f32 v194, v164, v165
  v_exp_f32 v167, v167
  v_exp_f32 v168, v168
  v_mfma_f32_32x32x16_bf16 v[224:239], v[148:151], v[204:207], v[224:239]
  s_waitcnt lgkmcnt(0)
  v_cvt_pk_bf16_f32 v195, v166, v167
  v_exp_f32 v169, v169
  v_exp_f32 v170, v170
  v_cvt_pk_bf16_f32 v196, v168, v169
  v_exp_f32 v171, v171
  v_exp_f32 v172, v172
  v_mfma_f32_32x32x16_bf16 a[16:31], a[92:95], a[80:83], a[16:31]
  global_load_dwordx4 a[68:71], v248, s[14:15] offset:-3072 sc1
  v_cvt_pk_bf16_f32 v197, v170, v171
  v_exp_f32 v173, v173
  v_exp_f32 v174, v174
  v_exp_f32 v175, v175
  v_cvt_pk_bf16_f32 v198, v172, v173
  v_cvt_pk_bf16_f32 v199, v174, v175
  v_mfma_f32_32x32x16_bf16 v[160:175], v[136:139], v[128:131], 0
  ds_read_b128 v[140:143], v7 offset:50176
  v_add_u32 v241, v242, v241
  v_exp_f32 v176, v176
  v_exp_f32 v177, v177
  v_exp_f32 v178, v178
  v_cvt_pk_bf16_f32 v200, v176, v177
  v_exp_f32 v179, v179
  v_mfma_f32_32x32x16_bf16 v[208:223], v[152:155], v[192:195], v[208:223]
  ds_read_b128 v[144:147], v241 offset:0
  v_exp_f32 v180, v180
  v_cvt_pk_bf16_f32 v201, v178, v179
  v_exp_f32 v181, v181
  v_exp_f32 v182, v182
  v_cvt_pk_bf16_f32 v202, v180, v181
  v_exp_f32 v183, v183
  v_mfma_f32_32x32x16_bf16 v[208:223], v[156:159], v[196:199], v[208:223]
  ds_read_b128 v[148:151], v241 offset:512
  v_exp_f32 v184, v184
  v_cvt_pk_bf16_f32 v203, v182, v183
  v_exp_f32 v185, v185
  v_exp_f32 v186, v186
  v_cvt_pk_bf16_f32 v204, v184, v185
  v_exp_f32 v187, v187
  v_exp_f32 v188, v188
  v_mfma_f32_32x32x16_bf16 a[32:47], a[84:87], a[88:91], a[32:47]
  global_load_dwordx4 a[72:75], v248, s[16:17] offset:-3072 sc1
  v_cvt_pk_bf16_f32 v205, v186, v187
  v_exp_f32 v189, v189
  v_exp_f32 v190, v190
  v_exp_f32 v191, v191
  v_cvt_pk_bf16_f32 v206, v188, v189
  v_cvt_pk_bf16_f32 v207, v190, v191
  v_cmp_ne_u32 vcc, s94, v60
  s_cbranch_vccnz mk_ps_spin
mk_ps_ok:
  v_mfma_f32_32x32x16_bf16 v[176:191], v[136:139], v[132:135], 0
  global_load_dwordx4 a[208:211], v62, s[32:33] offset:0 sc1
  v_exp_f32 v160, v160
  v_exp_f32 v161, v161
  v_exp_f32 v162, v162
  v_cvt_pk_bf16_f32 v192, v160, v161
  v_exp_f32 v163, v163
  v_exp_f32 v164, v164
  v_mfma_f32_32x32x16_bf16 v[224:239], v[152:155], v[200:203], v[224:239]
  v_cvt_pk_bf16_f32 v193, v162, v163
  v_exp_f32 v165, v165
  v_exp_f32 v166, v166
  v_cvt_pk_bf16_f32 v194, v164, v165
  v_exp_f32 v167, v167
  v_exp_f32 v168, v168
  v_mfma_f32_32x32x16_bf16 v[224:239], v[156:159], v[204:207], v[224:239]
  s_waitcnt lgkmcnt(0)
  global_load_dwordx4 a[8:11], v249, s[16:17] offset:3072 sc1
  v_cvt_pk_bf16_f32 v195, v166, v167
  v_exp_f32 v169, v169
  v_exp_f32 v170, v170
  v_cvt_pk_bf16_f32 v196, v168, v169
  v_exp_f32 v171, v171
  v_exp_f32 v172, v172
  v_mfma_f32_32x32x16_bf16 a[48:63], a[92:95], a[88:91], a[48:63]
  s_waitcnt vmcnt(6)
  global_load_dwordx4 a[76:79], v248, s[18:19] offset:-3072 sc1
  v_cvt_pk_bf16_f32 v197, v170, v171
  v_exp_f32 v173, v173
  v_exp_f32 v174, v174
  v_exp_f32 v175, v175
  v_cvt_pk_bf16_f32 v198, v172, v173
  v_cvt_pk_bf16_f32 v199, v174, v175
  v_mfma_f32_32x32x16_bf16 v[160:175], v[140:143], v[128:131], 0
  ds_read_b128 v[136:139], v7 offset:51200
  global_load_dwordx4 a[12:15], v249, s[18:19] offset:3072 sc1
  v_exp_f32 v176, v176
  v_exp_f32 v177, v177
  v_exp_f32 v178, v178
  v_cvt_pk_bf16_f32 v200, v176, v177
  v_exp_f32 v179, v179
  v_mfma_f32_32x32x16_bf16 v[208:223], v[144:147], v[192:195], v[208:223]
  ds_read_b128 v[152:155], v241 offset:1024
  v_exp_f32 v180, v180
  v_cvt_pk_bf16_f32 v201, v178, v179
  v_exp_f32 v181, v181
  v_exp_f32 v182, v182
  v_mfma_f32_32x32x16_bf16 v[208:223], v[148:151], v[196:199], v[208:223]
  ds_read_b128 v[156:159], v241 offset:1536
  v_cvt_pk_bf16_f32 v202, v180, v181
  v_exp_f32 v183, v183
  v_exp_f32 v184, v184
  v_cvt_pk_bf16_f32 v203, v182, v183
  v_exp_f32 v185, v185
  v_mfma_f32_32x32x16_bf16 v[32:47], a[100:103], a[96:99], v[32:47]
  global_load_dwordx4 a[80:83], v248, s[12:13] offset:-2048 sc1
  v_exp_f32 v186, v186
  v_cvt_pk_bf16_f32 v204, v184, v185
  v_exp_f32 v187, v187
  v_exp_f32 v188, v188
  v_cvt_pk_bf16_f32 v205, v186, v187
  v_mfma_f32_32x32x16_bf16 a[16:31], a[108:111], a[96:99], a[16:31]
  global_load_dwordx4 a[84:87], v248, s[14:15] offset:-2048 sc1
  v_exp_f32 v189, v189
  v_exp_f32 v190, v190
  v_exp_f32 v191, v191
  v_cvt_pk_bf16_f32 v206, v188, v189
  v_cvt_pk_bf16_f32 v207, v190, v191
  v_mfma_f32_32x32x16_bf16 v[176:191], v[140:143], v[132:135], 0
  global_load_dwordx4 a[112:115], v250, s[12:13] offset:-4096 sc1
  v_exp_f32 v160, v160
  v_exp_f32 v161, v161
  v_exp_f32 v162, v162
  v_cvt_pk_bf16_f32 v192, v160, v161
  v_exp_f32 v163, v163
  v_exp_f32 v164, v164
  v_mfma_f32_32x32x16_bf16 v[224:239], v[144:147], v[200:203], v[224:239]
  v_cvt_pk_bf16_f32 v193, v162, v163
  v_exp_f32 v165, v165
  v_exp_f32 v166, v166
  v_cvt_pk_bf16_f32 v194, v164, v165
  v_exp_f32 v167, v167
  v_exp_f32 v168, v168
  v_mfma_f32_32x32x16_bf16 v[224:239], v[148:151], v[204:207], v[224:239]
  s_waitcnt lgkmcnt(0)
  v_cvt_pk_bf16_f32 v195, v166, v167
  v_exp_f32 v169, v169
  v_exp_f32 v170, v170
  v_cvt_pk_bf16_f32 v196, v168, v169
  v_exp_f32 v171, v171
  v_exp_f32 v172, v172
  v_mfma_f32_32x32x16_bf16 a[32:47], a[100:103], a[104:107], a[32:47]
  global_load_dwordx4 a[88:91], v248, s[16:17] offset:-2048 sc1
  v_cvt_pk_bf16_f32 v197, v170, v171
  v_exp_f32 v173, v173
  v_exp_f32 v174, v174
  v_exp_f32 v175, v175
  v_cvt_pk_bf16_f32 v198, v172, v173
  v_cvt_pk_bf16_f32 v199, v174, v175
  v_mfma_f32_32x32x16_bf16 v[160:175], v[136:139], v[128:131], 0
  ds_read_b128 v[140:143], v7 offset:52224
  global_load_dwordx4 a[116:119], v250, s[14:15] offset:-4096 sc1
  v_exp_f32 v176, v176
  v_exp_f32 v177, v177
  v_exp_f32 v178, v178
  v_cvt_pk_bf16_f32 v200, v176, v177
  v_exp_f32 v179, v179
  v_exp_f32 v180, v180
  v_mfma_f32_32x32x16_bf16 v[208:223], v[152:155], v[192:195], v[208:223]
  ds_read_b128 v[144:147], v241 offset:2048
  v_cvt_pk_bf16_f32 v201, v178, v179
  v_exp_f32 v181, v181
  v_exp_f32 v182, v182
  v_cvt_pk_bf16_f32 v202, v180, v181
  v_exp_f32 v183, v183
  v_exp_f32 v184, v184
  v_mfma_f32_32x32x16_bf16 v[208:223], v[156:159], v[196:199], v[208:223]
  ds_read_b128 v[148:151], v241 offset:2560
  v_cvt_pk_bf16_f32 v203, v182, v183
  v_exp_f32 v185, v185
  v_exp_f32 v186, v186
  v_cvt_pk_bf16_f32 v204, v184, v185
  v_exp_f32 v187, v187
  v_exp_f32 v188, v188
  v_mfma_f32_32x32x16_bf16 a[48:63], a[108:111], a[104:107], a[48:63]
  s_waitcnt vmcnt(6)
  global_load_dwordx4 a[92:95], v248, s[18:19] offset:-2048 sc1
  v_cvt_pk_bf16_f32 v205, v186, v187
  v_exp_f32 v189, v189
  v_exp_f32 v190, v190
  v_exp_f32 v191, v191
  v_cvt_pk_bf16_f32 v206, v188, v189
  v_cvt_pk_bf16_f32 v207, v190, v191
  v_mfma_f32_32x32x16_bf16 v[176:191], v[136:139], v[132:135], 0
  global_load_dwordx4 a[212:215], v62, s[34:35] offset:0 sc1
  v_exp_f32 v160, v160
  v_exp_f32 v161, v161
  v_exp_f32 v162, v162
  v_cvt_pk_bf16_f32 v192, v160, v161
  v_exp_f32 v163, v163
  v_mfma_f32_32x32x16_bf16 v[224:239], v[152:155], v[200:203], v[224:239]
  v_exp_f32 v164, v164
  v_cvt_pk_bf16_f32 v193, v162, v163
  v_exp_f32 v165, v165
  v_exp_f32 v166, v166
  v_mfma_f32_32x32x16_bf16 v[224:239], v[156:159], v[204:207], v[224:239]
  s_waitcnt lgkmcnt(0)
  v_cvt_pk_bf16_f32 v194, v164, v165
  v_exp_f32 v167, v167
  v_exp_f32 v168, v168
  v_cvt_pk_bf16_f32 v195, v166, v167
  v_exp_f32 v169, v169
  v_mfma_f32_32x32x16_bf16 v[32:47], a[68:71], a[64:67], v[32:47]
  global_load_dwordx4 a[96:99], v248, s[12:13] offset:-1024 sc1
  v_exp_f32 v170, v170
  v_cvt_pk_bf16_f32 v196, v168, v169
  v_exp_f32 v171, v171
  v_exp_f32 v172, v172
  v_cvt_pk_bf16_f32 v197, v170, v171
  v_mfma_f32_32x32x16_bf16 a[16:31], a[76:79], a[64:67], a[16:31]
  global_load_dwordx4 a[100:103], v248, s[14:15] offset:-1024 sc1
  v_exp_f32 v173, v173
  v_exp_f32 v174, v174
  v_exp_f32 v175, v175
  v_cvt_pk_bf16_f32 v198, v172, v173
  v_cvt_pk_bf16_f32 v199, v174, v175
  v_mfma_f32_32x32x16_bf16 v[160:175], v[140:143], v[128:131], 0
  ds_read_b128 v[136:139], v7 offset:53248
  global_load_dwordx4 a[120:123], v250, s[16:17] offset:-4096 sc1
  v_exp_f32 v176, v176
  v_exp_f32 v177, v177
  v_exp_f32 v178, v178
  v_cvt_pk_bf16_f32 v200, v176, v177
  v_exp_f32 v179, v179
  v_exp_f32 v180, v180
  v_mfma_f32_32x32x16_bf16 v[208:223], v[144:147], v[192:195], v[208:223]
  ds_read_b128 v[152:155], v241 offset:3072
  v_cvt_pk_bf16_f32 v201, v178, v179
  v_exp_f32 v181, v181
  v_exp_f32 v182, v182
  v_cvt_pk_bf16_f32 v202, v180, v181
  v_exp_f32 v183, v183
  v_exp_f32 v184, v184
  v_mfma_f32_32x32x16_bf16 v[208:223], v[148:151], v[196:199], v[208:223]
  ds_read_b128 v[156:159], v241 offset:3584
  v_cvt_pk_bf16_f32 v203, v182, v183
  v_exp_f32 v185, v185
  v_exp_f32 v186, v186
  v_cvt_pk_bf16_f32 v204, v184, v185
  v_exp_f32 v187, v187
  v_exp_f32 v188, v188
  v_mfma_f32_32x32x16_bf16 a[32:47], a[68:71], a[72:75], a[32:47]
  global_load_dwordx4 a[104:107], v248, s[16:17] offset:-1024 sc1
  v_cvt_pk_bf16_f32 v205, v186, v187
  v_exp_f32 v189, v189
  v_exp_f32 v190, v190
  v_exp_f32 v191, v191
  v_cvt_pk_bf16_f32 v206, v188, v189
  v_cvt_pk_bf16_f32 v207, v190, v191
  v_mfma_f32_32x32x16_bf16 v[176:191], v[140:143], v[132:135], 0
  global_load_dwordx4 a[216:219], v62, s[32:33] offset:1024 sc1
  v_exp_f32 v160, v160
  v_exp_f32 v161, v161
  v_exp_f32 v162, v162
  v_cvt_pk_bf16_f32 v192, v160, v161
  v_exp_f32 v163, v163
  v_exp_f32 v164, v164
  v_mfma_f32_32x32x16_bf16 v[224:239], v[144:147], v[200:203], v[224:239]
  v_cvt_pk_bf16_f32 v193, v162, v163
  v_exp_f32 v165, v165
  v_exp_f32 v166, v166
  v_cvt_pk_bf16_f32 v194, v164, v165
  v_exp_f32 v167, v167
  v_exp_f32 v168, v168
  v_mfma_f32_32x32x16_bf16 v[224:239], v[148:151], v[204:207], v[224:239]
  s_waitcnt lgkmcnt(0)
  global_load_dwordx4 a[124:127], v250, s[18:19] offset:-4096 sc1
  v_cvt_pk_bf16_f32 v195, v166, v167
  v_exp_f32 v169, v169
  v_exp_f32 v170, v170
  v_cvt_pk_bf16_f32 v196, v168, v169
  v_exp_f32 v171, v171
  v_exp_f32 v172, v172
  v_mfma_f32_32x32x16_bf16 a[48:63], a[76:79], a[72:75], a[48:63]
  s_waitcnt vmcnt(7)
  global_load_dwordx4 a[108:111], v248, s[18:19] offset:-1024 sc1
  v_cvt_pk_bf16_f32 v197, v170, v171
  v_exp_f32 v173, v173
  v_exp_f32 v174, v174
  v_exp_f32 v175, v175
  v_cvt_pk_bf16_f32 v198, v172, v173
  v_cvt_pk_bf16_f32 v199, v174, v175
  v_mfma_f32_32x32x16_bf16 v[160:175], v[136:139], v[128:131], 0
  ds_read_b128 v[140:143], v7 offset:54272
  global_load_dwordx4 a[128:131], v250, s[12:13] offset:-3072 sc1
  v_exp_f32 v176, v176
  v_exp_f32 v177, v177
  v_exp_f32 v178, v178
  v_cvt_pk_bf16_f32 v200, v176, v177
  v_exp_f32 v179, v179
  v_exp_f32 v180, v180
  v_mfma_f32_32x32x16_bf16 v[208:223], v[152:155], v[192:195], v[208:223]
  ds_read_b128 v[144:147], v241 offset:4096
  v_cvt_pk_bf16_f32 v201, v178, v179
  v_exp_f32 v181, v181
  v_exp_f32 v182, v182
  v_cvt_pk_bf16_f32 v202, v180, v181
  v_exp_f32 v183, v183
  v_exp_f32 v184, v184
  v_mfma_f32_32x32x16_bf16 v[208:223], v[156:159], v[196:199], v[208:223]
  ds_read_b128 v[148:151], v241 offset:4608
  v_cvt_pk_bf16_f32 v203, v182, v183
  v_exp_f32 v185, v185
  v_exp_f32 v186, v186
  v_cvt_pk_bf16_f32 v204, v184, v185
  v_exp_f32 v187, v187
  v_exp_f32 v188, v188
  v_mfma_f32_32x32x16_bf16 v[32:47], a[84:87], a[80:83], v[32:47]
  global_load_dwordx4 a[64:67], v248, s[12:13] offset:0 sc1
  v_cvt_pk_bf16_f32 v205, v186, v187
  v_exp_f32 v189, v189
  v_exp_f32 v190, v190
  v_exp_f32 v191, v191
  v_cvt_pk_bf16_f32 v206, v188, v189
  v_cvt_pk_bf16_f32 v207, v190, v191
  v_mfma_f32_32x32x16_bf16 v[176:191], v[136:139], v[132:135], 0
  global_load_dwordx4 a[132:135], v250, s[14:15] offset:-3072 sc1
  v_exp_f32 v160, v160
  v_exp_f32 v161, v161
  v_exp_f32 v162, v162
  v_cvt_pk_bf16_f32 v192, v160, v161
  v_exp_f32 v163, v163
  v_mfma_f32_32x32x16_bf16 v[224:239], v[152:155], v[200:203], v[224:239]
  v_exp_f32 v164, v164
  v_cvt_pk_bf16_f32 v193, v162, v163
  v_exp_f32 v165, v165
  v_exp_f32 v166, v166
  v_mfma_f32_32x32x16_bf16 v[224:239], v[156:159], v[204:207], v[224:239]
  s_waitcnt lgkmcnt(0)
  v_cvt_pk_bf16_f32 v194, v164, v165
  v_exp_f32 v167, v167
  v_exp_f32 v168, v168
  v_cvt_pk_bf16_f32 v195, v166, v167
  v_exp_f32 v169, v169
  v_mfma_f32_32x32x16_bf16 a[16:31], a[92:95], a[80:83], a[16:31]
  global_load_dwordx4 a[68:71], v248, s[14:15] offset:0 sc1
  v_exp_f32 v170, v170
  v_cvt_pk_bf16_f32 v196, v168, v169
  v_exp_f32 v171, v171
  v_exp_f32 v172, v172
  v_cvt_pk_bf16_f32 v197, v170, v171
  v_mfma_f32_32x32x16_bf16 a[32:47], a[84:87], a[88:91], a[32:47]
  global_load_dwordx4 a[72:75], v248, s[16:17] offset:0 sc1
  v_exp_f32 v173, v173
  v_exp_f32 v174, v174
  v_exp_f32 v175, v175
  v_cvt_pk_bf16_f32 v198, v172, v173
  v_cvt_pk_bf16_f32 v199, v174, v175
  v_mfma_f32_32x32x16_bf16 v[160:175], v[140:143], v[128:131], 0
  ds_read_b128 v[136:139], v7 offset:55296
  global_load_dwordx4 a[136:139], v250, s[16:17] offset:-3072 sc1
  v_exp_f32 v176, v176
  v_exp_f32 v177, v177
  v_exp_f32 v178, v178
  v_cvt_pk_bf16_f32 v200, v176, v177
  v_exp_f32 v179, v179
  v_exp_f32 v180, v180
  v_mfma_f32_32x32x16_bf16 v[208:223], v[144:147], v[192:195], v[208:223]
  ds_read_b128 v[152:155], v241 offset:5120
  v_cvt_pk_bf16_f32 v201, v178, v179
  v_exp_f32 v181, v181
  v_exp_f32 v182, v182
  v_cvt_pk_bf16_f32 v202, v180, v181
  v_exp_f32 v183, v183
  v_exp_f32 v184, v184
  v_mfma_f32_32x32x16_bf16 v[208:223], v[148:151], v[196:199], v[208:223]
  ds_read_b128 v[156:159], v241 offset:5632
  v_cvt_pk_bf16_f32 v203, v182, v183
  v_exp_f32 v185, v185
  v_exp_f32 v186, v186
  v_cvt_pk_bf16_f32 v204, v184, v185
  v_exp_f32 v187, v187
  v_exp_f32 v188, v188
  v_mfma_f32_32x32x16_bf16 a[48:63], a[92:95], a[88:91], a[48:63]
  s_waitcnt vmcnt(6)
  global_load_dwordx4 a[76:79], v248, s[18:19] offset:0 sc1
  v_cvt_pk_bf16_f32 v205, v186, v187
  v_exp_f32 v189, v189
  v_exp_f32 v190, v190
  v_exp_f32 v191, v191
  v_cvt_pk_bf16_f32 v206, v188, v189
  v_cvt_pk_bf16_f32 v207, v190, v191
  v_mfma_f32_32x32x16_bf16 v[176:191], v[140:143], v[132:135], 0
  global_load_dwordx4 a[220:223], v62, s[34:35] offset:1024 sc1
  v_exp_f32 v160, v160
  v_exp_f32 v161, v161
  v_exp_f32 v162, v162
  v_cvt_pk_bf16_f32 v192, v160, v161
  v_exp_f32 v163, v163
  v_exp_f32 v164, v164
  v_mfma_f32_32x32x16_bf16 v[224:239], v[144:147], v[200:203], v[224:239]
  v_cvt_pk_bf16_f32 v193, v162, v163
  v_exp_f32 v165, v165
  v_exp_f32 v166, v166
  v_cvt_pk_bf16_f32 v194, v164, v165
  v_exp_f32 v167, v167
  v_exp_f32 v168, v168
  v_mfma_f32_32x32x16_bf16 v[224:239], v[148:151], v[204:207], v[224:239]
  s_waitcnt lgkmcnt(0)
  v_cvt_pk_bf16_f32 v195, v166, v167
mk_wJ5:
  s_cbranch_execz mk_wr1
  v_exp_f32 v169, v169
  v_exp_f32 v170, v170
  v_cvt_pk_bf16_f32 v196, v168, v169
  v_exp_f32 v171, v171
  v_exp_f32 v172, v172
  v_mfma_f32_32x32x16_bf16 v[32:47], a[100:103], a[96:99], v[32:47]
  global_load_dwordx4 a[80:83], v248, s[12:13] offset:1024 sc1
  v_cvt_pk_bf16_f32 v197, v170, v171
  v_exp_f32 v173, v173
  v_exp_f32 v174, v174
  v_exp_f32 v175, v175
  v_cvt_pk_bf16_f32 v198, v172, v173
  v_cvt_pk_bf16_f32 v199, v174, v175
  v_mfma_f32_32x32x16_bf16 v[160:175], v[136:139], v[128:131], 0
  ds_read_b128 v[140:143], v7 offset:56320
  global_load_dwordx4 a[140:143], v250, s[18:19] offset:-3072 sc1
  v_exp_f32 v176, v176
  v_exp_f32 v177, v177
  v_exp_f32 v178, v178
  v_cvt_pk_bf16_f32 v200, v176, v177
  v_exp_f32 v179, v179
  v_mfma_f32_32x32x16_bf16 v[208:223], v[152:155], v[192:195], v[208:223]
  ds_read_b128 v[144:147], v241 offset:6144
  v_exp_f32 v180, v180
  v_cvt_pk_bf16_f32 v201, v178, v179
  v_exp_f32 v181, v181
  v_exp_f32 v182, v182
  v_mfma_f32_32x32x16_bf16 v[208:223], v[156:159], v[196:199], v[208:223]
  ds_read_b128 v[148:151], v241 offset:6656
  v_cvt_pk_bf16_f32 v202, v180, v181
  v_exp_f32 v183, v183
  v_exp_f32 v184, v184
  v_cvt_pk_bf16_f32 v203, v182, v183
  v_exp_f32 v185, v185
  v_mfma_f32_32x32x16_bf16 a[16:31], a[108:111], a[96:99], a[16:31]
  global_load_dwordx4 a[84:87], v248, s[14:15] offset:1024 sc1
  v_exp_f32 v186, v186
  v_cvt_pk_bf16_f32 v204, v184, v185
  v_exp_f32 v187, v187
  v_exp_f32 v188, v188
  v_cvt_pk_bf16_f32 v205, v186, v187
  v_mfma_f32_32x32x16_bf16 a[32:47], a[100:103], a[104:107], a[32:47]
  global_load_dwordx4 a[88:91], v248, s[16:17] offset:1024 sc1
  v_exp_f32 v189, v189
  v_exp_f32 v190, v190
  v_exp_f32 v191, v191
  v_cvt_pk_bf16_f32 v206, v188, v189
  v_cvt_pk_bf16_f32 v207, v190, v191
  v_mfma_f32_32x32x16_bf16 v[176:191], v[136:139], v[132:135], 0
  global_load_dwordx4 a[224:227], v62, s[32:33] offset:2048 sc1
  v_exp_f32 v160, v160
  v_exp_f32 v161, v161
  v_exp_f32 v162, v162
  v_cvt_pk_bf16_f32 v192, v160, v161
  v_exp_f32 v163, v163
  v_exp_f32 v164, v164
  v_mfma_f32_32x32x16_bf16 v[224:239], v[152:155], v[200:203], v[224:239]
  v_cvt_pk_bf16_f32 v193, v162, v163
  v_exp_f32 v165, v165
  v_exp_f32 v166, v166
  v_cvt_pk_bf16_f32 v194, v164, v165
  v_exp_f32 v167, v167
  v_exp_f32 v168, v168
  v_mfma_f32_32x32x16_bf16 v[224:239], v[156:159], v[204:207], v[224:239]
  s_waitcnt lgkmcnt(0)
  global_load_dwordx4 a[144:147], v250, s[12:13] offset:-2048 sc1
  v_cvt_pk_bf16_f32 v195, v166, v167
  v_exp_f32 v169, v169
  v_exp_f32 v170, v170
  v_cvt_pk_bf16_f32 v196, v168, v169
  v_exp_f32 v171, v171
  v_exp_f32 v172, v172
  v_mfma_f32_32x32x16_bf16 a[48:63], a[108:111], a[104:107], a[48:63]
  s_waitcnt vmcnt(7)
  global_load_dwordx4 a[92:95], v248, s[18:19] offset:1024 sc1
  v_cvt_pk_bf16_f32 v197, v170, v171
  v_exp_f32 v173, v173
  v_exp_f32 v174, v174
  v_exp_f32 v175, v175
  v_cvt_pk_bf16_f32 v198, v172, v173
  v_cvt_pk_bf16_f32 v199, v174, v175
  v_mfma_f32_32x32x16_bf16 v[160:175], v[140:143], v[128:131], 0
  ds_read_b128 v[136:139], v7 offset:57344
  global_load_dwordx4 a[148:151], v250, s[14:15] offset:-2048 sc1
  v_exp_f32 v176, v176
  v_exp_f32 v177, v177
  v_exp_f32 v178, v178
  v_cvt_pk_bf16_f32 v200, v176, v177
  v_exp_f32 v179, v179
  v_exp_f32 v180, v180
  v_mfma_f32_32x32x16_bf16 v[208:223], v[144:147], v[192:195], v[208:223]
  ds_read_b128 v[152:155], v241 offset:7168
  v_cvt_pk_bf16_f32 v201, v178, v179
  v_exp_f32 v181, v181
  v_exp_f32 v182, v182
  v_cvt_pk_bf16_f32 v202, v180, v181
  v_exp_f32 v183, v183
  v_exp_f32 v184, v184
  v_mfma_f32_32x32x16_bf16 v[208:223], v[148:151], v[196:199], v[208:223]
  ds_read_b128 v[156:159], v241 offset:7680
  v_cvt_pk_bf16_f32 v203, v182, v183
  v_exp_f32 v185, v185
  v_exp_f32 v186, v186
  v_cvt_pk_bf16_f32 v204, v184, v185
  v_exp_f32 v187, v187
  v_exp_f32 v188, v188
  v_mfma_f32_32x32x16_bf16 v[32:47], a[68:71], a[64:67], v[32:47]
  global_load_dwordx4 a[96:99], v248, s[12:13] offset:2048 sc1
  v_cvt_pk_bf16_f32 v205, v186, v187
  v_exp_f32 v189, v189
  v_exp_f32 v190, v190
  v_exp_f32 v191, v191
  v_cvt_pk_bf16_f32 v206, v188, v189
  v_cvt_pk_bf16_f32 v207, v190, v191
  v_mfma_f32_32x32x16_bf16 v[176:191], v[140:143], v[132:135], 0
  global_load_dwordx4 a[152:155], v250, s[16:17] offset:-2048 sc1
  v_exp_f32 v160, v160
  v_exp_f32 v161, v161
  v_exp_f32 v162, v162
  v_cvt_pk_bf16_f32 v192, v160, v161
  v_exp_f32 v163, v163
  v_exp_f32 v164, v164
  v_mfma_f32_32x32x16_bf16 v[224:239], v[144:147], v[200:203], v[224:239]
  v_cvt_pk_bf16_f32 v193, v162, v163
  v_exp_f32 v165, v165
  v_exp_f32 v166, v166
  v_cvt_pk_bf16_f32 v194, v164, v165
  v_exp_f32 v167, v167
  v_exp_f32 v168, v168
  v_mfma_f32_32x32x16_bf16 v[224:239], v[148:151], v[204:207], v[224:239]
  s_waitcnt lgkmcnt(0)
  v_cvt_pk_bf16_f32 v195, v166, v167
  v_exp_f32 v169, v169
  v_exp_f32 v170, v170
  v_cvt_pk_bf16_f32 v196, v168, v169
  v_exp_f32 v171, v171
  v_exp_f32 v172, v172
  v_mfma_f32_32x32x16_bf16 a[16:31], a[76:79], a[64:67], a[16:31]
  global_load_dwordx4 a[100:103], v248, s[14:15] offset:2048 sc1
  v_cvt_pk_bf16_f32 v197, v170, v171
  v_exp_f32 v173, v173
  v_exp_f32 v174, v174
  v_exp_f32 v175, v175
  v_cvt_pk_bf16_f32 v198, v172, v173
  v_cvt_pk_bf16_f32 v199, v174, v175
  v_mfma_f32_32x32x16_bf16 v[160:175], v[136:139], v[128:131], 0
  ds_read_b128 v[140:143], v7 offset:58368
  global_load_dwordx4 a[156:159], v250, s[18:19] offset:-2048 sc1
  v_add_u32 v241, v242, v241
  v_exp_f32 v176, v176
  v_exp_f32 v177, v177
  v_exp_f32 v178, v178
  v_cvt_pk_bf16_f32 v200, v176, v177
  v_mfma_f32_32x32x16_bf16 v[208:223], v[152:155], v[192:195], v[208:223]
  ds_read_b128 v[144:147], v241 offset:0
  v_exp_f32 v179, v179
  v_exp_f32 v180, v180
  v_cvt_pk_bf16_f32 v201, v178, v179
  v_exp_f32 v181, v181
  v_exp_f32 v182, v182
  v_mfma_f32_32x32x16_bf16 v[208:223], v[156:159], v[196:199], v[208:223]
  ds_read_b128 v[148:151], v241 offset:512
  v_cvt_pk_bf16_f32 v202, v180, v181
  v_exp_f32 v183, v183
  v_exp_f32 v184, v184
  v_cvt_pk_bf16_f32 v203, v182, v183
  v_exp_f32 v185, v185
  v_mfma_f32_32x32x16_bf16 a[32:47], a[68:71], a[72:75], a[32:47]
  global_load_dwordx4 a[104:107], v248, s[16:17] offset:2048 sc1
  v_exp_f32 v186, v186
  v_cvt_pk_bf16_f32 v204, v184, v185
  v_exp_f32 v187, v187
  v_exp_f32 v188, v188
  v_cvt_pk_bf16_f32 v205, v186, v187
  v_mfma_f32_32x32x16_bf16 a[48:63], a[76:79], a[72:75], a[48:63]
  s_waitcnt vmcnt(6)
  global_load_dwordx4 a[108:111], v248, s[18:19] offset:2048 sc1
  v_exp_f32 v189, v189
  v_exp_f32 v190, v190
  v_exp_f32 v191, v191
  v_cvt_pk_bf16_f32 v206, v188, v189
  v_cvt_pk_bf16_f32 v207, v190, v191
  v_mfma_f32_32x32x16_bf16 v[176:191], v[136:139], v[132:135], 0
  global_load_dwordx4 a[228:231], v62, s[34:35] offset:2048 sc1
  v_exp_f32 v160, v160
  v_exp_f32 v161, v161
  v_exp_f32 v162, v162
  v_cvt_pk_bf16_f32 v192, v160, v161
  v_exp_f32 v163, v163
  v_exp_f32 v164, v164
  v_mfma_f32_32x32x16_bf16 v[224:239], v[152:155], v[200:203], v[224:239]
  v_cvt_pk_bf16_f32 v193, v162, v163
  v_exp_f32 v165, v165
  v_exp_f32 v166, v166
  v_cvt_pk_bf16_f32 v194, v164, v165
  v_exp_f32 v167, v167
  v_exp_f32 v168, v168
  v_mfma_f32_32x32x16_bf16 v[224:239], v[156:159], v[204:207], v[224:239]
  s_waitcnt lgkmcnt(0)
  v_cvt_pk_bf16_f32 v195, v166, v167
  v_exp_f32 v169, v169
  v_exp_f32 v170, v170
  v_cvt_pk_bf16_f32 v196, v168, v169
  v_exp_f32 v171, v171
  v_exp_f32 v172, v172
  v_mfma_f32_32x32x16_bf16 v[32:47], a[84:87], a[80:83], v[32:47]
  global_load_dwordx4 a[64:67], v248, s[12:13] offset:3072 sc1
  v_cvt_pk_bf16_f32 v197, v170, v171
  v_exp_f32 v173, v173
  v_exp_f32 v174, v174
  v_exp_f32 v175, v175
  v_cvt_pk_bf16_f32 v198, v172, v173
  v_cvt_pk_bf16_f32 v199, v174, v175
  v_mfma_f32_32x32x16_bf16 v[160:175], v[140:143], v[128:131], 0
  ds_read_b128 v[136:139], v7 offset:59392
  global_load_dwordx4 a[160:163], v250, s[12:13] offset:-1024 sc1
  v_exp_f32 v176, v176
  v_exp_f32 v177, v177
  v_exp_f32 v178, v178
  v_cvt_pk_bf16_f32 v200, v176, v177
  v_exp_f32 v179, v179
  v_exp_f32 v180, v180
  v_mfma_f32_32x32x16_bf16 v[208:223], v[144:147], v[192:195], v[208:223]
  ds_read_b128 v[152:155], v241 offset:1024
  v_cvt_pk_bf16_f32 v201, v178, v179
  v_exp_f32 v181, v181
  v_exp_f32 v182, v182
  v_cvt_pk_bf16_f32 v202, v180, v181
  v_exp_f32 v183, v183
  v_exp_f32 v184, v184
  v_mfma_f32_32x32x16_bf16 v[208:223], v[148:151], v[196:199], v[208:223]
  ds_read_b128 v[156:159], v241 offset:1536
  v_cvt_pk_bf16_f32 v203, v182, v183
  v_exp_f32 v185, v185
  v_exp_f32 v186, v186
  v_cvt_pk_bf16_f32 v204, v184, v185
  v_exp_f32 v187, v187
  v_exp_f32 v188, v188
  v_mfma_f32_32x32x16_bf16 a[16:31], a[92:95], a[80:83], a[16:31]
  global_load_dwordx4 a[68:71], v248, s[14:15] offset:3072 sc1
  v_cvt_pk_bf16_f32 v205, v186, v187
  v_exp_f32 v189, v189
  v_exp_f32 v190, v190
  v_exp_f32 v191, v191
  v_cvt_pk_bf16_f32 v206, v188, v189
  v_cvt_pk_bf16_f32 v207, v190, v191
  v_mfma_f32_32x32x16_bf16 v[176:191], v[140:143], v[132:135], 0
  global_load_dwordx4 a[232:235], v62, s[32:33] offset:3072 sc1
  v_exp_f32 v160, v160
  v_exp_f32 v161, v161
  v_exp_f32 v162, v162
  v_cvt_pk_bf16_f32 v192, v160, v161
  v_exp_f32 v163, v163
  v_mfma_f32_32x32x16_bf16 v[224:239], v[144:147], v[200:203], v[224:239]
  v_exp_f32 v164, v164
  v_cvt_pk_bf16_f32 v193, v162, v163
  v_exp_f32 v165, v165
  v_exp_f32 v166, v166
  v_mfma_f32_32x32x16_bf16 v[224:239], v[148:151], v[204:207], v[224:239]
  s_waitcnt lgkmcnt(0)
  global_load_dwordx4 a[164:167], v250, s[14:15] offset:-1024 sc1
  v_cvt_pk_bf16_f32 v194, v164, v165
  v_exp_f32 v167, v167
  v_exp_f32 v168, v168
  v_cvt_pk_bf16_f32 v195, v166, v167
  v_exp_f32 v169, v169
  v_mfma_f32_32x32x16_bf16 a[32:47], a[84:87], a[88:91], a[32:47]
  global_load_dwordx4 a[72:75], v248, s[16:17] offset:3072 sc1
  v_exp_f32 v170, v170
  v_cvt_pk_bf16_f32 v196, v168, v169
  v_exp_f32 v171, v171
  v_exp_f32 v172, v172
  v_cvt_pk_bf16_f32 v197, v170, v171
  v_mfma_f32_32x32x16_bf16 a[48:63], a[92:95], a[88:91], a[48:63]
  s_waitcnt vmcnt(7)
  global_load_dwordx4 a[76:79], v248, s[18:19] offset:3072 sc1
  v_exp_f32 v173, v173
  v_exp_f32 v174, v174
  v_exp_f32 v175, v175
  v_cvt_pk_bf16_f32 v198, v172, v173
  v_cvt_pk_bf16_f32 v199, v174, v175
  v_mfma_f32_32x32x16_bf16 v[160:175], v[136:139], v[128:131], 0
  ds_read_b128 v[140:143], v7 offset:60416
  global_load_dwordx4 a[168:171], v250, s[16:17] offset:-1024 sc1
  v_exp_f32 v176, v176
  v_exp_f32 v177, v177
  v_exp_f32 v178, v178
  v_cvt_pk_bf16_f32 v200, v176, v177
  v_exp_f32 v179, v179
  v_exp_f32 v180, v180
  v_mfma_f32_32x32x16_bf16 v[208:223], v[152:155], v[192:195], v[208:223]
  ds_read_b128 v[144:147], v241 offset:2048
  v_cvt_pk_bf16_f32 v201, v178, v179
  v_exp_f32 v181, v181
  v_exp_f32 v182, v182
  v_cvt_pk_bf16_f32 v202, v180, v181
  v_exp_f32 v183, v183
  v_exp_f32 v184, v184
  v_mfma_f32_32x32x16_bf16 v[208:223], v[156:159], v[196:199], v[208:223]
  ds_read_b128 v[148:151], v241 offset:2560
  v_cvt_pk_bf16_f32 v203, v182, v183
  v_exp_f32 v185, v185
  v_exp_f32 v186, v186
  v_cvt_pk_bf16_f32 v204, v184, v185
  v_exp_f32 v187, v187
  v_exp_f32 v188, v188
  v_mfma_f32_32x32x16_bf16 v[32:47], a[100:103], a[96:99], v[32:47]
  global_load_dwordx4 a[80:83], v249, s[12:13] offset:-4096 sc1
  v_cvt_pk_bf16_f32 v205, v186, v187
  v_exp_f32 v189, v189
  v_exp_f32 v190, v190
  v_exp_f32 v191, v191
  v_cvt_pk_bf16_f32 v206, v188, v189
  v_cvt_pk_bf16_f32 v207, v190, v191
  v_mfma_f32_32x32x16_bf16 v[176:191], v[136:139], v[132:135], 0
  global_load_dwordx4 a[172:175], v250, s[18:19] offset:-1024 sc1
  v_exp_f32 v160, v160
  v_exp_f32 v161, v161
  v_exp_f32 v162, v162
  v_cvt_pk_bf16_f32 v192, v160, v161
  v_exp_f32 v163, v163
  v_exp_f32 v164, v164
  v_mfma_f32_32x32x16_bf16 v[224:239], v[152:155], v[200:203], v[224:239]
  v_cvt_pk_bf16_f32 v193, v162, v163
  v_exp_f32 v165, v165
  v_exp_f32 v166, v166
  v_cvt_pk_bf16_f32 v194, v164, v165
  v_exp_f32 v167, v167
  v_exp_f32 v168, v168
  v_mfma_f32_32x32x16_bf16 v[224:239], v[156:159], v[204:207], v[224:239]
  s_waitcnt lgkmcnt(0)
  v_cvt_pk_bf16_f32 v195, v166, v167
  v_exp_f32 v169, v169
  v_exp_f32 v170, v170
  v_cvt_pk_bf16_f32 v196, v168, v169
  v_exp_f32 v171, v171
  v_exp_f32 v172, v172
  v_mfma_f32_32x32x16_bf16 a[16:31], a[108:111], a[96:99], a[16:31]
  global_load_dwordx4 a[84:87], v249, s[14:15] offset:-4096 sc1
  v_cvt_pk_bf16_f32 v197, v170, v171
  v_exp_f32 v173, v173
  v_exp_f32 v174, v174
  v_exp_f32 v175, v175
  v_cvt_pk_bf16_f32 v198, v172, v173
  v_cvt_pk_bf16_f32 v199, v174, v175
  v_mfma_f32_32x32x16_bf16 v[160:175], v[140:143], v[128:131], 0
  ds_read_b128 v[136:139], v7 offset:61440
  v_exp_f32 v176, v176
  v_exp_f32 v177, v177
  v_exp_f32 v178, v178
  v_cvt_pk_bf16_f32 v200, v176, v177
  v_exp_f32 v179, v179
  v_exp_f32 v180, v180
  v_mfma_f32_32x32x16_bf16 v[208:223], v[144:147], v[192:195], v[208:223]
  ds_read_b128 v[152:155], v241 offset:3072
  v_cvt_pk_bf16_f32 v201, v178, v179
  v_exp_f32 v181, v181
  v_exp_f32 v182, v182
  v_cvt_pk_bf16_f32 v202, v180, v181
  v_exp_f32 v183, v183
  v_exp_f32 v184, v184
  v_mfma_f32_32x32x16_bf16 v[208:223], v[148:151], v[196:199], v[208:223]
  ds_read_b128 v[156:159], v241 offset:3584
  v_cvt_pk_bf16_f32 v203, v182, v183
  v_exp_f32 v185, v185
  v_exp_f32 v186, v186
  v_cvt_pk_bf16_f32 v204, v184, v185
  v_exp_f32 v187, v187
  v_exp_f32 v188, v188
  v_mfma_f32_32x32x16_bf16 a[32:47], a[100:103], a[104:107], a[32:47]
  global_load_dwordx4 a[88:91], v249, s[16:17] offset:-4096 sc1
  v_cvt_pk_bf16_f32 v205, v186, v187
  v_exp_f32 v189, v189
  v_exp_f32 v190, v190
  v_exp_f32 v191, v191
  v_cvt_pk_bf16_f32 v206, v188, v189
  v_cvt_pk_bf16_f32 v207, v190, v191
  v_mfma_f32_32x32x16_bf16 v[176:191], v[140:143], v[132:135], 0
  global_load_dwordx4 a[236:239], v62, s[34:35] offset:3072 sc1
  v_exp_f32 v160, v160
  v_exp_f32 v161, v161
  v_exp_f32 v162, v162
  v_cvt_pk_bf16_f32 v192, v160, v161
  v_exp_f32 v163, v163
  v_mfma_f32_32x32x16_bf16 v[224:239], v[144:147], v[200:203], v[224:239]
  v_exp_f32 v164, v164
  v_cvt_pk_bf16_f32 v193, v162, v163
  v_exp_f32 v165, v165
  v_exp_f32 v166, v166
  v_mfma_f32_32x32x16_bf16 v[224:239], v[148:151], v[204:207], v[224:239]
  s_waitcnt lgkmcnt(0)
  v_cvt_pk_bf16_f32 v194, v164, v165
  v_exp_f32 v167, v167
  v_exp_f32 v168, v168
  v_cvt_pk_bf16_f32 v195, v166, v167
  v_exp_f32 v169, v169
  v_mfma_f32_32x32x16_bf16 a[48:63], a[108:111], a[104:107], a[48:63]
  s_waitcnt vmcnt(6)
  global_load_dwordx4 a[92:95], v249, s[18:19] offset:-4096 sc1
  v_exp_f32 v170, v170
  v_cvt_pk_bf16_f32 v196, v168, v169
  v_exp_f32 v171, v171
  v_exp_f32 v172, v172
  v_cvt_pk_bf16_f32 v197, v170, v171
  v_mfma_f32_32x32x16_bf16 v[32:47], a[68:71], a[64:67], v[32:47]
  global_load_dwordx4 a[96:99], v249, s[12:13] offset:-3072 sc1
  v_exp_f32 v173, v173
  v_exp_f32 v174, v174
  v_exp_f32 v175, v175
  v_cvt_pk_bf16_f32 v198, v172, v173
  v_cvt_pk_bf16_f32 v199, v174, v175
  v_mfma_f32_32x32x16_bf16 v[160:175], v[136:139], v[128:131], 0
  ds_read_b128 v[140:143], v7 offset:62464
  v_exp_f32 v176, v176
  v_exp_f32 v177, v177
  v_exp_f32 v178, v178
  v_cvt_pk_bf16_f32 v200, v176, v177
  v_exp_f32 v179, v179
  v_exp_f32 v180, v180
  v_mfma_f32_32x32x16_bf16 v[208:223], v[152:155], v[192:195], v[208:223]
  ds_read_b128 v[144:147], v241 offset:4096
  v_cvt_pk_bf16_f32 v201, v178, v179
  v_exp_f32 v181, v181
  v_exp_f32 v182, v182
  v_cvt_pk_bf16_f32 v202, v180, v181
  v_exp_f32 v183, v183
  v_exp_f32 v184, v184
  v_mfma_f32_32x32x16_bf16 v[208:223], v[156:159], v[196:199], v[208:223]
  ds_read_b128 v[148:151], v241 offset:4608
  v_cvt_pk_bf16_f32 v203, v182, v183
  v_exp_f32 v185, v185
  v_exp_f32 v186, v186
  v_cvt_pk_bf16_f32 v204, v184, v185
  v_exp_f32 v187, v187
  v_exp_f32 v188, v188
  v_mfma_f32_32x32x16_bf16 a[16:31], a[76:79], a[64:67], a[16:31]
  global_load_dwordx4 a[100:103], v249, s[14:15] offset:-3072 sc1
  v_cvt_pk_bf16_f32 v205, v186, v187
  v_exp_f32 v189, v189
  v_exp_f32 v190, v190
  v_exp_f32 v191, v191
  v_cvt_pk_bf16_f32 v206, v188, v189
  v_cvt_pk_bf16_f32 v207, v190, v191
  v_mfma_f32_32x32x16_bf16 v[176:191], v[136:139], v[132:135], 0
  v_exp_f32 v160, v160
  v_exp_f32 v161, v161
  v_exp_f32 v162, v162
  v_cvt_pk_bf16_f32 v192, v160, v161
  v_exp_f32 v163, v163
  v_exp_f32 v164, v164
  v_mfma_f32_32x32x16_bf16 v[224:239], v[152:155], v[200:203], v[224:239]
  v_cvt_pk_bf16_f32 v193, v162, v163
  v_exp_f32 v165, v165
  v_exp_f32 v166, v166
  v_cvt_pk_bf16_f32 v194, v164, v165
  v_exp_f32 v167, v167
  v_exp_f32 v168, v168
  v_mfma_f32_32x32x16_bf16 v[224:239], v[156:159], v[204:207], v[224:239]
  s_waitcnt lgkmcnt(0)
  v_cvt_pk_bf16_f32 v195, v166, v167
  v_exp_f32 v169, v169
  v_exp_f32 v170, v170
  v_cvt_pk_bf16_f32 v196, v168, v169
  v_exp_f32 v171, v171
  v_exp_f32 v172, v172
  v_mfma_f32_32x32x16_bf16 a[32:47], a[68:71], a[72:75], a[32:47]
  global_load_dwordx4 a[104:107], v249, s[16:17] offset:-3072 sc1
  v_cvt_pk_bf16_f32 v197, v170, v171
  v_exp_f32 v173, v173
  v_exp_f32 v174, v174
  v_exp_f32 v175, v175
  v_cvt_pk_bf16_f32 v198, v172, v173
  v_cvt_pk_bf16_f32 v199, v174, v175
  v_mfma_f32_32x32x16_bf16 v[160:175], v[140:143], v[128:131], 0
  ds_read_b128 v[136:139], v7 offset:63488
  v_exp_f32 v176, v176
  v_exp_f32 v177, v177
  v_exp_f32 v178, v178
  v_cvt_pk_bf16_f32 v200, v176, v177
  v_exp_f32 v179, v179
  v_exp_f32 v180, v180
  v_mfma_f32_32x32x16_bf16 v[208:223], v[144:147], v[192:195], v[208:223]
  ds_read_b128 v[152:155], v241 offset:5120
  v_cvt_pk_bf16_f32 v201, v178, v179
  v_exp_f32 v181, v181
  v_exp_f32 v182, v182
  v_cvt_pk_bf16_f32 v202, v180, v181
  v_exp_f32 v183, v183
  v_exp_f32 v184, v184
  v_mfma_f32_32x32x16_bf16 v[208:223], v[148:151], v[196:199], v[208:223]
  ds_read_b128 v[156:159], v241 offset:5632
  v_cvt_pk_bf16_f32 v203, v182, v183
  v_exp_f32 v185, v185
  v_exp_f32 v186, v186
  v_cvt_pk_bf16_f32 v204, v184, v185
  v_exp_f32 v187, v187
  v_exp_f32 v188, v188
  v_mfma_f32_32x32x16_bf16 a[48:63], a[76:79], a[72:75], a[48:63]
  global_load_dwordx4 a[108:111], v249, s[18:19] offset:-3072 sc1
  v_cvt_pk_bf16_f32 v205, v186, v187
  v_exp_f32 v189, v189
  v_exp_f32 v190, v190
  v_exp_f32 v191, v191
  v_cvt_pk_bf16_f32 v206, v188, v189
  v_cvt_pk_bf16_f32 v207, v190, v191
  v_mfma_f32_32x32x16_bf16 v[176:191], v[140:143], v[132:135], 0
  global_load_dwordx4 a[64:67], v249, s[12:13] offset:-2048 sc1
  v_exp_f32 v160, v160
  v_exp_f32 v161, v161
  v_exp_f32 v162, v162
  v_cvt_pk_bf16_f32 v192, v160, v161
  v_exp_f32 v163, v163
  v_exp_f32 v164, v164
  v_cvt_pk_bf16_f32 v193, v162, v163
  v_exp_f32 v165, v165
  v_mfma_f32_32x32x16_bf16 v[224:239], v[144:147], v[200:203], v[224:239]
  global_load_dwordx4 a[68:71], v249, s[14:15] offset:-2048 sc1
  v_exp_f32 v166, v166
  v_cvt_pk_bf16_f32 v194, v164, v165
  v_exp_f32 v167, v167
  v_exp_f32 v168, v168
  v_cvt_pk_bf16_f32 v195, v166, v167
  v_exp_f32 v169, v169
  v_exp_f32 v170, v170
  v_cvt_pk_bf16_f32 v196, v168, v169
  v_mfma_f32_32x32x16_bf16 v[224:239], v[148:151], v[204:207], v[224:239]
  s_waitcnt lgkmcnt(0)
  v_exp_f32 v171, v171
  v_exp_f32 v172, v172
  v_cvt_pk_bf16_f32 v197, v170, v171
  v_exp_f32 v173, v173
  v_exp_f32 v174, v174
  v_exp_f32 v175, v175
  v_cvt_pk_bf16_f32 v198, v172, v173
  v_cvt_pk_bf16_f32 v199, v174, v175
  v_mfma_f32_32x32x16_bf16 v[160:175], v[136:139], v[128:131], 0
  ds_read_b128 v[140:143], v7 offset:64512
  global_load_dwordx4 a[72:75], v249, s[16:17] offset:-2048 sc1
  v_exp_f32 v176, v176
  v_exp_f32 v177, v177
  v_exp_f32 v178, v178
  v_cvt_pk_bf16_f32 v200, v176, v177
  v_exp_f32 v179, v179
  v_exp_f32 v180, v180
  v_cvt_pk_bf16_f32 v201, v178, v179
  v_exp_f32 v181, v181
  v_mfma_f32_32x32x16_bf16 v[208:223], v[152:155], v[192:195], v[208:223]
  ds_read_b128 v[144:147], v241 offset:6144
  global_load_dwordx4 a[76:79], v249, s[18:19] offset:-2048 sc1
  v_exp_f32 v182, v182
  v_cvt_pk_bf16_f32 v202, v180, v181
  v_exp_f32 v183, v183
  v_exp_f32 v184, v184
  v_cvt_pk_bf16_f32 v203, v182, v183
  v_exp_f32 v185, v185
  v_exp_f32 v186, v186
  v_cvt_pk_bf16_f32 v204, v184, v185
  v_mfma_f32_32x32x16_bf16 v[208:223], v[156:159], v[196:199], v[208:223]
  ds_read_b128 v[148:151], v241 offset:6656
  v_exp_f32 v187, v187
  v_exp_f32 v188, v188
  v_cvt_pk_bf16_f32 v205, v186, v187
  v_exp_f32 v189, v189
  v_exp_f32 v190, v190
  v_exp_f32 v191, v191
  v_cvt_pk_bf16_f32 v206, v188, v189
  v_cvt_pk_bf16_f32 v207, v190, v191
  v_mfma_f32_32x32x16_bf16 v[176:191], v[136:139], v[132:135], 0
  v_exp_f32 v160, v160
  v_exp_f32 v161, v161
  v_exp_f32 v162, v162
  v_cvt_pk_bf16_f32 v192, v160, v161
  v_exp_f32 v163, v163
  v_exp_f32 v164, v164
  v_cvt_pk_bf16_f32 v193, v162, v163
  v_exp_f32 v165, v165
  v_mfma_f32_32x32x16_bf16 v[224:239], v[152:155], v[200:203], v[224:239]
  v_exp_f32 v166, v166
  v_cvt_pk_bf16_f32 v194, v164, v165
  v_exp_f32 v167, v167
  v_exp_f32 v168, v168
  v_cvt_pk_bf16_f32 v195, v166, v167
  v_exp_f32 v169, v169
  v_exp_f32 v170, v170
  v_cvt_pk_bf16_f32 v196, v168, v169
  v_mfma_f32_32x32x16_bf16 v[224:239], v[156:159], v[204:207], v[224:239]
  s_waitcnt lgkmcnt(0)
  v_exp_f32 v171, v171
  v_exp_f32 v172, v172
  v_cvt_pk_bf16_f32 v197, v170, v171
  v_exp_f32 v173, v173
  v_exp_f32 v174, v174
  v_exp_f32 v175, v175
  v_cvt_pk_bf16_f32 v198, v172, v173
  v_cvt_pk_bf16_f32 v199, v174, v175
  v_mfma_f32_32x32x16_bf16 v[160:175], v[140:143], v[128:131], 0
  v_exp_f32 v176, v176
  v_exp_f32 v177, v177
  v_exp_f32 v178, v178
  v_cvt_pk_bf16_f32 v200, v176, v177
  v_exp_f32 v179, v179
  v_exp_f32 v180, v180
  v_cvt_pk_bf16_f32 v201, v178, v179
  v_exp_f32 v181, v181
  v_mfma_f32_32x32x16_bf16 v[208:223], v[144:147], v[192:195], v[208:223]
  ds_read_b128 v[152:155], v241 offset:7168
  v_exp_f32 v182, v182
  v_cvt_pk_bf16_f32 v202, v180, v181
  v_exp_f32 v183, v183
  v_exp_f32 v184, v184
  v_cvt_pk_bf16_f32 v203, v182, v183
  v_exp_f32 v185, v185
  v_exp_f32 v186, v186
  v_cvt_pk_bf16_f32 v204, v184, v185
  v_mfma_f32_32x32x16_bf16 v[208:223], v[148:151], v[196:199], v[208:223]
  ds_read_b128 v[156:159], v241 offset:7680
  v_exp_f32 v187, v187
  v_exp_f32 v188, v188
  v_cvt_pk_bf16_f32 v205, v186, v187
  v_exp_f32 v189, v189
  v_exp_f32 v190, v190
  v_exp_f32 v191, v191
  v_cvt_pk_bf16_f32 v206, v188, v189
  v_cvt_pk_bf16_f32 v207, v190, v191
  v_mfma_f32_32x32x16_bf16 v[176:191], v[140:143], v[132:135], 0
  v_exp_f32 v160, v160
  v_exp_f32 v161, v161
  v_exp_f32 v162, v162
  v_cvt_pk_bf16_f32 v192, v160, v161
  v_exp_f32 v163, v163
  v_exp_f32 v164, v164
  v_cvt_pk_bf16_f32 v193, v162, v163
  v_exp_f32 v165, v165
  v_mfma_f32_32x32x16_bf16 v[224:239], v[144:147], v[200:203], v[224:239]
  v_exp_f32 v166, v166
  v_cvt_pk_bf16_f32 v194, v164, v165
  v_exp_f32 v167, v167
  v_exp_f32 v168, v168
  v_cvt_pk_bf16_f32 v195, v166, v167
  v_exp_f32 v169, v169
  v_exp_f32 v170, v170
  v_cvt_pk_bf16_f32 v196, v168, v169
  v_mfma_f32_32x32x16_bf16 v[224:239], v[148:151], v[204:207], v[224:239]
  s_waitcnt lgkmcnt(0)
  v_exp_f32 v171, v171
  v_exp_f32 v172, v172
  v_cvt_pk_bf16_f32 v197, v170, v171
  v_exp_f32 v173, v173
  v_exp_f32 v174, v174
  v_exp_f32 v175, v175
  v_cvt_pk_bf16_f32 v198, v172, v173
  v_cvt_pk_bf16_f32 v199, v174, v175
  v_mfma_f32_32x32x16_bf16 v[208:223], v[152:155], v[192:195], v[208:223]
  v_add_u32 v241, v242, v241
  v_exp_f32 v176, v176
  v_exp_f32 v177, v177
  v_exp_f32 v178, v178
  v_cvt_pk_bf16_f32 v200, v176, v177
  v_exp_f32 v179, v179
  v_exp_f32 v180, v180
  v_cvt_pk_bf16_f32 v201, v178, v179
  v_exp_f32 v181, v181
  v_exp_f32 v182, v182
  v_cvt_pk_bf16_f32 v202, v180, v181
  v_exp_f32 v183, v183
  v_mfma_f32_32x32x16_bf16 v[208:223], v[156:159], v[196:199], v[208:223]
  v_exp_f32 v184, v184
  v_cvt_pk_bf16_f32 v203, v182, v183
  v_exp_f32 v185, v185
  v_exp_f32 v186, v186
  v_cvt_pk_bf16_f32 v204, v184, v185
  v_exp_f32 v187, v187
  v_exp_f32 v188, v188
  v_cvt_pk_bf16_f32 v205, v186, v187
  v_exp_f32 v189, v189
  v_exp_f32 v190, v190
  v_exp_f32 v191, v191
  v_cvt_pk_bf16_f32 v206, v188, v189
  v_cvt_pk_bf16_f32 v207, v190, v191
  s_mov_b32 s58, 0x33800000
  s_nop 0
  v_mfma_f32_32x32x16_bf16 v[224:239], v[152:155], v[200:203], v[224:239]
  v_mfma_f32_32x32x16_bf16 v[224:239], v[156:159], v[204:207], v[224:239]
  s_mov_b32 s59, 0x57800000
  v_add_u32 v8, s70, v7
  v_add_u32 v9, 1024, v8
  s_xor_b32 s57, s40, 1
  s_mul_i32 s57, s57, 12288
  v_add_u32 v3, s57, v7
  s_xor_b32 s57, s40, 2
  s_mul_i32 s57, s57, 12288
  v_add_u32 v4, s57, v7
  s_xor_b32 s57, s40, 3
  s_mul_i32 s57, s57, 12288
  v_add_u32 v5, s57, v7
mk_wJ6:
  s_cbranch_execz mk_wr1
  v_min_f32 v244, v216, v232
  v_max_f32 v245, v216, v232
  v_cmp_u_f32 s[84:85], v216, v232
  v_cmp_gt_f32 vcc, s58, v244
  v_cmp_lt_f32 s[86:87], s59, v245
  s_or_b64 vcc, vcc, s[84:85]
  s_or_b64 vcc, vcc, s[86:87]
  s_cbranch_scc1 mk_slow
mk_fin:
  v_rcp_f32 v244, v216
  v_rcp_f32 v246, v232
  v_pk_mul_f32 v[208:209], v[208:209], v[244:245] op_sel_hi:[1,0]
  v_pk_mul_f32 v[210:211], v[210:211], v[244:245] op_sel_hi:[1,0]
  v_pk_mul_f32 v[212:213], v[212:213], v[244:245] op_sel_hi:[1,0]
  v_pk_mul_f32 v[214:215], v[214:215], v[244:245] op_sel_hi:[1,0]
  v_cvt_pk_bf16_f32 v208, v208, v209
  v_cvt_pk_bf16_f32 v209, v210, v211
  v_cvt_pk_bf16_f32 v210, v212, v213
  v_cvt_pk_bf16_f32 v211, v214, v215
  global_store_dwordx4 v8, v[208:211], s[38:39] sc1
  v_pk_mul_f32 v[224:225], v[224:225], v[246:247] op_sel_hi:[1,0]
  v_pk_mul_f32 v[226:227], v[226:227], v[246:247] op_sel_hi:[1,0]
  v_pk_mul_f32 v[228:229], v[228:229], v[246:247] op_sel_hi:[1,0]
  v_pk_mul_f32 v[230:231], v[230:231], v[246:247] op_sel_hi:[1,0]
  v_cvt_pk_bf16_f32 v224, v224, v225
  v_cvt_pk_bf16_f32 v225, v226, v227
  v_cvt_pk_bf16_f32 v226, v228, v229
  v_cvt_pk_bf16_f32 v227, v230, v231
  global_store_dwordx4 v9, v[224:227], s[38:39] sc1
  s_waitcnt vmcnt(6)
  v_mfma_f32_32x32x16_bf16 v[32:47], a[84:87], a[80:83], v[32:47]
  s_and_b32 s57, s2, 1
  s_lshl_b32 s57, s57, 18
  v_add_u32 v236, s57, v7
  v_xor_b32 v232, 262144, v236
  v_mfma_f32_32x32x16_bf16 a[16:31], a[92:95], a[80:83], a[16:31]
  v_add_u32 v233, 65536, v232
  v_add_u32 v237, 65536, v236
  v_add_u32 v234, 131072, v232
  v_add_u32 v238, 131072, v236
  v_mfma_f32_32x32x16_bf16 a[32:47], a[84:87], a[88:91], a[32:47]
  v_add_u32 v235, 196608, v232
  v_add_u32 v239, 196608, v236
  s_mul_i32 s57, s40, 12288
  v_add_u32 v2, s57, v7
  v_mfma_f32_32x32x16_bf16 a[48:63], a[92:95], a[88:91], a[48:63]
  v_lshlrev_b32 v192, 16, v48
  v_and_b32 v193, 0xffff0000, v48
  v_lshlrev_b32 v194, 16, v49
  v_and_b32 v195, 0xffff0000, v49
  v_mfma_f32_32x32x16_bf16 v[32:47], a[100:103], a[96:99], v[32:47]
  s_barrier
  v_lshlrev_b32 v196, 16, v50
  v_and_b32 v197, 0xffff0000, v50
  v_lshlrev_b32 v198, 16, v51
  v_and_b32 v199, 0xffff0000, v51
  v_mfma_f32_32x32x16_bf16 a[16:31], a[108:111], a[96:99], a[16:31]
  v_lshlrev_b32 v200, 16, v52
  v_and_b32 v201, 0xffff0000, v52
  v_lshlrev_b32 v202, 16, v53
  v_and_b32 v203, 0xffff0000, v53
  v_mfma_f32_32x32x16_bf16 a[32:47], a[100:103], a[104:107], a[32:47]
  v_lshlrev_b32 v204, 16, v54
  v_and_b32 v205, 0xffff0000, v54
  v_lshlrev_b32 v206, 16, v55
  v_and_b32 v207, 0xffff0000, v55
  v_mfma_f32_32x32x16_bf16 a[48:63], a[108:111], a[104:107], a[48:63]
  v_lshrrev_b32 v240, 5, v1
  v_lshl_add_u32 v56, v240, 3, v56
  v_mfma_f32_32x32x16_bf16 v[32:47], v[68:71], v[64:67], v[32:47]
  v_mfma_f32_32x32x16_bf16 a[16:31], v[76:79], v[64:67], a[16:31]
  v_mfma_f32_32x32x16_bf16 a[32:47], v[68:71], v[72:75], a[32:47]
  v_mfma_f32_32x32x16_bf16 a[48:63], v[76:79], v[72:75], a[48:63]
  v_mfma_f32_32x32x16_bf16 v[32:47], v[84:87], v[80:83], v[32:47]
  v_mfma_f32_32x32x16_bf16 a[16:31], v[92:95], v[80:83], a[16:31]
  v_mfma_f32_32x32x16_bf16 a[32:47], v[84:87], v[88:91], a[32:47]
  v_mfma_f32_32x32x16_bf16 a[48:63], v[92:95], v[88:91], a[48:63]
  v_mfma_f32_32x32x16_bf16 v[32:47], v[100:103], v[96:99], v[32:47]
  global_load_dwordx4 v[128:131], v232, s[4:5] sc1
  v_mfma_f32_32x32x16_bf16 a[16:31], v[108:111], v[96:99], a[16:31]
  global_load_dwordx4 v[132:135], v232, s[6:7] sc1
  v_mfma_f32_32x32x16_bf16 a[32:47], v[100:103], v[104:107], a[32:47]
  global_load_dwordx4 v[136:139], v233, s[4:5] sc1
  v_mfma_f32_32x32x16_bf16 a[48:63], v[108:111], v[104:107], a[48:63]
  global_load_dwordx4 v[140:143], v233, s[6:7] sc1
  v_mfma_f32_32x32x16_bf16 v[32:47], v[116:119], v[112:115], v[32:47]
  global_load_dwordx4 v[144:147], v234, s[4:5] sc1
  v_mfma_f32_32x32x16_bf16 a[16:31], v[124:127], v[112:115], a[16:31]
  global_load_dwordx4 v[148:151], v234, s[6:7] sc1
  v_mfma_f32_32x32x16_bf16 a[32:47], v[116:119], v[120:123], a[32:47]
  global_load_dwordx4 v[152:155], v235, s[4:5] sc1
  v_mfma_f32_32x32x16_bf16 a[48:63], v[124:127], v[120:123], a[48:63]
  global_load_dwordx4 v[156:159], v235, s[6:7] sc1
  v_mfma_f32_32x32x16_bf16 v[32:47], a[4:7], a[0:3], v[32:47]
  v_mfma_f32_32x32x16_bf16 a[16:31], a[12:15], a[0:3], a[16:31]
  v_mfma_f32_32x32x16_bf16 a[32:47], a[4:7], a[8:11], a[32:47]
  v_mfma_f32_32x32x16_bf16 a[48:63], a[12:15], a[8:11], a[48:63]
  v_mfma_f32_32x32x16_bf16 v[32:47], a[116:119], a[112:115], v[32:47]
  global_load_dwordx4 v[160:163], v236, s[4:5] sc1
  v_mfma_f32_32x32x16_bf16 a[16:31], a[124:127], a[112:115], a[16:31]
  global_load_dwordx4 v[164:167], v236, s[6:7] sc1
  v_mfma_f32_32x32x16_bf16 a[32:47], a[116:119], a[120:123], a[32:47]
  global_load_dwordx4 v[168:171], v237, s[4:5] sc1
  v_mfma_f32_32x32x16_bf16 a[48:63], a[124:127], a[120:123], a[48:63]
  global_load_dwordx4 v[172:175], v237, s[6:7] sc1
  v_mfma_f32_32x32x16_bf16 v[32:47], a[132:135], a[128:131], v[32:47]
  global_load_dwordx4 v[176:179], v238, s[4:5] sc1
  v_mfma_f32_32x32x16_bf16 a[16:31], a[140:143], a[128:131], a[16:31]
  global_load_dwordx4 v[180:183], v238, s[6:7] sc1
  v_mfma_f32_32x32x16_bf16 a[32:47], a[132:135], a[136:139], a[32:47]
  global_load_dwordx4 v[184:187], v239, s[4:5] sc1
  v_mfma_f32_32x32x16_bf16 a[48:63], a[140:143], a[136:139], a[48:63]
  global_load_dwordx4 v[188:191], v239, s[6:7] sc1
  v_mfma_f32_32x32x16_bf16 v[32:47], a[148:151], a[144:147], v[32:47]
  v_mfma_f32_32x32x16_bf16 a[16:31], a[156:159], a[144:147], a[16:31]
  v_mfma_f32_32x32x16_bf16 a[32:47], a[148:151], a[152:155], a[32:47]
  v_mfma_f32_32x32x16_bf16 a[48:63], a[156:159], a[152:155], a[48:63]
  v_mfma_f32_32x32x16_bf16 v[32:47], a[164:167], a[160:163], v[32:47]
  v_mfma_f32_32x32x16_bf16 a[16:31], a[172:175], a[160:163], a[16:31]
  v_mfma_f32_32x32x16_bf16 a[32:47], a[164:167], a[168:171], a[32:47]
  v_mfma_f32_32x32x16_bf16 a[48:63], a[172:175], a[168:171], a[48:63]
  s_waitcnt vmcnt(18)
  v_mfma_f32_32x32x16_bf16 v[32:47], a[68:71], a[64:67], v[32:47]
  s_waitcnt vmcnt(8)
  v_max_u32 v244, v128, v129
  v_max3_u32 v244, v130, v131, v244
  v_max3_u32 v244, v132, v133, v244
  v_max3_u32 v244, v134, v135, v244
  v_mfma_f32_32x32x16_bf16 a[16:31], a[76:79], a[64:67], a[16:31]
  v_max3_u32 v244, v136, v137, v244
  v_max3_u32 v244, v138, v139, v244
  v_max3_u32 v244, v140, v141, v244
  v_max3_u32 v244, v142, v143, v244
  v_mfma_f32_32x32x16_bf16 a[32:47], a[68:71], a[72:75], a[32:47]
  v_max3_u32 v244, v144, v145, v244
  v_max3_u32 v244, v146, v147, v244
  v_max3_u32 v244, v148, v149, v244
  v_max3_u32 v244, v150, v151, v244
  v_mfma_f32_32x32x16_bf16 a[48:63], a[76:79], a[72:75], a[48:63]
  v_max3_u32 v244, v152, v153, v244
  v_max3_u32 v244, v154, v155, v244
  v_max3_u32 v244, v156, v157, v244
  v_max3_u32 v244, v158, v159, v244
  v_cmp_eq_u32 vcc, -1, v244
  s_cbranch_vccnz mk_rt0
mk_ok0:
  v_mfma_f32_32x32x16_bf16 v[32:47], a[176:179], v[128:131], v[32:47]
  v_mfma_f32_32x32x16_bf16 a[16:31], a[180:183], v[128:131], a[16:31]
  v_mfma_f32_32x32x16_bf16 a[32:47], a[176:179], v[132:135], a[32:47]
  v_mfma_f32_32x32x16_bf16 a[48:63], a[180:183], v[132:135], a[48:63]
  v_mfma_f32_32x32x16_bf16 v[32:47], a[184:187], v[136:139], v[32:47]
  v_mfma_f32_32x32x16_bf16 a[16:31], a[188:191], v[136:139], a[16:31]
  v_mfma_f32_32x32x16_bf16 a[32:47], a[184:187], v[140:143], a[32:47]
  v_mfma_f32_32x32x16_bf16 a[48:63], a[188:191], v[140:143], a[48:63]
  v_mfma_f32_32x32x16_bf16 v[32:47], a[192:195], v[144:147], v[32:47]
  v_mfma_f32_32x32x16_bf16 a[16:31], a[196:199], v[144:147], a[16:31]
  v_mfma_f32_32x32x16_bf16 a[32:47], a[192:195], v[148:151], a[32:47]
  v_mfma_f32_32x32x16_bf16 a[48:63], a[196:199], v[148:151], a[48:63]
  s_waitcnt vmcnt(0)
  v_max_u32 v245, v160, v161
  v_max3_u32 v245, v162, v163, v245
  v_max3_u32 v245, v164, v165, v245
  v_max3_u32 v245, v166, v167, v245
  v_mfma_f32_32x32x16_bf16 v[32:47], a[200:203], v[152:155], v[32:47]
  v_max3_u32 v245, v168, v169, v245
  v_max3_u32 v245, v170, v171, v245
  v_max3_u32 v245, v172, v173, v245
  v_max3_u32 v245, v174, v175, v245
  v_mfma_f32_32x32x16_bf16 a[16:31], a[204:207], v[152:155], a[16:31]
  v_max3_u32 v245, v176, v177, v245
  v_max3_u32 v245, v178, v179, v245
  v_max3_u32 v245, v180, v181, v245
  v_max3_u32 v245, v182, v183, v245
  v_mfma_f32_32x32x16_bf16 a[32:47], a[200:203], v[156:159], a[32:47]
  v_max3_u32 v245, v184, v185, v245
  v_max3_u32 v245, v186, v187, v245
  v_max3_u32 v245, v188, v189, v245
  v_max3_u32 v245, v190, v191, v245
  v_mfma_f32_32x32x16_bf16 a[48:63], a[204:207], v[156:159], a[48:63]
  v_cmp_eq_u32 vcc, -1, v245
  s_cbranch_vccnz mk_rt1
mk_ok1:
  v_mfma_f32_32x32x16_bf16 a[16:31], a[212:215], v[160:163], a[16:31]
  v_mfma_f32_32x32x16_bf16 a[16:31], a[220:223], v[168:171], a[16:31]
  v_mfma_f32_32x32x16_bf16 a[16:31], a[228:231], v[176:179], a[16:31]
  v_mfma_f32_32x32x16_bf16 a[16:31], a[236:239], v[184:187], a[16:31]
  v_mfma_f32_32x32x16_bf16 a[32:47], a[208:211], v[164:167], a[32:47]
  s_nop 2
  v_mfma_f32_32x32x16_bf16 a[32:47], a[216:219], v[172:175], a[32:47]
  s_nop 2
  v_mfma_f32_32x32x16_bf16 a[32:47], a[224:227], v[180:183], a[32:47]
  s_nop 2
  v_mfma_f32_32x32x16_bf16 a[32:47], a[232:235], v[188:191], a[32:47]
  s_nop 2
  v_mfma_f32_32x32x16_bf16 a[48:63], a[212:215], v[164:167], a[48:63]
  ds_write_b128 v3, a[16:19] offset:0
  s_nop 1
  v_mfma_f32_32x32x16_bf16 a[48:63], a[220:223], v[172:175], a[48:63]
  ds_write_b128 v3, a[20:23] offset:1024
  s_nop 1
  v_mfma_f32_32x32x16_bf16 a[48:63], a[228:231], v[180:183], a[48:63]
  ds_write_b128 v3, a[24:27] offset:2048
  s_nop 1
  v_mfma_f32_32x32x16_bf16 a[48:63], a[236:239], v[188:191], a[48:63]
  ds_write_b128 v3, a[28:31] offset:3072
  s_nop 1
  v_mfma_f32_32x32x16_bf16 v[32:47], a[208:211], v[160:163], v[32:47]
  ds_write_b128 v4, a[32:35] offset:4096
  s_nop 1
  v_mfma_f32_32x32x16_bf16 v[32:47], a[216:219], v[168:171], v[32:47]
  ds_write_b128 v4, a[36:39] offset:5120
  s_nop 1
  v_mfma_f32_32x32x16_bf16 v[32:47], a[224:227], v[176:179], v[32:47]
  ds_write_b128 v4, a[40:43] offset:6144
  s_nop 1
  v_mfma_f32_32x32x16_bf16 v[32:47], a[232:235], v[184:187], v[32:47]
  ds_write_b128 v4, a[44:47] offset:7168
  s_nop 1
  ds_write_b128 v5, a[48:51] offset:8192
  ds_write_b128 v5, a[52:55] offset:9216
  ds_write_b128 v5, a[56:59] offset:10240
  ds_write_b128 v5, a[60:63] offset:11264
  s_nop 7
  v_pk_add_f32 v[32:33], v[32:33], v[192:193]
  v_pk_add_f32 v[34:35], v[34:35], v[194:195]
  v_pk_add_f32 v[36:37], v[36:37], v[196:197]
  v_pk_add_f32 v[38:39], v[38:39], v[198:199]
  v_pk_add_f32 v[40:41], v[40:41], v[200:201]
  v_pk_add_f32 v[42:43], v[42:43], v[202:203]
  v_pk_add_f32 v[44:45], v[44:45], v[204:205]
  v_pk_add_f32 v[46:47], v[46:47], v[206:207]
  s_waitcnt lgkmcnt(0)
  s_barrier
  ds_read_b128 v[64:67], v2 offset:0
  ds_read_b128 v[80:83], v2 offset:4096
  ds_read_b128 v[96:99], v2 offset:8192
  ds_read_b128 v[68:71], v2 offset:1024
  ds_read_b128 v[84:87], v2 offset:5120
  ds_read_b128 v[100:103], v2 offset:9216
  ds_read_b128 v[72:75], v2 offset:2048
  ds_read_b128 v[88:91], v2 offset:6144
  ds_read_b128 v[104:107], v2 offset:10240
  ds_read_b128 v[76:79], v2 offset:3072
  ds_read_b128 v[92:95], v2 offset:7168
  ds_read_b128 v[108:111], v2 offset:11264
  s_waitcnt lgkmcnt(9)
  v_pk_add_f32 v[32:33], v[32:33], v[64:65]
  v_pk_add_f32 v[34:35], v[34:35], v[66:67]
  v_pk_add_f32 v[32:33], v[32:33], v[80:81]
  v_pk_add_f32 v[34:35], v[34:35], v[82:83]
  v_pk_add_f32 v[32:33], v[32:33], v[96:97]
  v_pk_add_f32 v[34:35], v[34:35], v[98:99]
  s_waitcnt lgkmcnt(6)
  v_pk_add_f32 v[36:37], v[36:37], v[68:69]
  v_pk_add_f32 v[38:39], v[38:39], v[70:71]
  v_pk_add_f32 v[36:37], v[36:37], v[84:85]
  v_pk_add_f32 v[38:39], v[38:39], v[86:87]
  v_pk_add_f32 v[36:37], v[36:37], v[100:101]
  v_pk_add_f32 v[38:39], v[38:39], v[102:103]
  s_waitcnt lgkmcnt(3)
  v_pk_add_f32 v[40:41], v[40:41], v[72:73]
  v_pk_add_f32 v[42:43], v[42:43], v[74:75]
  v_pk_add_f32 v[40:41], v[40:41], v[88:89]
  v_pk_add_f32 v[42:43], v[42:43], v[90:91]
  v_pk_add_f32 v[40:41], v[40:41], v[104:105]
  v_pk_add_f32 v[42:43], v[42:43], v[106:107]
  s_waitcnt lgkmcnt(0)
  v_pk_add_f32 v[44:45], v[44:45], v[76:77]
  v_pk_add_f32 v[46:47], v[46:47], v[78:79]
  v_pk_add_f32 v[44:45], v[44:45], v[92:93]
  v_pk_add_f32 v[46:47], v[46:47], v[94:95]
  v_pk_add_f32 v[44:45], v[44:45], v[108:109]
  v_pk_add_f32 v[46:47], v[46:47], v[110:111]
  v_cvt_pk_bf16_f32 v32, v32, v33
  v_cvt_pk_bf16_f32 v33, v34, v35
  v_cvt_pk_bf16_f32 v34, v36, v37
  v_cvt_pk_bf16_f32 v35, v38, v39
  v_cvt_pk_bf16_f32 v36, v40, v41
  v_cvt_pk_bf16_f32 v37, v42, v43
  v_cvt_pk_bf16_f32 v38, v44, v45
  v_cvt_pk_bf16_f32 v39, v46, v47
  s_nop 1
  v_permlane32_swap_b32 v32, v34
  v_permlane32_swap_b32 v33, v35
  buffer_store_dwordx4 v[32:35], v56, s[28:31], 0 offen offset:0
  v_permlane32_swap_b32 v36, v38
  v_permlane32_swap_b32 v37, v39
  buffer_store_dwordx4 v[36:39], v56, s[28:31], 0 offen offset:32
mk_end:
  s_endpgm
mk_slow:
  s_mov_b32 s84, 0
mk_sq:
  s_mov_b32 s58, 64
  v_mov_b32 v240, v7
  v_mov_b32 v244, 0xff800000
mk_mx:
  ds_read_b128 v[136:139], v240
  v_add_u32 v240, 1024, v240
  s_waitcnt lgkmcnt(0)
  v_mfma_f32_32x32x16_bf16 v[160:175], v[136:139], v[128:131], 0
  s_nop 15
  v_max3_f32 v244, v160, v161, v244
  v_max3_f32 v244, v162, v163, v244
  v_max3_f32 v244, v164, v165, v244
  v_max3_f32 v244, v166, v167, v244
  v_max3_f32 v244, v168, v169, v244
  v_max3_f32 v244, v170, v171, v244
  v_max3_f32 v244, v172, v173, v244
  v_max3_f32 v244, v174, v175, v244
  s_sub_u32 s58, s58, 1
  s_cmp_lg_u32 s58, 0
  s_cbranch_scc1 mk_mx
  v_mov_b32 v245, v244
  s_nop 1
  v_permlane32_swap_b32 v244, v245
  v_max_f32 v244, v244, v245
  v_sub_f32 v176, 0, v244
  v_mov_b32 v208, 0
  v_sub_f32 v177, 0, v244
  v_mov_b32 v209, 0
  v_sub_f32 v178, 0, v244
  v_mov_b32 v210, 0
  v_sub_f32 v179, 0, v244
  v_mov_b32 v211, 0
  v_sub_f32 v180, 0, v244
  v_mov_b32 v212, 0
  v_sub_f32 v181, 0, v244
  v_mov_b32 v213, 0
  v_sub_f32 v182, 0, v244
  v_mov_b32 v214, 0
  v_sub_f32 v183, 0, v244
  v_mov_b32 v215, 0
  v_sub_f32 v184, 0, v244
  v_mov_b32 v216, 0
  v_sub_f32 v185, 0, v244
  v_mov_b32 v217, 0
  v_sub_f32 v186, 0, v244
  v_mov_b32 v218, 0
  v_sub_f32 v187, 0, v244
  v_mov_b32 v219, 0
  v_sub_f32 v188, 0, v244
  v_mov_b32 v220, 0
  v_sub_f32 v189, 0, v244
  v_mov_b32 v221, 0
  v_sub_f32 v190, 0, v244
  v_mov_b32 v222, 0
  v_sub_f32 v191, 0, v244
  v_mov_b32 v223, 0
  v_mov_b32 v240, v7
  v_lshlrev_b32 v244, 3, v242
  v_sub_u32 v245, v241, v244
  v_lshrrev_b32 v244, 3, v242
  s_mov_b32 s58, 64
mk_sl:
  ds_read_b128 v[136:139], v240
  ds_read_b128 v[144:147], v245
  ds_read_b128 v[148:151], v245 offset:512
  v_add_u32 v240, 1024, v240
  v_add_u32 v245, v244, v245
  s_waitcnt lgkmcnt(0)
  v_mfma_f32_32x32x16_bf16 v[160:175], v[136:139], v[128:131], v[176:191]
  s_nop 15
  v_exp_f32 v160, v160
  v_exp_f32 v161, v161
  v_exp_f32 v162, v162
  v_exp_f32 v163, v163
  v_exp_f32 v164, v164
  v_exp_f32 v165, v165
  v_exp_f32 v166, v166
  v_exp_f32 v167, v167
  v_exp_f32 v168, v168
  v_exp_f32 v169, v169
  v_exp_f32 v170, v170
  v_exp_f32 v171, v171
  v_exp_f32 v172, v172
  v_exp_f32 v173, v173
  v_exp_f32 v174, v174
  v_exp_f32 v175, v175
  s_nop 0
  v_cvt_pk_bf16_f32 v192, v160, v161
  v_cvt_pk_bf16_f32 v193, v162, v163
  v_cvt_pk_bf16_f32 v194, v164, v165
  v_cvt_pk_bf16_f32 v195, v166, v167
  v_cvt_pk_bf16_f32 v196, v168, v169
  v_cvt_pk_bf16_f32 v197, v170, v171
  v_cvt_pk_bf16_f32 v198, v172, v173
  v_cvt_pk_bf16_f32 v199, v174, v175
  s_nop 1
  v_mfma_f32_32x32x16_bf16 v[208:223], v[144:147], v[192:195], v[208:223]
  v_mfma_f32_32x32x16_bf16 v[208:223], v[148:151], v[196:199], v[208:223]
  s_sub_u32 s58, s58, 1
  s_cmp_lg_u32 s58, 0
  s_cbranch_scc1 mk_sl
  s_nop 15
  v_swap_b32 v208, v224
  v_swap_b32 v209, v225
  v_swap_b32 v210, v226
  v_swap_b32 v211, v227
  v_swap_b32 v212, v228
  v_swap_b32 v213, v229
  v_swap_b32 v214, v230
  v_swap_b32 v215, v231
  v_swap_b32 v216, v232
  v_swap_b32 v217, v233
  v_swap_b32 v218, v234
  v_swap_b32 v219, v235
  v_swap_b32 v220, v236
  v_swap_b32 v221, v237
  v_swap_b32 v222, v238
  v_swap_b32 v223, v239
  v_swap_b32 v128, v132
  v_swap_b32 v129, v133
  v_swap_b32 v130, v134
  v_swap_b32 v131, v135
  s_add_u32 s84, s84, 1
  s_cmp_lt_u32 s84, 2
  s_cbranch_scc1 mk_sq
  s_branch mk_fin
mk_ph_spin:
  s_mov_b32 s88, 0x20000
mk_ph_l:
  s_sleep 4
  global_load_dword v60, v58, s[38:39] sc1
  s_waitcnt vmcnt(0)
  v_cmp_ne_u32 vcc, s94, v60
  s_sub_u32 s88, s88, 1
  s_cbranch_vccz mk_ph_ok
  s_cmp_lg_u32 s88, 0
  s_cbranch_scc1 mk_ph_l
  s_branch mk_ph_ok
mk_ps_spin:
  s_mov_b32 s88, 0x20000
mk_ps_l:
  s_sleep 4
  global_load_dword v60, v59, s[38:39] sc1
  s_waitcnt vmcnt(0)
  v_cmp_ne_u32 vcc, s94, v60
  s_sub_u32 s88, s88, 1
  s_cbranch_vccz mk_ps_ok
  s_cmp_lg_u32 s88, 0
  s_cbranch_scc1 mk_ps_l
  s_branch mk_ps_ok
mk_rt0:
  s_mov_b32 s88, 0x8000
mk_rl0:
  global_load_dwordx4 v[128:131], v232, s[4:5] sc1
  global_load_dwordx4 v[132:135], v232, s[6:7] sc1
  global_load_dwordx4 v[136:139], v233, s[4:5] sc1
  global_load_dwordx4 v[140:143], v233, s[6:7] sc1
  global_load_dwordx4 v[144:147], v234, s[4:5] sc1
  global_load_dwordx4 v[148:151], v234, s[6:7] sc1
  global_load_dwordx4 v[152:155], v235, s[4:5] sc1
  global_load_dwordx4 v[156:159], v235, s[6:7] sc1
  global_load_dwordx4 v[160:163], v236, s[4:5] sc1
  global_load_dwordx4 v[164:167], v236, s[6:7] sc1
  global_load_dwordx4 v[168:171], v237, s[4:5] sc1
  global_load_dwordx4 v[172:175], v237, s[6:7] sc1
  global_load_dwordx4 v[176:179], v238, s[4:5] sc1
  global_load_dwordx4 v[180:183], v238, s[6:7] sc1
  global_load_dwordx4 v[184:187], v239, s[4:5] sc1
  global_load_dwordx4 v[188:191], v239, s[6:7] sc1
  s_waitcnt vmcnt(8)
  v_max_u32 v244, v128, v129
  v_max3_u32 v244, v130, v131, v244
  v_max3_u32 v244, v132, v133, v244
  v_max3_u32 v244, v134, v135, v244
  v_max3_u32 v244, v136, v137, v244
  v_max3_u32 v244, v138, v139, v244
  v_max3_u32 v244, v140, v141, v244
  v_max3_u32 v244, v142, v143, v244
  v_max3_u32 v244, v144, v145, v244
  v_max3_u32 v244, v146, v147, v244
  v_max3_u32 v244, v148, v149, v244
  v_max3_u32 v244, v150, v151, v244
  v_max3_u32 v244, v152, v153, v244
  v_max3_u32 v244, v154, v155, v244
  v_max3_u32 v244, v156, v157, v244
  v_max3_u32 v244, v158, v159, v244
  v_cmp_eq_u32 vcc, -1, v244
  s_sub_u32 s88, s88, 1
  s_cbranch_vccz mk_ok0
  s_waitcnt vmcnt(0)
  s_cmp_lg_u32 s88, 0
  s_cbranch_scc1 mk_rl0
  s_branch mk_ok0
mk_rt1:
  s_mov_b32 s88, 0x8000
mk_rl1:
  global_load_dwordx4 v[160:163], v236, s[4:5] sc1
  global_load_dwordx4 v[164:167], v236, s[6:7] sc1
  global_load_dwordx4 v[168:171], v237, s[4:5] sc1
  global_load_dwordx4 v[172:175], v237, s[6:7] sc1
  global_load_dwordx4 v[176:179], v238, s[4:5] sc1
  global_load_dwordx4 v[180:183], v238, s[6:7] sc1
  global_load_dwordx4 v[184:187], v239, s[4:5] sc1
  global_load_dwordx4 v[188:191], v239, s[6:7] sc1
  s_waitcnt vmcnt(0)
  v_max_u32 v245, v160, v161
  v_max3_u32 v245, v162, v163, v245
  v_max3_u32 v245, v164, v165, v245
  v_max3_u32 v245, v166, v167, v245
  v_max3_u32 v245, v168, v169, v245
  v_max3_u32 v245, v170, v171, v245
  v_max3_u32 v245, v172, v173, v245
  v_max3_u32 v245, v174, v175, v245
  v_max3_u32 v245, v176, v177, v245
  v_max3_u32 v245, v178, v179, v245
  v_max3_u32 v245, v180, v181, v245
  v_max3_u32 v245, v182, v183, v245
  v_max3_u32 v245, v184, v185, v245
  v_max3_u32 v245, v186, v187, v245
  v_max3_u32 v245, v188, v189, v245
  v_max3_u32 v245, v190, v191, v245
  v_cmp_eq_u32 vcc, -1, v245
  s_sub_u32 s88, s88, 1
  s_cbranch_vccz mk_ok1
  s_waitcnt vmcnt(0)
  s_cmp_lg_u32 s88, 0
  s_cbranch_scc1 mk_rl1
  s_branch mk_ok1
mk_pdA_spin:
  s_mov_b32 s88, 0x20000
mk_pdA_l:
  s_sleep 4
  global_load_dword v31, v30, s[36:37] sc1
  s_waitcnt vmcnt(0)
  v_cmp_eq_u32 vcc, 0, v31
  s_sub_u32 s88, s88, 1
  s_cbranch_vccz mk_pdA_ok
  s_cmp_lg_u32 s88, 0
  s_cbranch_scc1 mk_pdA_l
  s_branch mk_pdA_ok
mk_pqA_spin:
  s_mov_b32 s88, 0x20000
mk_pqA_l:
  s_sleep 4
  global_load_dword v12, v11, s[38:39] sc1
  s_waitcnt vmcnt(0)
  v_cmp_ne_u32 vcc, s94, v12
  s_sub_u32 s88, s88, 1
  s_cbranch_vccz mk_pqA_ok
  s_cmp_lg_u32 s88, 0
  s_cbranch_scc1 mk_pqA_l
  s_branch mk_pqA_ok
mk_pdB_spin:
  s_mov_b32 s88, 0x20000
mk_pdB_l:
  s_sleep 4
  global_load_dword v31, v30, s[36:37] sc1
  s_waitcnt vmcnt(0)
  v_cmp_eq_u32 vcc, 0, v31
  s_sub_u32 s88, s88, 1
  s_cbranch_vccz mk_pdB_ok
  s_cmp_lg_u32 s88, 0
  s_cbranch_scc1 mk_pdB_l
  s_branch mk_pdB_ok
mk_pqB_spin:
  s_mov_b32 s88, 0x20000
mk_pqB_l:
  s_sleep 4
  global_load_dword v12, v11, s[38:39] sc1
  s_waitcnt vmcnt(0)
  v_cmp_ne_u32 vcc, s94, v12
  s_sub_u32 s88, s88, 1
  s_cbranch_vccz mk_pqB_ok
  s_cmp_lg_u32 s88, 0
  s_cbranch_scc1 mk_pqB_l
  s_branch mk_pqB_ok
mk_pdC_spin:
  s_mov_b32 s88, 0x20000
mk_pdC_l:
  s_sleep 4
  global_load_dword v31, v30, s[36:37] sc1
  s_waitcnt vmcnt(0)
  v_cmp_eq_u32 vcc, 0, v31
  s_sub_u32 s88, s88, 1
  s_cbranch_vccz mk_pdC_ok
  s_cmp_lg_u32 s88, 0
  s_cbranch_scc1 mk_pdC_l
  s_branch mk_pdC_ok
mk_pqC_spin:
  s_mov_b32 s88, 0x20000
mk_pqC_l:
  s_sleep 4
  global_load_dword v12, v11, s[38:39] sc1
  s_waitcnt vmcnt(0)
  v_cmp_ne_u32 vcc, s94, v12
  s_sub_u32 s88, s88, 1
  s_cbranch_vccz mk_pqC_ok
  s_cmp_lg_u32 s88, 0
  s_cbranch_scc1 mk_pqC_l
  s_branch mk_pqC_ok
.p2align 12
mk_typeB:
mk_wB0:
  s_cbranch_execz mk_wJ0
  s_barrier
  s_add_u32 s49, s44, 0
  s_and_b32 s49, s49, 7
  s_mul_i32 s49, s49, 196608
  s_add_u32 s49, s49, s47
  s_add_u32 m0, s43, 131072
  s_add_u32 s50, s49, 128
  s_add_u32 s49, s49, 2048
  buffer_load_dwordx4 v11, s[12:15], s49 offen offset:0 lds
  buffer_load_dwordx4 v12, s[12:15], s49 offen offset:1024 lds
  s_waitcnt lgkmcnt(0)
  v_dot2c_f32_bf16 v64, s65, v192
  v_dot2c_f32_bf16 v68, v192, v192
  v_dot2c_f32_bf16 v65, s65, v193
  v_dot2c_f32_bf16 v69, v193, v193
  v_dot2c_f32_bf16 v66, s65, v194
  v_dot2c_f32_bf16 v70, v194, v194
  v_dot2c_f32_bf16 v67, s65, v195
  v_dot2c_f32_bf16 v71, v195, v195
  v_dot2c_f32_bf16 v64, s65, v196
  v_dot2c_f32_bf16 v68, v196, v196
  v_dot2c_f32_bf16 v65, s65, v197
  v_dot2c_f32_bf16 v69, v197, v197
  v_dot2c_f32_bf16 v66, s65, v198
  v_dot2c_f32_bf16 v70, v198, v198
  v_dot2c_f32_bf16 v67, s65, v199
  v_dot2c_f32_bf16 v71, v199, v199
  buffer_load_dwordx4 v11, s[12:15], s50 offen offset:2048 lds
  buffer_load_dwordx4 v12, s[12:15], s50 offen offset:3072 lds
  v_dot2c_f32_bf16 v64, s65, v200
  v_dot2c_f32_bf16 v68, v200, v200
  v_dot2c_f32_bf16 v65, s65, v201
  v_dot2c_f32_bf16 v69, v201, v201
  v_dot2c_f32_bf16 v66, s65, v202
  v_dot2c_f32_bf16 v70, v202, v202
  v_dot2c_f32_bf16 v67, s65, v203
  v_dot2c_f32_bf16 v71, v203, v203
  v_dot2c_f32_bf16 v64, s65, v204
  v_dot2c_f32_bf16 v68, v204, v204
  v_dot2c_f32_bf16 v65, s65, v205
  v_dot2c_f32_bf16 v69, v205, v205
  v_dot2c_f32_bf16 v66, s65, v206
  v_dot2c_f32_bf16 v70, v206, v206
  v_dot2c_f32_bf16 v67, s65, v207
  v_dot2c_f32_bf16 v71, v207, v207
  v_dot2c_f32_bf16 v64, s65, v208
  v_dot2c_f32_bf16 v68, v208, v208
  v_dot2c_f32_bf16 v65, s65, v209
  v_dot2c_f32_bf16 v69, v209, v209
  v_dot2c_f32_bf16 v66, s65, v210
  v_dot2c_f32_bf16 v70, v210, v210
  v_dot2c_f32_bf16 v67, s65, v211
  v_dot2c_f32_bf16 v71, v211, v211
  v_dot2c_f32_bf16 v64, s65, v212
  v_dot2c_f32_bf16 v68, v212, v212
  v_dot2c_f32_bf16 v65, s65, v213
  v_dot2c_f32_bf16 v69, v213, v213
  v_dot2c_f32_bf16 v66, s65, v214
  v_dot2c_f32_bf16 v70, v214, v214
  v_dot2c_f32_bf16 v67, s65, v215
  v_dot2c_f32_bf16 v71, v215, v215
  v_dot2c_f32_bf16 v64, s65, v216
  v_dot2c_f32_bf16 v68, v216, v216
  v_dot2c_f32_bf16 v65, s65, v217
  v_dot2c_f32_bf16 v69, v217, v217
  v_dot2c_f32_bf16 v66, s65, v218
  v_dot2c_f32_bf16 v70, v218, v218
  v_dot2c_f32_bf16 v67, s65, v219
  v_dot2c_f32_bf16 v71, v219, v219
  v_dot2c_f32_bf16 v64, s65, v220
  v_dot2c_f32_bf16 v68, v220, v220
  v_dot2c_f32_bf16 v65, s65, v221
  v_dot2c_f32_bf16 v69, v221, v221
  v_dot2c_f32_bf16 v66, s65, v222
  v_dot2c_f32_bf16 v70, v222, v222
  v_dot2c_f32_bf16 v67, s65, v223
  v_dot2c_f32_bf16 v71, v223, v223
  s_waitcnt vmcnt(4)
  ds_read_b128 v[224:227], v56 offset:24576
  ds_read_b128 v[228:231], v57 offset:24576
  ds_read_b128 v[232:235], v58 offset:24576
  ds_read_b128 v[236:239], v59 offset:24576
  ds_read_b128 v[240:243], v60 offset:24576
  ds_read_b128 v[244:247], v61 offset:24576
  ds_read_b128 v[248:251], v62 offset:24576
  ds_read_b128 v[252:255], v63 offset:24576
  s_waitcnt lgkmcnt(0)
  s_barrier
  v_dot2c_f32_bf16 v64, s65, v224
  v_dot2c_f32_bf16 v68, v224, v224
  v_dot2c_f32_bf16 v65, s65, v225
  v_dot2c_f32_bf16 v69, v225, v225
  v_dot2c_f32_bf16 v66, s65, v226
  v_dot2c_f32_bf16 v70, v226, v226
  v_dot2c_f32_bf16 v67, s65, v227
  v_dot2c_f32_bf16 v71, v227, v227
  v_dot2c_f32_bf16 v64, s65, v228
  v_dot2c_f32_bf16 v68, v228, v228
  v_dot2c_f32_bf16 v65, s65, v229
  v_dot2c_f32_bf16 v69, v229, v229
  v_dot2c_f32_bf16 v66, s65, v230
  v_dot2c_f32_bf16 v70, v230, v230
  v_dot2c_f32_bf16 v67, s65, v231
  v_dot2c_f32_bf16 v71, v231, v231
  v_dot2c_f32_bf16 v64, s65, v232
  v_dot2c_f32_bf16 v68, v232, v232
  v_dot2c_f32_bf16 v65, s65, v233
  v_dot2c_f32_bf16 v69, v233, v233
  v_dot2c_f32_bf16 v66, s65, v234
  v_dot2c_f32_bf16 v70, v234, v234
  v_dot2c_f32_bf16 v67, s65, v235
  v_dot2c_f32_bf16 v71, v235, v235
  v_dot2c_f32_bf16 v64, s65, v236
  v_dot2c_f32_bf16 v68, v236, v236
  v_dot2c_f32_bf16 v65, s65, v237
  v_dot2c_f32_bf16 v69, v237, v237
  v_dot2c_f32_bf16 v66, s65, v238
  v_dot2c_f32_bf16 v70, v238, v238
  v_dot2c_f32_bf16 v67, s65, v239
  v_dot2c_f32_bf16 v71, v239, v239
  v_dot2c_f32_bf16 v64, s65, v240
  v_dot2c_f32_bf16 v68, v240, v240
  v_dot2c_f32_bf16 v65, s65, v241
  v_dot2c_f32_bf16 v69, v241, v241
  v_dot2c_f32_bf16 v66, s65, v242
  v_dot2c_f32_bf16 v70, v242, v242
  v_dot2c_f32_bf16 v67, s65, v243
  v_dot2c_f32_bf16 v71, v243, v243
  v_dot2c_f32_bf16 v64, s65, v244
  v_dot2c_f32_bf16 v68, v244, v244
  v_dot2c_f32_bf16 v65, s65, v245
  v_dot2c_f32_bf16 v69, v245, v245
  v_dot2c_f32_bf16 v66, s65, v246
  v_dot2c_f32_bf16 v70, v246, v246
  v_dot2c_f32_bf16 v67, s65, v247
  v_dot2c_f32_bf16 v71, v247, v247
  v_dot2c_f32_bf16 v64, s65, v248
  v_dot2c_f32_bf16 v68, v248, v248
  v_dot2c_f32_bf16 v65, s65, v249
  v_dot2c_f32_bf16 v69, v249, v249
  v_dot2c_f32_bf16 v66, s65, v250
  v_dot2c_f32_bf16 v70, v250, v250
  v_dot2c_f32_bf16 v67, s65, v251
  v_dot2c_f32_bf16 v71, v251, v251
  v_dot2c_f32_bf16 v64, s65, v252
  v_dot2c_f32_bf16 v68, v252, v252
  v_dot2c_f32_bf16 v65, s65, v253
  v_dot2c_f32_bf16 v69, v253, v253
  v_dot2c_f32_bf16 v66, s65, v254
  v_dot2c_f32_bf16 v70, v254, v254
  v_dot2c_f32_bf16 v67, s65, v255
  v_dot2c_f32_bf16 v71, v255, v255
  s_nop 2
  v_add_f32 v64, v64, v65
  v_add_f32 v66, v66, v67
  v_add_f32 v68, v68, v69
  v_add_f32 v70, v70, v71
  v_add_f32 v64, v64, v66
  v_add_f32 v68, v68, v70
  v_mov_b32 v65, v64
  v_mov_b32 v69, v68
  s_nop 1
  v_permlane32_swap_b32 v64, v65
  v_permlane32_swap_b32 v68, v69
  v_add_f32 v64, v64, v65
  v_add_f32 v68, v68, v69
  v_mul_f32 v64, 0x3b000000, v64
  v_mul_f32 v68, 0x3b000000, v68
  v_fma_f32 v68, -v64, v64, v68
  v_max_f32 v68, 0, v68
  v_cvt_pk_bf16_f32 v22, v64, v68
  v_lshlrev_b32 v2, 16, v22
  v_xor_b32 v2, 0x80000000, v2
  v_dot2_f32_bf16 v32, v128, s56, v2
  v_dot2_f32_bf16 v33, v128, s57, v2
  v_dot2_f32_bf16 v34, v129, s56, v2
  v_dot2_f32_bf16 v35, v129, s57, v2
  v_dot2_f32_bf16 v36, v130, s56, v2
  v_dot2_f32_bf16 v37, v130, s57, v2
  v_dot2_f32_bf16 v38, v131, s56, v2
  v_dot2_f32_bf16 v39, v131, s57, v2
  v_dot2_f32_bf16 v40, v132, s56, v2
  v_dot2_f32_bf16 v41, v132, s57, v2
  v_cvt_pk_bf16_f32 v128, v32, v33
  v_dot2_f32_bf16 v42, v133, s56, v2
  v_dot2_f32_bf16 v43, v133, s57, v2
  v_cvt_pk_bf16_f32 v129, v34, v35
  v_dot2_f32_bf16 v44, v134, s56, v2
  v_dot2_f32_bf16 v45, v134, s57, v2
  v_cvt_pk_bf16_f32 v130, v36, v37
  v_dot2_f32_bf16 v46, v135, s56, v2
  v_dot2_f32_bf16 v47, v135, s57, v2
  v_cvt_pk_bf16_f32 v131, v38, v39
  v_dot2_f32_bf16 v32, v136, s56, v2
  v_dot2_f32_bf16 v33, v136, s57, v2
  v_cvt_pk_bf16_f32 v132, v40, v41
  v_dot2_f32_bf16 v34, v137, s56, v2
  v_dot2_f32_bf16 v35, v137, s57, v2
  v_cvt_pk_bf16_f32 v133, v42, v43
  v_dot2_f32_bf16 v36, v138, s56, v2
  v_dot2_f32_bf16 v37, v138, s57, v2
  v_cvt_pk_bf16_f32 v134, v44, v45
  v_dot2_f32_bf16 v38, v139, s56, v2
  v_dot2_f32_bf16 v39, v139, s57, v2
  v_cvt_pk_bf16_f32 v135, v46, v47
  s_add_u32 s49, s44, 1
  s_and_b32 s49, s49, 7
  s_mul_i32 s49, s49, 196608
  s_add_u32 s49, s49, s47
  s_add_u32 m0, s43, 147456
  s_add_u32 s50, s49, 128
  s_add_u32 s49, s49, 2048
  buffer_load_dwordx4 v11, s[12:15], s49 offen offset:0 lds
  buffer_load_dwordx4 v12, s[12:15], s49 offen offset:1024 lds
  buffer_load_dwordx4 v11, s[12:15], s50 offen offset:2048 lds
  buffer_load_dwordx4 v12, s[12:15], s50 offen offset:3072 lds
  v_dot2_f32_bf16 v40, v140, s56, v2
  v_dot2_f32_bf16 v41, v140, s57, v2
  v_cvt_pk_bf16_f32 v136, v32, v33
  v_dot2_f32_bf16 v42, v141, s56, v2
  v_dot2_f32_bf16 v43, v141, s57, v2
  v_cvt_pk_bf16_f32 v137, v34, v35
  v_dot2_f32_bf16 v44, v142, s56, v2
  v_dot2_f32_bf16 v45, v142, s57, v2
  v_cvt_pk_bf16_f32 v138, v36, v37
  v_dot2_f32_bf16 v46, v143, s56, v2
  v_dot2_f32_bf16 v47, v143, s57, v2
  v_cvt_pk_bf16_f32 v139, v38, v39
  v_dot2_f32_bf16 v32, v144, s56, v2
  v_dot2_f32_bf16 v33, v144, s57, v2
  v_cvt_pk_bf16_f32 v140, v40, v41
  v_dot2_f32_bf16 v34, v145, s56, v2
  v_dot2_f32_bf16 v35, v145, s57, v2
  v_cvt_pk_bf16_f32 v141, v42, v43
  v_dot2_f32_bf16 v36, v146, s56, v2
  v_dot2_f32_bf16 v37, v146, s57, v2
  v_cvt_pk_bf16_f32 v142, v44, v45
  v_dot2_f32_bf16 v38, v147, s56, v2
  v_dot2_f32_bf16 v39, v147, s57, v2
  v_cvt_pk_bf16_f32 v143, v46, v47
  v_dot2_f32_bf16 v40, v148, s56, v2
  v_dot2_f32_bf16 v41, v148, s57, v2
  v_cvt_pk_bf16_f32 v144, v32, v33
  v_dot2_f32_bf16 v42, v149, s56, v2
  v_dot2_f32_bf16 v43, v149, s57, v2
  v_cvt_pk_bf16_f32 v145, v34, v35
  v_dot2_f32_bf16 v44, v150, s56, v2
  v_dot2_f32_bf16 v45, v150, s57, v2
  v_cvt_pk_bf16_f32 v146, v36, v37
  v_dot2_f32_bf16 v46, v151, s56, v2
  v_dot2_f32_bf16 v47, v151, s57, v2
  v_cvt_pk_bf16_f32 v147, v38, v39
  v_dot2_f32_bf16 v32, v152, s56, v2
  v_dot2_f32_bf16 v33, v152, s57, v2
  v_cvt_pk_bf16_f32 v148, v40, v41
  v_dot2_f32_bf16 v34, v153, s56, v2
  v_dot2_f32_bf16 v35, v153, s57, v2
  v_cvt_pk_bf16_f32 v149, v42, v43
  v_dot2_f32_bf16 v36, v154, s56, v2
  v_dot2_f32_bf16 v37, v154, s57, v2
  v_cvt_pk_bf16_f32 v150, v44, v45
  v_dot2_f32_bf16 v38, v155, s56, v2
  v_dot2_f32_bf16 v39, v155, s57, v2
  v_cvt_pk_bf16_f32 v151, v46, v47
  v_dot2_f32_bf16 v40, v156, s56, v2
  v_dot2_f32_bf16 v41, v156, s57, v2
  v_cvt_pk_bf16_f32 v152, v32, v33
  v_dot2_f32_bf16 v42, v157, s56, v2
  v_dot2_f32_bf16 v43, v157, s57, v2
  v_cvt_pk_bf16_f32 v153, v34, v35
  v_dot2_f32_bf16 v44, v158, s56, v2
  v_dot2_f32_bf16 v45, v158, s57, v2
  v_cvt_pk_bf16_f32 v154, v36, v37
  v_dot2_f32_bf16 v46, v159, s56, v2
  v_dot2_f32_bf16 v47, v159, s57, v2
  v_cvt_pk_bf16_f32 v155, v38, v39
  v_dot2_f32_bf16 v32, v160, s56, v2
  v_dot2_f32_bf16 v33, v160, s57, v2
  v_cvt_pk_bf16_f32 v156, v40, v41
  v_dot2_f32_bf16 v34, v161, s56, v2
  v_dot2_f32_bf16 v35, v161, s57, v2
  v_cvt_pk_bf16_f32 v157, v42, v43
  v_dot2_f32_bf16 v36, v162, s56, v2
  v_dot2_f32_bf16 v37, v162, s57, v2
  v_cvt_pk_bf16_f32 v158, v44, v45
  v_dot2_f32_bf16 v38, v163, s56, v2
  v_dot2_f32_bf16 v39, v163, s57, v2
  v_cvt_pk_bf16_f32 v159, v46, v47
  v_dot2_f32_bf16 v40, v164, s56, v2
  v_dot2_f32_bf16 v41, v164, s57, v2
  v_cvt_pk_bf16_f32 v160, v32, v33
  v_dot2_f32_bf16 v42, v165, s56, v2
  v_dot2_f32_bf16 v43, v165, s57, v2
  v_cvt_pk_bf16_f32 v161, v34, v35
  s_add_u32 s49, s44, 2
  s_and_b32 s49, s49, 7
  s_mul_i32 s49, s49, 196608
  s_add_u32 s49, s49, s47
  s_add_u32 m0, s43, 0
  s_add_u32 s50, s49, 128
  s_add_u32 s49, s49, 2048
  buffer_load_dwordx4 v11, s[12:15], s49 offen offset:0 lds
  buffer_load_dwordx4 v12, s[12:15], s49 offen offset:1024 lds
  buffer_load_dwordx4 v11, s[12:15], s50 offen offset:2048 lds
  buffer_load_dwordx4 v12, s[12:15], s50 offen offset:3072 lds
  v_dot2_f32_bf16 v44, v166, s56, v2
  v_dot2_f32_bf16 v45, v166, s57, v2
  v_cvt_pk_bf16_f32 v162, v36, v37
  v_dot2_f32_bf16 v46, v167, s56, v2
  v_dot2_f32_bf16 v47, v167, s57, v2
  v_cvt_pk_bf16_f32 v163, v38, v39
  v_dot2_f32_bf16 v32, v168, s56, v2
  v_dot2_f32_bf16 v33, v168, s57, v2
  v_cvt_pk_bf16_f32 v164, v40, v41
  v_dot2_f32_bf16 v34, v169, s56, v2
  v_dot2_f32_bf16 v35, v169, s57, v2
  v_cvt_pk_bf16_f32 v165, v42, v43
  v_dot2_f32_bf16 v36, v170, s56, v2
  v_dot2_f32_bf16 v37, v170, s57, v2
  v_cvt_pk_bf16_f32 v166, v44, v45
  v_dot2_f32_bf16 v38, v171, s56, v2
  v_dot2_f32_bf16 v39, v171, s57, v2
  v_cvt_pk_bf16_f32 v167, v46, v47
  v_dot2_f32_bf16 v40, v172, s56, v2
  v_dot2_f32_bf16 v41, v172, s57, v2
  v_cvt_pk_bf16_f32 v168, v32, v33
  v_dot2_f32_bf16 v42, v173, s56, v2
  v_dot2_f32_bf16 v43, v173, s57, v2
  v_cvt_pk_bf16_f32 v169, v34, v35
  v_dot2_f32_bf16 v44, v174, s56, v2
  v_dot2_f32_bf16 v45, v174, s57, v2
  v_cvt_pk_bf16_f32 v170, v36, v37
  v_dot2_f32_bf16 v46, v175, s56, v2
  v_dot2_f32_bf16 v47, v175, s57, v2
  v_cvt_pk_bf16_f32 v171, v38, v39
  v_dot2_f32_bf16 v32, v176, s56, v2
  v_dot2_f32_bf16 v33, v176, s57, v2
  v_cvt_pk_bf16_f32 v172, v40, v41
  v_dot2_f32_bf16 v34, v177, s56, v2
  v_dot2_f32_bf16 v35, v177, s57, v2
  v_cvt_pk_bf16_f32 v173, v42, v43
  v_dot2_f32_bf16 v36, v178, s56, v2
  v_dot2_f32_bf16 v37, v178, s57, v2
  v_cvt_pk_bf16_f32 v174, v44, v45
  v_dot2_f32_bf16 v38, v179, s56, v2
  v_dot2_f32_bf16 v39, v179, s57, v2
  v_cvt_pk_bf16_f32 v175, v46, v47
  v_dot2_f32_bf16 v40, v180, s56, v2
  v_dot2_f32_bf16 v41, v180, s57, v2
  v_cvt_pk_bf16_f32 v176, v32, v33
  v_dot2_f32_bf16 v42, v181, s56, v2
  v_dot2_f32_bf16 v43, v181, s57, v2
  v_cvt_pk_bf16_f32 v177, v34, v35
  v_dot2_f32_bf16 v44, v182, s56, v2
  v_dot2_f32_bf16 v45, v182, s57, v2
  v_cvt_pk_bf16_f32 v178, v36, v37
  v_dot2_f32_bf16 v46, v183, s56, v2
  v_dot2_f32_bf16 v47, v183, s57, v2
  v_cvt_pk_bf16_f32 v179, v38, v39
  v_dot2_f32_bf16 v32, v184, s56, v2
  v_dot2_f32_bf16 v33, v184, s57, v2
  v_cvt_pk_bf16_f32 v180, v40, v41
  v_dot2_f32_bf16 v34, v185, s56, v2
  v_dot2_f32_bf16 v35, v185, s57, v2
  v_cvt_pk_bf16_f32 v181, v42, v43
  v_dot2_f32_bf16 v36, v186, s56, v2
  v_dot2_f32_bf16 v37, v186, s57, v2
  v_cvt_pk_bf16_f32 v182, v44, v45
  v_dot2_f32_bf16 v38, v187, s56, v2
  v_dot2_f32_bf16 v39, v187, s57, v2
  v_cvt_pk_bf16_f32 v183, v46, v47
  v_dot2_f32_bf16 v40, v188, s56, v2
  v_dot2_f32_bf16 v41, v188, s57, v2
  v_cvt_pk_bf16_f32 v184, v32, v33
  v_dot2_f32_bf16 v42, v189, s56, v2
  v_dot2_f32_bf16 v43, v189, s57, v2
  v_cvt_pk_bf16_f32 v185, v34, v35
  v_dot2_f32_bf16 v44, v190, s56, v2
  v_dot2_f32_bf16 v45, v190, s57, v2
  v_cvt_pk_bf16_f32 v186, v36, v37
  v_dot2_f32_bf16 v46, v191, s56, v2
  v_dot2_f32_bf16 v47, v191, s57, v2
  v_cvt_pk_bf16_f32 v187, v38, v39
  s_add_u32 s49, s44, 3
  s_and_b32 s49, s49, 7
  s_mul_i32 s49, s49, 196608
  s_add_u32 s49, s49, s47
  s_add_u32 m0, s43, 16384
  s_add_u32 s50, s49, 128
  s_add_u32 s49, s49, 2048
  buffer_load_dwordx4 v11, s[12:15], s49 offen offset:0 lds
  buffer_load_dwordx4 v12, s[12:15], s49 offen offset:1024 lds
  buffer_load_dwordx4 v11, s[12:15], s50 offen offset:2048 lds
  buffer_load_dwordx4 v12, s[12:15], s50 offen offset:3072 lds
  v_dot2_f32_bf16 v32, v192, s56, v2
  v_dot2_f32_bf16 v33, v192, s57, v2
  v_cvt_pk_bf16_f32 v188, v40, v41
  v_dot2_f32_bf16 v34, v193, s56, v2
  v_dot2_f32_bf16 v35, v193, s57, v2
  v_cvt_pk_bf16_f32 v189, v42, v43
  v_dot2_f32_bf16 v36, v194, s56, v2
  v_dot2_f32_bf16 v37, v194, s57, v2
  v_cvt_pk_bf16_f32 v190, v44, v45
  v_dot2_f32_bf16 v38, v195, s56, v2
  v_dot2_f32_bf16 v39, v195, s57, v2
  v_cvt_pk_bf16_f32 v191, v46, v47
  v_dot2_f32_bf16 v40, v196, s56, v2
  v_dot2_f32_bf16 v41, v196, s57, v2
  v_cvt_pk_bf16_f32 v192, v32, v33
  v_dot2_f32_bf16 v42, v197, s56, v2
  v_dot2_f32_bf16 v43, v197, s57, v2
  v_cvt_pk_bf16_f32 v193, v34, v35
  v_dot2_f32_bf16 v44, v198, s56, v2
  v_dot2_f32_bf16 v45, v198, s57, v2
  v_cvt_pk_bf16_f32 v194, v36, v37
  v_dot2_f32_bf16 v46, v199, s56, v2
  v_dot2_f32_bf16 v47, v199, s57, v2
  v_cvt_pk_bf16_f32 v195, v38, v39
  v_cvt_pk_bf16_f32 v196, v40, v41
  v_cvt_pk_bf16_f32 v197, v42, v43
  v_cvt_pk_bf16_f32 v198, v44, v45
  v_cvt_pk_bf16_f32 v199, v46, v47
  v_and_b32 v22, 0xffff0000, v22
  v_add_f32 v22, 0x3727c5ac, v22
  v_cvt_pk_bf16_f32 v22, v22, v22
  v_and_b32 v22, 0xffff0000, v22
  v_sqrt_f32 v22, v22
  s_nop 0
  v_cvt_pk_bf16_f32 v22, v22, v22
  v_and_b32 v22, 0xffff0000, v22
  v_rcp_f32 v5, v22
  v_mul_f32 v6, v22, v22
  v_mul_f32 v3, s60, v5
  v_mul_f32 v4, 0xbfb8aa3b, v5
  s_waitcnt vmcnt(12)
  s_barrier
  v_add_u32 v18, 122880, v9
  v_xor_b32 v19, 64, v18
  ds_read_b64_tr_b16 a[64:65], v18 offset:8192
  ds_read_b64_tr_b16 a[66:67], v18 offset:8704
  ds_read_b64_tr_b16 a[68:69], v19 offset:8192
  ds_read_b64_tr_b16 a[70:71], v19 offset:8704
  ds_read_b64_tr_b16 a[72:73], v18 offset:10240
  ds_read_b64_tr_b16 a[74:75], v18 offset:10752
  ds_read_b64_tr_b16 a[76:77], v19 offset:10240
  ds_read_b64_tr_b16 a[78:79], v19 offset:10752
  ds_read_b64_tr_b16 a[80:81], v18 offset:12288
  ds_read_b64_tr_b16 a[82:83], v18 offset:12800
  ds_read_b64_tr_b16 a[84:85], v19 offset:12288
  ds_read_b64_tr_b16 a[86:87], v19 offset:12800
  s_waitcnt lgkmcnt(10)
  v_mfma_f32_32x32x16_bf16 v[64:79], v[128:131], a[64:67], 0
  s_waitcnt lgkmcnt(8)
  ds_read_b64_tr_b16 a[88:89], v18 offset:14336
  ds_read_b64_tr_b16 a[90:91], v18 offset:14848
  v_lshlrev_b32 v32, 16, v200
  s_add_u32 s49, s44, 4
  s_and_b32 s49, s49, 7
  s_mul_i32 s49, s49, 196608
  v_mfma_f32_32x32x16_bf16 v[80:95], v[128:131], a[68:71], 0
  s_waitcnt lgkmcnt(8)
  ds_read_b64_tr_b16 a[92:93], v19 offset:14336
  ds_read_b64_tr_b16 a[94:95], v19 offset:14848
  s_add_u32 s49, s49, s47
  s_add_u32 m0, s43, 32768
  s_add_u32 s50, s49, 128
  s_add_u32 s49, s49, 2048
  v_mfma_f32_32x32x16_bf16 v[96:111], v[128:131], a[72:75], 0
  s_waitcnt lgkmcnt(8)
  ds_read_b64_tr_b16 a[64:65], v18 offset:16384
  ds_read_b64_tr_b16 a[66:67], v18 offset:16896
  buffer_load_dwordx4 v11, s[12:15], s49 offen offset:0 lds
  v_and_b32 v33, s90, v200
  v_lshlrev_b32 v34, 16, v201
  v_mfma_f32_32x32x16_bf16 v[112:127], v[128:131], a[76:79], 0
  s_waitcnt lgkmcnt(8)
  ds_read_b64_tr_b16 a[68:69], v19 offset:16384
  ds_read_b64_tr_b16 a[70:71], v19 offset:16896
  buffer_load_dwordx4 v12, s[12:15], s49 offen offset:1024 lds
  v_and_b32 v35, s90, v201
  v_add_f32 v32, v32, v2
  v_mfma_f32_32x32x16_bf16 v[64:79], v[132:135], a[80:83], v[64:79]
  s_waitcnt lgkmcnt(8)
  ds_read_b64_tr_b16 a[72:73], v18 offset:18432
  ds_read_b64_tr_b16 a[74:75], v18 offset:18944
  v_add_f32 v33, v33, v2
  v_add_f32 v34, v34, v2
  v_add_f32 v35, v35, v2
  v_cvt_pk_bf16_f32 v200, v32, v33
  v_mfma_f32_32x32x16_bf16 v[80:95], v[132:135], a[84:87], v[80:95]
  s_waitcnt lgkmcnt(8)
  ds_read_b64_tr_b16 a[76:77], v19 offset:18432
  ds_read_b64_tr_b16 a[78:79], v19 offset:18944
  v_cvt_pk_bf16_f32 v201, v34, v35
  v_lshlrev_b32 v36, 16, v202
  v_and_b32 v37, s90, v202
  v_lshlrev_b32 v38, 16, v203
  v_mfma_f32_32x32x16_bf16 v[96:111], v[132:135], a[88:91], v[96:111]
  s_waitcnt lgkmcnt(8)
  ds_read_b64_tr_b16 a[80:81], v18 offset:20480
  ds_read_b64_tr_b16 a[82:83], v18 offset:20992
  buffer_load_dwordx4 v11, s[12:15], s50 offen offset:2048 lds
  v_and_b32 v39, s90, v203
  v_add_f32 v36, v36, v2
  v_mfma_f32_32x32x16_bf16 v[112:127], v[132:135], a[92:95], v[112:127]
  s_waitcnt lgkmcnt(8)
  ds_read_b64_tr_b16 a[84:85], v19 offset:20480
  ds_read_b64_tr_b16 a[86:87], v19 offset:20992
  buffer_load_dwordx4 v12, s[12:15], s50 offen offset:3072 lds
  v_add_f32 v37, v37, v2
  v_add_f32 v38, v38, v2
  v_mfma_f32_32x32x16_bf16 v[64:79], v[136:139], a[64:67], v[64:79]
  s_waitcnt lgkmcnt(8)
  ds_read_b64_tr_b16 a[88:89], v18 offset:22528
  ds_read_b64_tr_b16 a[90:91], v18 offset:23040
  v_add_f32 v39, v39, v2
  s_add_u32 s49, s44, 5
  s_and_b32 s49, s49, 7
  s_mul_i32 s49, s49, 196608
  v_mfma_f32_32x32x16_bf16 v[80:95], v[136:139], a[68:71], v[80:95]
  s_waitcnt lgkmcnt(8)
  ds_read_b64_tr_b16 a[92:93], v19 offset:22528
  ds_read_b64_tr_b16 a[94:95], v19 offset:23040
  s_add_u32 s49, s49, s47
  s_add_u32 m0, s43, 49152
  s_add_u32 s50, s49, 128
  s_add_u32 s49, s49, 2048
  v_mfma_f32_32x32x16_bf16 v[96:111], v[136:139], a[72:75], v[96:111]
  s_waitcnt vmcnt(12) lgkmcnt(8)
  s_barrier
  ds_read_b64_tr_b16 a[64:65], v18 offset:24576
  ds_read_b64_tr_b16 a[66:67], v18 offset:25088
  buffer_load_dwordx4 v11, s[12:15], s49 offen offset:0 lds
  v_mfma_f32_32x32x16_bf16 v[112:127], v[136:139], a[76:79], v[112:127]
  s_waitcnt lgkmcnt(8)
  ds_read_b64_tr_b16 a[68:69], v19 offset:24576
  ds_read_b64_tr_b16 a[70:71], v19 offset:25088
  buffer_load_dwordx4 v12, s[12:15], s49 offen offset:1024 lds
  v_cvt_pk_bf16_f32 v202, v36, v37
  v_cvt_pk_bf16_f32 v203, v38, v39
  v_mfma_f32_32x32x16_bf16 v[64:79], v[140:143], a[80:83], v[64:79]
  s_waitcnt lgkmcnt(8)
  ds_read_b64_tr_b16 a[72:73], v18 offset:26624
  ds_read_b64_tr_b16 a[74:75], v18 offset:27136
  v_lshlrev_b32 v40, 16, v204
  v_and_b32 v41, s90, v204
  v_lshlrev_b32 v42, 16, v205
  v_and_b32 v43, s90, v205
  v_mfma_f32_32x32x16_bf16 v[80:95], v[140:143], a[84:87], v[80:95]
  s_waitcnt lgkmcnt(8)
  ds_read_b64_tr_b16 a[76:77], v19 offset:26624
  ds_read_b64_tr_b16 a[78:79], v19 offset:27136
  v_add_f32 v40, v40, v2
  v_add_f32 v41, v41, v2
  v_add_f32 v42, v42, v2
  v_add_f32 v43, v43, v2
  v_mfma_f32_32x32x16_bf16 v[96:111], v[140:143], a[88:91], v[96:111]
  s_waitcnt lgkmcnt(8)
  ds_read_b64_tr_b16 a[80:81], v18 offset:28672
  ds_read_b64_tr_b16 a[82:83], v18 offset:29184
  buffer_load_dwordx4 v11, s[12:15], s50 offen offset:2048 lds
  v_cvt_pk_bf16_f32 v204, v40, v41
  v_cvt_pk_bf16_f32 v205, v42, v43
  v_mfma_f32_32x32x16_bf16 v[112:127], v[140:143], a[92:95], v[112:127]
  s_waitcnt lgkmcnt(8)
  ds_read_b64_tr_b16 a[84:85], v19 offset:28672
  ds_read_b64_tr_b16 a[86:87], v19 offset:29184
  buffer_load_dwordx4 v12, s[12:15], s50 offen offset:3072 lds
  v_lshlrev_b32 v44, 16, v206
  v_and_b32 v45, s90, v206
  v_mfma_f32_32x32x16_bf16 v[64:79], v[144:147], a[64:67], v[64:79]
  s_waitcnt lgkmcnt(8)
  ds_read_b64_tr_b16 a[88:89], v18 offset:30720
  ds_read_b64_tr_b16 a[90:91], v18 offset:31232
  v_lshlrev_b32 v46, 16, v207
  s_add_u32 s49, s44, 6
  s_and_b32 s49, s49, 7
  s_mul_i32 s49, s49, 196608
  v_mfma_f32_32x32x16_bf16 v[80:95], v[144:147], a[68:71], v[80:95]
  s_waitcnt lgkmcnt(8)
  ds_read_b64_tr_b16 a[92:93], v19 offset:30720
  ds_read_b64_tr_b16 a[94:95], v19 offset:31232
  s_add_u32 s49, s49, s47
  s_add_u32 m0, s43, 65536
  s_add_u32 s50, s49, 128
  s_add_u32 s49, s49, 2048
  v_mfma_f32_32x32x16_bf16 v[96:111], v[144:147], a[72:75], v[96:111]
  s_waitcnt lgkmcnt(8)
  ds_read_b64_tr_b16 a[64:65], v18 offset:32768
  ds_read_b64_tr_b16 a[66:67], v18 offset:33280
  buffer_load_dwordx4 v11, s[12:15], s49 offen offset:0 lds
  v_and_b32 v47, s90, v207
  v_add_f32 v44, v44, v2
  v_mfma_f32_32x32x16_bf16 v[112:127], v[144:147], a[76:79], v[112:127]
  s_waitcnt lgkmcnt(8)
  ds_read_b64_tr_b16 a[68:69], v19 offset:32768
  ds_read_b64_tr_b16 a[70:71], v19 offset:33280
  buffer_load_dwordx4 v12, s[12:15], s49 offen offset:1024 lds
  v_add_f32 v45, v45, v2
  v_add_f32 v46, v46, v2
  v_mfma_f32_32x32x16_bf16 v[64:79], v[148:151], a[80:83], v[64:79]
  s_waitcnt lgkmcnt(8)
  ds_read_b64_tr_b16 a[72:73], v18 offset:34816
  ds_read_b64_tr_b16 a[74:75], v18 offset:35328
  v_add_f32 v47, v47, v2
  v_cvt_pk_bf16_f32 v206, v44, v45
  v_cvt_pk_bf16_f32 v207, v46, v47
  v_lshlrev_b32 v32, 16, v208
  v_mfma_f32_32x32x16_bf16 v[80:95], v[148:151], a[84:87], v[80:95]
  s_waitcnt lgkmcnt(8)
  ds_read_b64_tr_b16 a[76:77], v19 offset:34816
  ds_read_b64_tr_b16 a[78:79], v19 offset:35328
  v_and_b32 v33, s90, v208
  v_lshlrev_b32 v34, 16, v209
  v_and_b32 v35, s90, v209
  v_add_f32 v32, v32, v2
  v_mfma_f32_32x32x16_bf16 v[96:111], v[148:151], a[88:91], v[96:111]
  s_waitcnt lgkmcnt(8)
  ds_read_b64_tr_b16 a[80:81], v18 offset:36864
  ds_read_b64_tr_b16 a[82:83], v18 offset:37376
  buffer_load_dwordx4 v11, s[12:15], s50 offen offset:2048 lds
  v_add_f32 v33, v33, v2
  v_add_f32 v34, v34, v2
  v_mfma_f32_32x32x16_bf16 v[112:127], v[148:151], a[92:95], v[112:127]
  s_waitcnt lgkmcnt(8)
  ds_read_b64_tr_b16 a[84:85], v19 offset:36864
  ds_read_b64_tr_b16 a[86:87], v19 offset:37376
  buffer_load_dwordx4 v12, s[12:15], s50 offen offset:3072 lds
  v_add_f32 v35, v35, v2
  v_cvt_pk_bf16_f32 v208, v32, v33
  v_mfma_f32_32x32x16_bf16 v[64:79], v[152:155], a[64:67], v[64:79]
  s_waitcnt lgkmcnt(8)
  ds_read_b64_tr_b16 a[88:89], v18 offset:38912
  ds_read_b64_tr_b16 a[90:91], v18 offset:39424
  v_cvt_pk_bf16_f32 v209, v34, v35
mk_wB1:
  s_cbranch_execz mk_wJ1
  s_add_u32 s49, s44, 7
  s_and_b32 s49, s49, 7
  s_mul_i32 s49, s49, 196608
  v_mfma_f32_32x32x16_bf16 v[80:95], v[152:155], a[68:71], v[80:95]
  s_waitcnt lgkmcnt(8)
  ds_read_b64_tr_b16 a[92:93], v19 offset:38912
  ds_read_b64_tr_b16 a[94:95], v19 offset:39424
  s_add_u32 s49, s49, s47
  s_add_u32 m0, s43, 81920
  s_add_u32 s50, s49, 128
  s_add_u32 s49, s49, 2048
  v_subrev_u32 v18, 122880, v18
  v_subrev_u32 v19, 122880, v19
  v_mfma_f32_32x32x16_bf16 v[96:111], v[152:155], a[72:75], v[96:111]
  s_waitcnt vmcnt(16) lgkmcnt(8)
  s_barrier
  ds_read_b64_tr_b16 a[64:65], v18 offset:0
  ds_read_b64_tr_b16 a[66:67], v18 offset:512
  buffer_load_dwordx4 v11, s[12:15], s49 offen offset:0 lds
  v_mfma_f32_32x32x16_bf16 v[112:127], v[152:155], a[76:79], v[112:127]
  s_waitcnt lgkmcnt(8)
  ds_read_b64_tr_b16 a[68:69], v19 offset:0
  ds_read_b64_tr_b16 a[70:71], v19 offset:512
  buffer_load_dwordx4 v12, s[12:15], s49 offen offset:1024 lds
  v_lshlrev_b32 v36, 16, v210
  v_and_b32 v37, s90, v210
  v_mfma_f32_32x32x16_bf16 v[64:79], v[156:159], a[80:83], v[64:79]
  s_waitcnt lgkmcnt(8)
  ds_read_b64_tr_b16 a[72:73], v18 offset:2048
  ds_read_b64_tr_b16 a[74:75], v18 offset:2560
  v_lshlrev_b32 v38, 16, v211
  v_and_b32 v39, s90, v211
  v_add_f32 v36, v36, v2
  v_add_f32 v37, v37, v2
  v_mfma_f32_32x32x16_bf16 v[80:95], v[156:159], a[84:87], v[80:95]
  s_waitcnt lgkmcnt(8)
  ds_read_b64_tr_b16 a[76:77], v19 offset:2048
  ds_read_b64_tr_b16 a[78:79], v19 offset:2560
  v_add_f32 v38, v38, v2
  v_add_f32 v39, v39, v2
  v_cvt_pk_bf16_f32 v210, v36, v37
  v_cvt_pk_bf16_f32 v211, v38, v39
  v_mfma_f32_32x32x16_bf16 v[96:111], v[156:159], a[88:91], v[96:111]
  s_waitcnt lgkmcnt(8)
  ds_read_b64_tr_b16 a[80:81], v18 offset:4096
  ds_read_b64_tr_b16 a[82:83], v18 offset:4608
  buffer_load_dwordx4 v11, s[12:15], s50 offen offset:2048 lds
  v_lshlrev_b32 v40, 16, v212
  v_and_b32 v41, s90, v212
  v_mfma_f32_32x32x16_bf16 v[112:127], v[156:159], a[92:95], v[112:127]
  s_waitcnt lgkmcnt(8)
  ds_read_b64_tr_b16 a[84:85], v19 offset:4096
  ds_read_b64_tr_b16 a[86:87], v19 offset:4608
  buffer_load_dwordx4 v12, s[12:15], s50 offen offset:3072 lds
  v_lshrrev_b32 v11, 2, v1
  v_mul_u32_u24 v11, 3584, v11
  v_and_or_b32 v11, v7, 48, v11
  v_xor_b32 v12, 32, v11
  v_mfma_f32_32x32x16_bf16 v[64:79], v[160:163], a[64:67], v[64:79]
  s_waitcnt lgkmcnt(8)
  ds_read_b64_tr_b16 a[88:89], v18 offset:6144
  ds_read_b64_tr_b16 a[90:91], v18 offset:6656
  v_lshlrev_b32 v42, 16, v213
  s_add_u32 s49, s89, 0
  s_and_b32 s49, s49, 31
  s_mul_i32 s49, s49, 57344
  v_mfma_f32_32x32x16_bf16 v[80:95], v[160:163], a[68:71], v[80:95]
  s_waitcnt lgkmcnt(8)
  ds_read_b64_tr_b16 a[92:93], v19 offset:6144
  ds_read_b64_tr_b16 a[94:95], v19 offset:6656
  v_and_b32 v43, s90, v213
  s_add_u32 s49, s49, s46
  s_add_u32 m0, s43, 98304
  s_add_u32 s50, s49, 56320
  v_mfma_f32_32x32x16_bf16 v[96:111], v[160:163], a[72:75], v[96:111]
  s_waitcnt lgkmcnt(8)
  ds_read_b64_tr_b16 a[64:65], v18 offset:8192
  ds_read_b64_tr_b16 a[66:67], v18 offset:8704
  buffer_load_dwordx4 v11, s[16:19], s49 offen offset:0 lds
  v_add_f32 v40, v40, v2
  v_add_f32 v41, v41, v2
  v_mfma_f32_32x32x16_bf16 v[112:127], v[160:163], a[76:79], v[112:127]
  s_waitcnt lgkmcnt(8)
  ds_read_b64_tr_b16 a[68:69], v19 offset:8192
  ds_read_b64_tr_b16 a[70:71], v19 offset:8704
  buffer_load_dwordx4 v11, s[16:19], s50 offen offset:1024 lds
  v_add_f32 v42, v42, v2
  v_add_f32 v43, v43, v2
  v_mfma_f32_32x32x16_bf16 v[64:79], v[164:167], a[80:83], v[64:79]
  s_waitcnt lgkmcnt(8)
  ds_read_b64_tr_b16 a[72:73], v18 offset:10240
  ds_read_b64_tr_b16 a[74:75], v18 offset:10752
  v_cvt_pk_bf16_f32 v212, v40, v41
  v_cvt_pk_bf16_f32 v213, v42, v43
  v_lshlrev_b32 v44, 16, v214
  v_and_b32 v45, s90, v214
  v_mfma_f32_32x32x16_bf16 v[80:95], v[164:167], a[84:87], v[80:95]
  s_waitcnt lgkmcnt(8)
  ds_read_b64_tr_b16 a[76:77], v19 offset:10240
  ds_read_b64_tr_b16 a[78:79], v19 offset:10752
  v_lshlrev_b32 v46, 16, v215
  v_and_b32 v47, s90, v215
  v_add_f32 v44, v44, v2
  v_add_f32 v45, v45, v2
  v_mfma_f32_32x32x16_bf16 v[96:111], v[164:167], a[88:91], v[96:111]
  s_waitcnt lgkmcnt(8)
  ds_read_b64_tr_b16 a[80:81], v18 offset:12288
  ds_read_b64_tr_b16 a[82:83], v18 offset:12800
  buffer_load_dwordx4 v12, s[20:23], s49 offen offset:2048 lds
  v_add_f32 v46, v46, v2
  v_add_f32 v47, v47, v2
  v_mfma_f32_32x32x16_bf16 v[112:127], v[164:167], a[92:95], v[112:127]
  s_waitcnt lgkmcnt(8)
  ds_read_b64_tr_b16 a[84:85], v19 offset:12288
  ds_read_b64_tr_b16 a[86:87], v19 offset:12800
  buffer_load_dwordx4 v12, s[20:23], s50 offen offset:3072 lds
  v_cvt_pk_bf16_f32 v214, v44, v45
  v_cvt_pk_bf16_f32 v215, v46, v47
  v_mfma_f32_32x32x16_bf16 v[64:79], v[168:171], a[64:67], v[64:79]
  s_waitcnt lgkmcnt(8)
  ds_read_b64_tr_b16 a[88:89], v18 offset:14336
  ds_read_b64_tr_b16 a[90:91], v18 offset:14848
  v_lshlrev_b32 v32, 16, v216
  s_add_u32 s49, s44, 0
  s_and_b32 s49, s49, 7
  s_mul_i32 s49, s49, 229376
  v_mfma_f32_32x32x16_bf16 v[80:95], v[168:171], a[68:71], v[80:95]
  s_waitcnt lgkmcnt(8)
  ds_read_b64_tr_b16 a[92:93], v19 offset:14336
  ds_read_b64_tr_b16 a[94:95], v19 offset:14848
  v_and_b32 v33, s90, v216
  v_lshlrev_b32 v34, 16, v217
  s_add_u32 m0, s43, 131072
  s_add_u32 s49, s49, s48
  v_mfma_f32_32x32x16_bf16 v[96:111], v[168:171], a[72:75], v[96:111]
  s_waitcnt vmcnt(20) lgkmcnt(8)
  s_barrier
  ds_read_b64_tr_b16 a[64:65], v18 offset:16384
  ds_read_b64_tr_b16 a[66:67], v18 offset:16896
  buffer_load_dwordx4 v13, s[16:19], s49 offen offset:0 lds
  v_mfma_f32_32x32x16_bf16 v[112:127], v[168:171], a[76:79], v[112:127]
  s_waitcnt lgkmcnt(8)
  ds_read_b64_tr_b16 a[68:69], v19 offset:16384
  ds_read_b64_tr_b16 a[70:71], v19 offset:16896
  buffer_load_dwordx4 v14, s[16:19], s49 offen offset:1024 lds
  v_and_b32 v35, s90, v217
  v_add_f32 v32, v32, v2
  v_mfma_f32_32x32x16_bf16 v[64:79], v[172:175], a[80:83], v[64:79]
  s_waitcnt lgkmcnt(8)
  ds_read_b64_tr_b16 a[72:73], v18 offset:18432
  ds_read_b64_tr_b16 a[74:75], v18 offset:18944
  v_add_f32 v33, v33, v2
  v_add_f32 v34, v34, v2
  v_add_f32 v35, v35, v2
  v_cvt_pk_bf16_f32 v216, v32, v33
  v_mfma_f32_32x32x16_bf16 v[80:95], v[172:175], a[84:87], v[80:95]
  s_waitcnt lgkmcnt(8)
  ds_read_b64_tr_b16 a[76:77], v19 offset:18432
  ds_read_b64_tr_b16 a[78:79], v19 offset:18944
  v_cvt_pk_bf16_f32 v217, v34, v35
  v_lshlrev_b32 v36, 16, v218
  v_and_b32 v37, s90, v218
  v_lshlrev_b32 v38, 16, v219
  v_mfma_f32_32x32x16_bf16 v[96:111], v[172:175], a[88:91], v[96:111]
  s_waitcnt lgkmcnt(8)
  ds_read_b64_tr_b16 a[80:81], v18 offset:20480
  ds_read_b64_tr_b16 a[82:83], v18 offset:20992
  buffer_load_dwordx4 v15, s[20:23], s49 offen offset:2048 lds
  v_and_b32 v39, s90, v219
  v_add_f32 v36, v36, v2
  v_mfma_f32_32x32x16_bf16 v[112:127], v[172:175], a[92:95], v[112:127]
  s_waitcnt lgkmcnt(8)
  ds_read_b64_tr_b16 a[84:85], v19 offset:20480
  ds_read_b64_tr_b16 a[86:87], v19 offset:20992
  buffer_load_dwordx4 v16, s[20:23], s49 offen offset:3072 lds
  v_add_f32 v37, v37, v2
  v_add_f32 v38, v38, v2
  v_mfma_f32_32x32x16_bf16 v[64:79], v[176:179], a[64:67], v[64:79]
  s_waitcnt lgkmcnt(8)
  ds_read_b64_tr_b16 a[88:89], v18 offset:22528
  ds_read_b64_tr_b16 a[90:91], v18 offset:23040
  v_add_f32 v39, v39, v2
  v_cvt_pk_bf16_f32 v218, v36, v37
  v_cvt_pk_bf16_f32 v219, v38, v39
  v_lshlrev_b32 v40, 16, v220
  v_mfma_f32_32x32x16_bf16 v[80:95], v[176:179], a[68:71], v[80:95]
  s_waitcnt lgkmcnt(8)
  ds_read_b64_tr_b16 a[92:93], v19 offset:22528
  ds_read_b64_tr_b16 a[94:95], v19 offset:23040
  v_and_b32 v41, s90, v220
  v_lshlrev_b32 v42, 16, v221
  v_and_b32 v43, s90, v221
  v_add_f32 v40, v40, v2
  v_mfma_f32_32x32x16_bf16 v[96:111], v[176:179], a[72:75], v[96:111]
  s_waitcnt lgkmcnt(8)
  ds_read_b64_tr_b16 a[64:65], v18 offset:24576
  ds_read_b64_tr_b16 a[66:67], v18 offset:25088
  v_add_f32 v41, v41, v2
  v_add_f32 v42, v42, v2
  v_add_f32 v43, v43, v2
  v_cvt_pk_bf16_f32 v220, v40, v41
  v_mfma_f32_32x32x16_bf16 v[112:127], v[176:179], a[76:79], v[112:127]
  s_waitcnt lgkmcnt(8)
  ds_read_b64_tr_b16 a[68:69], v19 offset:24576
  ds_read_b64_tr_b16 a[70:71], v19 offset:25088
  v_cvt_pk_bf16_f32 v221, v42, v43
  v_lshlrev_b32 v44, 16, v222
  v_and_b32 v45, s90, v222
  v_lshlrev_b32 v46, 16, v223
  v_mfma_f32_32x32x16_bf16 v[64:79], v[180:183], a[80:83], v[64:79]
  s_waitcnt lgkmcnt(8)
  ds_read_b64_tr_b16 a[72:73], v18 offset:26624
  ds_read_b64_tr_b16 a[74:75], v18 offset:27136
  v_and_b32 v47, s90, v223
  v_add_f32 v44, v44, v2
  v_add_f32 v45, v45, v2
  v_add_f32 v46, v46, v2
  v_mfma_f32_32x32x16_bf16 v[80:95], v[180:183], a[84:87], v[80:95]
  s_waitcnt lgkmcnt(8)
  ds_read_b64_tr_b16 a[76:77], v19 offset:26624
  ds_read_b64_tr_b16 a[78:79], v19 offset:27136
  v_add_f32 v47, v47, v2
  v_cvt_pk_bf16_f32 v222, v44, v45
  v_cvt_pk_bf16_f32 v223, v46, v47
  v_lshlrev_b32 v32, 16, v224
  v_mfma_f32_32x32x16_bf16 v[96:111], v[180:183], a[88:91], v[96:111]
  s_waitcnt lgkmcnt(8)
  ds_read_b64_tr_b16 a[80:81], v18 offset:28672
  ds_read_b64_tr_b16 a[82:83], v18 offset:29184
  v_and_b32 v33, s90, v224
  v_lshlrev_b32 v34, 16, v225
  v_and_b32 v35, s90, v225
  v_add_f32 v32, v32, v2
  v_mfma_f32_32x32x16_bf16 v[112:127], v[180:183], a[92:95], v[112:127]
  s_waitcnt lgkmcnt(8)
  ds_read_b64_tr_b16 a[84:85], v19 offset:28672
  ds_read_b64_tr_b16 a[86:87], v19 offset:29184
  v_add_f32 v33, v33, v2
  v_add_f32 v34, v34, v2
  v_add_f32 v35, v35, v2
  v_cvt_pk_bf16_f32 v224, v32, v33
  v_mfma_f32_32x32x16_bf16 v[64:79], v[184:187], a[64:67], v[64:79]
  s_waitcnt lgkmcnt(8)
  ds_read_b64_tr_b16 a[88:89], v18 offset:30720
  ds_read_b64_tr_b16 a[90:91], v18 offset:31232
  v_cvt_pk_bf16_f32 v225, v34, v35
  v_lshlrev_b32 v36, 16, v226
  v_and_b32 v37, s90, v226
  v_lshlrev_b32 v38, 16, v227
  v_mfma_f32_32x32x16_bf16 v[80:95], v[184:187], a[68:71], v[80:95]
  s_waitcnt lgkmcnt(8)
  ds_read_b64_tr_b16 a[92:93], v19 offset:30720
  ds_read_b64_tr_b16 a[94:95], v19 offset:31232
  v_and_b32 v39, s90, v227
  v_add_f32 v36, v36, v2
  v_add_f32 v37, v37, v2
  v_add_f32 v38, v38, v2
  v_mfma_f32_32x32x16_bf16 v[96:111], v[184:187], a[72:75], v[96:111]
  s_waitcnt vmcnt(16) lgkmcnt(8)
  s_barrier
  ds_read_b64_tr_b16 a[64:65], v18 offset:32768
  ds_read_b64_tr_b16 a[66:67], v18 offset:33280
  v_add_f32 v39, v39, v2
  v_cvt_pk_bf16_f32 v226, v36, v37
  v_mfma_f32_32x32x16_bf16 v[112:127], v[184:187], a[76:79], v[112:127]
  s_waitcnt lgkmcnt(8)
  ds_read_b64_tr_b16 a[68:69], v19 offset:32768
  ds_read_b64_tr_b16 a[70:71], v19 offset:33280
  v_cvt_pk_bf16_f32 v227, v38, v39
  v_lshlrev_b32 v40, 16, v228
  v_and_b32 v41, s90, v228
  v_lshlrev_b32 v42, 16, v229
  v_mfma_f32_32x32x16_bf16 v[64:79], v[188:191], a[80:83], v[64:79]
  s_waitcnt lgkmcnt(8)
  ds_read_b64_tr_b16 a[72:73], v18 offset:34816
  ds_read_b64_tr_b16 a[74:75], v18 offset:35328
  v_and_b32 v43, s90, v229
  v_add_f32 v40, v40, v2
  v_add_f32 v41, v41, v2
  v_add_f32 v42, v42, v2
  v_mfma_f32_32x32x16_bf16 v[80:95], v[188:191], a[84:87], v[80:95]
  s_waitcnt lgkmcnt(8)
  ds_read_b64_tr_b16 a[76:77], v19 offset:34816
  ds_read_b64_tr_b16 a[78:79], v19 offset:35328
  v_add_f32 v43, v43, v2
  v_cvt_pk_bf16_f32 v228, v40, v41
  v_cvt_pk_bf16_f32 v229, v42, v43
  v_lshlrev_b32 v44, 16, v230
  v_mfma_f32_32x32x16_bf16 v[96:111], v[188:191], a[88:91], v[96:111]
  s_waitcnt lgkmcnt(8)
  ds_read_b64_tr_b16 a[80:81], v18 offset:36864
  ds_read_b64_tr_b16 a[82:83], v18 offset:37376
  v_and_b32 v45, s90, v230
  v_lshlrev_b32 v46, 16, v231
  v_and_b32 v47, s90, v231
  v_add_f32 v44, v44, v2
  v_mfma_f32_32x32x16_bf16 v[112:127], v[188:191], a[92:95], v[112:127]
  s_waitcnt lgkmcnt(8)
  ds_read_b64_tr_b16 a[84:85], v19 offset:36864
  ds_read_b64_tr_b16 a[86:87], v19 offset:37376
  v_add_f32 v45, v45, v2
  v_add_f32 v46, v46, v2
  v_add_f32 v47, v47, v2
  v_cvt_pk_bf16_f32 v230, v44, v45
  v_mfma_f32_32x32x16_bf16 v[64:79], v[192:195], a[64:67], v[64:79]
  s_waitcnt lgkmcnt(8)
  ds_read_b64_tr_b16 a[88:89], v18 offset:38912
  ds_read_b64_tr_b16 a[90:91], v18 offset:39424
  v_cvt_pk_bf16_f32 v231, v46, v47
  v_lshlrev_b32 v32, 16, v232
  v_and_b32 v33, s90, v232
  v_lshlrev_b32 v34, 16, v233
  v_mfma_f32_32x32x16_bf16 v[80:95], v[192:195], a[68:71], v[80:95]
  s_waitcnt lgkmcnt(8)
  ds_read_b64_tr_b16 a[92:93], v19 offset:38912
  ds_read_b64_tr_b16 a[94:95], v19 offset:39424
  v_and_b32 v35, s90, v233
  v_add_f32 v32, v32, v2
  v_add_f32 v33, v33, v2
  v_add_f32 v34, v34, v2
  v_mfma_f32_32x32x16_bf16 v[96:111], v[192:195], a[72:75], v[96:111]
  s_waitcnt lgkmcnt(8)
  ds_read_b64_tr_b16 a[64:65], v18 offset:40960
  ds_read_b64_tr_b16 a[66:67], v18 offset:41472
  v_add_f32 v35, v35, v2
  v_cvt_pk_bf16_f32 v232, v32, v33
  v_cvt_pk_bf16_f32 v233, v34, v35
  v_lshlrev_b32 v36, 16, v234
  v_mfma_f32_32x32x16_bf16 v[112:127], v[192:195], a[76:79], v[112:127]
  s_waitcnt lgkmcnt(8)
  ds_read_b64_tr_b16 a[68:69], v19 offset:40960
  ds_read_b64_tr_b16 a[70:71], v19 offset:41472
  v_and_b32 v37, s90, v234
  v_lshlrev_b32 v38, 16, v235
  v_and_b32 v39, s90, v235
  v_add_f32 v36, v36, v2
  v_mfma_f32_32x32x16_bf16 v[64:79], v[196:199], a[80:83], v[64:79]
  s_waitcnt lgkmcnt(8)
  ds_read_b64_tr_b16 a[72:73], v18 offset:43008
  ds_read_b64_tr_b16 a[74:75], v18 offset:43520
  v_add_f32 v37, v37, v2
  v_add_f32 v38, v38, v2
  v_add_f32 v39, v39, v2
  v_cvt_pk_bf16_f32 v234, v36, v37
  v_mfma_f32_32x32x16_bf16 v[80:95], v[196:199], a[84:87], v[80:95]
  s_waitcnt lgkmcnt(8)
  ds_read_b64_tr_b16 a[76:77], v19 offset:43008
  ds_read_b64_tr_b16 a[78:79], v19 offset:43520
  v_cvt_pk_bf16_f32 v235, v38, v39
  v_lshlrev_b32 v40, 16, v236
  v_and_b32 v41, s90, v236
  v_lshlrev_b32 v42, 16, v237
  v_mfma_f32_32x32x16_bf16 v[96:111], v[196:199], a[88:91], v[96:111]
  s_waitcnt lgkmcnt(8)
  ds_read_b64_tr_b16 a[80:81], v18 offset:45056
  ds_read_b64_tr_b16 a[82:83], v18 offset:45568
  v_and_b32 v43, s90, v237
  v_add_f32 v40, v40, v2
  v_add_f32 v41, v41, v2
  v_add_f32 v42, v42, v2
  v_mfma_f32_32x32x16_bf16 v[112:127], v[196:199], a[92:95], v[112:127]
  s_waitcnt lgkmcnt(8)
  ds_read_b64_tr_b16 a[84:85], v19 offset:45056
  ds_read_b64_tr_b16 a[86:87], v19 offset:45568
  v_add_f32 v43, v43, v2
  v_cvt_pk_bf16_f32 v236, v40, v41
  v_cvt_pk_bf16_f32 v237, v42, v43
  v_lshlrev_b32 v44, 16, v238
  v_mfma_f32_32x32x16_bf16 v[64:79], v[200:203], a[64:67], v[64:79]
  s_waitcnt lgkmcnt(8)
  ds_read_b64_tr_b16 a[88:89], v18 offset:47104
  ds_read_b64_tr_b16 a[90:91], v18 offset:47616
  v_and_b32 v45, s90, v238
  v_lshlrev_b32 v46, 16, v239
  v_and_b32 v47, s90, v239
  v_mov_b32 v30, 0
  v_mfma_f32_32x32x16_bf16 v[80:95], v[200:203], a[68:71], v[80:95]
  s_waitcnt lgkmcnt(8)
  ds_read_b64_tr_b16 a[92:93], v19 offset:47104
  ds_read_b64_tr_b16 a[94:95], v19 offset:47616
  global_load_dword v31, v30, s[36:37] sc1
  v_add_f32 v44, v44, v2
  v_add_f32 v45, v45, v2
  v_add_f32 v46, v46, v2
  v_mfma_f32_32x32x16_bf16 v[96:111], v[200:203], a[72:75], v[96:111]
  s_waitcnt lgkmcnt(8)
  ds_read_b64_tr_b16 a[64:65], v18 offset:49152
  ds_read_b64_tr_b16 a[66:67], v18 offset:49664
  v_add_f32 v47, v47, v2
  v_cvt_pk_bf16_f32 v238, v44, v45
  v_cvt_pk_bf16_f32 v239, v46, v47
  v_lshlrev_b32 v32, 16, v240
  v_mfma_f32_32x32x16_bf16 v[112:127], v[200:203], a[76:79], v[112:127]
  s_waitcnt lgkmcnt(8)
  ds_read_b64_tr_b16 a[68:69], v19 offset:49152
  ds_read_b64_tr_b16 a[70:71], v19 offset:49664
  v_and_b32 v33, s90, v240
  v_lshlrev_b32 v34, 16, v241
  v_and_b32 v35, s90, v241
  v_add_f32 v32, v32, v2
  v_mfma_f32_32x32x16_bf16 v[64:79], v[204:207], a[80:83], v[64:79]
  s_waitcnt lgkmcnt(8)
  ds_read_b64_tr_b16 a[72:73], v18 offset:51200
  ds_read_b64_tr_b16 a[74:75], v18 offset:51712
  v_add_f32 v33, v33, v2
  s_add_u32 s49, s89, 8
  s_and_b32 s49, s49, 31
  s_mul_i32 s49, s49, 57344
  v_mfma_f32_32x32x16_bf16 v[80:95], v[204:207], a[84:87], v[80:95]
  s_waitcnt lgkmcnt(8)
  ds_read_b64_tr_b16 a[76:77], v19 offset:51200
  ds_read_b64_tr_b16 a[78:79], v19 offset:51712
  v_add_f32 v34, v34, v2
  s_add_u32 s49, s49, s46
  s_add_u32 m0, s43, 114688
  s_add_u32 s50, s49, 56320
  v_mfma_f32_32x32x16_bf16 v[96:111], v[204:207], a[88:91], v[96:111]
  s_waitcnt lgkmcnt(8)
  ds_read_b64_tr_b16 a[80:81], v18 offset:53248
  ds_read_b64_tr_b16 a[82:83], v18 offset:53760
  buffer_load_dwordx4 v11, s[16:19], s49 offen offset:0 lds
  v_add_f32 v35, v35, v2
  v_cvt_pk_bf16_f32 v240, v32, v33
  v_mfma_f32_32x32x16_bf16 v[112:127], v[204:207], a[92:95], v[112:127]
  s_waitcnt lgkmcnt(8)
  ds_read_b64_tr_b16 a[84:85], v19 offset:53248
  ds_read_b64_tr_b16 a[86:87], v19 offset:53760
  v_cvt_pk_bf16_f32 v241, v34, v35
  v_lshlrev_b32 v36, 16, v242
  v_and_b32 v37, s90, v242
  v_lshlrev_b32 v38, 16, v243
  v_mfma_f32_32x32x16_bf16 v[64:79], v[208:211], a[64:67], v[64:79]
  s_waitcnt lgkmcnt(8)
  ds_read_b64_tr_b16 a[88:89], v18 offset:55296
  ds_read_b64_tr_b16 a[90:91], v18 offset:55808
  v_and_b32 v39, s90, v243
  v_add_f32 v36, v36, v2
  v_add_f32 v37, v37, v2
  v_add_f32 v38, v38, v2
  v_mfma_f32_32x32x16_bf16 v[80:95], v[208:211], a[68:71], v[80:95]
  s_waitcnt lgkmcnt(8)
  ds_read_b64_tr_b16 a[92:93], v19 offset:55296
  ds_read_b64_tr_b16 a[94:95], v19 offset:55808
  v_add_f32 v39, v39, v2
  v_cvt_pk_bf16_f32 v242, v36, v37
  v_cvt_pk_bf16_f32 v243, v38, v39
  v_lshlrev_b32 v40, 16, v244
  v_mfma_f32_32x32x16_bf16 v[96:111], v[208:211], a[72:75], v[96:111]
  s_waitcnt lgkmcnt(8)
  ds_read_b64_tr_b16 a[64:65], v18 offset:57344
  ds_read_b64_tr_b16 a[66:67], v18 offset:57856
  buffer_load_dwordx4 v11, s[16:19], s50 offen offset:1024 lds
  v_and_b32 v41, s90, v244
  v_lshlrev_b32 v42, 16, v245
  v_mfma_f32_32x32x16_bf16 v[112:127], v[208:211], a[76:79], v[112:127]
  s_waitcnt lgkmcnt(8)
  ds_read_b64_tr_b16 a[68:69], v19 offset:57344
  ds_read_b64_tr_b16 a[70:71], v19 offset:57856
  v_and_b32 v43, s90, v245
  v_add_f32 v40, v40, v2
  v_add_f32 v41, v41, v2
  v_add_f32 v42, v42, v2
  v_mfma_f32_32x32x16_bf16 v[64:79], v[212:215], a[80:83], v[64:79]
  s_waitcnt lgkmcnt(8)
  ds_read_b64_tr_b16 a[72:73], v18 offset:59392
  ds_read_b64_tr_b16 a[74:75], v18 offset:59904
  v_add_f32 v43, v43, v2
  v_cvt_pk_bf16_f32 v244, v40, v41
  v_cvt_pk_bf16_f32 v245, v42, v43
  v_lshlrev_b32 v44, 16, v246
  v_mfma_f32_32x32x16_bf16 v[80:95], v[212:215], a[84:87], v[80:95]
  s_waitcnt lgkmcnt(8)
  ds_read_b64_tr_b16 a[76:77], v19 offset:59392
  ds_read_b64_tr_b16 a[78:79], v19 offset:59904
  v_and_b32 v45, s90, v246
  v_lshlrev_b32 v46, 16, v247
  v_add_u32 v18, 61440, v18
  v_add_u32 v19, 61440, v19
  v_mfma_f32_32x32x16_bf16 v[96:111], v[212:215], a[88:91], v[96:111]
  s_waitcnt lgkmcnt(8)
  ds_read_b64_tr_b16 a[80:81], v18 offset:0
  ds_read_b64_tr_b16 a[82:83], v18 offset:512
  buffer_load_dwordx4 v12, s[20:23], s49 offen offset:2048 lds
  v_and_b32 v47, s90, v247
  v_add_f32 v44, v44, v2
  v_mfma_f32_32x32x16_bf16 v[112:127], v[212:215], a[92:95], v[112:127]
  s_waitcnt lgkmcnt(8)
  ds_read_b64_tr_b16 a[84:85], v19 offset:0
  ds_read_b64_tr_b16 a[86:87], v19 offset:512
  v_add_f32 v45, v45, v2
  v_add_f32 v46, v46, v2
  v_add_f32 v47, v47, v2
  v_cvt_pk_bf16_f32 v246, v44, v45
  v_mfma_f32_32x32x16_bf16 v[64:79], v[216:219], a[64:67], v[64:79]
  s_waitcnt lgkmcnt(8)
  ds_read_b64_tr_b16 a[88:89], v18 offset:2048
  ds_read_b64_tr_b16 a[90:91], v18 offset:2560
  v_cvt_pk_bf16_f32 v247, v46, v47
  v_lshlrev_b32 v32, 16, v248
  v_and_b32 v33, s90, v248
  v_lshlrev_b32 v34, 16, v249
  v_mfma_f32_32x32x16_bf16 v[80:95], v[216:219], a[68:71], v[80:95]
  s_waitcnt lgkmcnt(8)
  ds_read_b64_tr_b16 a[92:93], v19 offset:2048
  ds_read_b64_tr_b16 a[94:95], v19 offset:2560
  v_and_b32 v35, s90, v249
  v_add_f32 v32, v32, v2
  v_add_f32 v33, v33, v2
  v_add_f32 v34, v34, v2
  v_mfma_f32_32x32x16_bf16 v[96:111], v[216:219], a[72:75], v[96:111]
  s_waitcnt vmcnt(12) lgkmcnt(8)
  s_barrier
  ds_read_b64_tr_b16 a[64:65], v18 offset:4096
  ds_read_b64_tr_b16 a[66:67], v18 offset:4608
  buffer_load_dwordx4 v12, s[20:23], s50 offen offset:3072 lds
  v_mfma_f32_32x32x16_bf16 v[112:127], v[216:219], a[76:79], v[112:127]
  s_waitcnt lgkmcnt(8)
  ds_read_b64_tr_b16 a[68:69], v19 offset:4096
  ds_read_b64_tr_b16 a[70:71], v19 offset:4608
  v_add_f32 v35, v35, v2
  v_cvt_pk_bf16_f32 v248, v32, v33
  v_cvt_pk_bf16_f32 v249, v34, v35
  v_lshlrev_b32 v36, 16, v250
  v_mfma_f32_32x32x16_bf16 v[64:79], v[220:223], a[80:83], v[64:79]
  s_waitcnt lgkmcnt(8)
  ds_read_b64_tr_b16 a[72:73], v18 offset:6144
  ds_read_b64_tr_b16 a[74:75], v18 offset:6656
  v_and_b32 v37, s90, v250
  s_add_u32 s49, s89, 16
  s_and_b32 s49, s49, 31
  s_mul_i32 s49, s49, 57344
  v_mfma_f32_32x32x16_bf16 v[80:95], v[220:223], a[84:87], v[80:95]
  s_waitcnt lgkmcnt(8)
  ds_read_b64_tr_b16 a[76:77], v19 offset:6144
  ds_read_b64_tr_b16 a[78:79], v19 offset:6656
  v_lshlrev_b32 v38, 16, v251
  s_add_u32 s49, s49, s46
  s_add_u32 m0, s43, 0
  s_add_u32 s50, s49, 56320
  v_mfma_f32_32x32x16_bf16 v[96:111], v[220:223], a[88:91], v[96:111]
  s_waitcnt lgkmcnt(8)
  ds_read_b64_tr_b16 a[80:81], v18 offset:8192
  ds_read_b64_tr_b16 a[82:83], v18 offset:8704
  buffer_load_dwordx4 v11, s[16:19], s49 offen offset:0 lds
  v_and_b32 v39, s90, v251
  v_add_f32 v36, v36, v2
  v_mfma_f32_32x32x16_bf16 v[112:127], v[220:223], a[92:95], v[112:127]
  s_waitcnt lgkmcnt(8)
  ds_read_b64_tr_b16 a[84:85], v19 offset:8192
  ds_read_b64_tr_b16 a[86:87], v19 offset:8704
  v_add_f32 v37, v37, v2
  v_add_f32 v38, v38, v2
  v_add_f32 v39, v39, v2
  v_cvt_pk_bf16_f32 v250, v36, v37
  v_mfma_f32_32x32x16_bf16 v[64:79], v[224:227], a[64:67], v[64:79]
  s_waitcnt lgkmcnt(8)
  ds_read_b64_tr_b16 a[88:89], v18 offset:10240
  ds_read_b64_tr_b16 a[90:91], v18 offset:10752
  v_cvt_pk_bf16_f32 v251, v38, v39
  v_lshlrev_b32 v40, 16, v252
  v_and_b32 v41, s90, v252
  v_lshlrev_b32 v42, 16, v253
  v_mfma_f32_32x32x16_bf16 v[80:95], v[224:227], a[68:71], v[80:95]
  s_waitcnt lgkmcnt(8)
  ds_read_b64_tr_b16 a[92:93], v19 offset:10240
  ds_read_b64_tr_b16 a[94:95], v19 offset:10752
  v_and_b32 v43, s90, v253
  v_add_f32 v40, v40, v2
  v_add_f32 v41, v41, v2
  v_add_f32 v42, v42, v2
  v_mfma_f32_32x32x16_bf16 v[96:111], v[224:227], a[72:75], v[96:111]
  s_waitcnt lgkmcnt(8)
  ds_read_b64_tr_b16 a[64:65], v18 offset:12288
  ds_read_b64_tr_b16 a[66:67], v18 offset:12800
  buffer_load_dwordx4 v11, s[16:19], s50 offen offset:1024 lds
  v_add_f32 v43, v43, v2
  v_cvt_pk_bf16_f32 v252, v40, v41
  v_mfma_f32_32x32x16_bf16 v[112:127], v[224:227], a[76:79], v[112:127]
  s_waitcnt lgkmcnt(8)
  ds_read_b64_tr_b16 a[68:69], v19 offset:12288
  ds_read_b64_tr_b16 a[70:71], v19 offset:12800
  v_cvt_pk_bf16_f32 v253, v42, v43
  v_lshlrev_b32 v44, 16, v254
  v_and_b32 v45, s90, v254
  v_lshlrev_b32 v46, 16, v255
  v_mfma_f32_32x32x16_bf16 v[64:79], v[228:231], a[80:83], v[64:79]
  s_waitcnt lgkmcnt(8)
  ds_read_b64_tr_b16 a[72:73], v18 offset:14336
  ds_read_b64_tr_b16 a[74:75], v18 offset:14848
  v_and_b32 v47, s90, v255
  v_add_f32 v44, v44, v2
  v_add_f32 v45, v45, v2
  v_add_f32 v46, v46, v2
  v_mfma_f32_32x32x16_bf16 v[80:95], v[228:231], a[84:87], v[80:95]
  s_waitcnt lgkmcnt(8)
  ds_read_b64_tr_b16 a[76:77], v19 offset:14336
  ds_read_b64_tr_b16 a[78:79], v19 offset:14848
  v_add_f32 v47, v47, v2
  v_cvt_pk_bf16_f32 v254, v44, v45
  v_cvt_pk_bf16_f32 v255, v46, v47
  v_lshrrev_b32 v23, 5, v1
  v_mfma_f32_32x32x16_bf16 v[96:111], v[228:231], a[88:91], v[96:111]
  s_waitcnt lgkmcnt(8)
  ds_read_b64_tr_b16 a[80:81], v18 offset:16384
  ds_read_b64_tr_b16 a[82:83], v18 offset:16896
  buffer_load_dwordx4 v12, s[20:23], s49 offen offset:2048 lds
  v_lshlrev_b32 v23, 4, v23
  v_mfma_f32_32x32x16_bf16 v[112:127], v[228:231], a[92:95], v[112:127]
  s_waitcnt lgkmcnt(8)
  ds_read_b64_tr_b16 a[84:85], v19 offset:16384
  ds_read_b64_tr_b16 a[86:87], v19 offset:16896
  ds_bpermute_b32 v48, v23, v5 offset:0
  v_mfma_f32_32x32x16_bf16 v[64:79], v[232:235], a[64:67], v[64:79]
  s_waitcnt lgkmcnt(9)
  ds_read_b64_tr_b16 a[88:89], v18 offset:18432
  ds_read_b64_tr_b16 a[90:91], v18 offset:18944
  ds_bpermute_b32 v49, v23, v5 offset:4
  v_mfma_f32_32x32x16_bf16 v[80:95], v[232:235], a[68:71], v[80:95]
  s_waitcnt lgkmcnt(10)
  ds_read_b64_tr_b16 a[92:93], v19 offset:18432
  ds_read_b64_tr_b16 a[94:95], v19 offset:18944
  ds_bpermute_b32 v50, v23, v5 offset:8
  v_mfma_f32_32x32x16_bf16 v[96:111], v[232:235], a[72:75], v[96:111]
  s_waitcnt lgkmcnt(11)
  ds_read_b64_tr_b16 a[64:65], v18 offset:20480
  ds_read_b64_tr_b16 a[66:67], v18 offset:20992
  buffer_load_dwordx4 v12, s[20:23], s50 offen offset:3072 lds
  v_mfma_f32_32x32x16_bf16 v[112:127], v[232:235], a[76:79], v[112:127]
  s_waitcnt lgkmcnt(11)
  ds_read_b64_tr_b16 a[68:69], v19 offset:20480
  ds_read_b64_tr_b16 a[70:71], v19 offset:20992
  ds_bpermute_b32 v51, v23, v5 offset:12
  v_mfma_f32_32x32x16_bf16 v[64:79], v[236:239], a[80:83], v[64:79]
  s_waitcnt lgkmcnt(12)
  ds_read_b64_tr_b16 a[72:73], v18 offset:22528
  ds_read_b64_tr_b16 a[74:75], v18 offset:23040
  s_add_u32 s49, s89, 24
  s_and_b32 s49, s49, 31
  s_mul_i32 s49, s49, 57344
  v_mfma_f32_32x32x16_bf16 v[80:95], v[236:239], a[84:87], v[80:95]
  s_waitcnt lgkmcnt(11)
  ds_read_b64_tr_b16 a[76:77], v19 offset:22528
  ds_read_b64_tr_b16 a[78:79], v19 offset:23040
  s_add_u32 s49, s49, s46
  s_add_u32 m0, s43, 16384
  s_add_u32 s50, s49, 56320
  v_mfma_f32_32x32x16_bf16 v[96:111], v[236:239], a[88:91], v[96:111]
  s_waitcnt lgkmcnt(10)
  ds_read_b64_tr_b16 a[80:81], v18 offset:24576
  ds_read_b64_tr_b16 a[82:83], v18 offset:25088
  buffer_load_dwordx4 v11, s[16:19], s49 offen offset:0 lds
  v_mfma_f32_32x32x16_bf16 v[112:127], v[236:239], a[92:95], v[112:127]
  s_waitcnt lgkmcnt(9)
  ds_read_b64_tr_b16 a[84:85], v19 offset:24576
  ds_read_b64_tr_b16 a[86:87], v19 offset:25088
  ds_bpermute_b32 v52, v23, v5 offset:32
  v_mfma_f32_32x32x16_bf16 v[64:79], v[240:243], a[64:67], v[64:79]
  s_waitcnt lgkmcnt(10)
  ds_read_b64_tr_b16 a[88:89], v18 offset:26624
  ds_read_b64_tr_b16 a[90:91], v18 offset:27136
  ds_bpermute_b32 v53, v23, v5 offset:36
mk_wB2:
  s_cbranch_execz mk_wJ2
  v_mfma_f32_32x32x16_bf16 v[80:95], v[240:243], a[68:71], v[80:95]
  s_waitcnt lgkmcnt(10)
  ds_read_b64_tr_b16 a[92:93], v19 offset:26624
  ds_read_b64_tr_b16 a[94:95], v19 offset:27136
  ds_bpermute_b32 v54, v23, v5 offset:40
  v_mfma_f32_32x32x16_bf16 v[96:111], v[240:243], a[72:75], v[96:111]
  s_waitcnt lgkmcnt(11)
  ds_read_b64_tr_b16 a[64:65], v18 offset:28672
  ds_read_b64_tr_b16 a[66:67], v18 offset:29184
  buffer_load_dwordx4 v11, s[16:19], s50 offen offset:1024 lds
  v_mfma_f32_32x32x16_bf16 v[112:127], v[240:243], a[76:79], v[112:127]
  s_waitcnt lgkmcnt(11)
  ds_read_b64_tr_b16 a[68:69], v19 offset:28672
  ds_read_b64_tr_b16 a[70:71], v19 offset:29184
  ds_bpermute_b32 v55, v23, v5 offset:44
  v_mfma_f32_32x32x16_bf16 v[64:79], v[244:247], a[80:83], v[64:79]
  s_waitcnt lgkmcnt(12)
  ds_read_b64_tr_b16 a[72:73], v18 offset:30720
  ds_read_b64_tr_b16 a[74:75], v18 offset:31232
  ds_bpermute_b32 v56, v23, v5 offset:64
  v_mfma_f32_32x32x16_bf16 v[80:95], v[244:247], a[84:87], v[80:95]
  s_waitcnt lgkmcnt(12)
  ds_read_b64_tr_b16 a[76:77], v19 offset:30720
  ds_read_b64_tr_b16 a[78:79], v19 offset:31232
  ds_bpermute_b32 v57, v23, v5 offset:68
  v_mfma_f32_32x32x16_bf16 v[96:111], v[244:247], a[88:91], v[96:111]
  s_waitcnt lgkmcnt(12)
  ds_read_b64_tr_b16 a[80:81], v18 offset:32768
  ds_read_b64_tr_b16 a[82:83], v18 offset:33280
  buffer_load_dwordx4 v12, s[20:23], s49 offen offset:2048 lds
  v_mfma_f32_32x32x16_bf16 v[112:127], v[244:247], a[92:95], v[112:127]
  s_waitcnt lgkmcnt(11)
  ds_read_b64_tr_b16 a[84:85], v19 offset:32768
  ds_read_b64_tr_b16 a[86:87], v19 offset:33280
  ds_bpermute_b32 v58, v23, v5 offset:72
  v_mfma_f32_32x32x16_bf16 v[64:79], v[248:251], a[64:67], v[64:79]
  s_waitcnt lgkmcnt(12)
  ds_read_b64_tr_b16 a[88:89], v18 offset:34816
  ds_read_b64_tr_b16 a[90:91], v18 offset:35328
  ds_bpermute_b32 v59, v23, v5 offset:76
  v_mfma_f32_32x32x16_bf16 v[80:95], v[248:251], a[68:71], v[80:95]
  s_waitcnt lgkmcnt(12)
  ds_read_b64_tr_b16 a[92:93], v19 offset:34816
  ds_read_b64_tr_b16 a[94:95], v19 offset:35328
  v_accvgpr_read_b32 v18, a248
  v_add_u32 v18, 61440, v18
  v_xor_b32 v19, 32, v18
  v_mfma_f32_32x32x16_bf16 v[96:111], v[248:251], a[72:75], v[96:111]
  s_waitcnt vmcnt(7) lgkmcnt(11)
  s_barrier
  ds_read_b64_tr_b16 a[64:65], v18 offset:36864
  ds_read_b64_tr_b16 a[66:67], v18 offset:37120
  buffer_load_dwordx4 v12, s[20:23], s50 offen offset:3072 lds
  v_mfma_f32_32x32x16_bf16 v[112:127], v[248:251], a[76:79], v[112:127]
  s_waitcnt lgkmcnt(10)
  ds_read_b64_tr_b16 a[68:69], v19 offset:36864
  ds_read_b64_tr_b16 a[70:71], v19 offset:37120
  ds_bpermute_b32 v60, v23, v5 offset:96
  v_mfma_f32_32x32x16_bf16 v[64:79], v[252:255], a[80:83], v[64:79]
  s_waitcnt lgkmcnt(11)
  ds_read_b64_tr_b16 a[72:73], v18 offset:37888
  ds_read_b64_tr_b16 a[74:75], v18 offset:38144
  s_add_u32 s49, s44, 1
  s_and_b32 s49, s49, 7
  s_mul_i32 s49, s49, 229376
  v_mfma_f32_32x32x16_bf16 v[80:95], v[252:255], a[84:87], v[80:95]
  s_waitcnt lgkmcnt(10)
  ds_read_b64_tr_b16 a[76:77], v19 offset:37888
  ds_read_b64_tr_b16 a[78:79], v19 offset:38144
  s_add_u32 m0, s43, 147456
  s_add_u32 s49, s49, s48
  v_cmp_eq_u32 vcc, 0, v31
  s_cbranch_vccnz mk_pdB_spin
mk_pdB_ok:
  v_readfirstlane_b32 s94, v31
  v_readfirstlane_b32 s95, v31
  v_mfma_f32_32x32x16_bf16 v[96:111], v[252:255], a[88:91], v[96:111]
  s_waitcnt lgkmcnt(9)
  ds_read_b64_tr_b16 a[80:81], v18 offset:40960
  ds_read_b64_tr_b16 a[82:83], v18 offset:41216
  buffer_load_dwordx4 v13, s[16:19], s49 offen offset:0 lds
  v_mfma_f32_32x32x16_bf16 v[112:127], v[252:255], a[92:95], v[112:127]
  s_waitcnt lgkmcnt(9)
  ds_read_b64_tr_b16 a[84:85], v19 offset:40960
  ds_read_b64_tr_b16 a[86:87], v19 offset:41216
  buffer_load_dwordx4 v14, s[16:19], s49 offen offset:1024 lds
  ds_bpermute_b32 v61, v23, v5 offset:100
  ds_bpermute_b32 v62, v23, v5 offset:104
  ds_bpermute_b32 v63, v23, v5 offset:108
  v_mfma_f32_32x32x16_bf16 a[128:143], a[64:67], v[128:131], 0
  s_waitcnt lgkmcnt(12)
  ds_read_b64_tr_b16 a[88:89], v18 offset:41984
  ds_read_b64_tr_b16 a[90:91], v18 offset:42240
  v_mfma_f32_32x32x16_bf16 a[144:159], a[68:71], v[128:131], 0
  s_waitcnt lgkmcnt(11)
  ds_read_b64_tr_b16 a[92:93], v19 offset:41984
  ds_read_b64_tr_b16 a[94:95], v19 offset:42240
  v_mfma_f32_32x32x16_bf16 a[128:143], a[72:75], v[132:135], a[128:143]
  s_waitcnt lgkmcnt(11)
  ds_read_b64_tr_b16 a[64:65], v18 offset:45056
  ds_read_b64_tr_b16 a[66:67], v18 offset:45312
  buffer_load_dwordx4 v15, s[20:23], s49 offen offset:2048 lds
  v_mfma_f32_32x32x16_bf16 a[144:159], a[76:79], v[132:135], a[144:159]
  s_waitcnt lgkmcnt(11)
  ds_read_b64_tr_b16 a[68:69], v19 offset:45056
  ds_read_b64_tr_b16 a[70:71], v19 offset:45312
  buffer_load_dwordx4 v16, s[20:23], s49 offen offset:3072 lds
  s_waitcnt lgkmcnt(8)
  v_mfma_f32_32x32x16_bf16 a[128:143], a[80:83], v[136:139], a[128:143]
  ds_read_b64_tr_b16 a[72:73], v18 offset:46080
  ds_read_b64_tr_b16 a[74:75], v18 offset:46336
  s_add_u32 s58, s51, 0
  v_mul_f32 v64, v64, v48
  v_mul_f32 v65, v65, v49
  v_mul_f32 v66, v66, v50
  v_mfma_f32_32x32x16_bf16 a[144:159], a[84:87], v[136:139], a[144:159]
  s_waitcnt lgkmcnt(8)
  ds_read_b64_tr_b16 a[76:77], v19 offset:46080
  ds_read_b64_tr_b16 a[78:79], v19 offset:46336
  v_mul_f32 v67, v67, v51
  v_mul_f32 v68, v68, v52
  v_mul_f32 v69, v69, v53
  v_mul_f32 v70, v70, v54
  v_mfma_f32_32x32x16_bf16 a[128:143], a[88:91], v[140:143], a[128:143]
  s_waitcnt lgkmcnt(8)
  ds_read_b64_tr_b16 a[80:81], v18 offset:49152
  ds_read_b64_tr_b16 a[82:83], v18 offset:49408
  v_mul_f32 v71, v71, v55
  v_mul_f32 v72, v72, v56
  v_mul_f32 v73, v73, v57
  v_mul_f32 v74, v74, v58
  v_mfma_f32_32x32x16_bf16 a[144:159], a[92:95], v[140:143], a[144:159]
  s_waitcnt lgkmcnt(8)
  ds_read_b64_tr_b16 a[84:85], v19 offset:49152
  ds_read_b64_tr_b16 a[86:87], v19 offset:49408
  v_mul_f32 v75, v75, v59
  v_mul_f32 v76, v76, v60
  v_mul_f32 v77, v77, v61
  v_mul_f32 v78, v78, v62
  v_mfma_f32_32x32x16_bf16 a[128:143], a[64:67], v[144:147], a[128:143]
  s_waitcnt lgkmcnt(8)
  ds_read_b64_tr_b16 a[88:89], v18 offset:50176
  ds_read_b64_tr_b16 a[90:91], v18 offset:50432
  v_mul_f32 v79, v79, v63
  v_cvt_pk_bf16_f32 v64, v64, v65
  v_cvt_pk_bf16_f32 v65, v66, v67
  v_cvt_pk_bf16_f32 v66, v68, v69
  v_mfma_f32_32x32x16_bf16 a[144:159], a[68:71], v[144:147], a[144:159]
  s_waitcnt lgkmcnt(8)
  ds_read_b64_tr_b16 a[92:93], v19 offset:50176
  ds_read_b64_tr_b16 a[94:95], v19 offset:50432
  v_cvt_pk_bf16_f32 v67, v70, v71
  v_cvt_pk_bf16_f32 v68, v72, v73
  v_cvt_pk_bf16_f32 v69, v74, v75
  v_cvt_pk_bf16_f32 v70, v76, v77
  v_mfma_f32_32x32x16_bf16 a[128:143], a[72:75], v[148:151], a[128:143]
  s_waitcnt lgkmcnt(8)
  ds_read_b64_tr_b16 a[64:65], v18 offset:53248
  ds_read_b64_tr_b16 a[66:67], v18 offset:53504
  v_cvt_pk_bf16_f32 v71, v78, v79
  v_add_u32 v72, s58, v8
  v_mfma_f32_32x32x16_bf16 a[144:159], a[76:79], v[148:151], a[144:159]
  s_waitcnt lgkmcnt(8)
  ds_read_b64_tr_b16 a[68:69], v19 offset:53248
  ds_read_b64_tr_b16 a[70:71], v19 offset:53504
  global_store_dwordx4 v72, v[64:67], s[38:39] offset:0 sc1
  global_store_dwordx4 v72, v[68:71], s[38:39] offset:512 sc1
  v_mfma_f32_32x32x16_bf16 a[128:143], a[80:83], v[152:155], a[128:143]
  s_waitcnt lgkmcnt(8)
  ds_read_b64_tr_b16 a[72:73], v18 offset:54272
  ds_read_b64_tr_b16 a[74:75], v18 offset:54528
  s_add_u32 s58, s51, 131072
  v_mul_f32 v80, v80, v48
  v_mul_f32 v81, v81, v49
  v_mul_f32 v82, v82, v50
  v_mfma_f32_32x32x16_bf16 a[144:159], a[84:87], v[152:155], a[144:159]
  s_waitcnt lgkmcnt(8)
  ds_read_b64_tr_b16 a[76:77], v19 offset:54272
  ds_read_b64_tr_b16 a[78:79], v19 offset:54528
  v_mul_f32 v83, v83, v51
  v_mul_f32 v84, v84, v52
  v_mul_f32 v85, v85, v53
  v_mul_f32 v86, v86, v54
  v_mfma_f32_32x32x16_bf16 a[128:143], a[88:91], v[156:159], a[128:143]
  s_waitcnt lgkmcnt(8)
  ds_read_b64_tr_b16 a[80:81], v18 offset:57344
  ds_read_b64_tr_b16 a[82:83], v18 offset:57600
  v_mul_f32 v87, v87, v55
  v_mul_f32 v88, v88, v56
  v_mul_f32 v89, v89, v57
  v_mul_f32 v90, v90, v58
  v_mfma_f32_32x32x16_bf16 a[144:159], a[92:95], v[156:159], a[144:159]
  s_waitcnt lgkmcnt(8)
  ds_read_b64_tr_b16 a[84:85], v19 offset:57344
  ds_read_b64_tr_b16 a[86:87], v19 offset:57600
  v_mul_f32 v91, v91, v59
  v_mul_f32 v92, v92, v60
  v_mul_f32 v93, v93, v61
  v_mul_f32 v94, v94, v62
  v_mfma_f32_32x32x16_bf16 a[128:143], a[64:67], v[160:163], a[128:143]
  s_waitcnt lgkmcnt(8)
  ds_read_b64_tr_b16 a[88:89], v18 offset:58368
  ds_read_b64_tr_b16 a[90:91], v18 offset:58624
  v_mul_f32 v95, v95, v63
  v_cvt_pk_bf16_f32 v80, v80, v81
  v_cvt_pk_bf16_f32 v81, v82, v83
  v_cvt_pk_bf16_f32 v82, v84, v85
  v_mfma_f32_32x32x16_bf16 a[144:159], a[68:71], v[160:163], a[144:159]
  s_waitcnt lgkmcnt(8)
  ds_read_b64_tr_b16 a[92:93], v19 offset:58368
  ds_read_b64_tr_b16 a[94:95], v19 offset:58624
  v_cvt_pk_bf16_f32 v83, v86, v87
  v_cvt_pk_bf16_f32 v84, v88, v89
  v_add_u32 v18, 61440, v18
  v_add_u32 v19, 61440, v19
  v_mfma_f32_32x32x16_bf16 a[128:143], a[72:75], v[164:167], a[128:143]
  s_waitcnt lgkmcnt(8)
  ds_read_b64_tr_b16 a[64:65], v18 offset:0
  ds_read_b64_tr_b16 a[66:67], v18 offset:256
  v_cvt_pk_bf16_f32 v85, v90, v91
  v_cvt_pk_bf16_f32 v86, v92, v93
  v_cvt_pk_bf16_f32 v87, v94, v95
  v_add_u32 v88, s58, v8
  v_mfma_f32_32x32x16_bf16 a[144:159], a[76:79], v[164:167], a[144:159]
  s_waitcnt lgkmcnt(8)
  ds_read_b64_tr_b16 a[68:69], v19 offset:0
  ds_read_b64_tr_b16 a[70:71], v19 offset:256
  global_store_dwordx4 v88, v[80:83], s[38:39] offset:0 sc1
  global_store_dwordx4 v88, v[84:87], s[38:39] offset:512 sc1
  v_mfma_f32_32x32x16_bf16 a[128:143], a[80:83], v[168:171], a[128:143]
  s_waitcnt lgkmcnt(8)
  ds_read_b64_tr_b16 a[72:73], v18 offset:1024
  ds_read_b64_tr_b16 a[74:75], v18 offset:1280
  v_mfma_f32_32x32x16_bf16 a[144:159], a[84:87], v[168:171], a[144:159]
  s_waitcnt lgkmcnt(8)
  ds_read_b64_tr_b16 a[76:77], v19 offset:1024
  ds_read_b64_tr_b16 a[78:79], v19 offset:1280
  v_mfma_f32_32x32x16_bf16 a[128:143], a[88:91], v[172:175], a[128:143]
  s_waitcnt lgkmcnt(8)
  ds_read_b64_tr_b16 a[80:81], v18 offset:4096
  ds_read_b64_tr_b16 a[82:83], v18 offset:4352
  v_mfma_f32_32x32x16_bf16 a[144:159], a[92:95], v[172:175], a[144:159]
  s_waitcnt lgkmcnt(8)
  ds_read_b64_tr_b16 a[84:85], v19 offset:4096
  ds_read_b64_tr_b16 a[86:87], v19 offset:4352
  v_mfma_f32_32x32x16_bf16 a[128:143], a[64:67], v[176:179], a[128:143]
  s_waitcnt lgkmcnt(8)
  ds_read_b64_tr_b16 a[88:89], v18 offset:5120
  ds_read_b64_tr_b16 a[90:91], v18 offset:5376
  s_add_u32 s58, s51, 262144
  v_mul_f32 v96, v96, v48
  v_mul_f32 v97, v97, v49
  v_mul_f32 v98, v98, v50
  v_mfma_f32_32x32x16_bf16 a[144:159], a[68:71], v[176:179], a[144:159]
  s_waitcnt lgkmcnt(8)
  ds_read_b64_tr_b16 a[92:93], v19 offset:5120
  ds_read_b64_tr_b16 a[94:95], v19 offset:5376
  v_mul_f32 v99, v99, v51
  v_mul_f32 v100, v100, v52
  v_subrev_u32 v18, 122880, v18
  v_subrev_u32 v19, 122880, v19
  v_mfma_f32_32x32x16_bf16 a[128:143], a[72:75], v[180:183], a[128:143]
  s_waitcnt vmcnt(8) lgkmcnt(8)
  s_barrier
  ds_read_b64_tr_b16 a[64:65], v18 offset:0
  ds_read_b64_tr_b16 a[66:67], v18 offset:256
  v_mul_f32 v101, v101, v53
  v_mul_f32 v102, v102, v54
  v_mfma_f32_32x32x16_bf16 a[144:159], a[76:79], v[180:183], a[144:159]
  s_waitcnt lgkmcnt(8)
  ds_read_b64_tr_b16 a[68:69], v19 offset:0
  ds_read_b64_tr_b16 a[70:71], v19 offset:256
  v_mul_f32 v103, v103, v55
  v_mul_f32 v104, v104, v56
  v_mul_f32 v105, v105, v57
  v_mul_f32 v106, v106, v58
  v_mfma_f32_32x32x16_bf16 a[128:143], a[80:83], v[184:187], a[128:143]
  s_waitcnt lgkmcnt(8)
  ds_read_b64_tr_b16 a[72:73], v18 offset:1024
  ds_read_b64_tr_b16 a[74:75], v18 offset:1280
  v_mul_f32 v107, v107, v59
  v_mul_f32 v108, v108, v60
  v_mul_f32 v109, v109, v61
  v_mul_f32 v110, v110, v62
  v_mfma_f32_32x32x16_bf16 a[144:159], a[84:87], v[184:187], a[144:159]
  s_waitcnt lgkmcnt(8)
  ds_read_b64_tr_b16 a[76:77], v19 offset:1024
  ds_read_b64_tr_b16 a[78:79], v19 offset:1280
  v_mul_f32 v111, v111, v63
  v_cvt_pk_bf16_f32 v96, v96, v97
  v_cvt_pk_bf16_f32 v97, v98, v99
  v_cvt_pk_bf16_f32 v98, v100, v101
  v_mfma_f32_32x32x16_bf16 a[128:143], a[88:91], v[188:191], a[128:143]
  s_waitcnt lgkmcnt(8)
  ds_read_b64_tr_b16 a[80:81], v18 offset:4096
  ds_read_b64_tr_b16 a[82:83], v18 offset:4352
  v_cvt_pk_bf16_f32 v99, v102, v103
  v_cvt_pk_bf16_f32 v100, v104, v105
  v_cvt_pk_bf16_f32 v101, v106, v107
  v_cvt_pk_bf16_f32 v102, v108, v109
  v_mfma_f32_32x32x16_bf16 a[144:159], a[92:95], v[188:191], a[144:159]
  s_waitcnt lgkmcnt(8)
  ds_read_b64_tr_b16 a[84:85], v19 offset:4096
  ds_read_b64_tr_b16 a[86:87], v19 offset:4352
  v_cvt_pk_bf16_f32 v103, v110, v111
  v_add_u32 v104, s58, v8
  v_mfma_f32_32x32x16_bf16 a[128:143], a[64:67], v[192:195], a[128:143]
  s_waitcnt lgkmcnt(8)
  ds_read_b64_tr_b16 a[88:89], v18 offset:5120
  ds_read_b64_tr_b16 a[90:91], v18 offset:5376
  global_store_dwordx4 v104, v[96:99], s[38:39] offset:0 sc1
  global_store_dwordx4 v104, v[100:103], s[38:39] offset:512 sc1
  s_add_u32 s58, s51, 393216
  v_mul_f32 v112, v112, v48
  v_mfma_f32_32x32x16_bf16 a[144:159], a[68:71], v[192:195], a[144:159]
  s_waitcnt lgkmcnt(8)
  ds_read_b64_tr_b16 a[92:93], v19 offset:5120
  ds_read_b64_tr_b16 a[94:95], v19 offset:5376
  v_mul_f32 v113, v113, v49
  v_mul_f32 v114, v114, v50
  v_mul_f32 v115, v115, v51
  v_mul_f32 v116, v116, v52
  v_mfma_f32_32x32x16_bf16 a[128:143], a[72:75], v[196:199], a[128:143]
  s_waitcnt lgkmcnt(8)
  ds_read_b64_tr_b16 a[64:65], v18 offset:8192
  ds_read_b64_tr_b16 a[66:67], v18 offset:8448
  v_mul_f32 v117, v117, v53
  v_mul_f32 v118, v118, v54
  v_mul_f32 v119, v119, v55
  v_mul_f32 v120, v120, v56
  v_mfma_f32_32x32x16_bf16 a[144:159], a[76:79], v[196:199], a[144:159]
  s_waitcnt lgkmcnt(8)
  ds_read_b64_tr_b16 a[68:69], v19 offset:8192
  ds_read_b64_tr_b16 a[70:71], v19 offset:8448
  v_mul_f32 v121, v121, v57
  v_mul_f32 v122, v122, v58
  v_mul_f32 v123, v123, v59
  v_mul_f32 v124, v124, v60
  v_mfma_f32_32x32x16_bf16 a[128:143], a[80:83], v[200:203], a[128:143]
  s_waitcnt lgkmcnt(8)
  ds_read_b64_tr_b16 a[72:73], v18 offset:9216
  ds_read_b64_tr_b16 a[74:75], v18 offset:9472
  v_mul_f32 v125, v125, v61
  v_mul_f32 v126, v126, v62
  v_mul_f32 v127, v127, v63
  v_cvt_pk_bf16_f32 v112, v112, v113
  v_mfma_f32_32x32x16_bf16 a[144:159], a[84:87], v[200:203], a[144:159]
  s_waitcnt lgkmcnt(8)
  ds_read_b64_tr_b16 a[76:77], v19 offset:9216
  ds_read_b64_tr_b16 a[78:79], v19 offset:9472
  v_cvt_pk_bf16_f32 v113, v114, v115
  v_cvt_pk_bf16_f32 v114, v116, v117
  v_cvt_pk_bf16_f32 v115, v118, v119
  v_cvt_pk_bf16_f32 v116, v120, v121
  v_mfma_f32_32x32x16_bf16 a[128:143], a[88:91], v[204:207], a[128:143]
  s_waitcnt lgkmcnt(8)
  ds_read_b64_tr_b16 a[80:81], v18 offset:12288
  ds_read_b64_tr_b16 a[82:83], v18 offset:12544
  v_cvt_pk_bf16_f32 v117, v122, v123
  v_cvt_pk_bf16_f32 v118, v124, v125
  v_cvt_pk_bf16_f32 v119, v126, v127
  v_add_u32 v120, s58, v8
  v_mfma_f32_32x32x16_bf16 a[144:159], a[92:95], v[204:207], a[144:159]
  s_waitcnt lgkmcnt(8)
  ds_read_b64_tr_b16 a[84:85], v19 offset:12288
  ds_read_b64_tr_b16 a[86:87], v19 offset:12544
  global_store_dwordx4 v120, v[112:115], s[38:39] offset:0 sc1
  global_store_dwordx4 v120, v[116:119], s[38:39] offset:512 sc1
  v_mfma_f32_32x32x16_bf16 a[128:143], a[64:67], v[208:211], a[128:143]
  s_waitcnt lgkmcnt(8)
  ds_read_b64_tr_b16 a[88:89], v18 offset:13312
  ds_read_b64_tr_b16 a[90:91], v18 offset:13568
  s_add_u32 s49, s44, 2
  s_and_b32 s49, s49, 7
  s_mul_i32 s49, s49, 229376
  v_mfma_f32_32x32x16_bf16 a[144:159], a[68:71], v[208:211], a[144:159]
  s_waitcnt lgkmcnt(8)
  ds_read_b64_tr_b16 a[92:93], v19 offset:13312
  ds_read_b64_tr_b16 a[94:95], v19 offset:13568
  s_add_u32 m0, s43, 65536
  s_add_u32 s49, s49, s48
  v_mfma_f32_32x32x16_bf16 a[128:143], a[72:75], v[212:215], a[128:143]
  s_waitcnt lgkmcnt(8)
  ds_read_b64_tr_b16 a[64:65], v18 offset:16384
  ds_read_b64_tr_b16 a[66:67], v18 offset:16640
  buffer_load_dwordx4 v13, s[16:19], s49 offen offset:0 lds
  v_mfma_f32_32x32x16_bf16 a[144:159], a[76:79], v[212:215], a[144:159]
  s_waitcnt lgkmcnt(8)
  ds_read_b64_tr_b16 a[68:69], v19 offset:16384
  ds_read_b64_tr_b16 a[70:71], v19 offset:16640
  buffer_load_dwordx4 v14, s[16:19], s49 offen offset:1024 lds
  v_mfma_f32_32x32x16_bf16 a[128:143], a[80:83], v[216:219], a[128:143]
  s_waitcnt lgkmcnt(8)
  ds_read_b64_tr_b16 a[72:73], v18 offset:17408
  ds_read_b64_tr_b16 a[74:75], v18 offset:17664
  v_mfma_f32_32x32x16_bf16 a[144:159], a[84:87], v[216:219], a[144:159]
  s_waitcnt lgkmcnt(8)
  ds_read_b64_tr_b16 a[76:77], v19 offset:17408
  ds_read_b64_tr_b16 a[78:79], v19 offset:17664
  v_mfma_f32_32x32x16_bf16 a[128:143], a[88:91], v[220:223], a[128:143]
  s_waitcnt lgkmcnt(8)
  ds_read_b64_tr_b16 a[80:81], v18 offset:20480
  ds_read_b64_tr_b16 a[82:83], v18 offset:20736
  buffer_load_dwordx4 v15, s[20:23], s49 offen offset:2048 lds
  v_mfma_f32_32x32x16_bf16 a[144:159], a[92:95], v[220:223], a[144:159]
  s_waitcnt lgkmcnt(8)
  ds_read_b64_tr_b16 a[84:85], v19 offset:20480
  ds_read_b64_tr_b16 a[86:87], v19 offset:20736
  buffer_load_dwordx4 v16, s[20:23], s49 offen offset:3072 lds
  v_mfma_f32_32x32x16_bf16 a[128:143], a[64:67], v[224:227], a[128:143]
  s_waitcnt lgkmcnt(8)
  ds_read_b64_tr_b16 a[88:89], v18 offset:21504
  ds_read_b64_tr_b16 a[90:91], v18 offset:21760
  s_add_u32 s49, s44, 3
  s_and_b32 s49, s49, 7
  s_mul_i32 s49, s49, 229376
  v_mfma_f32_32x32x16_bf16 a[144:159], a[68:71], v[224:227], a[144:159]
  s_waitcnt lgkmcnt(8)
  ds_read_b64_tr_b16 a[92:93], v19 offset:21504
  ds_read_b64_tr_b16 a[94:95], v19 offset:21760
  s_add_u32 m0, s43, 32768
  s_add_u32 s49, s49, s48
  v_mfma_f32_32x32x16_bf16 a[128:143], a[72:75], v[228:231], a[128:143]
  s_waitcnt lgkmcnt(8)
  ds_read_b64_tr_b16 a[64:65], v18 offset:24576
  ds_read_b64_tr_b16 a[66:67], v18 offset:24832
  buffer_load_dwordx4 v13, s[16:19], s49 offen offset:0 lds
  v_mfma_f32_32x32x16_bf16 a[144:159], a[76:79], v[228:231], a[144:159]
  s_waitcnt lgkmcnt(8)
  ds_read_b64_tr_b16 a[68:69], v19 offset:24576
  ds_read_b64_tr_b16 a[70:71], v19 offset:24832
  buffer_load_dwordx4 v14, s[16:19], s49 offen offset:1024 lds
  v_mfma_f32_32x32x16_bf16 a[128:143], a[80:83], v[232:235], a[128:143]
  s_waitcnt lgkmcnt(8)
  ds_read_b64_tr_b16 a[72:73], v18 offset:25600
  ds_read_b64_tr_b16 a[74:75], v18 offset:25856
  v_mfma_f32_32x32x16_bf16 a[144:159], a[84:87], v[232:235], a[144:159]
  s_waitcnt lgkmcnt(8)
  ds_read_b64_tr_b16 a[76:77], v19 offset:25600
  ds_read_b64_tr_b16 a[78:79], v19 offset:25856
  v_mfma_f32_32x32x16_bf16 a[128:143], a[88:91], v[236:239], a[128:143]
  s_waitcnt lgkmcnt(8)
  ds_read_b64_tr_b16 a[80:81], v18 offset:28672
  ds_read_b64_tr_b16 a[82:83], v18 offset:28928
  buffer_load_dwordx4 v15, s[20:23], s49 offen offset:2048 lds
  v_mfma_f32_32x32x16_bf16 a[144:159], a[92:95], v[236:239], a[144:159]
  s_waitcnt lgkmcnt(8)
  ds_read_b64_tr_b16 a[84:85], v19 offset:28672
  ds_read_b64_tr_b16 a[86:87], v19 offset:28928
  buffer_load_dwordx4 v16, s[20:23], s49 offen offset:3072 lds
  v_mfma_f32_32x32x16_bf16 a[128:143], a[64:67], v[240:243], a[128:143]
  s_waitcnt lgkmcnt(8)
  ds_read_b64_tr_b16 a[88:89], v18 offset:29696
  ds_read_b64_tr_b16 a[90:91], v18 offset:29952
  v_mfma_f32_32x32x16_bf16 a[144:159], a[68:71], v[240:243], a[144:159]
  s_waitcnt lgkmcnt(8)
  ds_read_b64_tr_b16 a[92:93], v19 offset:29696
  ds_read_b64_tr_b16 a[94:95], v19 offset:29952
  v_bfe_u32 v18, v1, 4, 1
  v_lshl_add_u32 v18, v18, 11, v9
  v_add_u32 v18, 122880, v18
  v_xor_b32 v19, 32, v18
  v_xor_b32 v20, 64, v18
  v_xor_b32 v21, 96, v18
  v_mfma_f32_32x32x16_bf16 a[128:143], a[72:75], v[244:247], a[128:143]
  s_waitcnt vmcnt(16) lgkmcnt(8)
  s_barrier
  ds_read_b64_tr_b16 a[64:65], v18 offset:8192
  ds_read_b64_tr_b16 a[66:67], v18 offset:8704
  v_mfma_f32_32x32x16_bf16 a[144:159], a[76:79], v[244:247], a[144:159]
  s_waitcnt lgkmcnt(8)
  ds_read_b64_tr_b16 a[68:69], v19 offset:8192
  ds_read_b64_tr_b16 a[70:71], v19 offset:8704
  v_mfma_f32_32x32x16_bf16 a[128:143], a[80:83], v[248:251], a[128:143]
  s_waitcnt lgkmcnt(8)
  ds_read_b64_tr_b16 a[72:73], v20 offset:8192
  ds_read_b64_tr_b16 a[74:75], v20 offset:8704
  s_add_u32 s49, s44, 4
  s_and_b32 s49, s49, 7
  s_mul_i32 s49, s49, 229376
  v_mfma_f32_32x32x16_bf16 a[144:159], a[84:87], v[248:251], a[144:159]
  s_waitcnt lgkmcnt(8)
  ds_read_b64_tr_b16 a[76:77], v21 offset:8192
  ds_read_b64_tr_b16 a[78:79], v21 offset:8704
  s_add_u32 m0, s43, 49152
  s_add_u32 s49, s49, s48
  v_mfma_f32_32x32x16_bf16 a[128:143], a[88:91], v[252:255], a[128:143]
  s_waitcnt lgkmcnt(8)
  ds_read_b64_tr_b16 a[80:81], v18 offset:12288
  ds_read_b64_tr_b16 a[82:83], v18 offset:12800
  buffer_load_dwordx4 v13, s[16:19], s49 offen offset:0 lds
  v_mfma_f32_32x32x16_bf16 a[144:159], a[92:95], v[252:255], a[144:159]
  s_waitcnt lgkmcnt(8)
  ds_read_b64_tr_b16 a[84:85], v19 offset:12288
  ds_read_b64_tr_b16 a[86:87], v19 offset:12800
  buffer_load_dwordx4 v14, s[16:19], s49 offen offset:1024 lds
  v_mfma_f32_32x32x16_bf16 v[64:79], a[64:67], v[128:131], 0
  s_waitcnt lgkmcnt(8)
  ds_read_b64_tr_b16 a[88:89], v20 offset:12288
  ds_read_b64_tr_b16 a[90:91], v20 offset:12800
  v_mfma_f32_32x32x16_bf16 v[80:95], a[68:71], v[128:131], 0
  s_waitcnt lgkmcnt(8)
  ds_read_b64_tr_b16 a[92:93], v21 offset:12288
  ds_read_b64_tr_b16 a[94:95], v21 offset:12800
  v_mfma_f32_32x32x16_bf16 v[96:111], a[72:75], v[128:131], 0
  s_waitcnt lgkmcnt(8)
  ds_read_b64_tr_b16 a[64:65], v18 offset:16384
  ds_read_b64_tr_b16 a[66:67], v18 offset:16896
  buffer_load_dwordx4 v15, s[20:23], s49 offen offset:2048 lds
  v_mfma_f32_32x32x16_bf16 v[112:127], a[76:79], v[128:131], 0
  s_waitcnt lgkmcnt(8)
  ds_read_b64_tr_b16 a[68:69], v19 offset:16384
  ds_read_b64_tr_b16 a[70:71], v19 offset:16896
  buffer_load_dwordx4 v16, s[20:23], s49 offen offset:3072 lds
  v_mov_b32 v46, s83
  v_mov_b32 v47, s94
  v_mfma_f32_32x32x16_bf16 v[64:79], a[80:83], v[132:135], v[64:79]
  s_waitcnt lgkmcnt(8)
  ds_read_b64_tr_b16 a[72:73], v20 offset:16384
  ds_read_b64_tr_b16 a[74:75], v20 offset:16896
  s_waitcnt vmcnt(12)
  s_mov_b64 exec, 1
  global_store_dword v46, v47, s[38:39] sc1
  s_mov_b64 exec, -1
  v_mfma_f32_32x32x16_bf16 v[80:95], a[84:87], v[132:135], v[80:95]
  s_waitcnt lgkmcnt(8)
  ds_read_b64_tr_b16 a[76:77], v21 offset:16384
  ds_read_b64_tr_b16 a[78:79], v21 offset:16896
  v_accvgpr_read_b32 v22, a128
  v_accvgpr_read_b32 v23, a129
  v_accvgpr_read_b32 v26, a130
  v_accvgpr_read_b32 v27, a131
  v_mfma_f32_32x32x16_bf16 v[96:111], a[88:91], v[132:135], v[96:111]
  s_waitcnt lgkmcnt(8)
  ds_read_b64_tr_b16 a[80:81], v18 offset:20480
  ds_read_b64_tr_b16 a[82:83], v18 offset:20992
  v_mul_f32 v24, v22, v4
  v_mul_f32 v25, v23, v4
  v_mul_f32 v2, v26, v4
  v_mul_f32 v5, v27, v4
  v_mfma_f32_32x32x16_bf16 v[112:127], a[92:95], v[132:135], v[112:127]
  s_waitcnt lgkmcnt(8)
  ds_read_b64_tr_b16 a[84:85], v19 offset:20480
  ds_read_b64_tr_b16 a[86:87], v19 offset:20992
  v_exp_f32 v24, v24
  v_exp_f32 v25, v25
  v_mfma_f32_32x32x16_bf16 v[64:79], a[64:67], v[136:139], v[64:79]
  s_waitcnt lgkmcnt(8)
  ds_read_b64_tr_b16 a[88:89], v20 offset:20480
  ds_read_b64_tr_b16 a[90:91], v20 offset:20992
  s_add_u32 s49, s44, 5
  s_and_b32 s49, s49, 7
  s_mul_i32 s49, s49, 229376
  v_mfma_f32_32x32x16_bf16 v[80:95], a[68:71], v[136:139], v[80:95]
  s_waitcnt lgkmcnt(8)
  ds_read_b64_tr_b16 a[92:93], v21 offset:20480
  ds_read_b64_tr_b16 a[94:95], v21 offset:20992
  v_exp_f32 v2, v2
  s_add_u32 m0, s43, 81920
  s_add_u32 s49, s49, s48
  v_mfma_f32_32x32x16_bf16 v[96:111], a[72:75], v[136:139], v[96:111]
  s_waitcnt lgkmcnt(8)
  ds_read_b64_tr_b16 a[64:65], v18 offset:24576
  ds_read_b64_tr_b16 a[66:67], v18 offset:25088
  buffer_load_dwordx4 v13, s[16:19], s49 offen offset:0 lds
  v_exp_f32 v5, v5
  v_mfma_f32_32x32x16_bf16 v[112:127], a[76:79], v[136:139], v[112:127]
  s_waitcnt lgkmcnt(8)
  ds_read_b64_tr_b16 a[68:69], v19 offset:24576
  ds_read_b64_tr_b16 a[70:71], v19 offset:25088
  buffer_load_dwordx4 v14, s[16:19], s49 offen offset:1024 lds
  v_fma_f32 v24, v24, v6, v6
  v_fma_f32 v25, v25, v6, v6
  v_mfma_f32_32x32x16_bf16 v[64:79], a[80:83], v[140:143], v[64:79]
  s_waitcnt lgkmcnt(8)
  ds_read_b64_tr_b16 a[72:73], v20 offset:24576
  ds_read_b64_tr_b16 a[74:75], v20 offset:25088
  v_fma_f32 v2, v2, v6, v6
  v_fma_f32 v5, v5, v6, v6
  v_rcp_f32 v24, v24
  v_mfma_f32_32x32x16_bf16 v[80:95], a[84:87], v[140:143], v[80:95]
  s_waitcnt lgkmcnt(8)
  ds_read_b64_tr_b16 a[76:77], v21 offset:24576
  ds_read_b64_tr_b16 a[78:79], v21 offset:25088
  v_rcp_f32 v25, v25
  v_rcp_f32 v2, v2
  v_mfma_f32_32x32x16_bf16 v[96:111], a[88:91], v[140:143], v[96:111]
  s_waitcnt lgkmcnt(8)
  ds_read_b64_tr_b16 a[80:81], v18 offset:28672
  ds_read_b64_tr_b16 a[82:83], v18 offset:29184
  buffer_load_dwordx4 v15, s[20:23], s49 offen offset:2048 lds
  v_rcp_f32 v5, v5
  v_mfma_f32_32x32x16_bf16 v[112:127], a[92:95], v[140:143], v[112:127]
  s_waitcnt lgkmcnt(8)
  ds_read_b64_tr_b16 a[84:85], v19 offset:28672
  ds_read_b64_tr_b16 a[86:87], v19 offset:29184
  buffer_load_dwordx4 v16, s[20:23], s49 offen offset:3072 lds
  v_mul_f32 v22, v22, v24
  v_mul_f32 v23, v23, v25
  v_mfma_f32_32x32x16_bf16 v[64:79], a[64:67], v[144:147], v[64:79]
  s_waitcnt lgkmcnt(8)
  ds_read_b64_tr_b16 a[88:89], v20 offset:28672
  ds_read_b64_tr_b16 a[90:91], v20 offset:29184
  v_mul_f32 v26, v26, v2
  s_add_u32 s49, s44, 6
  s_and_b32 s49, s49, 7
  s_mul_i32 s49, s49, 229376
  v_mfma_f32_32x32x16_bf16 v[80:95], a[68:71], v[144:147], v[80:95]
  s_waitcnt lgkmcnt(8)
  ds_read_b64_tr_b16 a[92:93], v21 offset:28672
  ds_read_b64_tr_b16 a[94:95], v21 offset:29184
  v_mul_f32 v27, v27, v5
  v_accvgpr_read_b32 v24, a136
  s_add_u32 m0, s43, 98304
  s_add_u32 s49, s49, s48
  v_mfma_f32_32x32x16_bf16 v[96:111], a[72:75], v[144:147], v[96:111]
  s_waitcnt lgkmcnt(8)
  ds_read_b64_tr_b16 a[64:65], v18 offset:32768
  ds_read_b64_tr_b16 a[66:67], v18 offset:33280
  buffer_load_dwordx4 v13, s[16:19], s49 offen offset:0 lds
  v_accvgpr_read_b32 v25, a137
mk_wB3:
  s_cbranch_execz mk_wB4
  v_accvgpr_read_b32 v2, a138
  v_mfma_f32_32x32x16_bf16 v[112:127], a[76:79], v[144:147], v[112:127]
  s_waitcnt lgkmcnt(8)
  ds_read_b64_tr_b16 a[68:69], v19 offset:32768
  ds_read_b64_tr_b16 a[70:71], v19 offset:33280
  buffer_load_dwordx4 v14, s[16:19], s49 offen offset:1024 lds
  v_accvgpr_read_b32 v5, a139
  v_mul_f32 v22, v22, v24
  v_mfma_f32_32x32x16_bf16 v[64:79], a[80:83], v[148:151], v[64:79]
  s_waitcnt lgkmcnt(8)
  ds_read_b64_tr_b16 a[72:73], v20 offset:32768
  ds_read_b64_tr_b16 a[74:75], v20 offset:33280
  v_mul_f32 v23, v23, v25
  v_mul_f32 v26, v26, v2
  v_mul_f32 v27, v27, v5
  v_cvt_pk_bf16_f32 v48, v22, v23
  v_mfma_f32_32x32x16_bf16 v[80:95], a[84:87], v[148:151], v[80:95]
  s_waitcnt lgkmcnt(8)
  ds_read_b64_tr_b16 a[76:77], v21 offset:32768
  ds_read_b64_tr_b16 a[78:79], v21 offset:33280
  v_cvt_pk_bf16_f32 v49, v26, v27
  v_accvgpr_read_b32 v22, a132
  v_accvgpr_read_b32 v23, a133
  v_accvgpr_read_b32 v26, a134
  v_mfma_f32_32x32x16_bf16 v[96:111], a[88:91], v[148:151], v[96:111]
  s_waitcnt lgkmcnt(8)
  ds_read_b64_tr_b16 a[80:81], v18 offset:36864
  ds_read_b64_tr_b16 a[82:83], v18 offset:37376
  buffer_load_dwordx4 v15, s[20:23], s49 offen offset:2048 lds
  v_accvgpr_read_b32 v27, a135
  v_mul_f32 v24, v22, v4
  v_mfma_f32_32x32x16_bf16 v[112:127], a[92:95], v[148:151], v[112:127]
  s_waitcnt lgkmcnt(8)
  ds_read_b64_tr_b16 a[84:85], v19 offset:36864
  ds_read_b64_tr_b16 a[86:87], v19 offset:37376
  buffer_load_dwordx4 v16, s[20:23], s49 offen offset:3072 lds
  v_mul_f32 v25, v23, v4
  v_mul_f32 v2, v26, v4
  v_mfma_f32_32x32x16_bf16 v[64:79], a[64:67], v[152:155], v[64:79]
  s_waitcnt lgkmcnt(8)
  ds_read_b64_tr_b16 a[88:89], v20 offset:36864
  ds_read_b64_tr_b16 a[90:91], v20 offset:37376
  v_mul_f32 v5, v27, v4
  s_add_u32 s49, s44, 7
  s_and_b32 s49, s49, 7
  s_mul_i32 s49, s49, 229376
  v_mfma_f32_32x32x16_bf16 v[80:95], a[68:71], v[152:155], v[80:95]
  s_waitcnt lgkmcnt(8)
  ds_read_b64_tr_b16 a[92:93], v21 offset:36864
  ds_read_b64_tr_b16 a[94:95], v21 offset:37376
  s_add_u32 m0, s43, 114688
  s_add_u32 s49, s49, s48
  v_subrev_u32 v18, 61440, v18
  v_subrev_u32 v19, 61440, v19
  v_subrev_u32 v20, 61440, v20
  v_subrev_u32 v21, 61440, v21
  v_mfma_f32_32x32x16_bf16 v[96:111], a[72:75], v[152:155], v[96:111]
  s_waitcnt vmcnt(13) lgkmcnt(8)
  s_barrier
  ds_read_b64_tr_b16 a[64:65], v18 offset:4096
  ds_read_b64_tr_b16 a[66:67], v18 offset:4608
  buffer_load_dwordx4 v13, s[16:19], s49 offen offset:0 lds
  v_mfma_f32_32x32x16_bf16 v[112:127], a[76:79], v[152:155], v[112:127]
  s_waitcnt lgkmcnt(8)
  ds_read_b64_tr_b16 a[68:69], v19 offset:4096
  ds_read_b64_tr_b16 a[70:71], v19 offset:4608
  buffer_load_dwordx4 v14, s[16:19], s49 offen offset:1024 lds
  v_exp_f32 v24, v24
  v_mfma_f32_32x32x16_bf16 v[64:79], a[80:83], v[156:159], v[64:79]
  s_waitcnt lgkmcnt(8)
  ds_read_b64_tr_b16 a[72:73], v20 offset:4096
  ds_read_b64_tr_b16 a[74:75], v20 offset:4608
  v_exp_f32 v25, v25
  v_exp_f32 v2, v2
  v_mfma_f32_32x32x16_bf16 v[80:95], a[84:87], v[156:159], v[80:95]
  s_waitcnt lgkmcnt(8)
  ds_read_b64_tr_b16 a[76:77], v21 offset:4096
  ds_read_b64_tr_b16 a[78:79], v21 offset:4608
  v_exp_f32 v5, v5
  v_fma_f32 v24, v24, v6, v6
  v_fma_f32 v25, v25, v6, v6
  v_mfma_f32_32x32x16_bf16 v[96:111], a[88:91], v[156:159], v[96:111]
  s_waitcnt lgkmcnt(8)
  ds_read_b64_tr_b16 a[80:81], v18 offset:8192
  ds_read_b64_tr_b16 a[82:83], v18 offset:8704
  buffer_load_dwordx4 v15, s[20:23], s49 offen offset:2048 lds
  v_fma_f32 v2, v2, v6, v6
  v_fma_f32 v5, v5, v6, v6
  v_mfma_f32_32x32x16_bf16 v[112:127], a[92:95], v[156:159], v[112:127]
  s_waitcnt lgkmcnt(8)
  ds_read_b64_tr_b16 a[84:85], v19 offset:8192
  ds_read_b64_tr_b16 a[86:87], v19 offset:8704
  buffer_load_dwordx4 v16, s[20:23], s49 offen offset:3072 lds
  v_rcp_f32 v24, v24
  v_mfma_f32_32x32x16_bf16 v[64:79], a[64:67], v[160:163], v[64:79]
  s_waitcnt lgkmcnt(8)
  ds_read_b64_tr_b16 a[88:89], v20 offset:8192
  ds_read_b64_tr_b16 a[90:91], v20 offset:8704
  v_rcp_f32 v25, v25
  v_rcp_f32 v2, v2
  v_mfma_f32_32x32x16_bf16 v[80:95], a[68:71], v[160:163], v[80:95]
  s_waitcnt lgkmcnt(8)
  ds_read_b64_tr_b16 a[92:93], v21 offset:8192
  ds_read_b64_tr_b16 a[94:95], v21 offset:8704
  v_rcp_f32 v5, v5
  v_mul_f32 v22, v22, v24
  v_mul_f32 v23, v23, v25
  v_mfma_f32_32x32x16_bf16 v[96:111], a[72:75], v[160:163], v[96:111]
  s_waitcnt lgkmcnt(8)
  ds_read_b64_tr_b16 a[64:65], v18 offset:12288
  ds_read_b64_tr_b16 a[66:67], v18 offset:12800
  v_mul_f32 v26, v26, v2
  v_mul_f32 v27, v27, v5
  v_accvgpr_read_b32 v24, a140
  v_accvgpr_read_b32 v25, a141
  v_mfma_f32_32x32x16_bf16 v[112:127], a[76:79], v[160:163], v[112:127]
  s_waitcnt lgkmcnt(8)
  ds_read_b64_tr_b16 a[68:69], v19 offset:12288
  ds_read_b64_tr_b16 a[70:71], v19 offset:12800
  v_accvgpr_read_b32 v2, a142
  v_accvgpr_read_b32 v5, a143
  v_mul_f32 v22, v22, v24
  v_mul_f32 v23, v23, v25
  v_mfma_f32_32x32x16_bf16 v[64:79], a[80:83], v[164:167], v[64:79]
  s_waitcnt lgkmcnt(8)
  ds_read_b64_tr_b16 a[72:73], v20 offset:12288
  ds_read_b64_tr_b16 a[74:75], v20 offset:12800
  v_mul_f32 v26, v26, v2
  v_mul_f32 v27, v27, v5
  v_cvt_pk_bf16_f32 v50, v22, v23
  v_cvt_pk_bf16_f32 v51, v26, v27
  v_mfma_f32_32x32x16_bf16 v[80:95], a[84:87], v[164:167], v[80:95]
  s_waitcnt lgkmcnt(8)
  ds_read_b64_tr_b16 a[76:77], v21 offset:12288
  ds_read_b64_tr_b16 a[78:79], v21 offset:12800
  v_accvgpr_read_b32 v22, a144
  v_accvgpr_read_b32 v23, a145
  v_accvgpr_read_b32 v26, a146
  v_accvgpr_read_b32 v27, a147
  v_mfma_f32_32x32x16_bf16 v[96:111], a[88:91], v[164:167], v[96:111]
  s_waitcnt lgkmcnt(8)
  ds_read_b64_tr_b16 a[80:81], v18 offset:16384
  ds_read_b64_tr_b16 a[82:83], v18 offset:16896
  v_mul_f32 v24, v22, v4
  v_mul_f32 v25, v23, v4
  v_mul_f32 v2, v26, v4
  v_mul_f32 v5, v27, v4
  v_mfma_f32_32x32x16_bf16 v[112:127], a[92:95], v[164:167], v[112:127]
  s_waitcnt lgkmcnt(8)
  ds_read_b64_tr_b16 a[84:85], v19 offset:16384
  ds_read_b64_tr_b16 a[86:87], v19 offset:16896
  v_exp_f32 v24, v24
  v_add_u32 v32, s67, v7
  v_add_u32 v33, s70, v7
  v_mfma_f32_32x32x16_bf16 v[64:79], a[64:67], v[168:171], v[64:79]
  s_waitcnt lgkmcnt(8)
  ds_read_b64_tr_b16 a[88:89], v20 offset:16384
  ds_read_b64_tr_b16 a[90:91], v20 offset:16896
  v_exp_f32 v25, v25
  v_exp_f32 v2, v2
  v_mfma_f32_32x32x16_bf16 v[80:95], a[68:71], v[168:171], v[80:95]
  s_waitcnt lgkmcnt(8)
  ds_read_b64_tr_b16 a[92:93], v21 offset:16384
  ds_read_b64_tr_b16 a[94:95], v21 offset:16896
  s_lshr_b32 s57, s2, 3
  s_lshl2_add_u32 s57, s57, s40
  s_lshl_b32 s57, s57, 8
  v_lshl_add_u32 v57, v1, 2, s57
  v_subrev_u32 v18, 61440, v18
  v_subrev_u32 v19, 61440, v19
  v_subrev_u32 v20, 61440, v20
  v_subrev_u32 v21, 61440, v21
  v_mfma_f32_32x32x16_bf16 v[96:111], a[72:75], v[168:171], v[96:111]
  s_waitcnt lgkmcnt(8)
  ds_read_b64_tr_b16 a[64:65], v18 offset:32768
  ds_read_b64_tr_b16 a[66:67], v18 offset:33280
  s_getpc_b64 s[22:23]
mk_pcB:
  s_add_u32 s22, s22, mk_join-mk_pcB
  s_addc_u32 s23, s23, -1
  v_mfma_f32_32x32x16_bf16 v[112:127], a[76:79], v[168:171], v[112:127]
  s_waitcnt lgkmcnt(8)
  ds_read_b64_tr_b16 a[68:69], v19 offset:32768
  ds_read_b64_tr_b16 a[70:71], v19 offset:33280
  global_load_dword v45, v57, s[22:23]
  v_mov_b32 v44, s54
  v_add_u32 v37, s92, v7
  v_mfma_f32_32x32x16_bf16 v[64:79], a[80:83], v[172:175], v[64:79]
  s_waitcnt lgkmcnt(8)
  ds_read_b64_tr_b16 a[72:73], v20 offset:32768
  ds_read_b64_tr_b16 a[74:75], v20 offset:33280
  v_exp_f32 v5, v5
  v_fma_f32 v24, v24, v6, v6
  v_fma_f32 v25, v25, v6, v6
  v_mfma_f32_32x32x16_bf16 v[80:95], a[84:87], v[172:175], v[80:95]
  s_waitcnt lgkmcnt(8)
  ds_read_b64_tr_b16 a[76:77], v21 offset:32768
  ds_read_b64_tr_b16 a[78:79], v21 offset:33280
  v_fma_f32 v2, v2, v6, v6
  v_fma_f32 v5, v5, v6, v6
  v_rcp_f32 v24, v24
  v_mfma_f32_32x32x16_bf16 v[96:111], a[88:91], v[172:175], v[96:111]
  s_waitcnt lgkmcnt(8)
  ds_read_b64_tr_b16 a[80:81], v18 offset:36864
  ds_read_b64_tr_b16 a[82:83], v18 offset:37376
  v_rcp_f32 v25, v25
  v_rcp_f32 v2, v2
  v_mfma_f32_32x32x16_bf16 v[112:127], a[92:95], v[172:175], v[112:127]
  s_waitcnt lgkmcnt(8)
  ds_read_b64_tr_b16 a[84:85], v19 offset:36864
  ds_read_b64_tr_b16 a[86:87], v19 offset:37376
  v_rcp_f32 v5, v5
  v_and_b32 v37, 0xffff, v37
  v_add_u32 v34, s62, v7
  v_mfma_f32_32x32x16_bf16 v[64:79], a[64:67], v[176:179], v[64:79]
  s_waitcnt lgkmcnt(8)
  ds_read_b64_tr_b16 a[88:89], v20 offset:36864
  ds_read_b64_tr_b16 a[90:91], v20 offset:37376
  v_mul_f32 v22, v22, v24
  v_mul_f32 v23, v23, v25
  v_mul_f32 v26, v26, v2
  v_mul_f32 v27, v27, v5
  v_mfma_f32_32x32x16_bf16 v[80:95], a[68:71], v[176:179], v[80:95]
  s_waitcnt lgkmcnt(8)
  ds_read_b64_tr_b16 a[92:93], v21 offset:36864
  ds_read_b64_tr_b16 a[94:95], v21 offset:37376
  v_accvgpr_read_b32 v24, a152
  v_accvgpr_read_b32 v25, a153
  v_accvgpr_read_b32 v2, a154
  v_accvgpr_read_b32 v5, a155
  v_mfma_f32_32x32x16_bf16 v[96:111], a[72:75], v[176:179], v[96:111]
  s_waitcnt lgkmcnt(8)
  ds_read_b64_tr_b16 a[64:65], v18 offset:40960
  ds_read_b64_tr_b16 a[66:67], v18 offset:41472
  v_mul_f32 v22, v22, v24
  v_mul_f32 v23, v23, v25
  v_mul_f32 v26, v26, v2
  v_mul_f32 v27, v27, v5
  v_mfma_f32_32x32x16_bf16 v[112:127], a[76:79], v[176:179], v[112:127]
  s_waitcnt lgkmcnt(8)
  ds_read_b64_tr_b16 a[68:69], v19 offset:40960
  ds_read_b64_tr_b16 a[70:71], v19 offset:41472
  v_cvt_pk_bf16_f32 v52, v22, v23
  v_cvt_pk_bf16_f32 v53, v26, v27
  v_add_u32 v41, s80, v17
  v_add_u32 v38, 16384, v37
  v_mfma_f32_32x32x16_bf16 v[64:79], a[80:83], v[180:183], v[64:79]
  s_waitcnt lgkmcnt(8)
  ds_read_b64_tr_b16 a[72:73], v20 offset:40960
  ds_read_b64_tr_b16 a[74:75], v20 offset:41472
  v_accvgpr_read_b32 v22, a148
  v_accvgpr_read_b32 v23, a149
  v_accvgpr_read_b32 v26, a150
  v_accvgpr_read_b32 v11, a249
  v_mfma_f32_32x32x16_bf16 v[80:95], a[84:87], v[180:183], v[80:95]
  s_waitcnt lgkmcnt(8)
  ds_read_b64_tr_b16 a[76:77], v21 offset:40960
  ds_read_b64_tr_b16 a[78:79], v21 offset:41472
  v_accvgpr_read_b32 v27, a151
  v_mul_f32 v24, v22, v4
  v_mul_f32 v25, v23, v4
  v_mul_f32 v2, v26, v4
  v_mfma_f32_32x32x16_bf16 v[96:111], a[88:91], v[180:183], v[96:111]
  s_waitcnt lgkmcnt(8)
  ds_read_b64_tr_b16 a[80:81], v18 offset:45056
  ds_read_b64_tr_b16 a[82:83], v18 offset:45568
  v_mul_f32 v5, v27, v4
  v_exp_f32 v24, v24
  v_mfma_f32_32x32x16_bf16 v[112:127], a[92:95], v[180:183], v[112:127]
  s_waitcnt lgkmcnt(8)
  ds_read_b64_tr_b16 a[84:85], v19 offset:45056
  ds_read_b64_tr_b16 a[86:87], v19 offset:45568
  v_exp_f32 v25, v25
  v_and_b32 v38, 0xffff, v38
  v_add_u32 v35, s63, v7
  v_mfma_f32_32x32x16_bf16 v[64:79], a[64:67], v[184:187], v[64:79]
  s_waitcnt lgkmcnt(8)
  ds_read_b64_tr_b16 a[88:89], v20 offset:45056
  ds_read_b64_tr_b16 a[90:91], v20 offset:45568
  v_exp_f32 v2, v2
  v_exp_f32 v5, v5
  v_mfma_f32_32x32x16_bf16 v[80:95], a[68:71], v[184:187], v[80:95]
  s_waitcnt lgkmcnt(8)
  ds_read_b64_tr_b16 a[92:93], v21 offset:45056
  ds_read_b64_tr_b16 a[94:95], v21 offset:45568
  global_load_dword v12, v11, s[38:39] sc1
  v_fma_f32 v24, v24, v6, v6
  v_fma_f32 v25, v25, v6, v6
  v_fma_f32 v2, v2, v6, v6
  v_mfma_f32_32x32x16_bf16 v[96:111], a[72:75], v[184:187], v[96:111]
  s_waitcnt vmcnt(2) lgkmcnt(8)
  s_barrier
  ds_read_b64_tr_b16 a[64:65], v18 offset:49152
  ds_read_b64_tr_b16 a[66:67], v18 offset:49664
  v_fma_f32 v5, v5, v6, v6
  v_mfma_f32_32x32x16_bf16 v[112:127], a[76:79], v[184:187], v[112:127]
  s_waitcnt lgkmcnt(8)
  ds_read_b64_tr_b16 a[68:69], v19 offset:49152
  ds_read_b64_tr_b16 a[70:71], v19 offset:49664
  v_rcp_f32 v24, v24
  v_add_u32 v42, s81, v17
  v_add_u32 v39, 32768, v37
  v_mfma_f32_32x32x16_bf16 v[64:79], a[80:83], v[188:191], v[64:79]
  s_waitcnt lgkmcnt(8)
  ds_read_b64_tr_b16 a[72:73], v20 offset:49152
  ds_read_b64_tr_b16 a[74:75], v20 offset:49664
  v_rcp_f32 v25, v25
  v_rcp_f32 v2, v2
  v_mfma_f32_32x32x16_bf16 v[80:95], a[84:87], v[188:191], v[80:95]
  s_waitcnt lgkmcnt(8)
  ds_read_b64_tr_b16 a[76:77], v21 offset:49152
  ds_read_b64_tr_b16 a[78:79], v21 offset:49664
  v_rcp_f32 v5, v5
  v_mul_f32 v22, v22, v24
  v_mul_f32 v23, v23, v25
  v_mfma_f32_32x32x16_bf16 v[96:111], a[88:91], v[188:191], v[96:111]
  s_waitcnt lgkmcnt(8)
  ds_read_b64_tr_b16 a[80:81], v18 offset:53248
  ds_read_b64_tr_b16 a[82:83], v18 offset:53760
  v_mul_f32 v26, v26, v2
  s_lshr_b32 s59, s43, 2
  s_add_u32 s59, s59, 131072
  v_add_u32 v13, s59, v7
  v_mfma_f32_32x32x16_bf16 v[112:127], a[92:95], v[188:191], v[112:127]
  s_waitcnt lgkmcnt(8)
  ds_read_b64_tr_b16 a[84:85], v19 offset:53248
  ds_read_b64_tr_b16 a[86:87], v19 offset:53760
  v_mul_f32 v27, v27, v5
  v_accvgpr_read_b32 v24, a156
  v_and_b32 v39, 0xffff, v39
  v_add_u32 v36, s64, v7
  v_mfma_f32_32x32x16_bf16 v[64:79], a[64:67], v[192:195], v[64:79]
  s_waitcnt lgkmcnt(8)
  ds_read_b64_tr_b16 a[88:89], v20 offset:53248
  ds_read_b64_tr_b16 a[90:91], v20 offset:53760
  ds_write_b128 v13, a[240:243] offset:0
  v_accvgpr_read_b32 v25, a157
  v_mfma_f32_32x32x16_bf16 v[80:95], a[68:71], v[192:195], v[80:95]
  s_waitcnt lgkmcnt(9)
  ds_read_b64_tr_b16 a[92:93], v21 offset:53248
  ds_read_b64_tr_b16 a[94:95], v21 offset:53760
  v_accvgpr_read_b32 v2, a158
  v_accvgpr_read_b32 v5, a159
  v_mul_f32 v22, v22, v24
  v_mul_f32 v23, v23, v25
  v_mfma_f32_32x32x16_bf16 v[96:111], a[72:75], v[192:195], v[96:111]
  s_waitcnt lgkmcnt(9)
  ds_read_b64_tr_b16 a[64:65], v18 offset:57344
  ds_read_b64_tr_b16 a[66:67], v18 offset:57856
  v_mul_f32 v26, v26, v2
  v_mul_f32 v27, v27, v5
  v_cvt_pk_bf16_f32 v54, v22, v23
  v_cvt_pk_bf16_f32 v55, v26, v27
  v_mfma_f32_32x32x16_bf16 v[112:127], a[76:79], v[192:195], v[112:127]
  s_waitcnt lgkmcnt(9)
  ds_read_b64_tr_b16 a[68:69], v19 offset:57344
  ds_read_b64_tr_b16 a[70:71], v19 offset:57856
  v_add_u32 v3, s61, v7
  v_add_u32 v43, s82, v17
  v_add_u32 v40, 49152, v37
  v_mfma_f32_32x32x16_bf16 v[64:79], a[80:83], v[196:199], v[64:79]
  s_waitcnt lgkmcnt(9)
  ds_read_b64_tr_b16 a[72:73], v20 offset:57344
  ds_read_b64_tr_b16 a[74:75], v20 offset:57856
  ds_write_b128 v13, a[240:243] offset:4096
  v_mfma_f32_32x32x16_bf16 v[80:95], a[84:87], v[196:199], v[80:95]
  s_waitcnt lgkmcnt(10)
  ds_read_b64_tr_b16 a[76:77], v21 offset:57344
  ds_read_b64_tr_b16 a[78:79], v21 offset:57856
  v_add_u32 v18, 61440, v18
  v_add_u32 v19, 61440, v19
  v_add_u32 v20, 61440, v20
  v_add_u32 v21, 61440, v21
  v_mfma_f32_32x32x16_bf16 v[96:111], a[88:91], v[196:199], v[96:111]
  s_waitcnt lgkmcnt(9)
  ds_read_b64_tr_b16 a[80:81], v18 offset:0
  ds_read_b64_tr_b16 a[82:83], v18 offset:512
  v_mfma_f32_32x32x16_bf16 v[112:127], a[92:95], v[196:199], v[112:127]
  s_waitcnt lgkmcnt(9)
  ds_read_b64_tr_b16 a[84:85], v19 offset:0
  ds_read_b64_tr_b16 a[86:87], v19 offset:512
  v_and_b32 v40, 0xffff, v40
  v_mfma_f32_32x32x16_bf16 v[64:79], a[64:67], v[200:203], v[64:79]
  s_waitcnt lgkmcnt(9)
  ds_read_b64_tr_b16 a[88:89], v20 offset:0
  ds_read_b64_tr_b16 a[90:91], v20 offset:512
  v_mfma_f32_32x32x16_bf16 v[80:95], a[68:71], v[200:203], v[80:95]
  s_waitcnt lgkmcnt(9)
  ds_read_b64_tr_b16 a[92:93], v21 offset:0
  ds_read_b64_tr_b16 a[94:95], v21 offset:512
  s_add_u32 s80, s38, s68
  s_addc_u32 s81, s39, 0
  v_mfma_f32_32x32x16_bf16 v[96:111], a[72:75], v[200:203], v[96:111]
  s_waitcnt lgkmcnt(8)
  ds_read_b64_tr_b16 a[64:65], v18 offset:20480
  ds_read_b64_tr_b16 a[66:67], v18 offset:20992
  s_add_u32 s82, s38, s69
  s_addc_u32 s83, s39, 0
  v_mfma_f32_32x32x16_bf16 v[112:127], a[76:79], v[200:203], v[112:127]
  s_waitcnt lgkmcnt(8)
  ds_read_b64_tr_b16 a[68:69], v19 offset:20480
  ds_read_b64_tr_b16 a[70:71], v19 offset:20992
  v_mfma_f32_32x32x16_bf16 v[64:79], a[80:83], v[204:207], v[64:79]
  s_waitcnt lgkmcnt(8)
  ds_read_b64_tr_b16 a[72:73], v20 offset:20480
  ds_read_b64_tr_b16 a[74:75], v20 offset:20992
  v_mfma_f32_32x32x16_bf16 v[80:95], a[84:87], v[204:207], v[80:95]
  s_waitcnt lgkmcnt(8)
  ds_read_b64_tr_b16 a[76:77], v21 offset:20480
  ds_read_b64_tr_b16 a[78:79], v21 offset:20992
  v_mfma_f32_32x32x16_bf16 v[96:111], a[88:91], v[204:207], v[96:111]
  s_waitcnt lgkmcnt(8)
  ds_read_b64_tr_b16 a[80:81], v18 offset:24576
  ds_read_b64_tr_b16 a[82:83], v18 offset:25088
  s_add_u32 s12, s38, s72
  s_addc_u32 s13, s39, 0
  v_mfma_f32_32x32x16_bf16 v[112:127], a[92:95], v[204:207], v[112:127]
  s_waitcnt lgkmcnt(8)
  ds_read_b64_tr_b16 a[84:85], v19 offset:24576
  ds_read_b64_tr_b16 a[86:87], v19 offset:25088
  s_add_u32 m0, s43, 0
  v_mfma_f32_32x32x16_bf16 v[64:79], a[64:67], v[208:211], v[64:79]
  s_waitcnt lgkmcnt(8)
  ds_read_b64_tr_b16 a[88:89], v20 offset:24576
  ds_read_b64_tr_b16 a[90:91], v20 offset:25088
  s_waitcnt vmcnt(0)
  v_cmp_ne_u32 vcc, s94, v12
  s_cbranch_vccnz mk_pqB_spin
mk_pqB_ok:
  v_mfma_f32_32x32x16_bf16 v[80:95], a[68:71], v[208:211], v[80:95]
  s_waitcnt lgkmcnt(8)
  ds_read_b64_tr_b16 a[92:93], v21 offset:24576
  ds_read_b64_tr_b16 a[94:95], v21 offset:25088
  global_load_lds_dwordx4 v37, s[80:81] offset:0 sc1
  v_mfma_f32_32x32x16_bf16 v[96:111], a[72:75], v[208:211], v[96:111]
  s_waitcnt lgkmcnt(8)
  ds_read_b64_tr_b16 a[64:65], v18 offset:28672
  ds_read_b64_tr_b16 a[66:67], v18 offset:29184
  s_add_u32 s14, s38, s74
  s_addc_u32 s15, s39, 0
  v_mfma_f32_32x32x16_bf16 v[112:127], a[76:79], v[208:211], v[112:127]
  s_waitcnt lgkmcnt(8)
  ds_read_b64_tr_b16 a[68:69], v19 offset:28672
  ds_read_b64_tr_b16 a[70:71], v19 offset:29184
  v_mfma_f32_32x32x16_bf16 v[64:79], a[80:83], v[212:215], v[64:79]
  s_waitcnt lgkmcnt(8)
  ds_read_b64_tr_b16 a[72:73], v20 offset:28672
  ds_read_b64_tr_b16 a[74:75], v20 offset:29184
  global_load_lds_dwordx4 v37, s[80:81] offset:1024 sc1
  v_mfma_f32_32x32x16_bf16 v[80:95], a[84:87], v[212:215], v[80:95]
  s_waitcnt lgkmcnt(8)
  ds_read_b64_tr_b16 a[76:77], v21 offset:28672
  ds_read_b64_tr_b16 a[78:79], v21 offset:29184
  v_mfma_f32_32x32x16_bf16 v[96:111], a[88:91], v[212:215], v[96:111]
  s_waitcnt lgkmcnt(8)
  ds_read_b64_tr_b16 a[80:81], v18 offset:32768
  ds_read_b64_tr_b16 a[82:83], v18 offset:33280
  s_add_u32 s16, s38, s73
  s_addc_u32 s17, s39, 0
  v_mfma_f32_32x32x16_bf16 v[112:127], a[92:95], v[212:215], v[112:127]
  s_waitcnt lgkmcnt(8)
  ds_read_b64_tr_b16 a[84:85], v19 offset:32768
  ds_read_b64_tr_b16 a[86:87], v19 offset:33280
  global_load_lds_dwordx4 v37, s[80:81] offset:2048 sc1
  v_mfma_f32_32x32x16_bf16 v[64:79], a[64:67], v[216:219], v[64:79]
  s_waitcnt lgkmcnt(8)
  ds_read_b64_tr_b16 a[88:89], v20 offset:32768
  ds_read_b64_tr_b16 a[90:91], v20 offset:33280
  v_mfma_f32_32x32x16_bf16 v[80:95], a[68:71], v[216:219], v[80:95]
  s_waitcnt lgkmcnt(8)
  ds_read_b64_tr_b16 a[92:93], v21 offset:32768
  ds_read_b64_tr_b16 a[94:95], v21 offset:33280
  v_mfma_f32_32x32x16_bf16 v[96:111], a[72:75], v[216:219], v[96:111]
  s_waitcnt lgkmcnt(8)
  ds_read_b64_tr_b16 a[64:65], v18 offset:36864
  ds_read_b64_tr_b16 a[66:67], v18 offset:37376
  global_load_lds_dwordx4 v37, s[80:81] offset:3072 sc1
  s_add_u32 s18, s38, s75
  s_addc_u32 s19, s39, 0
  v_mfma_f32_32x32x16_bf16 v[112:127], a[76:79], v[216:219], v[112:127]
  s_waitcnt lgkmcnt(8)
  ds_read_b64_tr_b16 a[68:69], v19 offset:36864
  ds_read_b64_tr_b16 a[70:71], v19 offset:37376
  v_mfma_f32_32x32x16_bf16 v[64:79], a[80:83], v[220:223], v[64:79]
  s_waitcnt lgkmcnt(8)
  ds_read_b64_tr_b16 a[72:73], v20 offset:36864
  ds_read_b64_tr_b16 a[74:75], v20 offset:37376
  v_mfma_f32_32x32x16_bf16 v[80:95], a[84:87], v[220:223], v[80:95]
  s_waitcnt lgkmcnt(8)
  ds_read_b64_tr_b16 a[76:77], v21 offset:36864
  ds_read_b64_tr_b16 a[78:79], v21 offset:37376
  buffer_load_dwordx4 v[128:131], v7, s[24:27], s70 offen offset:0 sc1
  s_add_u32 m0, s43, 65536
  v_mfma_f32_32x32x16_bf16 v[96:111], a[88:91], v[220:223], v[96:111]
  s_waitcnt lgkmcnt(8)
  ds_read_b64_tr_b16 a[80:81], v18 offset:40960
  ds_read_b64_tr_b16 a[82:83], v18 offset:41472
  s_mul_i32 s56, s40, 20480
  s_add_u32 s56, s56, 32768
  v_mfma_f32_32x32x16_bf16 v[112:127], a[92:95], v[220:223], v[112:127]
  s_waitcnt lgkmcnt(8)
  ds_read_b64_tr_b16 a[84:85], v19 offset:40960
  ds_read_b64_tr_b16 a[86:87], v19 offset:41472
  v_mfma_f32_32x32x16_bf16 v[64:79], a[64:67], v[224:227], v[64:79]
  s_waitcnt lgkmcnt(8)
  ds_read_b64_tr_b16 a[88:89], v20 offset:40960
  ds_read_b64_tr_b16 a[90:91], v20 offset:41472
  v_mfma_f32_32x32x16_bf16 v[80:95], a[68:71], v[224:227], v[80:95]
  s_waitcnt lgkmcnt(8)
  ds_read_b64_tr_b16 a[92:93], v21 offset:40960
  ds_read_b64_tr_b16 a[94:95], v21 offset:41472
  buffer_load_dwordx4 v[132:135], v7, s[24:27], s70 offen offset:1024 sc1
  v_mfma_f32_32x32x16_bf16 v[96:111], a[72:75], v[224:227], v[96:111]
  s_waitcnt lgkmcnt(8)
  ds_read_b64_tr_b16 a[64:65], v18 offset:45056
  ds_read_b64_tr_b16 a[66:67], v18 offset:45568
  v_mfma_f32_32x32x16_bf16 v[112:127], a[76:79], v[224:227], v[112:127]
  s_waitcnt lgkmcnt(8)
  ds_read_b64_tr_b16 a[68:69], v19 offset:45056
  ds_read_b64_tr_b16 a[70:71], v19 offset:45568
  v_mfma_f32_32x32x16_bf16 v[64:79], a[80:83], v[228:231], v[64:79]
  s_waitcnt lgkmcnt(8)
  ds_read_b64_tr_b16 a[72:73], v20 offset:45056
  ds_read_b64_tr_b16 a[74:75], v20 offset:45568
  global_load_lds_dwordx4 v37, s[82:83] offset:0 sc1
  v_mfma_f32_32x32x16_bf16 v[80:95], a[84:87], v[228:231], v[80:95]
  s_waitcnt lgkmcnt(8)
  ds_read_b64_tr_b16 a[76:77], v21 offset:45056
  ds_read_b64_tr_b16 a[78:79], v21 offset:45568
  v_mfma_f32_32x32x16_bf16 v[96:111], a[88:91], v[228:231], v[96:111]
  s_waitcnt lgkmcnt(8)
  ds_read_b64_tr_b16 a[80:81], v18 offset:49152
  ds_read_b64_tr_b16 a[82:83], v18 offset:49664
  v_mfma_f32_32x32x16_bf16 v[112:127], a[92:95], v[228:231], v[112:127]
  s_waitcnt lgkmcnt(8)
  ds_read_b64_tr_b16 a[84:85], v19 offset:49152
  ds_read_b64_tr_b16 a[86:87], v19 offset:49664
  global_load_lds_dwordx4 v37, s[82:83] offset:1024 sc1
  v_mfma_f32_32x32x16_bf16 v[64:79], a[64:67], v[232:235], v[64:79]
  s_waitcnt lgkmcnt(8)
  ds_read_b64_tr_b16 a[88:89], v20 offset:49152
  ds_read_b64_tr_b16 a[90:91], v20 offset:49664
  v_mfma_f32_32x32x16_bf16 v[80:95], a[68:71], v[232:235], v[80:95]
  s_waitcnt lgkmcnt(8)
  ds_read_b64_tr_b16 a[92:93], v21 offset:49152
  ds_read_b64_tr_b16 a[94:95], v21 offset:49664
  v_mfma_f32_32x32x16_bf16 v[96:111], a[72:75], v[232:235], v[96:111]
  s_waitcnt lgkmcnt(8)
  ds_read_b64_tr_b16 a[64:65], v18 offset:53248
  ds_read_b64_tr_b16 a[66:67], v18 offset:53760
  global_load_lds_dwordx4 v37, s[82:83] offset:2048 sc1
  v_mfma_f32_32x32x16_bf16 v[112:127], a[76:79], v[232:235], v[112:127]
  s_waitcnt lgkmcnt(8)
  ds_read_b64_tr_b16 a[68:69], v19 offset:53248
  ds_read_b64_tr_b16 a[70:71], v19 offset:53760
  v_mfma_f32_32x32x16_bf16 v[64:79], a[80:83], v[236:239], v[64:79]
  s_waitcnt lgkmcnt(8)
  ds_read_b64_tr_b16 a[72:73], v20 offset:53248
  ds_read_b64_tr_b16 a[74:75], v20 offset:53760
  v_mfma_f32_32x32x16_bf16 v[80:95], a[84:87], v[236:239], v[80:95]
  s_waitcnt lgkmcnt(8)
  ds_read_b64_tr_b16 a[76:77], v21 offset:53248
  ds_read_b64_tr_b16 a[78:79], v21 offset:53760
  global_load_lds_dwordx4 v37, s[82:83] offset:3072 sc1
  v_mfma_f32_32x32x16_bf16 v[96:111], a[88:91], v[236:239], v[96:111]
  s_waitcnt lgkmcnt(8)
  ds_read_b64_tr_b16 a[80:81], v18 offset:57344
  ds_read_b64_tr_b16 a[82:83], v18 offset:57856
  v_mfma_f32_32x32x16_bf16 v[112:127], a[92:95], v[236:239], v[112:127]
  s_waitcnt lgkmcnt(8)
  ds_read_b64_tr_b16 a[84:85], v19 offset:57344
  ds_read_b64_tr_b16 a[86:87], v19 offset:57856
  v_mfma_f32_32x32x16_bf16 v[64:79], a[64:67], v[240:243], v[64:79]
  s_waitcnt lgkmcnt(8)
  ds_read_b64_tr_b16 a[88:89], v20 offset:57344
  ds_read_b64_tr_b16 a[90:91], v20 offset:57856
  v_mfma_f32_32x32x16_bf16 v[80:95], a[68:71], v[240:243], v[80:95]
  s_waitcnt lgkmcnt(8)
  ds_read_b64_tr_b16 a[92:93], v21 offset:57344
  ds_read_b64_tr_b16 a[94:95], v21 offset:57856
  v_add_u32 v18, 61440, v18
  v_add_u32 v19, 61440, v19
  v_add_u32 v20, 61440, v20
  v_add_u32 v21, 61440, v21
  v_mfma_f32_32x32x16_bf16 v[96:111], a[72:75], v[240:243], v[96:111]
  s_waitcnt lgkmcnt(8)
  ds_read_b64_tr_b16 a[64:65], v18 offset:0
  ds_read_b64_tr_b16 a[66:67], v18 offset:512
  v_mfma_f32_32x32x16_bf16 v[112:127], a[76:79], v[240:243], v[112:127]
  s_waitcnt lgkmcnt(8)
  ds_read_b64_tr_b16 a[68:69], v19 offset:0
  ds_read_b64_tr_b16 a[70:71], v19 offset:512
  v_mfma_f32_32x32x16_bf16 v[64:79], a[80:83], v[244:247], v[64:79]
  s_waitcnt lgkmcnt(8)
  ds_read_b64_tr_b16 a[72:73], v20 offset:0
  ds_read_b64_tr_b16 a[74:75], v20 offset:512
  v_mfma_f32_32x32x16_bf16 v[80:95], a[84:87], v[244:247], v[80:95]
  s_waitcnt lgkmcnt(8)
  ds_read_b64_tr_b16 a[76:77], v21 offset:0
  ds_read_b64_tr_b16 a[78:79], v21 offset:512
  v_mfma_f32_32x32x16_bf16 v[96:111], a[88:91], v[244:247], v[96:111]
  s_waitcnt lgkmcnt(8)
  ds_read_b64_tr_b16 a[80:81], v18 offset:4096
  ds_read_b64_tr_b16 a[82:83], v18 offset:4608
  v_mfma_f32_32x32x16_bf16 v[112:127], a[92:95], v[244:247], v[112:127]
  s_waitcnt lgkmcnt(8)
  ds_read_b64_tr_b16 a[84:85], v19 offset:4096
  ds_read_b64_tr_b16 a[86:87], v19 offset:4608
  v_mfma_f32_32x32x16_bf16 v[64:79], a[64:67], v[248:251], v[64:79]
  s_waitcnt lgkmcnt(8)
  ds_read_b64_tr_b16 a[88:89], v20 offset:4096
  ds_read_b64_tr_b16 a[90:91], v20 offset:4608
  v_mfma_f32_32x32x16_bf16 v[80:95], a[68:71], v[248:251], v[80:95]
  s_waitcnt lgkmcnt(8)
  ds_read_b64_tr_b16 a[92:93], v21 offset:4096
  ds_read_b64_tr_b16 a[94:95], v21 offset:4608
mk_wB4:
  s_cbranch_execz mk_wJ3
  v_mfma_f32_32x32x16_bf16 v[96:111], a[72:75], v[248:251], v[96:111]
  s_waitcnt lgkmcnt(8)
  v_mfma_f32_32x32x16_bf16 v[112:127], a[76:79], v[248:251], v[112:127]
  s_waitcnt lgkmcnt(6)
  v_mfma_f32_32x32x16_bf16 v[64:79], a[80:83], v[252:255], v[64:79]
  s_waitcnt lgkmcnt(4)
  v_mfma_f32_32x32x16_bf16 v[80:95], a[84:87], v[252:255], v[80:95]
  s_waitcnt lgkmcnt(2)
  v_mfma_f32_32x32x16_bf16 v[96:111], a[88:91], v[252:255], v[96:111]
  s_waitcnt lgkmcnt(0)
  v_mfma_f32_32x32x16_bf16 v[112:127], a[92:95], v[252:255], v[112:127]
  s_waitcnt lgkmcnt(0)
  s_branch mk_join
.p2align 12
mk_typeC:
mk_wC0:
  s_cbranch_execz mk_wJ0
  s_barrier
  s_add_u32 s49, s44, 0
  s_and_b32 s49, s49, 7
  s_mul_i32 s49, s49, 229376
  s_add_u32 m0, s43, 131072
  s_add_u32 s49, s49, s47
  buffer_load_dwordx4 v13, s[16:19], s49 offen offset:0 lds
  buffer_load_dwordx4 v14, s[16:19], s49 offen offset:1024 lds
  s_waitcnt lgkmcnt(0)
  v_dot2c_f32_bf16 v64, s65, v192
  v_dot2c_f32_bf16 v68, v192, v192
  v_dot2c_f32_bf16 v65, s65, v193
  v_dot2c_f32_bf16 v69, v193, v193
  v_dot2c_f32_bf16 v66, s65, v194
  v_dot2c_f32_bf16 v70, v194, v194
  v_dot2c_f32_bf16 v67, s65, v195
  v_dot2c_f32_bf16 v71, v195, v195
  v_dot2c_f32_bf16 v64, s65, v196
  v_dot2c_f32_bf16 v68, v196, v196
  v_dot2c_f32_bf16 v65, s65, v197
  v_dot2c_f32_bf16 v69, v197, v197
  v_dot2c_f32_bf16 v66, s65, v198
  v_dot2c_f32_bf16 v70, v198, v198
  v_dot2c_f32_bf16 v67, s65, v199
  v_dot2c_f32_bf16 v71, v199, v199
  buffer_load_dwordx4 v15, s[20:23], s49 offen offset:2048 lds
  buffer_load_dwordx4 v16, s[20:23], s49 offen offset:3072 lds
  v_dot2c_f32_bf16 v64, s65, v200
  v_dot2c_f32_bf16 v68, v200, v200
  v_dot2c_f32_bf16 v65, s65, v201
  v_dot2c_f32_bf16 v69, v201, v201
  v_dot2c_f32_bf16 v66, s65, v202
  v_dot2c_f32_bf16 v70, v202, v202
  v_dot2c_f32_bf16 v67, s65, v203
  v_dot2c_f32_bf16 v71, v203, v203
  v_dot2c_f32_bf16 v64, s65, v204
  v_dot2c_f32_bf16 v68, v204, v204
  v_dot2c_f32_bf16 v65, s65, v205
  v_dot2c_f32_bf16 v69, v205, v205
  v_dot2c_f32_bf16 v66, s65, v206
  v_dot2c_f32_bf16 v70, v206, v206
  v_dot2c_f32_bf16 v67, s65, v207
  v_dot2c_f32_bf16 v71, v207, v207
  v_dot2c_f32_bf16 v64, s65, v208
  v_dot2c_f32_bf16 v68, v208, v208
  v_dot2c_f32_bf16 v65, s65, v209
  v_dot2c_f32_bf16 v69, v209, v209
  v_dot2c_f32_bf16 v66, s65, v210
  v_dot2c_f32_bf16 v70, v210, v210
  v_dot2c_f32_bf16 v67, s65, v211
  v_dot2c_f32_bf16 v71, v211, v211
  v_dot2c_f32_bf16 v64, s65, v212
  v_dot2c_f32_bf16 v68, v212, v212
  v_dot2c_f32_bf16 v65, s65, v213
  v_dot2c_f32_bf16 v69, v213, v213
  v_dot2c_f32_bf16 v66, s65, v214
  v_dot2c_f32_bf16 v70, v214, v214
  v_dot2c_f32_bf16 v67, s65, v215
  v_dot2c_f32_bf16 v71, v215, v215
  v_dot2c_f32_bf16 v64, s65, v216
  v_dot2c_f32_bf16 v68, v216, v216
  v_dot2c_f32_bf16 v65, s65, v217
  v_dot2c_f32_bf16 v69, v217, v217
  v_dot2c_f32_bf16 v66, s65, v218
  v_dot2c_f32_bf16 v70, v218, v218
  v_dot2c_f32_bf16 v67, s65, v219
  v_dot2c_f32_bf16 v71, v219, v219
  v_dot2c_f32_bf16 v64, s65, v220
  v_dot2c_f32_bf16 v68, v220, v220
  v_dot2c_f32_bf16 v65, s65, v221
  v_dot2c_f32_bf16 v69, v221, v221
  v_dot2c_f32_bf16 v66, s65, v222
  v_dot2c_f32_bf16 v70, v222, v222
  v_dot2c_f32_bf16 v67, s65, v223
  v_dot2c_f32_bf16 v71, v223, v223
  s_waitcnt vmcnt(4)
  ds_read_b128 v[224:227], v56 offset:24576
  ds_read_b128 v[228:231], v57 offset:24576
  ds_read_b128 v[232:235], v58 offset:24576
  ds_read_b128 v[236:239], v59 offset:24576
  ds_read_b128 v[240:243], v60 offset:24576
  ds_read_b128 v[244:247], v61 offset:24576
  ds_read_b128 v[248:251], v62 offset:24576
  ds_read_b128 v[252:255], v63 offset:24576
  s_waitcnt lgkmcnt(0)
  s_barrier
  v_dot2c_f32_bf16 v64, s65, v224
  v_dot2c_f32_bf16 v68, v224, v224
  v_dot2c_f32_bf16 v65, s65, v225
  v_dot2c_f32_bf16 v69, v225, v225
  v_dot2c_f32_bf16 v66, s65, v226
  v_dot2c_f32_bf16 v70, v226, v226
  v_dot2c_f32_bf16 v67, s65, v227
  v_dot2c_f32_bf16 v71, v227, v227
  v_dot2c_f32_bf16 v64, s65, v228
  v_dot2c_f32_bf16 v68, v228, v228
  v_dot2c_f32_bf16 v65, s65, v229
  v_dot2c_f32_bf16 v69, v229, v229
  v_dot2c_f32_bf16 v66, s65, v230
  v_dot2c_f32_bf16 v70, v230, v230
  v_dot2c_f32_bf16 v67, s65, v231
  v_dot2c_f32_bf16 v71, v231, v231
  v_dot2c_f32_bf16 v64, s65, v232
  v_dot2c_f32_bf16 v68, v232, v232
  v_dot2c_f32_bf16 v65, s65, v233
  v_dot2c_f32_bf16 v69, v233, v233
  v_dot2c_f32_bf16 v66, s65, v234
  v_dot2c_f32_bf16 v70, v234, v234
  v_dot2c_f32_bf16 v67, s65, v235
  v_dot2c_f32_bf16 v71, v235, v235
  v_dot2c_f32_bf16 v64, s65, v236
  v_dot2c_f32_bf16 v68, v236, v236
  v_dot2c_f32_bf16 v65, s65, v237
  v_dot2c_f32_bf16 v69, v237, v237
  v_dot2c_f32_bf16 v66, s65, v238
  v_dot2c_f32_bf16 v70, v238, v238
  v_dot2c_f32_bf16 v67, s65, v239
  v_dot2c_f32_bf16 v71, v239, v239
  v_dot2c_f32_bf16 v64, s65, v240
  v_dot2c_f32_bf16 v68, v240, v240
  v_dot2c_f32_bf16 v65, s65, v241
  v_dot2c_f32_bf16 v69, v241, v241
  v_dot2c_f32_bf16 v66, s65, v242
  v_dot2c_f32_bf16 v70, v242, v242
  v_dot2c_f32_bf16 v67, s65, v243
  v_dot2c_f32_bf16 v71, v243, v243
  v_dot2c_f32_bf16 v64, s65, v244
  v_dot2c_f32_bf16 v68, v244, v244
  v_dot2c_f32_bf16 v65, s65, v245
  v_dot2c_f32_bf16 v69, v245, v245
  v_dot2c_f32_bf16 v66, s65, v246
  v_dot2c_f32_bf16 v70, v246, v246
  v_dot2c_f32_bf16 v67, s65, v247
  v_dot2c_f32_bf16 v71, v247, v247
  v_dot2c_f32_bf16 v64, s65, v248
  v_dot2c_f32_bf16 v68, v248, v248
  v_dot2c_f32_bf16 v65, s65, v249
  v_dot2c_f32_bf16 v69, v249, v249
  v_dot2c_f32_bf16 v66, s65, v250
  v_dot2c_f32_bf16 v70, v250, v250
  v_dot2c_f32_bf16 v67, s65, v251
  v_dot2c_f32_bf16 v71, v251, v251
  v_dot2c_f32_bf16 v64, s65, v252
  v_dot2c_f32_bf16 v68, v252, v252
  v_dot2c_f32_bf16 v65, s65, v253
  v_dot2c_f32_bf16 v69, v253, v253
  v_dot2c_f32_bf16 v66, s65, v254
  v_dot2c_f32_bf16 v70, v254, v254
  v_dot2c_f32_bf16 v67, s65, v255
  v_dot2c_f32_bf16 v71, v255, v255
  s_nop 2
  v_add_f32 v64, v64, v65
  v_add_f32 v66, v66, v67
  v_add_f32 v68, v68, v69
  v_add_f32 v70, v70, v71
  v_add_f32 v64, v64, v66
  v_add_f32 v68, v68, v70
  v_mov_b32 v65, v64
  v_mov_b32 v69, v68
  s_nop 1
  v_permlane32_swap_b32 v64, v65
  v_permlane32_swap_b32 v68, v69
  v_add_f32 v64, v64, v65
  v_add_f32 v68, v68, v69
  v_mul_f32 v64, 0x3b000000, v64
  v_mul_f32 v68, 0x3b000000, v68
  v_fma_f32 v68, -v64, v64, v68
  v_max_f32 v68, 0, v68
  v_cvt_pk_bf16_f32 v22, v64, v68
  v_lshlrev_b32 v2, 16, v22
  v_xor_b32 v2, 0x80000000, v2
  v_dot2_f32_bf16 v32, v128, s56, v2
  v_dot2_f32_bf16 v33, v128, s57, v2
  v_dot2_f32_bf16 v34, v129, s56, v2
  v_dot2_f32_bf16 v35, v129, s57, v2
  v_dot2_f32_bf16 v36, v130, s56, v2
  v_dot2_f32_bf16 v37, v130, s57, v2
  v_dot2_f32_bf16 v38, v131, s56, v2
  v_dot2_f32_bf16 v39, v131, s57, v2
  v_dot2_f32_bf16 v40, v132, s56, v2
  v_dot2_f32_bf16 v41, v132, s57, v2
  v_cvt_pk_bf16_f32 v128, v32, v33
  v_dot2_f32_bf16 v42, v133, s56, v2
  v_dot2_f32_bf16 v43, v133, s57, v2
  v_cvt_pk_bf16_f32 v129, v34, v35
  v_dot2_f32_bf16 v44, v134, s56, v2
  v_dot2_f32_bf16 v45, v134, s57, v2
  v_cvt_pk_bf16_f32 v130, v36, v37
  v_dot2_f32_bf16 v46, v135, s56, v2
  v_dot2_f32_bf16 v47, v135, s57, v2
  v_cvt_pk_bf16_f32 v131, v38, v39
  v_dot2_f32_bf16 v32, v136, s56, v2
  v_dot2_f32_bf16 v33, v136, s57, v2
  v_cvt_pk_bf16_f32 v132, v40, v41
  s_add_u32 s49, s44, 1
  s_and_b32 s49, s49, 7
  s_mul_i32 s49, s49, 229376
  s_add_u32 m0, s43, 147456
  s_add_u32 s49, s49, s47
  buffer_load_dwordx4 v13, s[16:19], s49 offen offset:0 lds
  buffer_load_dwordx4 v14, s[16:19], s49 offen offset:1024 lds
  buffer_load_dwordx4 v15, s[20:23], s49 offen offset:2048 lds
  buffer_load_dwordx4 v16, s[20:23], s49 offen offset:3072 lds
  v_dot2_f32_bf16 v34, v137, s56, v2
  v_dot2_f32_bf16 v35, v137, s57, v2
  v_cvt_pk_bf16_f32 v133, v42, v43
  v_dot2_f32_bf16 v36, v138, s56, v2
  v_dot2_f32_bf16 v37, v138, s57, v2
  v_cvt_pk_bf16_f32 v134, v44, v45
  v_dot2_f32_bf16 v38, v139, s56, v2
  v_dot2_f32_bf16 v39, v139, s57, v2
  v_cvt_pk_bf16_f32 v135, v46, v47
  v_dot2_f32_bf16 v40, v140, s56, v2
  v_dot2_f32_bf16 v41, v140, s57, v2
  v_cvt_pk_bf16_f32 v136, v32, v33
  v_dot2_f32_bf16 v42, v141, s56, v2
  v_dot2_f32_bf16 v43, v141, s57, v2
  v_cvt_pk_bf16_f32 v137, v34, v35
  v_dot2_f32_bf16 v44, v142, s56, v2
  v_dot2_f32_bf16 v45, v142, s57, v2
  v_cvt_pk_bf16_f32 v138, v36, v37
  v_dot2_f32_bf16 v46, v143, s56, v2
  v_dot2_f32_bf16 v47, v143, s57, v2
  v_cvt_pk_bf16_f32 v139, v38, v39
  v_dot2_f32_bf16 v32, v144, s56, v2
  v_dot2_f32_bf16 v33, v144, s57, v2
  v_cvt_pk_bf16_f32 v140, v40, v41
  v_dot2_f32_bf16 v34, v145, s56, v2
  v_dot2_f32_bf16 v35, v145, s57, v2
  v_cvt_pk_bf16_f32 v141, v42, v43
  v_dot2_f32_bf16 v36, v146, s56, v2
  v_dot2_f32_bf16 v37, v146, s57, v2
  v_cvt_pk_bf16_f32 v142, v44, v45
  v_dot2_f32_bf16 v38, v147, s56, v2
  v_dot2_f32_bf16 v39, v147, s57, v2
  v_cvt_pk_bf16_f32 v143, v46, v47
  v_dot2_f32_bf16 v40, v148, s56, v2
  v_dot2_f32_bf16 v41, v148, s57, v2
  v_cvt_pk_bf16_f32 v144, v32, v33
  v_dot2_f32_bf16 v42, v149, s56, v2
  v_dot2_f32_bf16 v43, v149, s57, v2
  v_cvt_pk_bf16_f32 v145, v34, v35
  v_dot2_f32_bf16 v44, v150, s56, v2
  v_dot2_f32_bf16 v45, v150, s57, v2
  v_cvt_pk_bf16_f32 v146, v36, v37
  v_dot2_f32_bf16 v46, v151, s56, v2
  v_dot2_f32_bf16 v47, v151, s57, v2
  v_cvt_pk_bf16_f32 v147, v38, v39
  v_dot2_f32_bf16 v32, v152, s56, v2
  v_dot2_f32_bf16 v33, v152, s57, v2
  v_cvt_pk_bf16_f32 v148, v40, v41
  v_dot2_f32_bf16 v34, v153, s56, v2
  v_dot2_f32_bf16 v35, v153, s57, v2
  v_cvt_pk_bf16_f32 v149, v42, v43
  v_dot2_f32_bf16 v36, v154, s56, v2
  v_dot2_f32_bf16 v37, v154, s57, v2
  v_cvt_pk_bf16_f32 v150, v44, v45
  v_dot2_f32_bf16 v38, v155, s56, v2
  v_dot2_f32_bf16 v39, v155, s57, v2
  v_cvt_pk_bf16_f32 v151, v46, v47
  v_dot2_f32_bf16 v40, v156, s56, v2
  v_dot2_f32_bf16 v41, v156, s57, v2
  v_cvt_pk_bf16_f32 v152, v32, v33
  v_dot2_f32_bf16 v42, v157, s56, v2
  v_dot2_f32_bf16 v43, v157, s57, v2
  v_cvt_pk_bf16_f32 v153, v34, v35
  v_dot2_f32_bf16 v44, v158, s56, v2
  v_dot2_f32_bf16 v45, v158, s57, v2
  v_cvt_pk_bf16_f32 v154, v36, v37
  v_dot2_f32_bf16 v46, v159, s56, v2
  v_dot2_f32_bf16 v47, v159, s57, v2
  v_cvt_pk_bf16_f32 v155, v38, v39
  v_dot2_f32_bf16 v32, v160, s56, v2
  v_dot2_f32_bf16 v33, v160, s57, v2
  v_cvt_pk_bf16_f32 v156, v40, v41
  s_add_u32 s49, s44, 2
  s_and_b32 s49, s49, 7
  s_mul_i32 s49, s49, 229376
  s_add_u32 m0, s43, 0
  s_add_u32 s49, s49, s47
  buffer_load_dwordx4 v13, s[16:19], s49 offen offset:0 lds
  buffer_load_dwordx4 v14, s[16:19], s49 offen offset:1024 lds
  buffer_load_dwordx4 v15, s[20:23], s49 offen offset:2048 lds
  buffer_load_dwordx4 v16, s[20:23], s49 offen offset:3072 lds
  v_dot2_f32_bf16 v34, v161, s56, v2
  v_dot2_f32_bf16 v35, v161, s57, v2
  v_cvt_pk_bf16_f32 v157, v42, v43
  v_dot2_f32_bf16 v36, v162, s56, v2
  v_dot2_f32_bf16 v37, v162, s57, v2
  v_cvt_pk_bf16_f32 v158, v44, v45
  v_dot2_f32_bf16 v38, v163, s56, v2
  v_dot2_f32_bf16 v39, v163, s57, v2
  v_cvt_pk_bf16_f32 v159, v46, v47
  v_dot2_f32_bf16 v40, v164, s56, v2
  v_dot2_f32_bf16 v41, v164, s57, v2
  v_cvt_pk_bf16_f32 v160, v32, v33
  v_dot2_f32_bf16 v42, v165, s56, v2
  v_dot2_f32_bf16 v43, v165, s57, v2
  v_cvt_pk_bf16_f32 v161, v34, v35
  v_dot2_f32_bf16 v44, v166, s56, v2
  v_dot2_f32_bf16 v45, v166, s57, v2
  v_cvt_pk_bf16_f32 v162, v36, v37
  v_dot2_f32_bf16 v46, v167, s56, v2
  v_dot2_f32_bf16 v47, v167, s57, v2
  v_cvt_pk_bf16_f32 v163, v38, v39
  v_dot2_f32_bf16 v32, v168, s56, v2
  v_dot2_f32_bf16 v33, v168, s57, v2
  v_cvt_pk_bf16_f32 v164, v40, v41
  v_dot2_f32_bf16 v34, v169, s56, v2
  v_dot2_f32_bf16 v35, v169, s57, v2
  v_cvt_pk_bf16_f32 v165, v42, v43
  v_dot2_f32_bf16 v36, v170, s56, v2
  v_dot2_f32_bf16 v37, v170, s57, v2
  v_cvt_pk_bf16_f32 v166, v44, v45
  v_dot2_f32_bf16 v38, v171, s56, v2
  v_dot2_f32_bf16 v39, v171, s57, v2
  v_cvt_pk_bf16_f32 v167, v46, v47
  v_dot2_f32_bf16 v40, v172, s56, v2
  v_dot2_f32_bf16 v41, v172, s57, v2
  v_cvt_pk_bf16_f32 v168, v32, v33
  v_dot2_f32_bf16 v42, v173, s56, v2
  v_dot2_f32_bf16 v43, v173, s57, v2
  v_cvt_pk_bf16_f32 v169, v34, v35
  v_dot2_f32_bf16 v44, v174, s56, v2
  v_dot2_f32_bf16 v45, v174, s57, v2
  v_cvt_pk_bf16_f32 v170, v36, v37
  v_dot2_f32_bf16 v46, v175, s56, v2
  v_dot2_f32_bf16 v47, v175, s57, v2
  v_cvt_pk_bf16_f32 v171, v38, v39
  v_dot2_f32_bf16 v32, v176, s56, v2
  v_dot2_f32_bf16 v33, v176, s57, v2
  v_cvt_pk_bf16_f32 v172, v40, v41
  v_dot2_f32_bf16 v34, v177, s56, v2
  v_dot2_f32_bf16 v35, v177, s57, v2
  v_cvt_pk_bf16_f32 v173, v42, v43
  v_dot2_f32_bf16 v36, v178, s56, v2
  v_dot2_f32_bf16 v37, v178, s57, v2
  v_cvt_pk_bf16_f32 v174, v44, v45
  v_dot2_f32_bf16 v38, v179, s56, v2
  v_dot2_f32_bf16 v39, v179, s57, v2
  v_cvt_pk_bf16_f32 v175, v46, v47
  v_dot2_f32_bf16 v40, v180, s56, v2
  v_dot2_f32_bf16 v41, v180, s57, v2
  v_cvt_pk_bf16_f32 v176, v32, v33
  v_dot2_f32_bf16 v42, v181, s56, v2
  v_dot2_f32_bf16 v43, v181, s57, v2
  v_cvt_pk_bf16_f32 v177, v34, v35
  v_dot2_f32_bf16 v44, v182, s56, v2
  v_dot2_f32_bf16 v45, v182, s57, v2
  v_cvt_pk_bf16_f32 v178, v36, v37
  v_dot2_f32_bf16 v46, v183, s56, v2
  v_dot2_f32_bf16 v47, v183, s57, v2
  v_cvt_pk_bf16_f32 v179, v38, v39
  v_dot2_f32_bf16 v32, v184, s56, v2
  v_dot2_f32_bf16 v33, v184, s57, v2
  v_cvt_pk_bf16_f32 v180, v40, v41
  s_add_u32 s49, s44, 3
  s_and_b32 s49, s49, 7
  s_mul_i32 s49, s49, 229376
  s_add_u32 m0, s43, 16384
  s_add_u32 s49, s49, s47
  buffer_load_dwordx4 v13, s[16:19], s49 offen offset:0 lds
  buffer_load_dwordx4 v14, s[16:19], s49 offen offset:1024 lds
  buffer_load_dwordx4 v15, s[20:23], s49 offen offset:2048 lds
  buffer_load_dwordx4 v16, s[20:23], s49 offen offset:3072 lds
  v_dot2_f32_bf16 v34, v185, s56, v2
  v_dot2_f32_bf16 v35, v185, s57, v2
  v_cvt_pk_bf16_f32 v181, v42, v43
  v_dot2_f32_bf16 v36, v186, s56, v2
  v_dot2_f32_bf16 v37, v186, s57, v2
  v_cvt_pk_bf16_f32 v182, v44, v45
  v_dot2_f32_bf16 v38, v187, s56, v2
  v_dot2_f32_bf16 v39, v187, s57, v2
  v_cvt_pk_bf16_f32 v183, v46, v47
  v_dot2_f32_bf16 v40, v188, s56, v2
  v_dot2_f32_bf16 v41, v188, s57, v2
  v_cvt_pk_bf16_f32 v184, v32, v33
  v_dot2_f32_bf16 v42, v189, s56, v2
  v_dot2_f32_bf16 v43, v189, s57, v2
  v_cvt_pk_bf16_f32 v185, v34, v35
  v_dot2_f32_bf16 v44, v190, s56, v2
  v_dot2_f32_bf16 v45, v190, s57, v2
  v_cvt_pk_bf16_f32 v186, v36, v37
  v_dot2_f32_bf16 v46, v191, s56, v2
  v_dot2_f32_bf16 v47, v191, s57, v2
  v_cvt_pk_bf16_f32 v187, v38, v39
  v_cvt_pk_bf16_f32 v188, v40, v41
  v_cvt_pk_bf16_f32 v189, v42, v43
  v_cvt_pk_bf16_f32 v190, v44, v45
  v_cvt_pk_bf16_f32 v191, v46, v47
  v_and_b32 v22, 0xffff0000, v22
  v_add_f32 v22, 0x3727c5ac, v22
  v_cvt_pk_bf16_f32 v22, v22, v22
  v_and_b32 v22, 0xffff0000, v22
  v_sqrt_f32 v22, v22
  s_nop 0
  v_cvt_pk_bf16_f32 v22, v22, v22
  v_and_b32 v22, 0xffff0000, v22
  v_rcp_f32 v5, v22
  v_mul_f32 v6, v22, v22
  v_mul_f32 v3, s60, v5
  v_mul_f32 v4, 0xbfb8aa3b, v5
  s_waitcnt vmcnt(12)
  s_barrier
  v_bfe_u32 v18, v1, 4, 1
  v_lshl_add_u32 v18, v18, 11, v9
  v_add_u32 v18, 122880, v18
  v_xor_b32 v19, 32, v18
  v_xor_b32 v20, 64, v18
  v_xor_b32 v21, 96, v18
  ds_read_b64_tr_b16 a[64:65], v18 offset:8192
  ds_read_b64_tr_b16 a[66:67], v18 offset:8704
  ds_read_b64_tr_b16 a[68:69], v19 offset:8192
  ds_read_b64_tr_b16 a[70:71], v19 offset:8704
  ds_read_b64_tr_b16 a[72:73], v20 offset:8192
  ds_read_b64_tr_b16 a[74:75], v20 offset:8704
  ds_read_b64_tr_b16 a[76:77], v21 offset:8192
  ds_read_b64_tr_b16 a[78:79], v21 offset:8704
  ds_read_b64_tr_b16 a[80:81], v18 offset:12288
  ds_read_b64_tr_b16 a[82:83], v18 offset:12800
  ds_read_b64_tr_b16 a[84:85], v19 offset:12288
  ds_read_b64_tr_b16 a[86:87], v19 offset:12800
  s_waitcnt lgkmcnt(10)
  v_mfma_f32_32x32x16_bf16 a[0:15], a[64:67], v[128:131], 0
  s_waitcnt lgkmcnt(8)
  ds_read_b64_tr_b16 a[88:89], v20 offset:12288
  ds_read_b64_tr_b16 a[90:91], v20 offset:12800
  v_lshlrev_b32 v32, 16, v192
  s_add_u32 s49, s44, 4
  s_and_b32 s49, s49, 7
  s_mul_i32 s49, s49, 229376
  v_mfma_f32_32x32x16_bf16 a[16:31], a[68:71], v[128:131], 0
  s_waitcnt lgkmcnt(8)
  ds_read_b64_tr_b16 a[92:93], v21 offset:12288
  ds_read_b64_tr_b16 a[94:95], v21 offset:12800
  v_and_b32 v33, s90, v192
  v_lshlrev_b32 v34, 16, v193
  s_add_u32 m0, s43, 32768
  s_add_u32 s49, s49, s47
  v_mfma_f32_32x32x16_bf16 a[32:47], a[72:75], v[128:131], 0
  s_waitcnt lgkmcnt(8)
  ds_read_b64_tr_b16 a[64:65], v18 offset:16384
  ds_read_b64_tr_b16 a[66:67], v18 offset:16896
  buffer_load_dwordx4 v13, s[16:19], s49 offen offset:0 lds
  v_and_b32 v35, s90, v193
  v_add_f32 v32, v32, v2
  v_mfma_f32_32x32x16_bf16 a[48:63], a[76:79], v[128:131], 0
  s_waitcnt lgkmcnt(8)
  ds_read_b64_tr_b16 a[68:69], v19 offset:16384
  ds_read_b64_tr_b16 a[70:71], v19 offset:16896
  buffer_load_dwordx4 v14, s[16:19], s49 offen offset:1024 lds
  v_add_f32 v33, v33, v2
  v_add_f32 v34, v34, v2
  v_mfma_f32_32x32x16_bf16 a[0:15], a[80:83], v[132:135], a[0:15]
  s_waitcnt lgkmcnt(8)
  ds_read_b64_tr_b16 a[72:73], v20 offset:16384
  ds_read_b64_tr_b16 a[74:75], v20 offset:16896
  v_add_f32 v35, v35, v2
  v_cvt_pk_bf16_f32 v192, v32, v33
  v_cvt_pk_bf16_f32 v193, v34, v35
  v_lshlrev_b32 v36, 16, v194
  v_mfma_f32_32x32x16_bf16 a[16:31], a[84:87], v[132:135], a[16:31]
  s_waitcnt lgkmcnt(8)
  ds_read_b64_tr_b16 a[76:77], v21 offset:16384
  ds_read_b64_tr_b16 a[78:79], v21 offset:16896
  v_and_b32 v37, s90, v194
  v_lshlrev_b32 v38, 16, v195
  v_and_b32 v39, s90, v195
  v_add_f32 v36, v36, v2
  v_mfma_f32_32x32x16_bf16 a[32:47], a[88:91], v[132:135], a[32:47]
  s_waitcnt lgkmcnt(8)
  ds_read_b64_tr_b16 a[80:81], v18 offset:20480
  ds_read_b64_tr_b16 a[82:83], v18 offset:20992
  buffer_load_dwordx4 v15, s[20:23], s49 offen offset:2048 lds
  v_add_f32 v37, v37, v2
  v_add_f32 v38, v38, v2
  v_mfma_f32_32x32x16_bf16 a[48:63], a[92:95], v[132:135], a[48:63]
  s_waitcnt lgkmcnt(8)
  ds_read_b64_tr_b16 a[84:85], v19 offset:20480
  ds_read_b64_tr_b16 a[86:87], v19 offset:20992
  buffer_load_dwordx4 v16, s[20:23], s49 offen offset:3072 lds
  v_add_f32 v39, v39, v2
  v_cvt_pk_bf16_f32 v194, v36, v37
  v_mfma_f32_32x32x16_bf16 a[0:15], a[64:67], v[136:139], a[0:15]
  s_waitcnt lgkmcnt(8)
  ds_read_b64_tr_b16 a[88:89], v20 offset:20480
  ds_read_b64_tr_b16 a[90:91], v20 offset:20992
  v_cvt_pk_bf16_f32 v195, v38, v39
  s_add_u32 s49, s44, 5
  s_and_b32 s49, s49, 7
  s_mul_i32 s49, s49, 229376
  v_mfma_f32_32x32x16_bf16 a[16:31], a[68:71], v[136:139], a[16:31]
  s_waitcnt lgkmcnt(8)
  ds_read_b64_tr_b16 a[92:93], v21 offset:20480
  ds_read_b64_tr_b16 a[94:95], v21 offset:20992
  v_lshlrev_b32 v40, 16, v196
  v_and_b32 v41, s90, v196
  s_add_u32 m0, s43, 49152
  s_add_u32 s49, s49, s47
  v_mfma_f32_32x32x16_bf16 a[32:47], a[72:75], v[136:139], a[32:47]
  s_waitcnt vmcnt(12) lgkmcnt(8)
  s_barrier
  ds_read_b64_tr_b16 a[64:65], v18 offset:24576
  ds_read_b64_tr_b16 a[66:67], v18 offset:25088
  buffer_load_dwordx4 v13, s[16:19], s49 offen offset:0 lds
  v_mfma_f32_32x32x16_bf16 a[48:63], a[76:79], v[136:139], a[48:63]
  s_waitcnt lgkmcnt(8)
  ds_read_b64_tr_b16 a[68:69], v19 offset:24576
  ds_read_b64_tr_b16 a[70:71], v19 offset:25088
  buffer_load_dwordx4 v14, s[16:19], s49 offen offset:1024 lds
  v_lshlrev_b32 v42, 16, v197
  v_and_b32 v43, s90, v197
  v_mfma_f32_32x32x16_bf16 a[0:15], a[80:83], v[140:143], a[0:15]
  s_waitcnt lgkmcnt(8)
  ds_read_b64_tr_b16 a[72:73], v20 offset:24576
  ds_read_b64_tr_b16 a[74:75], v20 offset:25088
  v_add_f32 v40, v40, v2
  v_add_f32 v41, v41, v2
  v_add_f32 v42, v42, v2
  v_add_f32 v43, v43, v2
  v_mfma_f32_32x32x16_bf16 a[16:31], a[84:87], v[140:143], a[16:31]
  s_waitcnt lgkmcnt(8)
  ds_read_b64_tr_b16 a[76:77], v21 offset:24576
  ds_read_b64_tr_b16 a[78:79], v21 offset:25088
  v_cvt_pk_bf16_f32 v196, v40, v41
  v_cvt_pk_bf16_f32 v197, v42, v43
  v_lshlrev_b32 v44, 16, v198
  v_and_b32 v45, s90, v198
  v_mfma_f32_32x32x16_bf16 a[32:47], a[88:91], v[140:143], a[32:47]
  s_waitcnt lgkmcnt(8)
  ds_read_b64_tr_b16 a[80:81], v18 offset:28672
  ds_read_b64_tr_b16 a[82:83], v18 offset:29184
  buffer_load_dwordx4 v15, s[20:23], s49 offen offset:2048 lds
  v_lshlrev_b32 v46, 16, v199
  v_and_b32 v47, s90, v199
  v_mfma_f32_32x32x16_bf16 a[48:63], a[92:95], v[140:143], a[48:63]
  s_waitcnt lgkmcnt(8)
  ds_read_b64_tr_b16 a[84:85], v19 offset:28672
  ds_read_b64_tr_b16 a[86:87], v19 offset:29184
  buffer_load_dwordx4 v16, s[20:23], s49 offen offset:3072 lds
  v_add_f32 v44, v44, v2
  v_add_f32 v45, v45, v2
  v_mfma_f32_32x32x16_bf16 a[0:15], a[64:67], v[144:147], a[0:15]
  s_waitcnt lgkmcnt(8)
  ds_read_b64_tr_b16 a[88:89], v20 offset:28672
  ds_read_b64_tr_b16 a[90:91], v20 offset:29184
  v_add_f32 v46, v46, v2
  s_add_u32 s49, s44, 6
  s_and_b32 s49, s49, 7
  s_mul_i32 s49, s49, 229376
  v_mfma_f32_32x32x16_bf16 a[16:31], a[68:71], v[144:147], a[16:31]
  s_waitcnt lgkmcnt(8)
  ds_read_b64_tr_b16 a[92:93], v21 offset:28672
  ds_read_b64_tr_b16 a[94:95], v21 offset:29184
  v_add_f32 v47, v47, v2
  v_cvt_pk_bf16_f32 v198, v44, v45
  s_add_u32 m0, s43, 65536
  s_add_u32 s49, s49, s47
  v_mfma_f32_32x32x16_bf16 a[32:47], a[72:75], v[144:147], a[32:47]
  s_waitcnt lgkmcnt(8)
  ds_read_b64_tr_b16 a[64:65], v18 offset:32768
  ds_read_b64_tr_b16 a[66:67], v18 offset:33280
  buffer_load_dwordx4 v13, s[16:19], s49 offen offset:0 lds
  v_cvt_pk_bf16_f32 v199, v46, v47
  v_lshlrev_b32 v32, 16, v200
  v_mfma_f32_32x32x16_bf16 a[48:63], a[76:79], v[144:147], a[48:63]
  s_waitcnt lgkmcnt(8)
  ds_read_b64_tr_b16 a[68:69], v19 offset:32768
  ds_read_b64_tr_b16 a[70:71], v19 offset:33280
  buffer_load_dwordx4 v14, s[16:19], s49 offen offset:1024 lds
  v_and_b32 v33, s90, v200
  v_lshlrev_b32 v34, 16, v201
  v_mfma_f32_32x32x16_bf16 a[0:15], a[80:83], v[148:151], a[0:15]
  s_waitcnt lgkmcnt(8)
  ds_read_b64_tr_b16 a[72:73], v20 offset:32768
  ds_read_b64_tr_b16 a[74:75], v20 offset:33280
  v_and_b32 v35, s90, v201
  v_add_f32 v32, v32, v2
  v_add_f32 v33, v33, v2
  v_add_f32 v34, v34, v2
  v_mfma_f32_32x32x16_bf16 a[16:31], a[84:87], v[148:151], a[16:31]
  s_waitcnt lgkmcnt(8)
  ds_read_b64_tr_b16 a[76:77], v21 offset:32768
  ds_read_b64_tr_b16 a[78:79], v21 offset:33280
  v_add_f32 v35, v35, v2
  v_cvt_pk_bf16_f32 v200, v32, v33
  v_cvt_pk_bf16_f32 v201, v34, v35
  v_lshlrev_b32 v36, 16, v202
  v_mfma_f32_32x32x16_bf16 a[32:47], a[88:91], v[148:151], a[32:47]
  s_waitcnt lgkmcnt(8)
  ds_read_b64_tr_b16 a[80:81], v18 offset:36864
  ds_read_b64_tr_b16 a[82:83], v18 offset:37376
  buffer_load_dwordx4 v15, s[20:23], s49 offen offset:2048 lds
  v_and_b32 v37, s90, v202
  v_lshlrev_b32 v38, 16, v203
  v_mfma_f32_32x32x16_bf16 a[48:63], a[92:95], v[148:151], a[48:63]
  s_waitcnt lgkmcnt(8)
  ds_read_b64_tr_b16 a[84:85], v19 offset:36864
  ds_read_b64_tr_b16 a[86:87], v19 offset:37376
  buffer_load_dwordx4 v16, s[20:23], s49 offen offset:3072 lds
  v_and_b32 v39, s90, v203
  v_add_f32 v36, v36, v2
  v_mfma_f32_32x32x16_bf16 a[0:15], a[64:67], v[152:155], a[0:15]
  s_waitcnt lgkmcnt(8)
  ds_read_b64_tr_b16 a[88:89], v20 offset:36864
  ds_read_b64_tr_b16 a[90:91], v20 offset:37376
  v_add_f32 v37, v37, v2
  s_add_u32 s49, s44, 7
  s_and_b32 s49, s49, 7
  s_mul_i32 s49, s49, 229376
  v_mfma_f32_32x32x16_bf16 a[16:31], a[68:71], v[152:155], a[16:31]
  s_waitcnt lgkmcnt(8)
  ds_read_b64_tr_b16 a[92:93], v21 offset:36864
  ds_read_b64_tr_b16 a[94:95], v21 offset:37376
  s_add_u32 m0, s43, 81920
  s_add_u32 s49, s49, s47
  v_subrev_u32 v18, 122880, v18
  v_subrev_u32 v19, 122880, v19
  v_subrev_u32 v20, 122880, v20
  v_subrev_u32 v21, 122880, v21
  v_mfma_f32_32x32x16_bf16 a[32:47], a[72:75], v[152:155], a[32:47]
  s_waitcnt vmcnt(16) lgkmcnt(8)
  s_barrier
  ds_read_b64_tr_b16 a[64:65], v18 offset:0
  ds_read_b64_tr_b16 a[66:67], v18 offset:512
  buffer_load_dwordx4 v13, s[16:19], s49 offen offset:0 lds
  v_mfma_f32_32x32x16_bf16 a[48:63], a[76:79], v[152:155], a[48:63]
  s_waitcnt lgkmcnt(8)
  ds_read_b64_tr_b16 a[68:69], v19 offset:0
  ds_read_b64_tr_b16 a[70:71], v19 offset:512
  buffer_load_dwordx4 v14, s[16:19], s49 offen offset:1024 lds
  v_add_f32 v38, v38, v2
  v_add_f32 v39, v39, v2
  v_mfma_f32_32x32x16_bf16 a[0:15], a[80:83], v[156:159], a[0:15]
  s_waitcnt lgkmcnt(8)
  ds_read_b64_tr_b16 a[72:73], v20 offset:0
  ds_read_b64_tr_b16 a[74:75], v20 offset:512
  v_cvt_pk_bf16_f32 v202, v36, v37
  v_cvt_pk_bf16_f32 v203, v38, v39
  v_lshlrev_b32 v40, 16, v204
  v_and_b32 v41, s90, v204
  v_mfma_f32_32x32x16_bf16 a[16:31], a[84:87], v[156:159], a[16:31]
  s_waitcnt lgkmcnt(8)
  ds_read_b64_tr_b16 a[76:77], v21 offset:0
  ds_read_b64_tr_b16 a[78:79], v21 offset:512
mk_wC1:
  s_cbranch_execz mk_wJ1
  v_lshlrev_b32 v42, 16, v205
  v_and_b32 v43, s90, v205
  v_add_f32 v40, v40, v2
  v_add_f32 v41, v41, v2
  v_mfma_f32_32x32x16_bf16 a[32:47], a[88:91], v[156:159], a[32:47]
  s_waitcnt lgkmcnt(8)
  ds_read_b64_tr_b16 a[80:81], v18 offset:4096
  ds_read_b64_tr_b16 a[82:83], v18 offset:4608
  buffer_load_dwordx4 v15, s[20:23], s49 offen offset:2048 lds
  v_add_f32 v42, v42, v2
  v_add_f32 v43, v43, v2
  v_mfma_f32_32x32x16_bf16 a[48:63], a[92:95], v[156:159], a[48:63]
  s_waitcnt lgkmcnt(8)
  ds_read_b64_tr_b16 a[84:85], v19 offset:4096
  ds_read_b64_tr_b16 a[86:87], v19 offset:4608
  buffer_load_dwordx4 v16, s[20:23], s49 offen offset:3072 lds
  v_lshrrev_b32 v11, 2, v1
  v_mul_u32_u24 v11, 3584, v11
  v_and_or_b32 v11, v7, 48, v11
  v_xor_b32 v12, 32, v11
  v_mfma_f32_32x32x16_bf16 a[0:15], a[64:67], v[160:163], a[0:15]
  s_waitcnt lgkmcnt(8)
  ds_read_b64_tr_b16 a[88:89], v20 offset:4096
  ds_read_b64_tr_b16 a[90:91], v20 offset:4608
  v_cvt_pk_bf16_f32 v204, v40, v41
  s_add_u32 s49, s89, 0
  s_and_b32 s49, s49, 31
  s_mul_i32 s49, s49, 57344
  v_mfma_f32_32x32x16_bf16 a[16:31], a[68:71], v[160:163], a[16:31]
  s_waitcnt lgkmcnt(8)
  ds_read_b64_tr_b16 a[92:93], v21 offset:4096
  ds_read_b64_tr_b16 a[94:95], v21 offset:4608
  v_cvt_pk_bf16_f32 v205, v42, v43
  s_add_u32 s49, s49, s46
  s_add_u32 m0, s43, 98304
  s_add_u32 s50, s49, 56320
  v_mfma_f32_32x32x16_bf16 a[32:47], a[72:75], v[160:163], a[32:47]
  s_waitcnt lgkmcnt(8)
  ds_read_b64_tr_b16 a[64:65], v18 offset:8192
  ds_read_b64_tr_b16 a[66:67], v18 offset:8704
  buffer_load_dwordx4 v11, s[16:19], s49 offen offset:0 lds
  v_lshlrev_b32 v44, 16, v206
  v_and_b32 v45, s90, v206
  v_mfma_f32_32x32x16_bf16 a[48:63], a[76:79], v[160:163], a[48:63]
  s_waitcnt lgkmcnt(8)
  ds_read_b64_tr_b16 a[68:69], v19 offset:8192
  ds_read_b64_tr_b16 a[70:71], v19 offset:8704
  buffer_load_dwordx4 v11, s[16:19], s50 offen offset:1024 lds
  v_lshlrev_b32 v46, 16, v207
  v_and_b32 v47, s90, v207
  v_mfma_f32_32x32x16_bf16 a[0:15], a[80:83], v[164:167], a[0:15]
  s_waitcnt lgkmcnt(8)
  ds_read_b64_tr_b16 a[72:73], v20 offset:8192
  ds_read_b64_tr_b16 a[74:75], v20 offset:8704
  v_add_f32 v44, v44, v2
  v_add_f32 v45, v45, v2
  v_add_f32 v46, v46, v2
  v_add_f32 v47, v47, v2
  v_mfma_f32_32x32x16_bf16 a[16:31], a[84:87], v[164:167], a[16:31]
  s_waitcnt lgkmcnt(8)
  ds_read_b64_tr_b16 a[76:77], v21 offset:8192
  ds_read_b64_tr_b16 a[78:79], v21 offset:8704
  v_cvt_pk_bf16_f32 v206, v44, v45
  v_cvt_pk_bf16_f32 v207, v46, v47
  v_lshlrev_b32 v32, 16, v208
  v_and_b32 v33, s90, v208
  v_mfma_f32_32x32x16_bf16 a[32:47], a[88:91], v[164:167], a[32:47]
  s_waitcnt lgkmcnt(8)
  ds_read_b64_tr_b16 a[80:81], v18 offset:12288
  ds_read_b64_tr_b16 a[82:83], v18 offset:12800
  buffer_load_dwordx4 v12, s[20:23], s49 offen offset:2048 lds
  v_lshlrev_b32 v34, 16, v209
  v_and_b32 v35, s90, v209
  v_mfma_f32_32x32x16_bf16 a[48:63], a[92:95], v[164:167], a[48:63]
  s_waitcnt lgkmcnt(8)
  ds_read_b64_tr_b16 a[84:85], v19 offset:12288
  ds_read_b64_tr_b16 a[86:87], v19 offset:12800
  buffer_load_dwordx4 v12, s[20:23], s50 offen offset:3072 lds
  v_add_f32 v32, v32, v2
  v_add_f32 v33, v33, v2
  v_mfma_f32_32x32x16_bf16 a[0:15], a[64:67], v[168:171], a[0:15]
  s_waitcnt lgkmcnt(8)
  ds_read_b64_tr_b16 a[88:89], v20 offset:12288
  ds_read_b64_tr_b16 a[90:91], v20 offset:12800
  v_add_f32 v34, v34, v2
  s_add_u32 s49, s44, 0
  s_and_b32 s49, s49, 7
  s_mul_i32 s49, s49, 229376
  v_mfma_f32_32x32x16_bf16 a[16:31], a[68:71], v[168:171], a[16:31]
  s_waitcnt lgkmcnt(8)
  ds_read_b64_tr_b16 a[92:93], v21 offset:12288
  ds_read_b64_tr_b16 a[94:95], v21 offset:12800
  v_add_f32 v35, v35, v2
  v_cvt_pk_bf16_f32 v208, v32, v33
  s_add_u32 m0, s43, 131072
  s_add_u32 s49, s49, s48
  v_mfma_f32_32x32x16_bf16 a[32:47], a[72:75], v[168:171], a[32:47]
  s_waitcnt vmcnt(20) lgkmcnt(8)
  s_barrier
  ds_read_b64_tr_b16 a[64:65], v18 offset:16384
  ds_read_b64_tr_b16 a[66:67], v18 offset:16896
  buffer_load_dwordx4 v13, s[16:19], s49 offen offset:0 lds
  v_mfma_f32_32x32x16_bf16 a[48:63], a[76:79], v[168:171], a[48:63]
  s_waitcnt lgkmcnt(8)
  ds_read_b64_tr_b16 a[68:69], v19 offset:16384
  ds_read_b64_tr_b16 a[70:71], v19 offset:16896
  buffer_load_dwordx4 v14, s[16:19], s49 offen offset:1024 lds
  v_cvt_pk_bf16_f32 v209, v34, v35
  v_lshlrev_b32 v36, 16, v210
  v_mfma_f32_32x32x16_bf16 a[0:15], a[80:83], v[172:175], a[0:15]
  s_waitcnt lgkmcnt(8)
  ds_read_b64_tr_b16 a[72:73], v20 offset:16384
  ds_read_b64_tr_b16 a[74:75], v20 offset:16896
  v_and_b32 v37, s90, v210
  v_lshlrev_b32 v38, 16, v211
  v_and_b32 v39, s90, v211
  v_add_f32 v36, v36, v2
  v_mfma_f32_32x32x16_bf16 a[16:31], a[84:87], v[172:175], a[16:31]
  s_waitcnt lgkmcnt(8)
  ds_read_b64_tr_b16 a[76:77], v21 offset:16384
  ds_read_b64_tr_b16 a[78:79], v21 offset:16896
  v_add_f32 v37, v37, v2
  v_add_f32 v38, v38, v2
  v_add_f32 v39, v39, v2
  v_cvt_pk_bf16_f32 v210, v36, v37
  v_mfma_f32_32x32x16_bf16 a[32:47], a[88:91], v[172:175], a[32:47]
  s_waitcnt lgkmcnt(8)
  ds_read_b64_tr_b16 a[80:81], v18 offset:20480
  ds_read_b64_tr_b16 a[82:83], v18 offset:20992
  buffer_load_dwordx4 v15, s[20:23], s49 offen offset:2048 lds
  v_cvt_pk_bf16_f32 v211, v38, v39
  v_lshlrev_b32 v40, 16, v212
  v_mfma_f32_32x32x16_bf16 a[48:63], a[92:95], v[172:175], a[48:63]
  s_waitcnt lgkmcnt(8)
  ds_read_b64_tr_b16 a[84:85], v19 offset:20480
  ds_read_b64_tr_b16 a[86:87], v19 offset:20992
  buffer_load_dwordx4 v16, s[20:23], s49 offen offset:3072 lds
  v_and_b32 v41, s90, v212
  v_lshlrev_b32 v42, 16, v213
  v_mfma_f32_32x32x16_bf16 a[0:15], a[64:67], v[176:179], a[0:15]
  s_waitcnt lgkmcnt(8)
  ds_read_b64_tr_b16 a[88:89], v20 offset:20480
  ds_read_b64_tr_b16 a[90:91], v20 offset:20992
  v_and_b32 v43, s90, v213
  v_add_f32 v40, v40, v2
  v_add_f32 v41, v41, v2
  v_add_f32 v42, v42, v2
  v_mfma_f32_32x32x16_bf16 a[16:31], a[68:71], v[176:179], a[16:31]
  s_waitcnt lgkmcnt(8)
  ds_read_b64_tr_b16 a[92:93], v21 offset:20480
  ds_read_b64_tr_b16 a[94:95], v21 offset:20992
  v_add_f32 v43, v43, v2
  v_cvt_pk_bf16_f32 v212, v40, v41
  v_cvt_pk_bf16_f32 v213, v42, v43
  v_lshlrev_b32 v44, 16, v214
  v_mfma_f32_32x32x16_bf16 a[32:47], a[72:75], v[176:179], a[32:47]
  s_waitcnt lgkmcnt(8)
  ds_read_b64_tr_b16 a[64:65], v18 offset:24576
  ds_read_b64_tr_b16 a[66:67], v18 offset:25088
  v_and_b32 v45, s90, v214
  v_lshlrev_b32 v46, 16, v215
  v_and_b32 v47, s90, v215
  v_add_f32 v44, v44, v2
  v_mfma_f32_32x32x16_bf16 a[48:63], a[76:79], v[176:179], a[48:63]
  s_waitcnt lgkmcnt(8)
  ds_read_b64_tr_b16 a[68:69], v19 offset:24576
  ds_read_b64_tr_b16 a[70:71], v19 offset:25088
  v_add_f32 v45, v45, v2
  v_add_f32 v46, v46, v2
  v_add_f32 v47, v47, v2
  v_cvt_pk_bf16_f32 v214, v44, v45
  v_mfma_f32_32x32x16_bf16 a[0:15], a[80:83], v[180:183], a[0:15]
  s_waitcnt lgkmcnt(8)
  ds_read_b64_tr_b16 a[72:73], v20 offset:24576
  ds_read_b64_tr_b16 a[74:75], v20 offset:25088
  v_cvt_pk_bf16_f32 v215, v46, v47
  v_lshlrev_b32 v32, 16, v216
  v_and_b32 v33, s90, v216
  v_lshlrev_b32 v34, 16, v217
  v_mfma_f32_32x32x16_bf16 a[16:31], a[84:87], v[180:183], a[16:31]
  s_waitcnt lgkmcnt(8)
  ds_read_b64_tr_b16 a[76:77], v21 offset:24576
  ds_read_b64_tr_b16 a[78:79], v21 offset:25088
  v_and_b32 v35, s90, v217
  v_add_f32 v32, v32, v2
  v_add_f32 v33, v33, v2
  v_add_f32 v34, v34, v2
  v_mfma_f32_32x32x16_bf16 a[32:47], a[88:91], v[180:183], a[32:47]
  s_waitcnt lgkmcnt(8)
  ds_read_b64_tr_b16 a[80:81], v18 offset:28672
  ds_read_b64_tr_b16 a[82:83], v18 offset:29184
  v_add_f32 v35, v35, v2
  v_cvt_pk_bf16_f32 v216, v32, v33
  v_cvt_pk_bf16_f32 v217, v34, v35
  v_lshlrev_b32 v36, 16, v218
  v_mfma_f32_32x32x16_bf16 a[48:63], a[92:95], v[180:183], a[48:63]
  s_waitcnt lgkmcnt(8)
  ds_read_b64_tr_b16 a[84:85], v19 offset:28672
  ds_read_b64_tr_b16 a[86:87], v19 offset:29184
  v_and_b32 v37, s90, v218
  v_lshlrev_b32 v38, 16, v219
  v_and_b32 v39, s90, v219
  v_add_f32 v36, v36, v2
  v_mfma_f32_32x32x16_bf16 a[0:15], a[64:67], v[184:187], a[0:15]
  s_waitcnt lgkmcnt(8)
  ds_read_b64_tr_b16 a[88:89], v20 offset:28672
  ds_read_b64_tr_b16 a[90:91], v20 offset:29184
  v_add_f32 v37, v37, v2
  v_add_f32 v38, v38, v2
  v_add_f32 v39, v39, v2
  v_cvt_pk_bf16_f32 v218, v36, v37
  v_mfma_f32_32x32x16_bf16 a[16:31], a[68:71], v[184:187], a[16:31]
  s_waitcnt lgkmcnt(8)
  ds_read_b64_tr_b16 a[92:93], v21 offset:28672
  ds_read_b64_tr_b16 a[94:95], v21 offset:29184
  v_cvt_pk_bf16_f32 v219, v38, v39
  v_lshlrev_b32 v40, 16, v220
  v_and_b32 v41, s90, v220
  v_lshlrev_b32 v42, 16, v221
  v_mfma_f32_32x32x16_bf16 a[32:47], a[72:75], v[184:187], a[32:47]
  s_waitcnt vmcnt(16) lgkmcnt(8)
  s_barrier
  ds_read_b64_tr_b16 a[64:65], v18 offset:32768
  ds_read_b64_tr_b16 a[66:67], v18 offset:33280
  v_and_b32 v43, s90, v221
  v_add_f32 v40, v40, v2
  v_mfma_f32_32x32x16_bf16 a[48:63], a[76:79], v[184:187], a[48:63]
  s_waitcnt lgkmcnt(8)
  ds_read_b64_tr_b16 a[68:69], v19 offset:32768
  ds_read_b64_tr_b16 a[70:71], v19 offset:33280
  v_add_f32 v41, v41, v2
  v_add_f32 v42, v42, v2
  v_add_f32 v43, v43, v2
  v_cvt_pk_bf16_f32 v220, v40, v41
  v_mfma_f32_32x32x16_bf16 a[0:15], a[80:83], v[188:191], a[0:15]
  s_waitcnt lgkmcnt(8)
  ds_read_b64_tr_b16 a[72:73], v20 offset:32768
  ds_read_b64_tr_b16 a[74:75], v20 offset:33280
  v_cvt_pk_bf16_f32 v221, v42, v43
  v_lshlrev_b32 v44, 16, v222
  v_and_b32 v45, s90, v222
  v_lshlrev_b32 v46, 16, v223
  v_mfma_f32_32x32x16_bf16 a[16:31], a[84:87], v[188:191], a[16:31]
  s_waitcnt lgkmcnt(8)
  ds_read_b64_tr_b16 a[76:77], v21 offset:32768
  ds_read_b64_tr_b16 a[78:79], v21 offset:33280
  v_and_b32 v47, s90, v223
  v_add_f32 v44, v44, v2
  v_add_f32 v45, v45, v2
  v_add_f32 v46, v46, v2
  v_mfma_f32_32x32x16_bf16 a[32:47], a[88:91], v[188:191], a[32:47]
  s_waitcnt lgkmcnt(8)
  ds_read_b64_tr_b16 a[80:81], v18 offset:36864
  ds_read_b64_tr_b16 a[82:83], v18 offset:37376
  v_add_f32 v47, v47, v2
  v_cvt_pk_bf16_f32 v222, v44, v45
  v_cvt_pk_bf16_f32 v223, v46, v47
  v_lshlrev_b32 v32, 16, v224
  v_mfma_f32_32x32x16_bf16 a[48:63], a[92:95], v[188:191], a[48:63]
  s_waitcnt lgkmcnt(8)
  ds_read_b64_tr_b16 a[84:85], v19 offset:36864
  ds_read_b64_tr_b16 a[86:87], v19 offset:37376
  v_and_b32 v33, s90, v224
  v_lshlrev_b32 v34, 16, v225
  v_and_b32 v35, s90, v225
  v_add_f32 v32, v32, v2
  v_mfma_f32_32x32x16_bf16 a[0:15], a[64:67], v[192:195], a[0:15]
  s_waitcnt lgkmcnt(8)
  ds_read_b64_tr_b16 a[88:89], v20 offset:36864
  ds_read_b64_tr_b16 a[90:91], v20 offset:37376
  v_add_f32 v33, v33, v2
  v_add_f32 v34, v34, v2
  v_add_f32 v35, v35, v2
  v_cvt_pk_bf16_f32 v224, v32, v33
  v_mfma_f32_32x32x16_bf16 a[16:31], a[68:71], v[192:195], a[16:31]
  s_waitcnt lgkmcnt(8)
  ds_read_b64_tr_b16 a[92:93], v21 offset:36864
  ds_read_b64_tr_b16 a[94:95], v21 offset:37376
  v_cvt_pk_bf16_f32 v225, v34, v35
  v_lshlrev_b32 v36, 16, v226
  v_and_b32 v37, s90, v226
  v_lshlrev_b32 v38, 16, v227
  v_mfma_f32_32x32x16_bf16 a[32:47], a[72:75], v[192:195], a[32:47]
  s_waitcnt lgkmcnt(8)
  ds_read_b64_tr_b16 a[64:65], v18 offset:40960
  ds_read_b64_tr_b16 a[66:67], v18 offset:41472
  v_and_b32 v39, s90, v227
  v_add_f32 v36, v36, v2
  v_add_f32 v37, v37, v2
  v_add_f32 v38, v38, v2
  v_mfma_f32_32x32x16_bf16 a[48:63], a[76:79], v[192:195], a[48:63]
  s_waitcnt lgkmcnt(8)
  ds_read_b64_tr_b16 a[68:69], v19 offset:40960
  ds_read_b64_tr_b16 a[70:71], v19 offset:41472
  v_add_f32 v39, v39, v2
  v_cvt_pk_bf16_f32 v226, v36, v37
  v_cvt_pk_bf16_f32 v227, v38, v39
  v_lshlrev_b32 v40, 16, v228
  v_mfma_f32_32x32x16_bf16 a[0:15], a[80:83], v[196:199], a[0:15]
  s_waitcnt lgkmcnt(8)
  ds_read_b64_tr_b16 a[72:73], v20 offset:40960
  ds_read_b64_tr_b16 a[74:75], v20 offset:41472
  v_and_b32 v41, s90, v228
  v_lshlrev_b32 v42, 16, v229
  v_and_b32 v43, s90, v229
  v_add_f32 v40, v40, v2
  v_mfma_f32_32x32x16_bf16 a[16:31], a[84:87], v[196:199], a[16:31]
  s_waitcnt lgkmcnt(8)
  ds_read_b64_tr_b16 a[76:77], v21 offset:40960
  ds_read_b64_tr_b16 a[78:79], v21 offset:41472
  v_add_f32 v41, v41, v2
  v_add_f32 v42, v42, v2
  v_add_f32 v43, v43, v2
  v_cvt_pk_bf16_f32 v228, v40, v41
  v_mfma_f32_32x32x16_bf16 a[32:47], a[88:91], v[196:199], a[32:47]
  s_waitcnt lgkmcnt(8)
  ds_read_b64_tr_b16 a[80:81], v18 offset:45056
  ds_read_b64_tr_b16 a[82:83], v18 offset:45568
  v_cvt_pk_bf16_f32 v229, v42, v43
  v_lshlrev_b32 v44, 16, v230
  v_and_b32 v45, s90, v230
  v_lshlrev_b32 v46, 16, v231
  v_mfma_f32_32x32x16_bf16 a[48:63], a[92:95], v[196:199], a[48:63]
  s_waitcnt lgkmcnt(8)
  ds_read_b64_tr_b16 a[84:85], v19 offset:45056
  ds_read_b64_tr_b16 a[86:87], v19 offset:45568
  v_and_b32 v47, s90, v231
  v_add_f32 v44, v44, v2
  v_add_f32 v45, v45, v2
  v_add_f32 v46, v46, v2
  v_mfma_f32_32x32x16_bf16 a[0:15], a[64:67], v[200:203], a[0:15]
  s_waitcnt lgkmcnt(8)
  ds_read_b64_tr_b16 a[88:89], v20 offset:45056
  ds_read_b64_tr_b16 a[90:91], v20 offset:45568
  v_add_f32 v47, v47, v2
  v_cvt_pk_bf16_f32 v230, v44, v45
  v_cvt_pk_bf16_f32 v231, v46, v47
  v_mov_b32 v30, 0
  v_mfma_f32_32x32x16_bf16 a[16:31], a[68:71], v[200:203], a[16:31]
  s_waitcnt lgkmcnt(8)
  ds_read_b64_tr_b16 a[92:93], v21 offset:45056
  ds_read_b64_tr_b16 a[94:95], v21 offset:45568
  global_load_dword v31, v30, s[36:37] sc1
  v_lshlrev_b32 v32, 16, v232
  v_and_b32 v33, s90, v232
  v_lshlrev_b32 v34, 16, v233
  v_mfma_f32_32x32x16_bf16 a[32:47], a[72:75], v[200:203], a[32:47]
  s_waitcnt lgkmcnt(8)
  ds_read_b64_tr_b16 a[64:65], v18 offset:49152
  ds_read_b64_tr_b16 a[66:67], v18 offset:49664
  v_and_b32 v35, s90, v233
  v_add_f32 v32, v32, v2
  v_add_f32 v33, v33, v2
  v_add_f32 v34, v34, v2
  v_mfma_f32_32x32x16_bf16 a[48:63], a[76:79], v[200:203], a[48:63]
  s_waitcnt lgkmcnt(8)
  ds_read_b64_tr_b16 a[68:69], v19 offset:49152
  ds_read_b64_tr_b16 a[70:71], v19 offset:49664
  v_add_f32 v35, v35, v2
  v_cvt_pk_bf16_f32 v232, v32, v33
  v_cvt_pk_bf16_f32 v233, v34, v35
  v_lshlrev_b32 v36, 16, v234
  v_mfma_f32_32x32x16_bf16 a[0:15], a[80:83], v[204:207], a[0:15]
  s_waitcnt lgkmcnt(8)
  ds_read_b64_tr_b16 a[72:73], v20 offset:49152
  ds_read_b64_tr_b16 a[74:75], v20 offset:49664
  v_and_b32 v37, s90, v234
  s_add_u32 s49, s89, 8
  s_and_b32 s49, s49, 31
  s_mul_i32 s49, s49, 57344
  v_mfma_f32_32x32x16_bf16 a[16:31], a[84:87], v[204:207], a[16:31]
  s_waitcnt lgkmcnt(8)
  ds_read_b64_tr_b16 a[76:77], v21 offset:49152
  ds_read_b64_tr_b16 a[78:79], v21 offset:49664
  v_lshlrev_b32 v38, 16, v235
  s_add_u32 s49, s49, s46
  s_add_u32 m0, s43, 114688
  s_add_u32 s50, s49, 56320
  v_mfma_f32_32x32x16_bf16 a[32:47], a[88:91], v[204:207], a[32:47]
  s_waitcnt lgkmcnt(8)
  ds_read_b64_tr_b16 a[80:81], v18 offset:53248
  ds_read_b64_tr_b16 a[82:83], v18 offset:53760
  buffer_load_dwordx4 v11, s[16:19], s49 offen offset:0 lds
  v_and_b32 v39, s90, v235
  v_add_f32 v36, v36, v2
  v_mfma_f32_32x32x16_bf16 a[48:63], a[92:95], v[204:207], a[48:63]
  s_waitcnt lgkmcnt(8)
  ds_read_b64_tr_b16 a[84:85], v19 offset:53248
  ds_read_b64_tr_b16 a[86:87], v19 offset:53760
  v_add_f32 v37, v37, v2
  v_add_f32 v38, v38, v2
  v_add_f32 v39, v39, v2
  v_cvt_pk_bf16_f32 v234, v36, v37
  v_mfma_f32_32x32x16_bf16 a[0:15], a[64:67], v[208:211], a[0:15]
  s_waitcnt lgkmcnt(8)
  ds_read_b64_tr_b16 a[88:89], v20 offset:53248
  ds_read_b64_tr_b16 a[90:91], v20 offset:53760
  v_cvt_pk_bf16_f32 v235, v38, v39
  v_lshlrev_b32 v40, 16, v236
  v_and_b32 v41, s90, v236
  v_lshlrev_b32 v42, 16, v237
  v_mfma_f32_32x32x16_bf16 a[16:31], a[68:71], v[208:211], a[16:31]
  s_waitcnt lgkmcnt(8)
  ds_read_b64_tr_b16 a[92:93], v21 offset:53248
  ds_read_b64_tr_b16 a[94:95], v21 offset:53760
  v_and_b32 v43, s90, v237
  v_add_f32 v40, v40, v2
  v_add_f32 v41, v41, v2
  v_add_f32 v42, v42, v2
  v_mfma_f32_32x32x16_bf16 a[32:47], a[72:75], v[208:211], a[32:47]
  s_waitcnt lgkmcnt(8)
  ds_read_b64_tr_b16 a[64:65], v18 offset:57344
  ds_read_b64_tr_b16 a[66:67], v18 offset:57856
  buffer_load_dwordx4 v11, s[16:19], s50 offen offset:1024 lds
  v_add_f32 v43, v43, v2
  v_cvt_pk_bf16_f32 v236, v40, v41
  v_mfma_f32_32x32x16_bf16 a[48:63], a[76:79], v[208:211], a[48:63]
  s_waitcnt lgkmcnt(8)
  ds_read_b64_tr_b16 a[68:69], v19 offset:57344
  ds_read_b64_tr_b16 a[70:71], v19 offset:57856
  v_cvt_pk_bf16_f32 v237, v42, v43
  v_lshlrev_b32 v44, 16, v238
  v_and_b32 v45, s90, v238
  v_lshlrev_b32 v46, 16, v239
  v_mfma_f32_32x32x16_bf16 a[0:15], a[80:83], v[212:215], a[0:15]
  s_waitcnt lgkmcnt(8)
  ds_read_b64_tr_b16 a[72:73], v20 offset:57344
  ds_read_b64_tr_b16 a[74:75], v20 offset:57856
  v_and_b32 v47, s90, v239
  v_add_f32 v44, v44, v2
  v_add_f32 v45, v45, v2
  v_add_f32 v46, v46, v2
  v_mfma_f32_32x32x16_bf16 a[16:31], a[84:87], v[212:215], a[16:31]
  s_waitcnt lgkmcnt(8)
  ds_read_b64_tr_b16 a[76:77], v21 offset:57344
  ds_read_b64_tr_b16 a[78:79], v21 offset:57856
  v_add_u32 v18, 61440, v18
  v_add_u32 v19, 61440, v19
  v_add_u32 v20, 61440, v20
  v_add_u32 v21, 61440, v21
  v_mfma_f32_32x32x16_bf16 a[32:47], a[88:91], v[212:215], a[32:47]
  s_waitcnt lgkmcnt(8)
  ds_read_b64_tr_b16 a[80:81], v18 offset:0
  ds_read_b64_tr_b16 a[82:83], v18 offset:512
  buffer_load_dwordx4 v12, s[20:23], s49 offen offset:2048 lds
  v_add_f32 v47, v47, v2
  v_cvt_pk_bf16_f32 v238, v44, v45
  v_mfma_f32_32x32x16_bf16 a[48:63], a[92:95], v[212:215], a[48:63]
  s_waitcnt lgkmcnt(8)
  ds_read_b64_tr_b16 a[84:85], v19 offset:0
  ds_read_b64_tr_b16 a[86:87], v19 offset:512
  v_cvt_pk_bf16_f32 v239, v46, v47
  v_lshlrev_b32 v32, 16, v240
  v_and_b32 v33, s90, v240
  v_lshlrev_b32 v34, 16, v241
  v_mfma_f32_32x32x16_bf16 a[0:15], a[64:67], v[216:219], a[0:15]
  s_waitcnt lgkmcnt(8)
  ds_read_b64_tr_b16 a[88:89], v20 offset:0
  ds_read_b64_tr_b16 a[90:91], v20 offset:512
  v_and_b32 v35, s90, v241
  v_add_f32 v32, v32, v2
  v_add_f32 v33, v33, v2
  v_add_f32 v34, v34, v2
  v_mfma_f32_32x32x16_bf16 a[16:31], a[68:71], v[216:219], a[16:31]
  s_waitcnt lgkmcnt(8)
  ds_read_b64_tr_b16 a[92:93], v21 offset:0
  ds_read_b64_tr_b16 a[94:95], v21 offset:512
  v_add_f32 v35, v35, v2
  v_cvt_pk_bf16_f32 v240, v32, v33
  v_cvt_pk_bf16_f32 v241, v34, v35
  v_lshlrev_b32 v36, 16, v242
  v_mfma_f32_32x32x16_bf16 a[32:47], a[72:75], v[216:219], a[32:47]
  s_waitcnt vmcnt(12) lgkmcnt(8)
  s_barrier
  ds_read_b64_tr_b16 a[64:65], v18 offset:4096
  ds_read_b64_tr_b16 a[66:67], v18 offset:4608
  buffer_load_dwordx4 v12, s[20:23], s50 offen offset:3072 lds
  v_mfma_f32_32x32x16_bf16 a[48:63], a[76:79], v[216:219], a[48:63]
  s_waitcnt lgkmcnt(8)
  ds_read_b64_tr_b16 a[68:69], v19 offset:4096
  ds_read_b64_tr_b16 a[70:71], v19 offset:4608
  v_and_b32 v37, s90, v242
  v_lshlrev_b32 v38, 16, v243
  v_and_b32 v39, s90, v243
  v_add_f32 v36, v36, v2
  v_mfma_f32_32x32x16_bf16 a[0:15], a[80:83], v[220:223], a[0:15]
  s_waitcnt lgkmcnt(8)
  ds_read_b64_tr_b16 a[72:73], v20 offset:4096
  ds_read_b64_tr_b16 a[74:75], v20 offset:4608
  v_add_f32 v37, v37, v2
  s_add_u32 s49, s89, 16
  s_and_b32 s49, s49, 31
  s_mul_i32 s49, s49, 57344
  v_mfma_f32_32x32x16_bf16 a[16:31], a[84:87], v[220:223], a[16:31]
  s_waitcnt lgkmcnt(8)
  ds_read_b64_tr_b16 a[76:77], v21 offset:4096
  ds_read_b64_tr_b16 a[78:79], v21 offset:4608
  v_add_f32 v38, v38, v2
  s_add_u32 s49, s49, s46
  s_add_u32 m0, s43, 0
  s_add_u32 s50, s49, 56320
  v_mfma_f32_32x32x16_bf16 a[32:47], a[88:91], v[220:223], a[32:47]
  s_waitcnt lgkmcnt(8)
  ds_read_b64_tr_b16 a[80:81], v18 offset:8192
  ds_read_b64_tr_b16 a[82:83], v18 offset:8704
  buffer_load_dwordx4 v11, s[16:19], s49 offen offset:0 lds
  v_add_f32 v39, v39, v2
  v_cvt_pk_bf16_f32 v242, v36, v37
  v_mfma_f32_32x32x16_bf16 a[48:63], a[92:95], v[220:223], a[48:63]
  s_waitcnt lgkmcnt(8)
  ds_read_b64_tr_b16 a[84:85], v19 offset:8192
  ds_read_b64_tr_b16 a[86:87], v19 offset:8704
  v_cvt_pk_bf16_f32 v243, v38, v39
  v_lshlrev_b32 v40, 16, v244
  v_and_b32 v41, s90, v244
  v_lshlrev_b32 v42, 16, v245
  v_mfma_f32_32x32x16_bf16 a[0:15], a[64:67], v[224:227], a[0:15]
  s_waitcnt lgkmcnt(8)
  ds_read_b64_tr_b16 a[88:89], v20 offset:8192
  ds_read_b64_tr_b16 a[90:91], v20 offset:8704
  v_and_b32 v43, s90, v245
  v_add_f32 v40, v40, v2
  v_add_f32 v41, v41, v2
  v_add_f32 v42, v42, v2
  v_mfma_f32_32x32x16_bf16 a[16:31], a[68:71], v[224:227], a[16:31]
  s_waitcnt lgkmcnt(8)
  ds_read_b64_tr_b16 a[92:93], v21 offset:8192
  ds_read_b64_tr_b16 a[94:95], v21 offset:8704
  v_add_f32 v43, v43, v2
  v_cvt_pk_bf16_f32 v244, v40, v41
  v_cvt_pk_bf16_f32 v245, v42, v43
  v_lshlrev_b32 v44, 16, v246
  v_mfma_f32_32x32x16_bf16 a[32:47], a[72:75], v[224:227], a[32:47]
  s_waitcnt lgkmcnt(8)
  ds_read_b64_tr_b16 a[64:65], v18 offset:12288
  ds_read_b64_tr_b16 a[66:67], v18 offset:12800
  buffer_load_dwordx4 v11, s[16:19], s50 offen offset:1024 lds
  v_and_b32 v45, s90, v246
  v_lshlrev_b32 v46, 16, v247
  v_mfma_f32_32x32x16_bf16 a[48:63], a[76:79], v[224:227], a[48:63]
  s_waitcnt lgkmcnt(8)
  ds_read_b64_tr_b16 a[68:69], v19 offset:12288
  ds_read_b64_tr_b16 a[70:71], v19 offset:12800
  v_and_b32 v47, s90, v247
  v_add_f32 v44, v44, v2
  v_add_f32 v45, v45, v2
  v_add_f32 v46, v46, v2
  v_mfma_f32_32x32x16_bf16 a[0:15], a[80:83], v[228:231], a[0:15]
  s_waitcnt lgkmcnt(8)
  ds_read_b64_tr_b16 a[72:73], v20 offset:12288
  ds_read_b64_tr_b16 a[74:75], v20 offset:12800
  v_add_f32 v47, v47, v2
  v_cvt_pk_bf16_f32 v246, v44, v45
  v_cvt_pk_bf16_f32 v247, v46, v47
  v_lshlrev_b32 v32, 16, v248
  v_mfma_f32_32x32x16_bf16 a[16:31], a[84:87], v[228:231], a[16:31]
  s_waitcnt lgkmcnt(8)
  ds_read_b64_tr_b16 a[76:77], v21 offset:12288
  ds_read_b64_tr_b16 a[78:79], v21 offset:12800
  v_and_b32 v33, s90, v248
  v_lshlrev_b32 v34, 16, v249
  v_and_b32 v35, s90, v249
  v_add_f32 v32, v32, v2
  v_mfma_f32_32x32x16_bf16 a[32:47], a[88:91], v[228:231], a[32:47]
  s_waitcnt lgkmcnt(8)
  ds_read_b64_tr_b16 a[80:81], v18 offset:16384
  ds_read_b64_tr_b16 a[82:83], v18 offset:16896
  buffer_load_dwordx4 v12, s[20:23], s49 offen offset:2048 lds
  v_add_f32 v33, v33, v2
  v_add_f32 v34, v34, v2
  v_mfma_f32_32x32x16_bf16 a[48:63], a[92:95], v[228:231], a[48:63]
  s_waitcnt lgkmcnt(8)
  ds_read_b64_tr_b16 a[84:85], v19 offset:16384
  ds_read_b64_tr_b16 a[86:87], v19 offset:16896
  v_add_f32 v35, v35, v2
  v_cvt_pk_bf16_f32 v248, v32, v33
  v_cvt_pk_bf16_f32 v249, v34, v35
  v_lshlrev_b32 v36, 16, v250
  v_mfma_f32_32x32x16_bf16 a[0:15], a[64:67], v[232:235], a[0:15]
  s_waitcnt lgkmcnt(8)
  ds_read_b64_tr_b16 a[88:89], v20 offset:16384
  ds_read_b64_tr_b16 a[90:91], v20 offset:16896
  v_and_b32 v37, s90, v250
  v_lshlrev_b32 v38, 16, v251
  v_and_b32 v39, s90, v251
  v_add_f32 v36, v36, v2
  v_mfma_f32_32x32x16_bf16 a[16:31], a[68:71], v[232:235], a[16:31]
  s_waitcnt lgkmcnt(8)
  ds_read_b64_tr_b16 a[92:93], v21 offset:16384
  ds_read_b64_tr_b16 a[94:95], v21 offset:16896
  v_add_f32 v37, v37, v2
  v_add_f32 v38, v38, v2
  v_add_f32 v39, v39, v2
  v_cvt_pk_bf16_f32 v250, v36, v37
  v_mfma_f32_32x32x16_bf16 a[32:47], a[72:75], v[232:235], a[32:47]
  s_waitcnt lgkmcnt(8)
  ds_read_b64_tr_b16 a[64:65], v18 offset:20480
  ds_read_b64_tr_b16 a[66:67], v18 offset:20992
  buffer_load_dwordx4 v12, s[20:23], s50 offen offset:3072 lds
  v_cvt_pk_bf16_f32 v251, v38, v39
  v_lshlrev_b32 v40, 16, v252
  v_mfma_f32_32x32x16_bf16 a[48:63], a[76:79], v[232:235], a[48:63]
  s_waitcnt lgkmcnt(8)
  ds_read_b64_tr_b16 a[68:69], v19 offset:20480
  ds_read_b64_tr_b16 a[70:71], v19 offset:20992
  v_and_b32 v41, s90, v252
  v_lshlrev_b32 v42, 16, v253
  v_and_b32 v43, s90, v253
  v_add_f32 v40, v40, v2
  v_mfma_f32_32x32x16_bf16 a[0:15], a[80:83], v[236:239], a[0:15]
  s_waitcnt lgkmcnt(8)
  ds_read_b64_tr_b16 a[72:73], v20 offset:20480
  ds_read_b64_tr_b16 a[74:75], v20 offset:20992
  v_add_f32 v41, v41, v2
  s_add_u32 s49, s89, 24
  s_and_b32 s49, s49, 31
  s_mul_i32 s49, s49, 57344
  v_mfma_f32_32x32x16_bf16 a[16:31], a[84:87], v[236:239], a[16:31]
  s_waitcnt lgkmcnt(8)
  ds_read_b64_tr_b16 a[76:77], v21 offset:20480
  ds_read_b64_tr_b16 a[78:79], v21 offset:20992
  v_add_f32 v42, v42, v2
  s_add_u32 s49, s49, s46
  s_add_u32 m0, s43, 16384
  s_add_u32 s50, s49, 56320
  v_mfma_f32_32x32x16_bf16 a[32:47], a[88:91], v[236:239], a[32:47]
  s_waitcnt lgkmcnt(8)
  ds_read_b64_tr_b16 a[80:81], v18 offset:24576
  ds_read_b64_tr_b16 a[82:83], v18 offset:25088
  buffer_load_dwordx4 v11, s[16:19], s49 offen offset:0 lds
  v_add_f32 v43, v43, v2
  v_cvt_pk_bf16_f32 v252, v40, v41
  v_mfma_f32_32x32x16_bf16 a[48:63], a[92:95], v[236:239], a[48:63]
  s_waitcnt lgkmcnt(8)
  ds_read_b64_tr_b16 a[84:85], v19 offset:24576
  ds_read_b64_tr_b16 a[86:87], v19 offset:25088
  v_cvt_pk_bf16_f32 v253, v42, v43
  v_lshlrev_b32 v44, 16, v254
  v_and_b32 v45, s90, v254
  v_lshlrev_b32 v46, 16, v255
  v_mfma_f32_32x32x16_bf16 a[0:15], a[64:67], v[240:243], a[0:15]
  s_waitcnt lgkmcnt(8)
  ds_read_b64_tr_b16 a[88:89], v20 offset:24576
  ds_read_b64_tr_b16 a[90:91], v20 offset:25088
  v_and_b32 v47, s90, v255
  v_add_f32 v44, v44, v2
  v_add_f32 v45, v45, v2
  v_add_f32 v46, v46, v2
  v_mfma_f32_32x32x16_bf16 a[16:31], a[68:71], v[240:243], a[16:31]
  s_waitcnt lgkmcnt(8)
  ds_read_b64_tr_b16 a[92:93], v21 offset:24576
  ds_read_b64_tr_b16 a[94:95], v21 offset:25088
  v_add_f32 v47, v47, v2
  v_cvt_pk_bf16_f32 v254, v44, v45
  v_cvt_pk_bf16_f32 v255, v46, v47
  v_mfma_f32_32x32x16_bf16 a[32:47], a[72:75], v[240:243], a[32:47]
  s_waitcnt lgkmcnt(8)
  ds_read_b64_tr_b16 a[64:65], v18 offset:28672
  ds_read_b64_tr_b16 a[66:67], v18 offset:29184
  buffer_load_dwordx4 v11, s[16:19], s50 offen offset:1024 lds
  v_mfma_f32_32x32x16_bf16 a[48:63], a[76:79], v[240:243], a[48:63]
  s_waitcnt lgkmcnt(8)
  ds_read_b64_tr_b16 a[68:69], v19 offset:28672
  ds_read_b64_tr_b16 a[70:71], v19 offset:29184
  v_mfma_f32_32x32x16_bf16 a[0:15], a[80:83], v[244:247], a[0:15]
  s_waitcnt lgkmcnt(8)
  ds_read_b64_tr_b16 a[72:73], v20 offset:28672
  ds_read_b64_tr_b16 a[74:75], v20 offset:29184
  v_mfma_f32_32x32x16_bf16 a[16:31], a[84:87], v[244:247], a[16:31]
mk_wC2:
  s_cbranch_execz mk_wJ2
  s_waitcnt lgkmcnt(8)
  ds_read_b64_tr_b16 a[76:77], v21 offset:28672
  ds_read_b64_tr_b16 a[78:79], v21 offset:29184
  v_mfma_f32_32x32x16_bf16 a[32:47], a[88:91], v[244:247], a[32:47]
  s_waitcnt lgkmcnt(8)
  ds_read_b64_tr_b16 a[80:81], v18 offset:32768
  ds_read_b64_tr_b16 a[82:83], v18 offset:33280
  buffer_load_dwordx4 v12, s[20:23], s49 offen offset:2048 lds
  v_mfma_f32_32x32x16_bf16 a[48:63], a[92:95], v[244:247], a[48:63]
  s_waitcnt lgkmcnt(8)
  ds_read_b64_tr_b16 a[84:85], v19 offset:32768
  ds_read_b64_tr_b16 a[86:87], v19 offset:33280
  v_mfma_f32_32x32x16_bf16 a[0:15], a[64:67], v[248:251], a[0:15]
  s_waitcnt lgkmcnt(8)
  ds_read_b64_tr_b16 a[88:89], v20 offset:32768
  ds_read_b64_tr_b16 a[90:91], v20 offset:33280
  v_mfma_f32_32x32x16_bf16 a[16:31], a[68:71], v[248:251], a[16:31]
  s_waitcnt lgkmcnt(8)
  ds_read_b64_tr_b16 a[92:93], v21 offset:32768
  ds_read_b64_tr_b16 a[94:95], v21 offset:33280
  v_accvgpr_read_b32 v18, a248
  v_add_u32 v18, 61440, v18
  v_xor_b32 v19, 32, v18
  v_mfma_f32_32x32x16_bf16 a[32:47], a[72:75], v[248:251], a[32:47]
  s_waitcnt vmcnt(7) lgkmcnt(8)
  s_barrier
  ds_read_b64_tr_b16 a[64:65], v18 offset:36864
  ds_read_b64_tr_b16 a[66:67], v18 offset:37120
  buffer_load_dwordx4 v12, s[20:23], s50 offen offset:3072 lds
  v_mfma_f32_32x32x16_bf16 a[48:63], a[76:79], v[248:251], a[48:63]
  s_waitcnt lgkmcnt(8)
  ds_read_b64_tr_b16 a[68:69], v19 offset:36864
  ds_read_b64_tr_b16 a[70:71], v19 offset:37120
  v_mfma_f32_32x32x16_bf16 a[0:15], a[80:83], v[252:255], a[0:15]
  s_waitcnt lgkmcnt(8)
  ds_read_b64_tr_b16 a[72:73], v18 offset:37888
  ds_read_b64_tr_b16 a[74:75], v18 offset:38144
  s_add_u32 s49, s44, 1
  s_and_b32 s49, s49, 7
  s_mul_i32 s49, s49, 229376
  v_mfma_f32_32x32x16_bf16 a[16:31], a[84:87], v[252:255], a[16:31]
  s_waitcnt lgkmcnt(8)
  ds_read_b64_tr_b16 a[76:77], v19 offset:37888
  ds_read_b64_tr_b16 a[78:79], v19 offset:38144
  s_add_u32 m0, s43, 147456
  s_add_u32 s49, s49, s48
  v_cmp_eq_u32 vcc, 0, v31
  s_cbranch_vccnz mk_pdC_spin
mk_pdC_ok:
  v_readfirstlane_b32 s94, v31
  v_readfirstlane_b32 s95, v31
  v_mfma_f32_32x32x16_bf16 a[32:47], a[88:91], v[252:255], a[32:47]
  s_waitcnt lgkmcnt(8)
  ds_read_b64_tr_b16 a[80:81], v18 offset:40960
  ds_read_b64_tr_b16 a[82:83], v18 offset:41216
  buffer_load_dwordx4 v13, s[16:19], s49 offen offset:0 lds
  v_mfma_f32_32x32x16_bf16 a[48:63], a[92:95], v[252:255], a[48:63]
  s_waitcnt lgkmcnt(8)
  ds_read_b64_tr_b16 a[84:85], v19 offset:40960
  ds_read_b64_tr_b16 a[86:87], v19 offset:41216
  buffer_load_dwordx4 v14, s[16:19], s49 offen offset:1024 lds
  v_mfma_f32_32x32x16_bf16 a[128:143], a[64:67], v[128:131], 0
  s_waitcnt lgkmcnt(8)
  ds_read_b64_tr_b16 a[88:89], v18 offset:41984
  ds_read_b64_tr_b16 a[90:91], v18 offset:42240
  v_mfma_f32_32x32x16_bf16 a[144:159], a[68:71], v[128:131], 0
  s_waitcnt lgkmcnt(8)
  ds_read_b64_tr_b16 a[92:93], v19 offset:41984
  ds_read_b64_tr_b16 a[94:95], v19 offset:42240
  v_mfma_f32_32x32x16_bf16 a[128:143], a[72:75], v[132:135], a[128:143]
  s_waitcnt lgkmcnt(8)
  ds_read_b64_tr_b16 a[64:65], v18 offset:45056
  ds_read_b64_tr_b16 a[66:67], v18 offset:45312
  buffer_load_dwordx4 v15, s[20:23], s49 offen offset:2048 lds
  v_mfma_f32_32x32x16_bf16 a[144:159], a[76:79], v[132:135], a[144:159]
  s_waitcnt lgkmcnt(8)
  ds_read_b64_tr_b16 a[68:69], v19 offset:45056
  ds_read_b64_tr_b16 a[70:71], v19 offset:45312
  buffer_load_dwordx4 v16, s[20:23], s49 offen offset:3072 lds
  v_mfma_f32_32x32x16_bf16 a[128:143], a[80:83], v[136:139], a[128:143]
  s_waitcnt lgkmcnt(8)
  ds_read_b64_tr_b16 a[72:73], v18 offset:46080
  ds_read_b64_tr_b16 a[74:75], v18 offset:46336
  v_accvgpr_read_b32 v22, a0
  v_accvgpr_read_b32 v23, a1
  v_accvgpr_read_b32 v26, a2
  v_accvgpr_read_b32 v27, a3
  v_mfma_f32_32x32x16_bf16 a[144:159], a[84:87], v[136:139], a[144:159]
  s_waitcnt lgkmcnt(8)
  ds_read_b64_tr_b16 a[76:77], v19 offset:46080
  ds_read_b64_tr_b16 a[78:79], v19 offset:46336
  v_mul_f32 v24, v22, v4
  v_mul_f32 v25, v23, v4
  v_mul_f32 v2, v26, v4
  v_mul_f32 v5, v27, v4
  v_mfma_f32_32x32x16_bf16 a[128:143], a[88:91], v[140:143], a[128:143]
  s_waitcnt lgkmcnt(8)
  ds_read_b64_tr_b16 a[80:81], v18 offset:49152
  ds_read_b64_tr_b16 a[82:83], v18 offset:49408
  v_exp_f32 v24, v24
  v_exp_f32 v25, v25
  v_mfma_f32_32x32x16_bf16 a[144:159], a[92:95], v[140:143], a[144:159]
  s_waitcnt lgkmcnt(8)
  ds_read_b64_tr_b16 a[84:85], v19 offset:49152
  ds_read_b64_tr_b16 a[86:87], v19 offset:49408
  v_exp_f32 v2, v2
  v_exp_f32 v5, v5
  v_mfma_f32_32x32x16_bf16 a[128:143], a[64:67], v[144:147], a[128:143]
  s_waitcnt lgkmcnt(8)
  ds_read_b64_tr_b16 a[88:89], v18 offset:50176
  ds_read_b64_tr_b16 a[90:91], v18 offset:50432
  v_fma_f32 v24, v24, v6, v6
  v_fma_f32 v25, v25, v6, v6
  v_fma_f32 v2, v2, v6, v6
  v_fma_f32 v5, v5, v6, v6
  v_mfma_f32_32x32x16_bf16 a[144:159], a[68:71], v[144:147], a[144:159]
  s_waitcnt lgkmcnt(8)
  ds_read_b64_tr_b16 a[92:93], v19 offset:50176
  ds_read_b64_tr_b16 a[94:95], v19 offset:50432
  v_rcp_f32 v24, v24
  v_rcp_f32 v25, v25
  v_mfma_f32_32x32x16_bf16 a[128:143], a[72:75], v[148:151], a[128:143]
  s_waitcnt lgkmcnt(8)
  ds_read_b64_tr_b16 a[64:65], v18 offset:53248
  ds_read_b64_tr_b16 a[66:67], v18 offset:53504
  v_rcp_f32 v2, v2
  v_rcp_f32 v5, v5
  v_mfma_f32_32x32x16_bf16 a[144:159], a[76:79], v[148:151], a[144:159]
  s_waitcnt lgkmcnt(8)
  ds_read_b64_tr_b16 a[68:69], v19 offset:53248
  ds_read_b64_tr_b16 a[70:71], v19 offset:53504
  v_mul_f32 v22, v22, v24
  v_mul_f32 v23, v23, v25
  v_mul_f32 v26, v26, v2
  v_mul_f32 v27, v27, v5
  v_mfma_f32_32x32x16_bf16 a[128:143], a[80:83], v[152:155], a[128:143]
  s_waitcnt lgkmcnt(8)
  ds_read_b64_tr_b16 a[72:73], v18 offset:54272
  ds_read_b64_tr_b16 a[74:75], v18 offset:54528
  v_accvgpr_read_b32 v24, a8
  v_accvgpr_read_b32 v25, a9
  v_accvgpr_read_b32 v2, a10
  v_accvgpr_read_b32 v5, a11
  v_mfma_f32_32x32x16_bf16 a[144:159], a[84:87], v[152:155], a[144:159]
  s_waitcnt lgkmcnt(8)
  ds_read_b64_tr_b16 a[76:77], v19 offset:54272
  ds_read_b64_tr_b16 a[78:79], v19 offset:54528
  v_mul_f32 v22, v22, v24
  v_mul_f32 v23, v23, v25
  v_mul_f32 v26, v26, v2
  v_mul_f32 v27, v27, v5
  v_mfma_f32_32x32x16_bf16 a[128:143], a[88:91], v[156:159], a[128:143]
  s_waitcnt lgkmcnt(8)
  ds_read_b64_tr_b16 a[80:81], v18 offset:57344
  ds_read_b64_tr_b16 a[82:83], v18 offset:57600
  v_cvt_pk_bf16_f32 v28, v22, v23
  v_cvt_pk_bf16_f32 v29, v26, v27
  v_accvgpr_read_b32 v22, a4
  v_accvgpr_read_b32 v23, a5
  v_mfma_f32_32x32x16_bf16 a[144:159], a[92:95], v[156:159], a[144:159]
  s_waitcnt lgkmcnt(8)
  ds_read_b64_tr_b16 a[84:85], v19 offset:57344
  ds_read_b64_tr_b16 a[86:87], v19 offset:57600
  v_accvgpr_read_b32 v26, a6
  v_accvgpr_read_b32 v27, a7
  v_mul_f32 v24, v22, v4
  v_mul_f32 v25, v23, v4
  v_mfma_f32_32x32x16_bf16 a[128:143], a[64:67], v[160:163], a[128:143]
  s_waitcnt lgkmcnt(8)
  ds_read_b64_tr_b16 a[88:89], v18 offset:58368
  ds_read_b64_tr_b16 a[90:91], v18 offset:58624
  v_mul_f32 v2, v26, v4
  v_mul_f32 v5, v27, v4
  v_exp_f32 v24, v24
  v_mfma_f32_32x32x16_bf16 a[144:159], a[68:71], v[160:163], a[144:159]
  s_waitcnt lgkmcnt(8)
  ds_read_b64_tr_b16 a[92:93], v19 offset:58368
  ds_read_b64_tr_b16 a[94:95], v19 offset:58624
  v_exp_f32 v25, v25
  v_add_u32 v18, 61440, v18
  v_add_u32 v19, 61440, v19
  v_mfma_f32_32x32x16_bf16 a[128:143], a[72:75], v[164:167], a[128:143]
  s_waitcnt lgkmcnt(8)
  ds_read_b64_tr_b16 a[64:65], v18 offset:0
  ds_read_b64_tr_b16 a[66:67], v18 offset:256
  v_exp_f32 v2, v2
  v_exp_f32 v5, v5
  v_mfma_f32_32x32x16_bf16 a[144:159], a[76:79], v[164:167], a[144:159]
  s_waitcnt lgkmcnt(8)
  ds_read_b64_tr_b16 a[68:69], v19 offset:0
  ds_read_b64_tr_b16 a[70:71], v19 offset:256
  v_fma_f32 v24, v24, v6, v6
  v_fma_f32 v25, v25, v6, v6
  v_fma_f32 v2, v2, v6, v6
  v_fma_f32 v5, v5, v6, v6
  v_mfma_f32_32x32x16_bf16 a[128:143], a[80:83], v[168:171], a[128:143]
  s_waitcnt lgkmcnt(8)
  ds_read_b64_tr_b16 a[72:73], v18 offset:1024
  ds_read_b64_tr_b16 a[74:75], v18 offset:1280
  v_rcp_f32 v24, v24
  v_rcp_f32 v25, v25
  v_mfma_f32_32x32x16_bf16 a[144:159], a[84:87], v[168:171], a[144:159]
  s_waitcnt lgkmcnt(8)
  ds_read_b64_tr_b16 a[76:77], v19 offset:1024
  ds_read_b64_tr_b16 a[78:79], v19 offset:1280
  v_rcp_f32 v2, v2
  v_rcp_f32 v5, v5
  v_mfma_f32_32x32x16_bf16 a[128:143], a[88:91], v[172:175], a[128:143]
  s_waitcnt lgkmcnt(8)
  ds_read_b64_tr_b16 a[80:81], v18 offset:4096
  ds_read_b64_tr_b16 a[82:83], v18 offset:4352
  v_mul_f32 v22, v22, v24
  v_mul_f32 v23, v23, v25
  v_mul_f32 v26, v26, v2
  v_mul_f32 v27, v27, v5
  v_mfma_f32_32x32x16_bf16 a[144:159], a[92:95], v[172:175], a[144:159]
  s_waitcnt lgkmcnt(8)
  ds_read_b64_tr_b16 a[84:85], v19 offset:4096
  ds_read_b64_tr_b16 a[86:87], v19 offset:4352
  v_accvgpr_read_b32 v24, a12
  v_accvgpr_read_b32 v25, a13
  v_accvgpr_read_b32 v2, a14
  v_accvgpr_read_b32 v5, a15
  v_mfma_f32_32x32x16_bf16 a[128:143], a[64:67], v[176:179], a[128:143]
  s_waitcnt lgkmcnt(8)
  ds_read_b64_tr_b16 a[88:89], v18 offset:5120
  ds_read_b64_tr_b16 a[90:91], v18 offset:5376
  v_mul_f32 v22, v22, v24
  v_mul_f32 v23, v23, v25
  v_mul_f32 v26, v26, v2
  v_mul_f32 v27, v27, v5
  v_mfma_f32_32x32x16_bf16 a[144:159], a[68:71], v[176:179], a[144:159]
  s_waitcnt lgkmcnt(8)
  ds_read_b64_tr_b16 a[92:93], v19 offset:5120
  ds_read_b64_tr_b16 a[94:95], v19 offset:5376
  v_cvt_pk_bf16_f32 v30, v22, v23
  v_add_u32 v24, s66, v7
  v_subrev_u32 v18, 122880, v18
  v_subrev_u32 v19, 122880, v19
  v_mfma_f32_32x32x16_bf16 a[128:143], a[72:75], v[180:183], a[128:143]
  s_waitcnt vmcnt(4) lgkmcnt(8)
  s_barrier
  ds_read_b64_tr_b16 a[64:65], v18 offset:0
  ds_read_b64_tr_b16 a[66:67], v18 offset:256
  v_cvt_pk_bf16_f32 v31, v26, v27
  v_mfma_f32_32x32x16_bf16 a[144:159], a[76:79], v[180:183], a[144:159]
  s_waitcnt lgkmcnt(8)
  ds_read_b64_tr_b16 a[68:69], v19 offset:0
  ds_read_b64_tr_b16 a[70:71], v19 offset:256
  global_store_dwordx4 v24, v[28:31], s[38:39] offset:0 sc1
  v_accvgpr_read_b32 v22, a16
  v_accvgpr_read_b32 v23, a17
  v_accvgpr_read_b32 v26, a18
  v_mfma_f32_32x32x16_bf16 a[128:143], a[80:83], v[184:187], a[128:143]
  s_waitcnt lgkmcnt(8)
  ds_read_b64_tr_b16 a[72:73], v18 offset:1024
  ds_read_b64_tr_b16 a[74:75], v18 offset:1280
  v_accvgpr_read_b32 v27, a19
  v_mul_f32 v24, v22, v4
  v_mul_f32 v25, v23, v4
  v_mul_f32 v2, v26, v4
  v_mfma_f32_32x32x16_bf16 a[144:159], a[84:87], v[184:187], a[144:159]
  s_waitcnt lgkmcnt(8)
  ds_read_b64_tr_b16 a[76:77], v19 offset:1024
  ds_read_b64_tr_b16 a[78:79], v19 offset:1280
  v_mul_f32 v5, v27, v4
  v_exp_f32 v24, v24
  v_mfma_f32_32x32x16_bf16 a[128:143], a[88:91], v[188:191], a[128:143]
  s_waitcnt lgkmcnt(8)
  ds_read_b64_tr_b16 a[80:81], v18 offset:4096
  ds_read_b64_tr_b16 a[82:83], v18 offset:4352
  v_exp_f32 v25, v25
  v_exp_f32 v2, v2
  v_mfma_f32_32x32x16_bf16 a[144:159], a[92:95], v[188:191], a[144:159]
  s_waitcnt lgkmcnt(8)
  ds_read_b64_tr_b16 a[84:85], v19 offset:4096
  ds_read_b64_tr_b16 a[86:87], v19 offset:4352
  v_exp_f32 v5, v5
  v_fma_f32 v24, v24, v6, v6
  v_fma_f32 v25, v25, v6, v6
  v_mfma_f32_32x32x16_bf16 a[128:143], a[64:67], v[192:195], a[128:143]
  s_waitcnt lgkmcnt(8)
  ds_read_b64_tr_b16 a[88:89], v18 offset:5120
  ds_read_b64_tr_b16 a[90:91], v18 offset:5376
  v_fma_f32 v2, v2, v6, v6
  v_fma_f32 v5, v5, v6, v6
  v_rcp_f32 v24, v24
  v_mfma_f32_32x32x16_bf16 a[144:159], a[68:71], v[192:195], a[144:159]
  s_waitcnt lgkmcnt(8)
  ds_read_b64_tr_b16 a[92:93], v19 offset:5120
  ds_read_b64_tr_b16 a[94:95], v19 offset:5376
  v_rcp_f32 v25, v25
  v_rcp_f32 v2, v2
  v_mfma_f32_32x32x16_bf16 a[128:143], a[72:75], v[196:199], a[128:143]
  s_waitcnt lgkmcnt(8)
  ds_read_b64_tr_b16 a[64:65], v18 offset:8192
  ds_read_b64_tr_b16 a[66:67], v18 offset:8448
  v_rcp_f32 v5, v5
  v_mul_f32 v22, v22, v24
  v_mul_f32 v23, v23, v25
  v_mfma_f32_32x32x16_bf16 a[144:159], a[76:79], v[196:199], a[144:159]
  s_waitcnt lgkmcnt(8)
  ds_read_b64_tr_b16 a[68:69], v19 offset:8192
  ds_read_b64_tr_b16 a[70:71], v19 offset:8448
  v_mul_f32 v26, v26, v2
  v_mul_f32 v27, v27, v5
  v_accvgpr_read_b32 v24, a24
  v_accvgpr_read_b32 v25, a25
  v_mfma_f32_32x32x16_bf16 a[128:143], a[80:83], v[200:203], a[128:143]
  s_waitcnt lgkmcnt(8)
  ds_read_b64_tr_b16 a[72:73], v18 offset:9216
  ds_read_b64_tr_b16 a[74:75], v18 offset:9472
  v_accvgpr_read_b32 v2, a26
  v_accvgpr_read_b32 v5, a27
  v_mul_f32 v22, v22, v24
  v_mul_f32 v23, v23, v25
  v_mfma_f32_32x32x16_bf16 a[144:159], a[84:87], v[200:203], a[144:159]
  s_waitcnt lgkmcnt(8)
  ds_read_b64_tr_b16 a[76:77], v19 offset:9216
  ds_read_b64_tr_b16 a[78:79], v19 offset:9472
  v_mul_f32 v26, v26, v2
  v_mul_f32 v27, v27, v5
  v_cvt_pk_bf16_f32 v28, v22, v23
  v_cvt_pk_bf16_f32 v29, v26, v27
  v_mfma_f32_32x32x16_bf16 a[128:143], a[88:91], v[204:207], a[128:143]
  s_waitcnt lgkmcnt(8)
  ds_read_b64_tr_b16 a[80:81], v18 offset:12288
  ds_read_b64_tr_b16 a[82:83], v18 offset:12544
  v_accvgpr_read_b32 v22, a20
  v_accvgpr_read_b32 v23, a21
  v_accvgpr_read_b32 v26, a22
  v_accvgpr_read_b32 v27, a23
  v_mfma_f32_32x32x16_bf16 a[144:159], a[92:95], v[204:207], a[144:159]
  s_waitcnt lgkmcnt(8)
  ds_read_b64_tr_b16 a[84:85], v19 offset:12288
  ds_read_b64_tr_b16 a[86:87], v19 offset:12544
  v_mul_f32 v24, v22, v4
  v_mul_f32 v25, v23, v4
  v_mul_f32 v2, v26, v4
  v_mul_f32 v5, v27, v4
  v_mfma_f32_32x32x16_bf16 a[128:143], a[64:67], v[208:211], a[128:143]
  s_waitcnt lgkmcnt(8)
  ds_read_b64_tr_b16 a[88:89], v18 offset:13312
  ds_read_b64_tr_b16 a[90:91], v18 offset:13568
  s_add_u32 s49, s44, 2
  s_and_b32 s49, s49, 7
  s_mul_i32 s49, s49, 229376
  v_mfma_f32_32x32x16_bf16 a[144:159], a[68:71], v[208:211], a[144:159]
  s_waitcnt lgkmcnt(8)
  ds_read_b64_tr_b16 a[92:93], v19 offset:13312
  ds_read_b64_tr_b16 a[94:95], v19 offset:13568
  v_exp_f32 v24, v24
  s_add_u32 m0, s43, 65536
  s_add_u32 s49, s49, s48
  v_mfma_f32_32x32x16_bf16 a[128:143], a[72:75], v[212:215], a[128:143]
  s_waitcnt lgkmcnt(8)
  ds_read_b64_tr_b16 a[64:65], v18 offset:16384
  ds_read_b64_tr_b16 a[66:67], v18 offset:16640
  buffer_load_dwordx4 v13, s[16:19], s49 offen offset:0 lds
  v_exp_f32 v25, v25
  v_mfma_f32_32x32x16_bf16 a[144:159], a[76:79], v[212:215], a[144:159]
  s_waitcnt lgkmcnt(8)
  ds_read_b64_tr_b16 a[68:69], v19 offset:16384
  ds_read_b64_tr_b16 a[70:71], v19 offset:16640
  buffer_load_dwordx4 v14, s[16:19], s49 offen offset:1024 lds
  v_exp_f32 v2, v2
  v_mfma_f32_32x32x16_bf16 a[128:143], a[80:83], v[216:219], a[128:143]
  s_waitcnt lgkmcnt(8)
  ds_read_b64_tr_b16 a[72:73], v18 offset:17408
  ds_read_b64_tr_b16 a[74:75], v18 offset:17664
  v_exp_f32 v5, v5
  v_fma_f32 v24, v24, v6, v6
  v_fma_f32 v25, v25, v6, v6
  v_mfma_f32_32x32x16_bf16 a[144:159], a[84:87], v[216:219], a[144:159]
  s_waitcnt lgkmcnt(8)
  ds_read_b64_tr_b16 a[76:77], v19 offset:17408
  ds_read_b64_tr_b16 a[78:79], v19 offset:17664
  v_fma_f32 v2, v2, v6, v6
  v_fma_f32 v5, v5, v6, v6
  v_rcp_f32 v24, v24
  v_mfma_f32_32x32x16_bf16 a[128:143], a[88:91], v[220:223], a[128:143]
  s_waitcnt lgkmcnt(8)
  ds_read_b64_tr_b16 a[80:81], v18 offset:20480
  ds_read_b64_tr_b16 a[82:83], v18 offset:20736
  buffer_load_dwordx4 v15, s[20:23], s49 offen offset:2048 lds
  v_rcp_f32 v25, v25
  v_mfma_f32_32x32x16_bf16 a[144:159], a[92:95], v[220:223], a[144:159]
  s_waitcnt lgkmcnt(8)
  ds_read_b64_tr_b16 a[84:85], v19 offset:20480
  ds_read_b64_tr_b16 a[86:87], v19 offset:20736
  buffer_load_dwordx4 v16, s[20:23], s49 offen offset:3072 lds
  v_rcp_f32 v2, v2
  v_mfma_f32_32x32x16_bf16 a[128:143], a[64:67], v[224:227], a[128:143]
  s_waitcnt lgkmcnt(8)
  ds_read_b64_tr_b16 a[88:89], v18 offset:21504
  ds_read_b64_tr_b16 a[90:91], v18 offset:21760
  s_add_u32 s49, s44, 3
  s_and_b32 s49, s49, 7
  s_mul_i32 s49, s49, 229376
  v_mfma_f32_32x32x16_bf16 a[144:159], a[68:71], v[224:227], a[144:159]
  s_waitcnt lgkmcnt(8)
  ds_read_b64_tr_b16 a[92:93], v19 offset:21504
  ds_read_b64_tr_b16 a[94:95], v19 offset:21760
  v_rcp_f32 v5, v5
  s_add_u32 m0, s43, 32768
  s_add_u32 s49, s49, s48
  v_mfma_f32_32x32x16_bf16 a[128:143], a[72:75], v[228:231], a[128:143]
  s_waitcnt lgkmcnt(8)
  ds_read_b64_tr_b16 a[64:65], v18 offset:24576
  ds_read_b64_tr_b16 a[66:67], v18 offset:24832
  buffer_load_dwordx4 v13, s[16:19], s49 offen offset:0 lds
  v_mul_f32 v22, v22, v24
  v_mul_f32 v23, v23, v25
  v_mfma_f32_32x32x16_bf16 a[144:159], a[76:79], v[228:231], a[144:159]
  s_waitcnt lgkmcnt(8)
  ds_read_b64_tr_b16 a[68:69], v19 offset:24576
  ds_read_b64_tr_b16 a[70:71], v19 offset:24832
  buffer_load_dwordx4 v14, s[16:19], s49 offen offset:1024 lds
  v_mul_f32 v26, v26, v2
  v_mul_f32 v27, v27, v5
  v_mfma_f32_32x32x16_bf16 a[128:143], a[80:83], v[232:235], a[128:143]
  s_waitcnt lgkmcnt(8)
  ds_read_b64_tr_b16 a[72:73], v18 offset:25600
  ds_read_b64_tr_b16 a[74:75], v18 offset:25856
  v_accvgpr_read_b32 v24, a28
  v_accvgpr_read_b32 v25, a29
  v_accvgpr_read_b32 v2, a30
  v_accvgpr_read_b32 v5, a31
  v_mfma_f32_32x32x16_bf16 a[144:159], a[84:87], v[232:235], a[144:159]
  s_waitcnt lgkmcnt(8)
  ds_read_b64_tr_b16 a[76:77], v19 offset:25600
  ds_read_b64_tr_b16 a[78:79], v19 offset:25856
  v_mul_f32 v22, v22, v24
  v_mul_f32 v23, v23, v25
  v_mul_f32 v26, v26, v2
  v_mul_f32 v27, v27, v5
  v_mfma_f32_32x32x16_bf16 a[128:143], a[88:91], v[236:239], a[128:143]
  s_waitcnt lgkmcnt(8)
  ds_read_b64_tr_b16 a[80:81], v18 offset:28672
  ds_read_b64_tr_b16 a[82:83], v18 offset:28928
  buffer_load_dwordx4 v15, s[20:23], s49 offen offset:2048 lds
  v_cvt_pk_bf16_f32 v30, v22, v23
  v_add_u32 v24, s66, v7
  v_mfma_f32_32x32x16_bf16 a[144:159], a[92:95], v[236:239], a[144:159]
  s_waitcnt lgkmcnt(8)
  ds_read_b64_tr_b16 a[84:85], v19 offset:28672
  ds_read_b64_tr_b16 a[86:87], v19 offset:28928
  buffer_load_dwordx4 v16, s[20:23], s49 offen offset:3072 lds
  v_cvt_pk_bf16_f32 v31, v26, v27
  v_mfma_f32_32x32x16_bf16 a[128:143], a[64:67], v[240:243], a[128:143]
  s_waitcnt lgkmcnt(8)
  ds_read_b64_tr_b16 a[88:89], v18 offset:29696
  ds_read_b64_tr_b16 a[90:91], v18 offset:29952
  global_store_dwordx4 v24, v[28:31], s[38:39] offset:1024 sc1
  v_accvgpr_read_b32 v22, a32
  v_accvgpr_read_b32 v23, a33
  v_accvgpr_read_b32 v26, a34
  v_mfma_f32_32x32x16_bf16 a[144:159], a[68:71], v[240:243], a[144:159]
  s_waitcnt lgkmcnt(8)
  ds_read_b64_tr_b16 a[92:93], v19 offset:29696
  ds_read_b64_tr_b16 a[94:95], v19 offset:29952
  v_bfe_u32 v18, v1, 4, 1
  v_lshl_add_u32 v18, v18, 11, v9
  v_add_u32 v18, 122880, v18
  v_xor_b32 v19, 32, v18
  v_xor_b32 v20, 64, v18
  v_xor_b32 v21, 96, v18
  v_mfma_f32_32x32x16_bf16 a[128:143], a[72:75], v[244:247], a[128:143]
  s_waitcnt vmcnt(10) lgkmcnt(8)
  s_barrier
  ds_read_b64_tr_b16 a[64:65], v18 offset:8192
  ds_read_b64_tr_b16 a[66:67], v18 offset:8704
  v_accvgpr_read_b32 v27, a35
  v_mul_f32 v24, v22, v4
  v_mfma_f32_32x32x16_bf16 a[144:159], a[76:79], v[244:247], a[144:159]
  s_waitcnt lgkmcnt(8)
  ds_read_b64_tr_b16 a[68:69], v19 offset:8192
  ds_read_b64_tr_b16 a[70:71], v19 offset:8704
  v_mul_f32 v25, v23, v4
  v_mul_f32 v2, v26, v4
  v_mul_f32 v5, v27, v4
  v_mfma_f32_32x32x16_bf16 a[128:143], a[80:83], v[248:251], a[128:143]
  s_waitcnt lgkmcnt(8)
  ds_read_b64_tr_b16 a[72:73], v20 offset:8192
  ds_read_b64_tr_b16 a[74:75], v20 offset:8704
  s_add_u32 s49, s44, 4
  s_and_b32 s49, s49, 7
  s_mul_i32 s49, s49, 229376
  v_mfma_f32_32x32x16_bf16 a[144:159], a[84:87], v[248:251], a[144:159]
  s_waitcnt lgkmcnt(8)
  ds_read_b64_tr_b16 a[76:77], v21 offset:8192
  ds_read_b64_tr_b16 a[78:79], v21 offset:8704
  v_exp_f32 v24, v24
  s_add_u32 m0, s43, 49152
  s_add_u32 s49, s49, s48
  v_mfma_f32_32x32x16_bf16 a[128:143], a[88:91], v[252:255], a[128:143]
  s_waitcnt lgkmcnt(8)
  ds_read_b64_tr_b16 a[80:81], v18 offset:12288
  ds_read_b64_tr_b16 a[82:83], v18 offset:12800
  buffer_load_dwordx4 v13, s[16:19], s49 offen offset:0 lds
  v_exp_f32 v25, v25
  v_mfma_f32_32x32x16_bf16 a[144:159], a[92:95], v[252:255], a[144:159]
  s_waitcnt lgkmcnt(8)
  ds_read_b64_tr_b16 a[84:85], v19 offset:12288
  ds_read_b64_tr_b16 a[86:87], v19 offset:12800
  buffer_load_dwordx4 v14, s[16:19], s49 offen offset:1024 lds
  v_exp_f32 v2, v2
  v_mfma_f32_32x32x16_bf16 v[64:79], a[64:67], v[128:131], 0
  s_waitcnt lgkmcnt(8)
  ds_read_b64_tr_b16 a[88:89], v20 offset:12288
  ds_read_b64_tr_b16 a[90:91], v20 offset:12800
  v_exp_f32 v5, v5
  v_fma_f32 v24, v24, v6, v6
  v_fma_f32 v25, v25, v6, v6
  v_mfma_f32_32x32x16_bf16 v[80:95], a[68:71], v[128:131], 0
  s_waitcnt lgkmcnt(8)
  ds_read_b64_tr_b16 a[92:93], v21 offset:12288
  ds_read_b64_tr_b16 a[94:95], v21 offset:12800
  v_fma_f32 v2, v2, v6, v6
  v_fma_f32 v5, v5, v6, v6
  v_rcp_f32 v24, v24
  v_mfma_f32_32x32x16_bf16 v[96:111], a[72:75], v[128:131], 0
  s_waitcnt lgkmcnt(8)
  ds_read_b64_tr_b16 a[64:65], v18 offset:16384
  ds_read_b64_tr_b16 a[66:67], v18 offset:16896
  buffer_load_dwordx4 v15, s[20:23], s49 offen offset:2048 lds
  v_rcp_f32 v25, v25
  v_mfma_f32_32x32x16_bf16 v[112:127], a[76:79], v[128:131], 0
  s_waitcnt lgkmcnt(8)
  ds_read_b64_tr_b16 a[68:69], v19 offset:16384
  ds_read_b64_tr_b16 a[70:71], v19 offset:16896
  buffer_load_dwordx4 v16, s[20:23], s49 offen offset:3072 lds
  v_mov_b32 v47, s94
  v_mfma_f32_32x32x16_bf16 v[64:79], a[80:83], v[132:135], v[64:79]
  s_waitcnt lgkmcnt(8)
  ds_read_b64_tr_b16 a[72:73], v20 offset:16384
  ds_read_b64_tr_b16 a[74:75], v20 offset:16896
  v_rcp_f32 v2, v2
  v_rcp_f32 v5, v5
  v_mfma_f32_32x32x16_bf16 v[80:95], a[84:87], v[132:135], v[80:95]
  s_waitcnt lgkmcnt(8)
  ds_read_b64_tr_b16 a[76:77], v21 offset:16384
  ds_read_b64_tr_b16 a[78:79], v21 offset:16896
  v_mul_f32 v22, v22, v24
  v_mul_f32 v23, v23, v25
  v_mul_f32 v26, v26, v2
  v_mul_f32 v27, v27, v5
  v_mfma_f32_32x32x16_bf16 v[96:111], a[88:91], v[132:135], v[96:111]
  s_waitcnt lgkmcnt(8)
  ds_read_b64_tr_b16 a[80:81], v18 offset:20480
  ds_read_b64_tr_b16 a[82:83], v18 offset:20992
  v_accvgpr_read_b32 v24, a40
  v_accvgpr_read_b32 v25, a41
  v_accvgpr_read_b32 v2, a42
  v_accvgpr_read_b32 v5, a43
  v_mfma_f32_32x32x16_bf16 v[112:127], a[92:95], v[132:135], v[112:127]
  s_waitcnt lgkmcnt(8)
  ds_read_b64_tr_b16 a[84:85], v19 offset:20480
  ds_read_b64_tr_b16 a[86:87], v19 offset:20992
  v_mul_f32 v22, v22, v24
  v_mul_f32 v23, v23, v25
  v_mul_f32 v26, v26, v2
  v_mul_f32 v27, v27, v5
  v_mfma_f32_32x32x16_bf16 v[64:79], a[64:67], v[136:139], v[64:79]
  s_waitcnt lgkmcnt(8)
  ds_read_b64_tr_b16 a[88:89], v20 offset:20480
  ds_read_b64_tr_b16 a[90:91], v20 offset:20992
  v_cvt_pk_bf16_f32 v28, v22, v23
  s_add_u32 s49, s44, 5
  s_and_b32 s49, s49, 7
  s_mul_i32 s49, s49, 229376
  v_mfma_f32_32x32x16_bf16 v[80:95], a[68:71], v[136:139], v[80:95]
  s_waitcnt lgkmcnt(8)
  ds_read_b64_tr_b16 a[92:93], v21 offset:20480
  ds_read_b64_tr_b16 a[94:95], v21 offset:20992
  v_cvt_pk_bf16_f32 v29, v26, v27
  v_accvgpr_read_b32 v22, a36
  s_add_u32 m0, s43, 81920
  s_add_u32 s49, s49, s48
  v_mfma_f32_32x32x16_bf16 v[96:111], a[72:75], v[136:139], v[96:111]
  s_waitcnt lgkmcnt(8)
  ds_read_b64_tr_b16 a[64:65], v18 offset:24576
  ds_read_b64_tr_b16 a[66:67], v18 offset:25088
  buffer_load_dwordx4 v13, s[16:19], s49 offen offset:0 lds
  v_accvgpr_read_b32 v23, a37
  v_accvgpr_read_b32 v26, a38
  v_mfma_f32_32x32x16_bf16 v[112:127], a[76:79], v[136:139], v[112:127]
  s_waitcnt lgkmcnt(8)
  ds_read_b64_tr_b16 a[68:69], v19 offset:24576
  ds_read_b64_tr_b16 a[70:71], v19 offset:25088
  buffer_load_dwordx4 v14, s[16:19], s49 offen offset:1024 lds
  v_accvgpr_read_b32 v27, a39
  v_mul_f32 v24, v22, v4
  v_mfma_f32_32x32x16_bf16 v[64:79], a[80:83], v[140:143], v[64:79]
  s_waitcnt lgkmcnt(8)
  ds_read_b64_tr_b16 a[72:73], v20 offset:24576
  ds_read_b64_tr_b16 a[74:75], v20 offset:25088
  v_mul_f32 v25, v23, v4
  v_mul_f32 v2, v26, v4
  v_mul_f32 v5, v27, v4
  v_mfma_f32_32x32x16_bf16 v[80:95], a[84:87], v[140:143], v[80:95]
  s_waitcnt lgkmcnt(8)
  ds_read_b64_tr_b16 a[76:77], v21 offset:24576
  ds_read_b64_tr_b16 a[78:79], v21 offset:25088
  v_exp_f32 v24, v24
  v_exp_f32 v25, v25
  v_mfma_f32_32x32x16_bf16 v[96:111], a[88:91], v[140:143], v[96:111]
  s_waitcnt lgkmcnt(8)
  ds_read_b64_tr_b16 a[80:81], v18 offset:28672
  ds_read_b64_tr_b16 a[82:83], v18 offset:29184
  buffer_load_dwordx4 v15, s[20:23], s49 offen offset:2048 lds
  v_exp_f32 v2, v2
  v_mfma_f32_32x32x16_bf16 v[112:127], a[92:95], v[140:143], v[112:127]
  s_waitcnt lgkmcnt(8)
  ds_read_b64_tr_b16 a[84:85], v19 offset:28672
  ds_read_b64_tr_b16 a[86:87], v19 offset:29184
  buffer_load_dwordx4 v16, s[20:23], s49 offen offset:3072 lds
  v_exp_f32 v5, v5
  v_mfma_f32_32x32x16_bf16 v[64:79], a[64:67], v[144:147], v[64:79]
  s_waitcnt lgkmcnt(8)
  ds_read_b64_tr_b16 a[88:89], v20 offset:28672
  ds_read_b64_tr_b16 a[90:91], v20 offset:29184
  v_fma_f32 v24, v24, v6, v6
  s_add_u32 s49, s44, 6
  s_and_b32 s49, s49, 7
  s_mul_i32 s49, s49, 229376
  v_mfma_f32_32x32x16_bf16 v[80:95], a[68:71], v[144:147], v[80:95]
mk_wC3:
  s_cbranch_execz mk_wC4
  s_waitcnt lgkmcnt(8)
  ds_read_b64_tr_b16 a[92:93], v21 offset:28672
  ds_read_b64_tr_b16 a[94:95], v21 offset:29184
  v_fma_f32 v25, v25, v6, v6
  v_fma_f32 v2, v2, v6, v6
  s_add_u32 m0, s43, 98304
  s_add_u32 s49, s49, s48
  v_mfma_f32_32x32x16_bf16 v[96:111], a[72:75], v[144:147], v[96:111]
  s_waitcnt lgkmcnt(8)
  ds_read_b64_tr_b16 a[64:65], v18 offset:32768
  ds_read_b64_tr_b16 a[66:67], v18 offset:33280
  buffer_load_dwordx4 v13, s[16:19], s49 offen offset:0 lds
  v_fma_f32 v5, v5, v6, v6
  v_mfma_f32_32x32x16_bf16 v[112:127], a[76:79], v[144:147], v[112:127]
  s_waitcnt lgkmcnt(8)
  ds_read_b64_tr_b16 a[68:69], v19 offset:32768
  ds_read_b64_tr_b16 a[70:71], v19 offset:33280
  buffer_load_dwordx4 v14, s[16:19], s49 offen offset:1024 lds
  v_rcp_f32 v24, v24
  v_mfma_f32_32x32x16_bf16 v[64:79], a[80:83], v[148:151], v[64:79]
  s_waitcnt lgkmcnt(8)
  ds_read_b64_tr_b16 a[72:73], v20 offset:32768
  ds_read_b64_tr_b16 a[74:75], v20 offset:33280
  v_rcp_f32 v25, v25
  v_rcp_f32 v2, v2
  v_mfma_f32_32x32x16_bf16 v[80:95], a[84:87], v[148:151], v[80:95]
  s_waitcnt lgkmcnt(8)
  ds_read_b64_tr_b16 a[76:77], v21 offset:32768
  ds_read_b64_tr_b16 a[78:79], v21 offset:33280
  v_rcp_f32 v5, v5
  v_mul_f32 v22, v22, v24
  v_mul_f32 v23, v23, v25
  v_mfma_f32_32x32x16_bf16 v[96:111], a[88:91], v[148:151], v[96:111]
  s_waitcnt lgkmcnt(8)
  ds_read_b64_tr_b16 a[80:81], v18 offset:36864
  ds_read_b64_tr_b16 a[82:83], v18 offset:37376
  buffer_load_dwordx4 v15, s[20:23], s49 offen offset:2048 lds
  v_mul_f32 v26, v26, v2
  v_mul_f32 v27, v27, v5
  v_mfma_f32_32x32x16_bf16 v[112:127], a[92:95], v[148:151], v[112:127]
  s_waitcnt lgkmcnt(8)
  ds_read_b64_tr_b16 a[84:85], v19 offset:36864
  ds_read_b64_tr_b16 a[86:87], v19 offset:37376
  buffer_load_dwordx4 v16, s[20:23], s49 offen offset:3072 lds
  v_accvgpr_read_b32 v24, a44
  v_accvgpr_read_b32 v25, a45
  v_mfma_f32_32x32x16_bf16 v[64:79], a[64:67], v[152:155], v[64:79]
  s_waitcnt lgkmcnt(8)
  ds_read_b64_tr_b16 a[88:89], v20 offset:36864
  ds_read_b64_tr_b16 a[90:91], v20 offset:37376
  v_accvgpr_read_b32 v2, a46
  s_add_u32 s49, s44, 7
  s_and_b32 s49, s49, 7
  s_mul_i32 s49, s49, 229376
  v_mfma_f32_32x32x16_bf16 v[80:95], a[68:71], v[152:155], v[80:95]
  s_waitcnt lgkmcnt(8)
  ds_read_b64_tr_b16 a[92:93], v21 offset:36864
  ds_read_b64_tr_b16 a[94:95], v21 offset:37376
  s_add_u32 m0, s43, 114688
  s_add_u32 s49, s49, s48
  v_subrev_u32 v18, 61440, v18
  v_subrev_u32 v19, 61440, v19
  v_subrev_u32 v20, 61440, v20
  v_subrev_u32 v21, 61440, v21
  v_mfma_f32_32x32x16_bf16 v[96:111], a[72:75], v[152:155], v[96:111]
  s_waitcnt vmcnt(13) lgkmcnt(8)
  s_barrier
  ds_read_b64_tr_b16 a[64:65], v18 offset:4096
  ds_read_b64_tr_b16 a[66:67], v18 offset:4608
  buffer_load_dwordx4 v13, s[16:19], s49 offen offset:0 lds
  v_mfma_f32_32x32x16_bf16 v[112:127], a[76:79], v[152:155], v[112:127]
  s_waitcnt lgkmcnt(8)
  ds_read_b64_tr_b16 a[68:69], v19 offset:4096
  ds_read_b64_tr_b16 a[70:71], v19 offset:4608
  buffer_load_dwordx4 v14, s[16:19], s49 offen offset:1024 lds
  v_accvgpr_read_b32 v5, a47
  v_mul_f32 v22, v22, v24
  v_mfma_f32_32x32x16_bf16 v[64:79], a[80:83], v[156:159], v[64:79]
  s_waitcnt lgkmcnt(8)
  ds_read_b64_tr_b16 a[72:73], v20 offset:4096
  ds_read_b64_tr_b16 a[74:75], v20 offset:4608
  v_mul_f32 v23, v23, v25
  v_mul_f32 v26, v26, v2
  v_mul_f32 v27, v27, v5
  v_cvt_pk_bf16_f32 v30, v22, v23
  v_mfma_f32_32x32x16_bf16 v[80:95], a[84:87], v[156:159], v[80:95]
  s_waitcnt lgkmcnt(8)
  ds_read_b64_tr_b16 a[76:77], v21 offset:4096
  ds_read_b64_tr_b16 a[78:79], v21 offset:4608
  v_add_u32 v24, s66, v7
  v_cvt_pk_bf16_f32 v31, v26, v27
  v_mfma_f32_32x32x16_bf16 v[96:111], a[88:91], v[156:159], v[96:111]
  s_waitcnt lgkmcnt(8)
  ds_read_b64_tr_b16 a[80:81], v18 offset:8192
  ds_read_b64_tr_b16 a[82:83], v18 offset:8704
  buffer_load_dwordx4 v15, s[20:23], s49 offen offset:2048 lds
  global_store_dwordx4 v24, v[28:31], s[38:39] offset:2048 sc1
  v_accvgpr_read_b32 v22, a48
  v_mfma_f32_32x32x16_bf16 v[112:127], a[92:95], v[156:159], v[112:127]
  s_waitcnt lgkmcnt(8)
  ds_read_b64_tr_b16 a[84:85], v19 offset:8192
  ds_read_b64_tr_b16 a[86:87], v19 offset:8704
  buffer_load_dwordx4 v16, s[20:23], s49 offen offset:3072 lds
  v_accvgpr_read_b32 v23, a49
  v_accvgpr_read_b32 v26, a50
  v_mfma_f32_32x32x16_bf16 v[64:79], a[64:67], v[160:163], v[64:79]
  s_waitcnt lgkmcnt(8)
  ds_read_b64_tr_b16 a[88:89], v20 offset:8192
  ds_read_b64_tr_b16 a[90:91], v20 offset:8704
  v_accvgpr_read_b32 v27, a51
  v_mul_f32 v24, v22, v4
  v_mul_f32 v25, v23, v4
  v_mul_f32 v2, v26, v4
  v_mfma_f32_32x32x16_bf16 v[80:95], a[68:71], v[160:163], v[80:95]
  s_waitcnt lgkmcnt(8)
  ds_read_b64_tr_b16 a[92:93], v21 offset:8192
  ds_read_b64_tr_b16 a[94:95], v21 offset:8704
  v_mul_f32 v5, v27, v4
  v_exp_f32 v24, v24
  v_mfma_f32_32x32x16_bf16 v[96:111], a[72:75], v[160:163], v[96:111]
  s_waitcnt lgkmcnt(8)
  ds_read_b64_tr_b16 a[64:65], v18 offset:12288
  ds_read_b64_tr_b16 a[66:67], v18 offset:12800
  v_exp_f32 v25, v25
  v_exp_f32 v2, v2
  v_mfma_f32_32x32x16_bf16 v[112:127], a[76:79], v[160:163], v[112:127]
  s_waitcnt lgkmcnt(8)
  ds_read_b64_tr_b16 a[68:69], v19 offset:12288
  ds_read_b64_tr_b16 a[70:71], v19 offset:12800
  v_exp_f32 v5, v5
  v_fma_f32 v24, v24, v6, v6
  v_fma_f32 v25, v25, v6, v6
  v_mfma_f32_32x32x16_bf16 v[64:79], a[80:83], v[164:167], v[64:79]
  s_waitcnt lgkmcnt(8)
  ds_read_b64_tr_b16 a[72:73], v20 offset:12288
  ds_read_b64_tr_b16 a[74:75], v20 offset:12800
  v_fma_f32 v2, v2, v6, v6
  v_fma_f32 v5, v5, v6, v6
  v_rcp_f32 v24, v24
  v_mfma_f32_32x32x16_bf16 v[80:95], a[84:87], v[164:167], v[80:95]
  s_waitcnt lgkmcnt(8)
  ds_read_b64_tr_b16 a[76:77], v21 offset:12288
  ds_read_b64_tr_b16 a[78:79], v21 offset:12800
  v_rcp_f32 v25, v25
  v_rcp_f32 v2, v2
  v_mfma_f32_32x32x16_bf16 v[96:111], a[88:91], v[164:167], v[96:111]
  s_waitcnt lgkmcnt(8)
  ds_read_b64_tr_b16 a[80:81], v18 offset:16384
  ds_read_b64_tr_b16 a[82:83], v18 offset:16896
  v_rcp_f32 v5, v5
  v_mul_f32 v22, v22, v24
  v_mul_f32 v23, v23, v25
  v_mfma_f32_32x32x16_bf16 v[112:127], a[92:95], v[164:167], v[112:127]
  s_waitcnt lgkmcnt(8)
  ds_read_b64_tr_b16 a[84:85], v19 offset:16384
  ds_read_b64_tr_b16 a[86:87], v19 offset:16896
  v_mul_f32 v26, v26, v2
  v_mul_f32 v27, v27, v5
  v_add_u32 v32, s67, v7
  v_add_u32 v33, s70, v7
  v_mfma_f32_32x32x16_bf16 v[64:79], a[64:67], v[168:171], v[64:79]
  s_waitcnt lgkmcnt(8)
  ds_read_b64_tr_b16 a[88:89], v20 offset:16384
  ds_read_b64_tr_b16 a[90:91], v20 offset:16896
  v_accvgpr_read_b32 v24, a56
  v_accvgpr_read_b32 v25, a57
  v_accvgpr_read_b32 v2, a58
  v_accvgpr_read_b32 v5, a59
  v_mfma_f32_32x32x16_bf16 v[80:95], a[68:71], v[168:171], v[80:95]
  s_waitcnt lgkmcnt(8)
  ds_read_b64_tr_b16 a[92:93], v21 offset:16384
  ds_read_b64_tr_b16 a[94:95], v21 offset:16896
  s_lshr_b32 s57, s2, 3
  s_lshl2_add_u32 s57, s57, s40
  s_lshl_b32 s57, s57, 8
  v_lshl_add_u32 v57, v1, 2, s57
  v_subrev_u32 v18, 61440, v18
  v_subrev_u32 v19, 61440, v19
  v_subrev_u32 v20, 61440, v20
  v_subrev_u32 v21, 61440, v21
  v_mfma_f32_32x32x16_bf16 v[96:111], a[72:75], v[168:171], v[96:111]
  s_waitcnt lgkmcnt(8)
  ds_read_b64_tr_b16 a[64:65], v18 offset:32768
  ds_read_b64_tr_b16 a[66:67], v18 offset:33280
  v_mul_f32 v22, v22, v24
  s_getpc_b64 s[22:23]
mk_pcC:
  s_add_u32 s22, s22, mk_join-mk_pcC
  s_addc_u32 s23, s23, -1
  v_mfma_f32_32x32x16_bf16 v[112:127], a[76:79], v[168:171], v[112:127]
  s_waitcnt lgkmcnt(8)
  ds_read_b64_tr_b16 a[68:69], v19 offset:32768
  ds_read_b64_tr_b16 a[70:71], v19 offset:33280
  global_load_dword v45, v57, s[22:23]
  v_mul_f32 v23, v23, v25
  v_mov_b32 v44, s54
  v_add_u32 v37, s92, v7
  v_mfma_f32_32x32x16_bf16 v[64:79], a[80:83], v[172:175], v[64:79]
  s_waitcnt lgkmcnt(8)
  ds_read_b64_tr_b16 a[72:73], v20 offset:32768
  ds_read_b64_tr_b16 a[74:75], v20 offset:33280
  v_mul_f32 v26, v26, v2
  v_mul_f32 v27, v27, v5
  v_cvt_pk_bf16_f32 v28, v22, v23
  v_cvt_pk_bf16_f32 v29, v26, v27
  v_mfma_f32_32x32x16_bf16 v[80:95], a[84:87], v[172:175], v[80:95]
  s_waitcnt lgkmcnt(8)
  ds_read_b64_tr_b16 a[76:77], v21 offset:32768
  ds_read_b64_tr_b16 a[78:79], v21 offset:33280
  v_accvgpr_read_b32 v22, a52
  v_accvgpr_read_b32 v23, a53
  v_accvgpr_read_b32 v26, a54
  v_accvgpr_read_b32 v27, a55
  v_mfma_f32_32x32x16_bf16 v[96:111], a[88:91], v[172:175], v[96:111]
  s_waitcnt lgkmcnt(8)
  ds_read_b64_tr_b16 a[80:81], v18 offset:36864
  ds_read_b64_tr_b16 a[82:83], v18 offset:37376
  v_mul_f32 v24, v22, v4
  v_mul_f32 v25, v23, v4
  v_mul_f32 v2, v26, v4
  v_mul_f32 v5, v27, v4
  v_mfma_f32_32x32x16_bf16 v[112:127], a[92:95], v[172:175], v[112:127]
  s_waitcnt lgkmcnt(8)
  ds_read_b64_tr_b16 a[84:85], v19 offset:36864
  ds_read_b64_tr_b16 a[86:87], v19 offset:37376
  v_exp_f32 v24, v24
  v_and_b32 v37, 0xffff, v37
  v_add_u32 v34, s62, v7
  v_mfma_f32_32x32x16_bf16 v[64:79], a[64:67], v[176:179], v[64:79]
  s_waitcnt lgkmcnt(8)
  ds_read_b64_tr_b16 a[88:89], v20 offset:36864
  ds_read_b64_tr_b16 a[90:91], v20 offset:37376
  v_exp_f32 v25, v25
  v_exp_f32 v2, v2
  v_mfma_f32_32x32x16_bf16 v[80:95], a[68:71], v[176:179], v[80:95]
  s_waitcnt lgkmcnt(8)
  ds_read_b64_tr_b16 a[92:93], v21 offset:36864
  ds_read_b64_tr_b16 a[94:95], v21 offset:37376
  v_exp_f32 v5, v5
  v_fma_f32 v24, v24, v6, v6
  v_fma_f32 v25, v25, v6, v6
  v_mfma_f32_32x32x16_bf16 v[96:111], a[72:75], v[176:179], v[96:111]
  s_waitcnt lgkmcnt(8)
  ds_read_b64_tr_b16 a[64:65], v18 offset:40960
  ds_read_b64_tr_b16 a[66:67], v18 offset:41472
  v_fma_f32 v2, v2, v6, v6
  v_fma_f32 v5, v5, v6, v6
  v_rcp_f32 v24, v24
  v_mfma_f32_32x32x16_bf16 v[112:127], a[76:79], v[176:179], v[112:127]
  s_waitcnt lgkmcnt(8)
  ds_read_b64_tr_b16 a[68:69], v19 offset:40960
  ds_read_b64_tr_b16 a[70:71], v19 offset:41472
  v_rcp_f32 v25, v25
  v_add_u32 v41, s80, v17
  v_add_u32 v38, 16384, v37
  v_mfma_f32_32x32x16_bf16 v[64:79], a[80:83], v[180:183], v[64:79]
  s_waitcnt lgkmcnt(8)
  ds_read_b64_tr_b16 a[72:73], v20 offset:40960
  ds_read_b64_tr_b16 a[74:75], v20 offset:41472
  v_rcp_f32 v2, v2
  v_accvgpr_read_b32 v11, a249
  v_mfma_f32_32x32x16_bf16 v[80:95], a[84:87], v[180:183], v[80:95]
  s_waitcnt lgkmcnt(8)
  ds_read_b64_tr_b16 a[76:77], v21 offset:40960
  ds_read_b64_tr_b16 a[78:79], v21 offset:41472
  v_rcp_f32 v5, v5
  v_mul_f32 v22, v22, v24
  v_mul_f32 v23, v23, v25
  v_mfma_f32_32x32x16_bf16 v[96:111], a[88:91], v[180:183], v[96:111]
  s_waitcnt lgkmcnt(8)
  ds_read_b64_tr_b16 a[80:81], v18 offset:45056
  ds_read_b64_tr_b16 a[82:83], v18 offset:45568
  v_mul_f32 v26, v26, v2
  v_mul_f32 v27, v27, v5
  v_accvgpr_read_b32 v24, a60
  v_accvgpr_read_b32 v25, a61
  v_mfma_f32_32x32x16_bf16 v[112:127], a[92:95], v[180:183], v[112:127]
  s_waitcnt lgkmcnt(8)
  ds_read_b64_tr_b16 a[84:85], v19 offset:45056
  ds_read_b64_tr_b16 a[86:87], v19 offset:45568
  v_accvgpr_read_b32 v2, a62
  v_accvgpr_read_b32 v5, a63
  v_and_b32 v38, 0xffff, v38
  v_add_u32 v35, s63, v7
  v_mfma_f32_32x32x16_bf16 v[64:79], a[64:67], v[184:187], v[64:79]
  s_waitcnt lgkmcnt(8)
  ds_read_b64_tr_b16 a[88:89], v20 offset:45056
  ds_read_b64_tr_b16 a[90:91], v20 offset:45568
  v_mul_f32 v22, v22, v24
  v_mul_f32 v23, v23, v25
  v_mul_f32 v26, v26, v2
  v_mul_f32 v27, v27, v5
  v_mfma_f32_32x32x16_bf16 v[80:95], a[68:71], v[184:187], v[80:95]
  s_waitcnt lgkmcnt(8)
  ds_read_b64_tr_b16 a[92:93], v21 offset:45056
  ds_read_b64_tr_b16 a[94:95], v21 offset:45568
  global_load_dword v12, v11, s[38:39] sc1
  v_cvt_pk_bf16_f32 v30, v22, v23
  v_add_u32 v24, s66, v7
  v_cvt_pk_bf16_f32 v31, v26, v27
  v_mfma_f32_32x32x16_bf16 v[96:111], a[72:75], v[184:187], v[96:111]
  s_waitcnt vmcnt(2) lgkmcnt(8)
  s_barrier
  ds_read_b64_tr_b16 a[64:65], v18 offset:49152
  ds_read_b64_tr_b16 a[66:67], v18 offset:49664
  global_store_dwordx4 v24, v[28:31], s[38:39] offset:3072 sc1
  v_accvgpr_read_b32 v22, a128
  v_mfma_f32_32x32x16_bf16 v[112:127], a[76:79], v[184:187], v[112:127]
  s_waitcnt lgkmcnt(8)
  ds_read_b64_tr_b16 a[68:69], v19 offset:49152
  ds_read_b64_tr_b16 a[70:71], v19 offset:49664
  v_accvgpr_read_b32 v23, a129
  v_accvgpr_read_b32 v26, a130
  v_add_u32 v42, s81, v17
  v_add_u32 v39, 32768, v37
  v_mfma_f32_32x32x16_bf16 v[64:79], a[80:83], v[188:191], v[64:79]
  s_waitcnt lgkmcnt(8)
  ds_read_b64_tr_b16 a[72:73], v20 offset:49152
  ds_read_b64_tr_b16 a[74:75], v20 offset:49664
  v_accvgpr_read_b32 v27, a131
  v_mul_f32 v24, v22, v4
  v_mul_f32 v25, v23, v4
  v_mul_f32 v2, v26, v4
  v_mfma_f32_32x32x16_bf16 v[80:95], a[84:87], v[188:191], v[80:95]
  s_waitcnt lgkmcnt(8)
  ds_read_b64_tr_b16 a[76:77], v21 offset:49152
  ds_read_b64_tr_b16 a[78:79], v21 offset:49664
  v_mul_f32 v5, v27, v4
  v_exp_f32 v24, v24
  v_mfma_f32_32x32x16_bf16 v[96:111], a[88:91], v[188:191], v[96:111]
  s_waitcnt lgkmcnt(8)
  ds_read_b64_tr_b16 a[80:81], v18 offset:53248
  ds_read_b64_tr_b16 a[82:83], v18 offset:53760
  s_lshr_b32 s59, s43, 2
  s_add_u32 s59, s59, 131072
  v_add_u32 v13, s59, v7
  v_mfma_f32_32x32x16_bf16 v[112:127], a[92:95], v[188:191], v[112:127]
  s_waitcnt lgkmcnt(8)
  ds_read_b64_tr_b16 a[84:85], v19 offset:53248
  ds_read_b64_tr_b16 a[86:87], v19 offset:53760
  v_exp_f32 v25, v25
  v_and_b32 v39, 0xffff, v39
  v_add_u32 v36, s64, v7
  v_mfma_f32_32x32x16_bf16 v[64:79], a[64:67], v[192:195], v[64:79]
  s_waitcnt lgkmcnt(8)
  ds_read_b64_tr_b16 a[88:89], v20 offset:53248
  ds_read_b64_tr_b16 a[90:91], v20 offset:53760
  ds_write_b128 v13, a[240:243] offset:0
  v_mfma_f32_32x32x16_bf16 v[80:95], a[68:71], v[192:195], v[80:95]
  s_waitcnt lgkmcnt(9)
  ds_read_b64_tr_b16 a[92:93], v21 offset:53248
  ds_read_b64_tr_b16 a[94:95], v21 offset:53760
  v_exp_f32 v2, v2
  v_exp_f32 v5, v5
  v_mfma_f32_32x32x16_bf16 v[96:111], a[72:75], v[192:195], v[96:111]
  s_waitcnt lgkmcnt(9)
  ds_read_b64_tr_b16 a[64:65], v18 offset:57344
  ds_read_b64_tr_b16 a[66:67], v18 offset:57856
  v_fma_f32 v24, v24, v6, v6
  v_fma_f32 v25, v25, v6, v6
  v_fma_f32 v2, v2, v6, v6
  v_fma_f32 v5, v5, v6, v6
  v_mfma_f32_32x32x16_bf16 v[112:127], a[76:79], v[192:195], v[112:127]
  s_waitcnt lgkmcnt(9)
  ds_read_b64_tr_b16 a[68:69], v19 offset:57344
  ds_read_b64_tr_b16 a[70:71], v19 offset:57856
  v_rcp_f32 v24, v24
  v_add_u32 v43, s82, v17
  v_add_u32 v40, 49152, v37
  v_mfma_f32_32x32x16_bf16 v[64:79], a[80:83], v[196:199], v[64:79]
  s_waitcnt lgkmcnt(9)
  ds_read_b64_tr_b16 a[72:73], v20 offset:57344
  ds_read_b64_tr_b16 a[74:75], v20 offset:57856
  ds_write_b128 v13, a[240:243] offset:4096
  v_mfma_f32_32x32x16_bf16 v[80:95], a[84:87], v[196:199], v[80:95]
  s_waitcnt lgkmcnt(10)
  ds_read_b64_tr_b16 a[76:77], v21 offset:57344
  ds_read_b64_tr_b16 a[78:79], v21 offset:57856
  v_add_u32 v18, 61440, v18
  v_add_u32 v19, 61440, v19
  v_add_u32 v20, 61440, v20
  v_add_u32 v21, 61440, v21
  v_mfma_f32_32x32x16_bf16 v[96:111], a[88:91], v[196:199], v[96:111]
  s_waitcnt lgkmcnt(9)
  ds_read_b64_tr_b16 a[80:81], v18 offset:0
  ds_read_b64_tr_b16 a[82:83], v18 offset:512
  v_rcp_f32 v25, v25
  v_rcp_f32 v2, v2
  v_mfma_f32_32x32x16_bf16 v[112:127], a[92:95], v[196:199], v[112:127]
  s_waitcnt lgkmcnt(9)
  ds_read_b64_tr_b16 a[84:85], v19 offset:0
  ds_read_b64_tr_b16 a[86:87], v19 offset:512
  v_rcp_f32 v5, v5
  v_mul_f32 v22, v22, v24
  v_and_b32 v40, 0xffff, v40
  v_mfma_f32_32x32x16_bf16 v[64:79], a[64:67], v[200:203], v[64:79]
  s_waitcnt lgkmcnt(9)
  ds_read_b64_tr_b16 a[88:89], v20 offset:0
  ds_read_b64_tr_b16 a[90:91], v20 offset:512
  v_mul_f32 v23, v23, v25
  v_mul_f32 v26, v26, v2
  v_mul_f32 v27, v27, v5
  v_accvgpr_read_b32 v24, a136
  v_mfma_f32_32x32x16_bf16 v[80:95], a[68:71], v[200:203], v[80:95]
  s_waitcnt lgkmcnt(9)
  ds_read_b64_tr_b16 a[92:93], v21 offset:0
  ds_read_b64_tr_b16 a[94:95], v21 offset:512
  v_accvgpr_read_b32 v25, a137
  v_accvgpr_read_b32 v2, a138
  s_add_u32 s80, s38, s68
  s_addc_u32 s81, s39, 0
  v_mfma_f32_32x32x16_bf16 v[96:111], a[72:75], v[200:203], v[96:111]
  s_waitcnt lgkmcnt(8)
  ds_read_b64_tr_b16 a[64:65], v18 offset:20480
  ds_read_b64_tr_b16 a[66:67], v18 offset:20992
  v_accvgpr_read_b32 v5, a139
  v_mul_f32 v22, v22, v24
  s_add_u32 s82, s38, s69
  s_addc_u32 s83, s39, 0
  v_mfma_f32_32x32x16_bf16 v[112:127], a[76:79], v[200:203], v[112:127]
  s_waitcnt lgkmcnt(8)
  ds_read_b64_tr_b16 a[68:69], v19 offset:20480
  ds_read_b64_tr_b16 a[70:71], v19 offset:20992
  v_mul_f32 v23, v23, v25
  v_mul_f32 v26, v26, v2
  v_mul_f32 v27, v27, v5
  v_cvt_pk_bf16_f32 v48, v22, v23
  v_mfma_f32_32x32x16_bf16 v[64:79], a[80:83], v[204:207], v[64:79]
  s_waitcnt lgkmcnt(8)
  ds_read_b64_tr_b16 a[72:73], v20 offset:20480
  ds_read_b64_tr_b16 a[74:75], v20 offset:20992
  v_cvt_pk_bf16_f32 v49, v26, v27
  v_accvgpr_read_b32 v22, a132
  v_accvgpr_read_b32 v23, a133
  v_accvgpr_read_b32 v26, a134
  v_mfma_f32_32x32x16_bf16 v[80:95], a[84:87], v[204:207], v[80:95]
  s_waitcnt lgkmcnt(8)
  ds_read_b64_tr_b16 a[76:77], v21 offset:20480
  ds_read_b64_tr_b16 a[78:79], v21 offset:20992
  v_accvgpr_read_b32 v27, a135
  v_mul_f32 v24, v22, v4
  v_mul_f32 v25, v23, v4
  v_mul_f32 v2, v26, v4
  v_mfma_f32_32x32x16_bf16 v[96:111], a[88:91], v[204:207], v[96:111]
  s_waitcnt lgkmcnt(8)
  ds_read_b64_tr_b16 a[80:81], v18 offset:24576
  ds_read_b64_tr_b16 a[82:83], v18 offset:25088
  v_mul_f32 v5, v27, v4
  s_add_u32 s12, s38, s72
  s_addc_u32 s13, s39, 0
  v_mfma_f32_32x32x16_bf16 v[112:127], a[92:95], v[204:207], v[112:127]
  s_waitcnt lgkmcnt(8)
  ds_read_b64_tr_b16 a[84:85], v19 offset:24576
  ds_read_b64_tr_b16 a[86:87], v19 offset:25088
  v_exp_f32 v24, v24
  s_add_u32 m0, s43, 0
  v_mfma_f32_32x32x16_bf16 v[64:79], a[64:67], v[208:211], v[64:79]
  s_waitcnt lgkmcnt(8)
  ds_read_b64_tr_b16 a[88:89], v20 offset:24576
  ds_read_b64_tr_b16 a[90:91], v20 offset:25088
  s_waitcnt vmcnt(1)
  v_cmp_ne_u32 vcc, s94, v12
  s_cbranch_vccnz mk_pqC_spin
mk_pqC_ok:
  v_mfma_f32_32x32x16_bf16 v[80:95], a[68:71], v[208:211], v[80:95]
  s_waitcnt lgkmcnt(8)
  ds_read_b64_tr_b16 a[92:93], v21 offset:24576
  ds_read_b64_tr_b16 a[94:95], v21 offset:25088
  global_load_lds_dwordx4 v37, s[80:81] offset:0 sc1
  v_exp_f32 v25, v25
  v_mfma_f32_32x32x16_bf16 v[96:111], a[72:75], v[208:211], v[96:111]
  s_waitcnt lgkmcnt(8)
  ds_read_b64_tr_b16 a[64:65], v18 offset:28672
  ds_read_b64_tr_b16 a[66:67], v18 offset:29184
  v_exp_f32 v2, v2
  s_add_u32 s14, s38, s74
  s_addc_u32 s15, s39, 0
  v_mfma_f32_32x32x16_bf16 v[112:127], a[76:79], v[208:211], v[112:127]
  s_waitcnt lgkmcnt(8)
  ds_read_b64_tr_b16 a[68:69], v19 offset:28672
  ds_read_b64_tr_b16 a[70:71], v19 offset:29184
  v_exp_f32 v5, v5
  v_fma_f32 v24, v24, v6, v6
  v_fma_f32 v25, v25, v6, v6
  v_mfma_f32_32x32x16_bf16 v[64:79], a[80:83], v[212:215], v[64:79]
  s_waitcnt lgkmcnt(8)
  ds_read_b64_tr_b16 a[72:73], v20 offset:28672
  ds_read_b64_tr_b16 a[74:75], v20 offset:29184
  global_load_lds_dwordx4 v37, s[80:81] offset:1024 sc1
  v_fma_f32 v2, v2, v6, v6
  v_fma_f32 v5, v5, v6, v6
  v_mfma_f32_32x32x16_bf16 v[80:95], a[84:87], v[212:215], v[80:95]
  s_waitcnt lgkmcnt(8)
  ds_read_b64_tr_b16 a[76:77], v21 offset:28672
  ds_read_b64_tr_b16 a[78:79], v21 offset:29184
  v_rcp_f32 v24, v24
  v_rcp_f32 v25, v25
  v_mfma_f32_32x32x16_bf16 v[96:111], a[88:91], v[212:215], v[96:111]
  s_waitcnt lgkmcnt(8)
  ds_read_b64_tr_b16 a[80:81], v18 offset:32768
  ds_read_b64_tr_b16 a[82:83], v18 offset:33280
  v_rcp_f32 v2, v2
  s_add_u32 s16, s38, s73
  s_addc_u32 s17, s39, 0
  v_mfma_f32_32x32x16_bf16 v[112:127], a[92:95], v[212:215], v[112:127]
  s_waitcnt lgkmcnt(8)
  ds_read_b64_tr_b16 a[84:85], v19 offset:32768
  ds_read_b64_tr_b16 a[86:87], v19 offset:33280
  global_load_lds_dwordx4 v37, s[80:81] offset:2048 sc1
  v_rcp_f32 v5, v5
  v_mul_f32 v22, v22, v24
  v_mfma_f32_32x32x16_bf16 v[64:79], a[64:67], v[216:219], v[64:79]
  s_waitcnt lgkmcnt(8)
  ds_read_b64_tr_b16 a[88:89], v20 offset:32768
  ds_read_b64_tr_b16 a[90:91], v20 offset:33280
  v_mul_f32 v23, v23, v25
  v_mul_f32 v26, v26, v2
  v_mul_f32 v27, v27, v5
  v_accvgpr_read_b32 v24, a140
  v_mfma_f32_32x32x16_bf16 v[80:95], a[68:71], v[216:219], v[80:95]
  s_waitcnt lgkmcnt(8)
  ds_read_b64_tr_b16 a[92:93], v21 offset:32768
  ds_read_b64_tr_b16 a[94:95], v21 offset:33280
  v_accvgpr_read_b32 v25, a141
  v_accvgpr_read_b32 v2, a142
  v_accvgpr_read_b32 v5, a143
  v_mul_f32 v22, v22, v24
  v_mfma_f32_32x32x16_bf16 v[96:111], a[72:75], v[216:219], v[96:111]
  s_waitcnt lgkmcnt(8)
  ds_read_b64_tr_b16 a[64:65], v18 offset:36864
  ds_read_b64_tr_b16 a[66:67], v18 offset:37376
  global_load_lds_dwordx4 v37, s[80:81] offset:3072 sc1
  v_mul_f32 v23, v23, v25
  s_add_u32 s18, s38, s75
  s_addc_u32 s19, s39, 0
  v_mfma_f32_32x32x16_bf16 v[112:127], a[76:79], v[216:219], v[112:127]
  s_waitcnt lgkmcnt(8)
  ds_read_b64_tr_b16 a[68:69], v19 offset:36864
  ds_read_b64_tr_b16 a[70:71], v19 offset:37376
  v_mul_f32 v26, v26, v2
  v_mul_f32 v27, v27, v5
  v_cvt_pk_bf16_f32 v50, v22, v23
  v_cvt_pk_bf16_f32 v51, v26, v27
  v_mfma_f32_32x32x16_bf16 v[64:79], a[80:83], v[220:223], v[64:79]
  s_waitcnt lgkmcnt(8)
  ds_read_b64_tr_b16 a[72:73], v20 offset:36864
  ds_read_b64_tr_b16 a[74:75], v20 offset:37376
  v_accvgpr_read_b32 v22, a144
  v_accvgpr_read_b32 v23, a145
  v_accvgpr_read_b32 v26, a146
  v_accvgpr_read_b32 v27, a147
  v_mfma_f32_32x32x16_bf16 v[80:95], a[84:87], v[220:223], v[80:95]
  s_waitcnt lgkmcnt(8)
  ds_read_b64_tr_b16 a[76:77], v21 offset:36864
  ds_read_b64_tr_b16 a[78:79], v21 offset:37376
  buffer_load_dwordx4 v[128:131], v7, s[24:27], s70 offen offset:0 sc1
  v_mul_f32 v24, v22, v4
  s_add_u32 m0, s43, 65536
  v_mfma_f32_32x32x16_bf16 v[96:111], a[88:91], v[220:223], v[96:111]
  s_waitcnt lgkmcnt(8)
  ds_read_b64_tr_b16 a[80:81], v18 offset:40960
  ds_read_b64_tr_b16 a[82:83], v18 offset:41472
  v_mul_f32 v25, v23, v4
  v_mul_f32 v2, v26, v4
  s_mul_i32 s56, s40, 20480
  s_add_u32 s56, s56, 32768
  v_mfma_f32_32x32x16_bf16 v[112:127], a[92:95], v[220:223], v[112:127]
  s_waitcnt lgkmcnt(8)
  ds_read_b64_tr_b16 a[84:85], v19 offset:40960
  ds_read_b64_tr_b16 a[86:87], v19 offset:41472
  v_mul_f32 v5, v27, v4
  v_exp_f32 v24, v24
  v_mfma_f32_32x32x16_bf16 v[64:79], a[64:67], v[224:227], v[64:79]
  s_waitcnt lgkmcnt(8)
  ds_read_b64_tr_b16 a[88:89], v20 offset:40960
  ds_read_b64_tr_b16 a[90:91], v20 offset:41472
  v_exp_f32 v25, v25
  v_exp_f32 v2, v2
  v_mfma_f32_32x32x16_bf16 v[80:95], a[68:71], v[224:227], v[80:95]
  s_waitcnt lgkmcnt(8)
  ds_read_b64_tr_b16 a[92:93], v21 offset:40960
  ds_read_b64_tr_b16 a[94:95], v21 offset:41472
  buffer_load_dwordx4 v[132:135], v7, s[24:27], s70 offen offset:1024 sc1
  v_exp_f32 v5, v5
  v_mfma_f32_32x32x16_bf16 v[96:111], a[72:75], v[224:227], v[96:111]
  s_waitcnt lgkmcnt(8)
  ds_read_b64_tr_b16 a[64:65], v18 offset:45056
  ds_read_b64_tr_b16 a[66:67], v18 offset:45568
  v_fma_f32 v24, v24, v6, v6
  v_fma_f32 v25, v25, v6, v6
  v_fma_f32 v2, v2, v6, v6
  v_fma_f32 v5, v5, v6, v6
  v_mfma_f32_32x32x16_bf16 v[112:127], a[76:79], v[224:227], v[112:127]
  s_waitcnt lgkmcnt(8)
  ds_read_b64_tr_b16 a[68:69], v19 offset:45056
  ds_read_b64_tr_b16 a[70:71], v19 offset:45568
  v_rcp_f32 v24, v24
  v_rcp_f32 v25, v25
  v_mfma_f32_32x32x16_bf16 v[64:79], a[80:83], v[228:231], v[64:79]
  s_waitcnt lgkmcnt(8)
  ds_read_b64_tr_b16 a[72:73], v20 offset:45056
  ds_read_b64_tr_b16 a[74:75], v20 offset:45568
  global_load_lds_dwordx4 v37, s[82:83] offset:0 sc1
  v_rcp_f32 v2, v2
  v_mfma_f32_32x32x16_bf16 v[80:95], a[84:87], v[228:231], v[80:95]
  s_waitcnt lgkmcnt(8)
  ds_read_b64_tr_b16 a[76:77], v21 offset:45056
  ds_read_b64_tr_b16 a[78:79], v21 offset:45568
  v_rcp_f32 v5, v5
  v_mul_f32 v22, v22, v24
  v_mul_f32 v23, v23, v25
  v_mfma_f32_32x32x16_bf16 v[96:111], a[88:91], v[228:231], v[96:111]
  s_waitcnt lgkmcnt(8)
  ds_read_b64_tr_b16 a[80:81], v18 offset:49152
  ds_read_b64_tr_b16 a[82:83], v18 offset:49664
  v_mul_f32 v26, v26, v2
  v_mul_f32 v27, v27, v5
  v_accvgpr_read_b32 v24, a152
  v_accvgpr_read_b32 v25, a153
  v_mfma_f32_32x32x16_bf16 v[112:127], a[92:95], v[228:231], v[112:127]
  s_waitcnt lgkmcnt(8)
  ds_read_b64_tr_b16 a[84:85], v19 offset:49152
  ds_read_b64_tr_b16 a[86:87], v19 offset:49664
  global_load_lds_dwordx4 v37, s[82:83] offset:1024 sc1
  v_accvgpr_read_b32 v2, a154
  v_accvgpr_read_b32 v5, a155
  v_mul_f32 v22, v22, v24
  v_mfma_f32_32x32x16_bf16 v[64:79], a[64:67], v[232:235], v[64:79]
  s_waitcnt lgkmcnt(8)
  ds_read_b64_tr_b16 a[88:89], v20 offset:49152
  ds_read_b64_tr_b16 a[90:91], v20 offset:49664
  v_mul_f32 v23, v23, v25
  v_mul_f32 v26, v26, v2
  v_mul_f32 v27, v27, v5
mk_wC4:
  s_cbranch_execz mk_wJ3
  v_cvt_pk_bf16_f32 v52, v22, v23
  v_mfma_f32_32x32x16_bf16 v[80:95], a[68:71], v[232:235], v[80:95]
  s_waitcnt lgkmcnt(8)
  ds_read_b64_tr_b16 a[92:93], v21 offset:49152
  ds_read_b64_tr_b16 a[94:95], v21 offset:49664
  v_cvt_pk_bf16_f32 v53, v26, v27
  v_accvgpr_read_b32 v22, a148
  v_accvgpr_read_b32 v23, a149
  v_accvgpr_read_b32 v26, a150
  v_mfma_f32_32x32x16_bf16 v[96:111], a[72:75], v[232:235], v[96:111]
  s_waitcnt lgkmcnt(8)
  ds_read_b64_tr_b16 a[64:65], v18 offset:53248
  ds_read_b64_tr_b16 a[66:67], v18 offset:53760
  global_load_lds_dwordx4 v37, s[82:83] offset:2048 sc1
  v_accvgpr_read_b32 v27, a151
  v_mul_f32 v24, v22, v4
  v_mul_f32 v25, v23, v4
  v_mfma_f32_32x32x16_bf16 v[112:127], a[76:79], v[232:235], v[112:127]
  s_waitcnt lgkmcnt(8)
  ds_read_b64_tr_b16 a[68:69], v19 offset:53248
  ds_read_b64_tr_b16 a[70:71], v19 offset:53760
  v_mul_f32 v2, v26, v4
  v_mul_f32 v5, v27, v4
  v_exp_f32 v24, v24
  v_mfma_f32_32x32x16_bf16 v[64:79], a[80:83], v[236:239], v[64:79]
  s_waitcnt lgkmcnt(8)
  ds_read_b64_tr_b16 a[72:73], v20 offset:53248
  ds_read_b64_tr_b16 a[74:75], v20 offset:53760
  v_exp_f32 v25, v25
  v_exp_f32 v2, v2
  v_mfma_f32_32x32x16_bf16 v[80:95], a[84:87], v[236:239], v[80:95]
  s_waitcnt lgkmcnt(8)
  ds_read_b64_tr_b16 a[76:77], v21 offset:53248
  ds_read_b64_tr_b16 a[78:79], v21 offset:53760
  global_load_lds_dwordx4 v37, s[82:83] offset:3072 sc1
  v_exp_f32 v5, v5
  v_fma_f32 v24, v24, v6, v6
  v_mfma_f32_32x32x16_bf16 v[96:111], a[88:91], v[236:239], v[96:111]
  s_waitcnt lgkmcnt(8)
  ds_read_b64_tr_b16 a[80:81], v18 offset:57344
  ds_read_b64_tr_b16 a[82:83], v18 offset:57856
  v_fma_f32 v25, v25, v6, v6
  v_fma_f32 v2, v2, v6, v6
  v_fma_f32 v5, v5, v6, v6
  v_mfma_f32_32x32x16_bf16 v[112:127], a[92:95], v[236:239], v[112:127]
  s_waitcnt lgkmcnt(8)
  ds_read_b64_tr_b16 a[84:85], v19 offset:57344
  ds_read_b64_tr_b16 a[86:87], v19 offset:57856
  v_rcp_f32 v24, v24
  v_rcp_f32 v25, v25
  v_mfma_f32_32x32x16_bf16 v[64:79], a[64:67], v[240:243], v[64:79]
  s_waitcnt lgkmcnt(8)
  ds_read_b64_tr_b16 a[88:89], v20 offset:57344
  ds_read_b64_tr_b16 a[90:91], v20 offset:57856
  v_rcp_f32 v2, v2
  v_rcp_f32 v5, v5
  v_mfma_f32_32x32x16_bf16 v[80:95], a[68:71], v[240:243], v[80:95]
  s_waitcnt lgkmcnt(8)
  ds_read_b64_tr_b16 a[92:93], v21 offset:57344
  ds_read_b64_tr_b16 a[94:95], v21 offset:57856
  v_add_u32 v18, 61440, v18
  v_add_u32 v19, 61440, v19
  v_add_u32 v20, 61440, v20
  v_add_u32 v21, 61440, v21
  v_mfma_f32_32x32x16_bf16 v[96:111], a[72:75], v[240:243], v[96:111]
  s_waitcnt lgkmcnt(8)
  ds_read_b64_tr_b16 a[64:65], v18 offset:0
  ds_read_b64_tr_b16 a[66:67], v18 offset:512
  v_mul_f32 v22, v22, v24
  v_mul_f32 v23, v23, v25
  v_mul_f32 v26, v26, v2
  v_mul_f32 v27, v27, v5
  v_mfma_f32_32x32x16_bf16 v[112:127], a[76:79], v[240:243], v[112:127]
  s_waitcnt lgkmcnt(8)
  ds_read_b64_tr_b16 a[68:69], v19 offset:0
  ds_read_b64_tr_b16 a[70:71], v19 offset:512
  v_accvgpr_read_b32 v24, a156
  v_accvgpr_read_b32 v25, a157
  v_accvgpr_read_b32 v2, a158
  v_accvgpr_read_b32 v5, a159
  v_mfma_f32_32x32x16_bf16 v[64:79], a[80:83], v[244:247], v[64:79]
  s_waitcnt lgkmcnt(8)
  ds_read_b64_tr_b16 a[72:73], v20 offset:0
  ds_read_b64_tr_b16 a[74:75], v20 offset:512
  v_mul_f32 v22, v22, v24
  v_mul_f32 v23, v23, v25
  v_mul_f32 v26, v26, v2
  v_mul_f32 v27, v27, v5
  v_mfma_f32_32x32x16_bf16 v[80:95], a[84:87], v[244:247], v[80:95]
  s_waitcnt lgkmcnt(8)
  ds_read_b64_tr_b16 a[76:77], v21 offset:0
  ds_read_b64_tr_b16 a[78:79], v21 offset:512
  v_cvt_pk_bf16_f32 v54, v22, v23
  v_cvt_pk_bf16_f32 v55, v26, v27
  v_add_u32 v3, s61, v7
  v_mfma_f32_32x32x16_bf16 v[96:111], a[88:91], v[244:247], v[96:111]
  s_waitcnt lgkmcnt(8)
  ds_read_b64_tr_b16 a[80:81], v18 offset:4096
  ds_read_b64_tr_b16 a[82:83], v18 offset:4608
  v_mfma_f32_32x32x16_bf16 v[112:127], a[92:95], v[244:247], v[112:127]
  s_waitcnt lgkmcnt(8)
  ds_read_b64_tr_b16 a[84:85], v19 offset:4096
  ds_read_b64_tr_b16 a[86:87], v19 offset:4608
  v_mfma_f32_32x32x16_bf16 v[64:79], a[64:67], v[248:251], v[64:79]
  s_waitcnt lgkmcnt(8)
  ds_read_b64_tr_b16 a[88:89], v20 offset:4096
  ds_read_b64_tr_b16 a[90:91], v20 offset:4608
  v_mfma_f32_32x32x16_bf16 v[80:95], a[68:71], v[248:251], v[80:95]
  s_waitcnt lgkmcnt(8)
  ds_read_b64_tr_b16 a[92:93], v21 offset:4096
  ds_read_b64_tr_b16 a[94:95], v21 offset:4608
  v_mfma_f32_32x32x16_bf16 v[96:111], a[72:75], v[248:251], v[96:111]
  s_waitcnt lgkmcnt(8)
  v_mfma_f32_32x32x16_bf16 v[112:127], a[76:79], v[248:251], v[112:127]
  s_waitcnt lgkmcnt(6)
  v_mfma_f32_32x32x16_bf16 v[64:79], a[80:83], v[252:255], v[64:79]
  s_waitcnt lgkmcnt(4)
  v_mfma_f32_32x32x16_bf16 v[80:95], a[84:87], v[252:255], v[80:95]
  s_waitcnt lgkmcnt(2)
  v_mfma_f32_32x32x16_bf16 v[96:111], a[88:91], v[252:255], v[96:111]
  s_waitcnt lgkmcnt(0)
  v_mfma_f32_32x32x16_bf16 v[112:127], a[92:95], v[252:255], v[112:127]
  s_waitcnt lgkmcnt(0)
  s_branch mk_join
mk_last:
.section .rodata,"a"
.p2align 6
.amdhsa_kernel parallel_sum__mha_block__glu_gated_swiglu__prompt_kernel
  .amdhsa_next_free_vgpr 512
  .amdhsa_next_free_sgpr 102
  .amdhsa_accum_offset 256
  .amdhsa_group_segment_fixed_size 0
  .amdhsa_kernarg_size 80
  .amdhsa_user_sgpr_count 2
  .amdhsa_user_sgpr_kernarg_segment_ptr 1
  .amdhsa_system_sgpr_workgroup_id_x 1
.end_amdhsa_kernel
```
